```python
import torch

def _softmax(x, axis=-1):
    return torch.softmax(x, dim=axis)
def _gelu(x):
    return torch.nn.functional.gelu(x, approximate="tanh")
def _silu(x):
    return torch.nn.functional.silu(x)
def _sigmoid(x):
    return torch.sigmoid(x)
def _layernorm(x, axis=-1, eps=1e-5):
    m = x.mean(dim=axis, keepdim=True)
    v = x.var(dim=axis, keepdim=True, unbiased=False)
    return (x - m) / torch.sqrt(v + eps)
def _scatter_add(tgt, idx, src, axis=0):
    return tgt.clone().index_add_(axis, idx, src)
def _segment_sum(src, seg, n):
    out = torch.zeros((n,) + src.shape[1:], dtype=src.dtype)
    return out.index_add_(0, seg, src)
def _pad(x, pw):
    flat = tuple(v for pair in reversed(pw) for v in pair)
    return torch.nn.functional.pad(x, flat)

kernel_name = 'standalone__cross_network_dcn__recsys'

def setup_inputs():

    _w = (lambda a: (lambda t: t.to(torch.bfloat16) if t.is_floating_point() else t)(torch.as_tensor(a)))
    B, F, D, L = 16384, 26, 32, 3
    Din = min(F * D, 1024)
    return {
        "x0": _w((lambda *s: torch.randn(*s, dtype=torch.bfloat16) * 0.05)(B, Din)),
        "ws": _w((lambda *s: torch.randn(*s, dtype=torch.bfloat16) * 0.4)(L, Din, Din) * (Din ** -0.5)),
        "bs": _w((lambda *s: torch.randn(*s, dtype=torch.bfloat16) * 3.2)(L, Din) * 0.01),
    }

def reference(x0, ws, bs):
    x = x0
    L = ws.shape[0]
    for l in range(L):
        proj = torch.einsum('bd,de->be', x, ws[l]) + bs[l]
        x = x0 * proj + x
    return x
```

```asm
; @launch kernel=dcn_prep_kernel grid=(312,1,1) block=(832,1,1) lds=0
; @launch kernel=standalone__cross_network_dcn__recsys_kernel grid=(256,1,1) block=(256,1,1) lds=163840
.amdgcn_target "amdgcn-amd-amdhsa--gfx950"
.text
.globl dcn_prep_kernel
.p2align 8
.type dcn_prep_kernel,@function
dcn_prep_kernel:
    s_cmp_ge_u32 s2, 312
    s_cbranch_scc1 L_prep_done
    s_load_dwordx2 s[4:5], s[0:1], 8
    s_load_dwordx2 s[6:7], s[0:1], 40
    s_load_dwordx2 s[8:9], s[0:1], 16
    s_mov_b32 s10, 41297763
    s_mul_hi_u32 s11, s2, s10
    s_mul_i32 s12, s11, 104
    s_sub_u32 s12, s2, s12
    s_lshr_b32 s13, s12, 2
    s_and_b32 s14, s12, 3
    v_lshlrev_b32 v56, 1, v0
    v_add_u32 v57, 4992, v56
    v_add_u32 v58, 9984, v56
    s_mul_i32 s36, s11, 832
    s_lshl_b32 s37, s13, 5
    s_add_u32 s36, s36, s37
    s_lshl_b32 s37, s14, 3
    s_add_u32 s36, s36, s37
    s_mul_i32 s36, s36, 1664
    s_mul_i32 s38, s11, 1664
    s_waitcnt lgkmcnt(0)
    s_mov_b32 s24, s4
    s_mov_b32 s25, s5
    s_mov_b32 s26, 4153344
    s_mov_b32 s27, 0x00020000
    s_mov_b32 s32, s8
    s_mov_b32 s33, s9
    s_mov_b32 s34, 4992
    s_mov_b32 s35, 0x00020000
    buffer_load_ushort v20, v56, s[24:27], s36 offen offset:0
    buffer_load_ushort v21, v56, s[24:27], s36 offen offset:1664
    buffer_load_ushort v22, v56, s[24:27], s36 offen offset:3328
    buffer_load_ushort v23, v57, s[24:27], s36 offen offset:0
    buffer_load_ushort v24, v57, s[24:27], s36 offen offset:1664
    buffer_load_ushort v25, v57, s[24:27], s36 offen offset:3328
    buffer_load_ushort v26, v58, s[24:27], s36 offen offset:0
    buffer_load_ushort v27, v58, s[24:27], s36 offen offset:1664
    buffer_load_ushort v68, v56, s[32:35], s38 offen
    s_mul_i32 s16, s13, 43
    s_lshr_b32 s16, s16, 8
    s_mul_i32 s17, s16, 6
    s_sub_u32 s17, s13, s17
    s_mul_i32 s18, s16, 3
    s_add_u32 s18, s18, s17
    s_add_u32 s19, s18, 11
    s_cmp_ge_u32 s17, 3
    s_cselect_b32 s18, s19, s18
    s_sub_u32 s19, s13, 12
    s_cmp_ge_u32 s13, 24
    s_cselect_b32 s18, s19, s18
    s_mul_i32 s20, s18, 7
    s_mul_i32 s21, s18, 6
    s_add_u32 s21, s21, 182
    s_mul_i32 s22, s11, 338
    s_add_u32 s20, s20, s22
    s_add_u32 s21, s21, s22
    s_lshl_b32 s23, s14, 4
    s_mov_b32 s28, s6
    s_mov_b32 s29, s7
    s_mov_b32 s30, 4163328
    s_mov_b32 s31, 0x00020000
    s_mul_i32 s39, s11, 832
    s_add_u32 s39, s39, 4153344
    v_lshrrev_b32 v11, 5, v0
    v_bfe_u32 v12, v0, 3, 2
    v_bfe_u32 v13, v0, 2, 1
    v_and_b32 v14, 3, v0
    v_mul_u32_u24 v15, 43, v11
    v_lshrrev_b32 v15, 8, v15
    v_mul_u32_u24 v16, 6, v15
    v_sub_u32 v16, v11, v16
    v_lshl_add_u32 v17, v16, 1, v13
    v_add_u32 v18, 1, v17
    v_add_u32 v18, s20, v18
    v_subrev_u32 v19, 6, v17
    v_add_u32 v19, s21, v19
    v_cmp_le_u32 vcc, 3, v16
    s_nop 1
    v_cndmask_b32 v18, v18, v19, vcc
    v_subrev_u32 v19, 24, v11
    v_lshl_add_u32 v19, v19, 1, v13
    v_cmp_le_u32 vcc, 24, v11
    s_nop 1
    v_cndmask_b32 v15, v15, v19, vcc
    v_mov_b32 v19, s20
    v_cndmask_b32 v18, v18, v19, vcc
    v_mov_b32 v19, 12
    v_cndmask_b32 v17, v17, v19, vcc
    v_mul_u32_u24 v19, 1014, v15
    v_add_u32 v19, v19, v18
    v_lshlrev_b32 v19, 10, v19
    v_lshl_add_u32 v60, v12, 2, v14
    v_add_u32 v60, s23, v60
    v_lshl_add_u32 v60, v60, 4, v19
    v_mul_u32_u24 v64, 2496, v15
    v_lshl_add_u32 v64, v17, 6, v64
    v_lshl_add_u32 v64, v12, 4, v64
    v_lshl_add_u32 v64, v14, 2, v64
    s_waitcnt vmcnt(0)
    v_lshl_or_b32 v20, v21, 16, v20
    v_lshl_or_b32 v21, v23, 16, v22
    v_lshl_or_b32 v22, v25, 16, v24
    v_lshl_or_b32 v23, v27, 16, v26
    buffer_store_dwordx4 v[20:23], v60, s[28:31], 0 offen
    s_cmp_lg_u32 s12, 0
    s_cbranch_scc1 L_prep_done
    v_lshlrev_b32 v68, 16, v68
    buffer_store_dword v68, v64, s[28:31], s39 offen
L_prep_done:
    s_endpgm
.globl standalone__cross_network_dcn__recsys_kernel
.p2align 8
.type standalone__cross_network_dcn__recsys_kernel,@function
standalone__cross_network_dcn__recsys_kernel:
    s_cmp_ge_u32 s2, 256
    s_cbranch_scc1 L_done
    s_load_dwordx2 s[4:5], s[0:1], 0
    s_load_dwordx2 s[6:7], s[0:1], 24
    s_load_dwordx2 s[8:9], s[0:1], 40
    v_and_b32 v1, 63, v0
    v_lshrrev_b32 v16, 6, v0
    s_nop 1
    v_readfirstlane_b32 s32, v16
    v_lshlrev_b32 v2, 4, v1
    v_mov_b32 v23, v1
    v_lshrrev_b32 v17, 4, v1
    v_and_b32 v18, 15, v1
    v_add_u32 v3, 106496, v2
    v_add_u32 v4, 57344, v2
    s_lshl_b32 s33, s32, 10
    s_mul_i32 s44, s32, 12288
    v_add_u32 v5, s44, v2
    v_add_u32 v6, 106496, v5
    v_add_u32 v9, 57344, v5
    s_lshr_b32 s45, s32, 1
    s_and_b32 s46, s32, 1
    s_add_u32 s47, s45, 12
    s_lshl_b32 s47, s47, 12
    s_lshl_b32 s48, s46, 3
    s_add_u32 s47, s47, s48
    v_add_u32 v7, s47, v2
    v_add_u32 v8, 106496, v7
    s_mul_i32 s37, s2, 106496
    v_mul_u32_u24 v19, 0x680, v18
    v_lshl_add_u32 v19, v17, 4, v19
    v_add_u32 v19, s37, v19
    s_mul_i32 s44, s32, 384
    v_add_u32 v10, s44, v19
    s_add_u32 s47, s45, 24
    s_lshl_b32 s47, s47, 6
    s_add_u32 s47, s47, s48
    v_add_u32 v11, s47, v19
    v_lshlrev_b32 v12, 4, v17
    s_mul_i32 s43, s32, 26624
    s_add_u32 s39, s37, s43
    v_mul_u32_u24 v20, 0x680, v18
    v_lshrrev_b32 v21, 1, v18
    v_add_u32 v22, 0, v17
    v_xor_b32 v22, v22, v21
    v_lshl_add_u32 v0, v22, 4, v20
    v_add_u32 v1, 53248, v0
    v_add_u32 v22, 4, v17
    v_xor_b32 v22, v22, v21
    v_lshl_add_u32 v46, v22, 4, v20
    v_add_u32 v47, 53248, v46
    v_xor_b32 v24, 0, v23
    v_lshlrev_b32 v24, 4, v24
    v_xor_b32 v25, 1, v23
    v_lshlrev_b32 v25, 4, v25
    v_xor_b32 v26, 2, v23
    v_lshlrev_b32 v26, 4, v26
    v_xor_b32 v27, 3, v23
    v_lshlrev_b32 v27, 4, v27
    v_xor_b32 v28, 4, v23
    v_lshlrev_b32 v28, 4, v28
    v_xor_b32 v29, 5, v23
    v_lshlrev_b32 v29, 4, v29
    v_xor_b32 v30, 6, v23
    v_lshlrev_b32 v30, 4, v30
    v_xor_b32 v31, 7, v23
    v_lshlrev_b32 v31, 4, v31
    v_cmp_gt_u32 vcc, 16, v23
    s_nop 1
    v_cndmask_b32 v32, v25, v24, vcc
    v_cmp_gt_u32 vcc, 32, v23
    s_nop 1
    v_cndmask_b32 v33, v26, v25, vcc
    v_cmp_gt_u32 vcc, 48, v23
    s_nop 1
    v_cndmask_b32 v34, v27, v26, vcc
    v_cmp_gt_u32 vcc, 0, v23
    s_nop 1
    v_cndmask_b32 v35, v28, v27, vcc
    v_cmp_gt_u32 vcc, 16, v23
    s_nop 1
    v_cndmask_b32 v36, v29, v28, vcc
    v_cmp_gt_u32 vcc, 32, v23
    s_nop 1
    v_cndmask_b32 v37, v30, v29, vcc
    v_cmp_gt_u32 vcc, 48, v23
    s_nop 1
    v_cndmask_b32 v38, v31, v30, vcc
    s_mov_b32 s40, 26624
    s_mov_b32 s41, 53248
    s_mov_b32 s42, 79872
    s_waitcnt lgkmcnt(0)
    s_mov_b32 s16, s4
    s_mov_b32 s17, s5
    s_mov_b32 s18, 27262976
    s_mov_b32 s19, 0x00020000
    s_mov_b32 s28, s6
    s_mov_b32 s29, s7
    s_mov_b32 s30, 27262976
    s_mov_b32 s31, 0x00020000
    s_mul_i32 s44, s32, 1038336
    s_add_u32 s20, s8, s44
    s_addc_u32 s21, s9, 0
    s_mov_b32 s22, 1038336
    s_mov_b32 s23, 0x00020000
    s_mul_i32 s44, s32, 2496
    s_add_u32 s44, s44, 4153344
    s_add_u32 s24, s8, s44
    s_addc_u32 s25, s9, 0
    s_mov_b32 s26, 2496
    s_mov_b32 s27, 0x00020000
    s_add_u32 m0, s43, 0
    s_add_u32 s35, s39, 0
    buffer_load_dwordx4 v24, s[16:19], s35 offen lds
    s_add_u32 m0, s43, 1024
    s_add_u32 s35, s39, 1024
    buffer_load_dwordx4 v24, s[16:19], s35 offen lds
    s_add_u32 m0, s43, 2048
    s_add_u32 s35, s39, 2048
    buffer_load_dwordx4 v24, s[16:19], s35 offen lds
    s_add_u32 m0, s43, 3072
    s_add_u32 s35, s39, 3072
    buffer_load_dwordx4 v32, s[16:19], s35 offen lds
    s_add_u32 m0, s43, 4096
    s_add_u32 s35, s39, 4096
    buffer_load_dwordx4 v25, s[16:19], s35 offen lds
    s_add_u32 m0, s43, 5120
    s_add_u32 s35, s39, 5120
    buffer_load_dwordx4 v25, s[16:19], s35 offen lds
    s_add_u32 m0, s43, 6144
    s_add_u32 s35, s39, 6144
    buffer_load_dwordx4 v33, s[16:19], s35 offen lds
    s_add_u32 m0, s43, 7168
    s_add_u32 s35, s39, 7168
    buffer_load_dwordx4 v26, s[16:19], s35 offen lds
    s_add_u32 m0, s43, 8192
    s_add_u32 s35, s39, 8192
    buffer_load_dwordx4 v26, s[16:19], s35 offen lds
    s_add_u32 m0, s43, 9216
    s_add_u32 s35, s39, 9216
    buffer_load_dwordx4 v34, s[16:19], s35 offen lds
    s_add_u32 m0, s43, 10240
    s_add_u32 s35, s39, 10240
    buffer_load_dwordx4 v27, s[16:19], s35 offen lds
    s_add_u32 m0, s43, 11264
    s_add_u32 s35, s39, 11264
    buffer_load_dwordx4 v27, s[16:19], s35 offen lds
    s_add_u32 m0, s43, 12288
    s_add_u32 s35, s39, 12288
    buffer_load_dwordx4 v27, s[16:19], s35 offen lds
    s_add_u32 m0, s43, 13312
    s_add_u32 s35, s39, 13312
    buffer_load_dwordx4 v28, s[16:19], s35 offen lds
    s_add_u32 m0, s43, 14336
    s_add_u32 s35, s39, 14336
    buffer_load_dwordx4 v28, s[16:19], s35 offen lds
    s_add_u32 m0, s43, 15360
    s_add_u32 s35, s39, 15360
    buffer_load_dwordx4 v28, s[16:19], s35 offen lds
    s_add_u32 m0, s43, 16384
    s_add_u32 s35, s39, 16384
    buffer_load_dwordx4 v36, s[16:19], s35 offen lds
    s_add_u32 m0, s43, 17408
    s_add_u32 s35, s39, 17408
    buffer_load_dwordx4 v29, s[16:19], s35 offen lds
    s_add_u32 m0, s43, 18432
    s_add_u32 s35, s39, 18432
    buffer_load_dwordx4 v29, s[16:19], s35 offen lds
    s_add_u32 m0, s43, 19456
    s_add_u32 s35, s39, 19456
    buffer_load_dwordx4 v37, s[16:19], s35 offen lds
    s_add_u32 m0, s43, 20480
    s_add_u32 s35, s39, 20480
    buffer_load_dwordx4 v30, s[16:19], s35 offen lds
    s_add_u32 m0, s43, 21504
    s_add_u32 s35, s39, 21504
    buffer_load_dwordx4 v30, s[16:19], s35 offen lds
    s_add_u32 m0, s43, 22528
    s_add_u32 s35, s39, 22528
    buffer_load_dwordx4 v38, s[16:19], s35 offen lds
    s_add_u32 m0, s43, 23552
    s_add_u32 s35, s39, 23552
    buffer_load_dwordx4 v31, s[16:19], s35 offen lds
    s_add_u32 m0, s43, 24576
    s_add_u32 s35, s39, 24576
    buffer_load_dwordx4 v31, s[16:19], s35 offen lds
    s_add_u32 m0, s43, 25600
    s_add_u32 s35, s39, 25600
    buffer_load_dwordx4 v31, s[16:19], s35 offen lds
    buffer_load_dwordx4 v[240:243], v12, s[24:27], 0 offen offset:768
    buffer_load_dwordx4 v[48:51], v12, s[24:27], 0 offen offset:0
    buffer_load_dwordx4 v[64:67], v12, s[24:27], 0 offen offset:64
    buffer_load_dwordx4 v[80:83], v12, s[24:27], 0 offen offset:128
    buffer_load_dwordx4 v[96:99], v12, s[24:27], 0 offen offset:192
    buffer_load_dwordx4 v[112:115], v12, s[24:27], 0 offen offset:256
    buffer_load_dwordx4 v[128:131], v12, s[24:27], 0 offen offset:320
    s_mov_b32 s34, 0
    buffer_load_dwordx4 a[0:3], v2, s[20:23], s34 offen offset:0
    buffer_load_dwordx4 a[4:7], v2, s[20:23], s34 offen offset:1024
    buffer_load_dwordx4 a[8:11], v2, s[20:23], s34 offen offset:2048
    buffer_load_dwordx4 a[12:15], v2, s[20:23], s34 offen offset:3072
    s_mov_b32 s34, 4096
    buffer_load_dwordx4 a[16:19], v2, s[20:23], s34 offen offset:0
    buffer_load_dwordx4 a[20:23], v2, s[20:23], s34 offen offset:1024
    buffer_load_dwordx4 a[24:27], v2, s[20:23], s34 offen offset:2048
    buffer_load_dwordx4 a[28:31], v2, s[20:23], s34 offen offset:3072
    s_mov_b32 s34, 8192
    buffer_load_dwordx4 a[32:35], v2, s[20:23], s34 offen offset:0
    buffer_load_dwordx4 a[36:39], v2, s[20:23], s34 offen offset:1024
    buffer_load_dwordx4 a[40:43], v2, s[20:23], s34 offen offset:2048
    buffer_load_dwordx4 a[44:47], v2, s[20:23], s34 offen offset:3072
    s_mov_b32 s34, 12288
    buffer_load_dwordx4 a[48:51], v2, s[20:23], s34 offen offset:0
    buffer_load_dwordx4 a[52:55], v2, s[20:23], s34 offen offset:1024
    s_waitcnt vmcnt(20)
    v_add_f32 v252, 1.0, v240
    v_add_f32 v253, 1.0, v241
    v_add_f32 v254, 1.0, v242
    v_add_f32 v255, 1.0, v243
    v_add_f32 v248, 1.0, v240
    v_add_f32 v249, 1.0, v241
    v_add_f32 v250, 1.0, v242
    v_add_f32 v251, 1.0, v243
    v_add_f32 v244, 1.0, v240
    v_add_f32 v245, 1.0, v241
    v_add_f32 v246, 1.0, v242
    v_add_f32 v247, 1.0, v243
    v_add_f32 v240, 1.0, v240
    v_add_f32 v241, 1.0, v241
    v_add_f32 v242, 1.0, v242
    v_add_f32 v243, 1.0, v243
    s_waitcnt vmcnt(19)
    v_add_f32 v60, 1.0, v48
    v_add_f32 v61, 1.0, v49
    v_add_f32 v62, 1.0, v50
    v_add_f32 v63, 1.0, v51
    v_add_f32 v56, 1.0, v48
    v_add_f32 v57, 1.0, v49
    v_add_f32 v58, 1.0, v50
    v_add_f32 v59, 1.0, v51
    v_add_f32 v52, 1.0, v48
    v_add_f32 v53, 1.0, v49
    v_add_f32 v54, 1.0, v50
    v_add_f32 v55, 1.0, v51
    v_add_f32 v48, 1.0, v48
    v_add_f32 v49, 1.0, v49
    v_add_f32 v50, 1.0, v50
    v_add_f32 v51, 1.0, v51
    s_waitcnt vmcnt(18)
    v_add_f32 v76, 1.0, v64
    v_add_f32 v77, 1.0, v65
    v_add_f32 v78, 1.0, v66
    v_add_f32 v79, 1.0, v67
    v_add_f32 v72, 1.0, v64
    v_add_f32 v73, 1.0, v65
    v_add_f32 v74, 1.0, v66
    v_add_f32 v75, 1.0, v67
    v_add_f32 v68, 1.0, v64
    v_add_f32 v69, 1.0, v65
    v_add_f32 v70, 1.0, v66
    v_add_f32 v71, 1.0, v67
    v_add_f32 v64, 1.0, v64
    v_add_f32 v65, 1.0, v65
    v_add_f32 v66, 1.0, v66
    v_add_f32 v67, 1.0, v67
    s_waitcnt vmcnt(17)
    v_add_f32 v92, 1.0, v80
    v_add_f32 v93, 1.0, v81
    v_add_f32 v94, 1.0, v82
    v_add_f32 v95, 1.0, v83
    v_add_f32 v88, 1.0, v80
    v_add_f32 v89, 1.0, v81
    v_add_f32 v90, 1.0, v82
    v_add_f32 v91, 1.0, v83
    v_add_f32 v84, 1.0, v80
    v_add_f32 v85, 1.0, v81
    v_add_f32 v86, 1.0, v82
    v_add_f32 v87, 1.0, v83
    v_add_f32 v80, 1.0, v80
    v_add_f32 v81, 1.0, v81
    v_add_f32 v82, 1.0, v82
    v_add_f32 v83, 1.0, v83
    s_waitcnt vmcnt(16)
    v_add_f32 v108, 1.0, v96
    v_add_f32 v109, 1.0, v97
    v_add_f32 v110, 1.0, v98
    v_add_f32 v111, 1.0, v99
    v_add_f32 v104, 1.0, v96
    v_add_f32 v105, 1.0, v97
    v_add_f32 v106, 1.0, v98
    v_add_f32 v107, 1.0, v99
    v_add_f32 v100, 1.0, v96
    v_add_f32 v101, 1.0, v97
    v_add_f32 v102, 1.0, v98
    v_add_f32 v103, 1.0, v99
    v_add_f32 v96, 1.0, v96
    v_add_f32 v97, 1.0, v97
    v_add_f32 v98, 1.0, v98
    v_add_f32 v99, 1.0, v99
    s_waitcnt vmcnt(15)
    v_add_f32 v124, 1.0, v112
    v_add_f32 v125, 1.0, v113
    v_add_f32 v126, 1.0, v114
    v_add_f32 v127, 1.0, v115
    v_add_f32 v120, 1.0, v112
    v_add_f32 v121, 1.0, v113
    v_add_f32 v122, 1.0, v114
    v_add_f32 v123, 1.0, v115
    v_add_f32 v116, 1.0, v112
    v_add_f32 v117, 1.0, v113
    v_add_f32 v118, 1.0, v114
    v_add_f32 v119, 1.0, v115
    v_add_f32 v112, 1.0, v112
    v_add_f32 v113, 1.0, v113
    v_add_f32 v114, 1.0, v114
    v_add_f32 v115, 1.0, v115
    s_waitcnt vmcnt(14)
    v_add_f32 v140, 1.0, v128
    v_add_f32 v141, 1.0, v129
    v_add_f32 v142, 1.0, v130
    v_add_f32 v143, 1.0, v131
    v_add_f32 v136, 1.0, v128
    v_add_f32 v137, 1.0, v129
    v_add_f32 v138, 1.0, v130
    v_add_f32 v139, 1.0, v131
    v_add_f32 v132, 1.0, v128
    v_add_f32 v133, 1.0, v129
    v_add_f32 v134, 1.0, v130
    v_add_f32 v135, 1.0, v131
    v_add_f32 v128, 1.0, v128
    v_add_f32 v129, 1.0, v129
    v_add_f32 v130, 1.0, v130
    v_add_f32 v131, 1.0, v131
    s_barrier
    ds_read_b128 a[112:115], v0 offset:0
    ds_read_b128 a[116:119], v0 offset:26624
    ds_read_b128 a[120:123], v1 offset:0
    ds_read_b128 a[124:127], v1 offset:26624
    s_waitcnt vmcnt(13) lgkmcnt(0)
    v_mfma_f32_16x16x32_bf16 v[240:243], a[0:3], a[112:115], v[240:243]
    buffer_load_dwordx4 a[56:59], v2, s[20:23], s34 offen offset:2048
    v_mfma_f32_16x16x32_bf16 v[244:247], a[0:3], a[116:119], v[244:247]
    ds_read_b128 a[128:131], v46 offset:0
    ds_read_b128 a[132:135], v46 offset:26624
    v_mfma_f32_16x16x32_bf16 v[248:251], a[0:3], a[120:123], v[248:251]
    ds_read_b128 a[136:139], v47 offset:0
    ds_read_b128 a[140:143], v47 offset:26624
    v_mfma_f32_16x16x32_bf16 v[252:255], a[0:3], a[124:127], v[252:255]
    buffer_load_dwordx4 a[60:63], v2, s[20:23], s34 offen offset:3072
    s_waitcnt vmcnt(14)
    v_mfma_f32_16x16x32_bf16 v[48:51], a[4:7], a[112:115], v[48:51]
    s_mov_b32 s34, 16384
    v_mfma_f32_16x16x32_bf16 v[52:55], a[4:7], a[116:119], v[52:55]
    buffer_load_dwordx4 a[64:67], v2, s[20:23], s34 offen offset:0
    v_mfma_f32_16x16x32_bf16 v[56:59], a[4:7], a[120:123], v[56:59]
    buffer_load_dwordx4 a[68:71], v2, s[20:23], s34 offen offset:1024
    v_mfma_f32_16x16x32_bf16 v[60:63], a[4:7], a[124:127], v[60:63]
    buffer_load_dwordx4 a[72:75], v2, s[20:23], s34 offen offset:2048
    s_waitcnt vmcnt(16)
    v_mfma_f32_16x16x32_bf16 v[64:67], a[8:11], a[112:115], v[64:67]
    buffer_load_dwordx4 a[76:79], v2, s[20:23], s34 offen offset:3072
    v_mfma_f32_16x16x32_bf16 v[68:71], a[8:11], a[116:119], v[68:71]
    s_mov_b32 s34, 20480
    v_mfma_f32_16x16x32_bf16 v[72:75], a[8:11], a[120:123], v[72:75]
    buffer_load_dwordx4 a[80:83], v2, s[20:23], s34 offen offset:0
    v_mfma_f32_16x16x32_bf16 v[76:79], a[8:11], a[124:127], v[76:79]
    buffer_load_dwordx4 a[84:87], v2, s[20:23], s34 offen offset:1024
    s_waitcnt vmcnt(18)
    v_mfma_f32_16x16x32_bf16 v[80:83], a[12:15], a[112:115], v[80:83]
    buffer_load_dwordx4 a[88:91], v2, s[20:23], s34 offen offset:2048
    v_mfma_f32_16x16x32_bf16 v[84:87], a[12:15], a[116:119], v[84:87]
    buffer_load_dwordx4 a[92:95], v2, s[20:23], s34 offen offset:3072
    v_mfma_f32_16x16x32_bf16 v[88:91], a[12:15], a[120:123], v[88:91]
    s_mov_b32 s34, 24576
    v_mfma_f32_16x16x32_bf16 v[92:95], a[12:15], a[124:127], v[92:95]
    buffer_load_dwordx4 a[96:99], v2, s[20:23], s34 offen offset:0
    s_waitcnt vmcnt(19)
    v_mfma_f32_16x16x32_bf16 v[96:99], a[16:19], a[112:115], v[96:99]
    buffer_load_dwordx4 a[100:103], v2, s[20:23], s34 offen offset:1024
    v_mfma_f32_16x16x32_bf16 v[100:103], a[16:19], a[116:119], v[100:103]
    buffer_load_dwordx4 a[104:107], v2, s[20:23], s34 offen offset:2048
    v_mfma_f32_16x16x32_bf16 v[104:107], a[16:19], a[120:123], v[104:107]
    buffer_load_dwordx4 a[108:111], v2, s[20:23], s34 offen offset:3072
    v_mfma_f32_16x16x32_bf16 v[108:111], a[16:19], a[124:127], v[108:111]
    s_mov_b32 s34, 28672
    v_mfma_f32_16x16x32_bf16 v[112:115], a[20:23], a[112:115], v[112:115]
    buffer_load_dwordx4 a[0:3], v2, s[20:23], s34 offen offset:0
    v_mfma_f32_16x16x32_bf16 v[116:119], a[20:23], a[116:119], v[116:119]
    buffer_load_dwordx4 a[4:7], v2, s[20:23], s34 offen offset:1024
    v_mfma_f32_16x16x32_bf16 v[120:123], a[20:23], a[120:123], v[120:123]
    buffer_load_dwordx4 a[8:11], v2, s[20:23], s34 offen offset:2048
    v_mfma_f32_16x16x32_bf16 v[124:127], a[20:23], a[124:127], v[124:127]
    buffer_load_dwordx4 a[12:15], v2, s[20:23], s34 offen offset:3072
    s_waitcnt vmcnt(19)
    v_mfma_f32_16x16x32_bf16 v[128:131], a[24:27], a[112:115], v[128:131]
    s_mov_b32 s34, 32768
    v_mfma_f32_16x16x32_bf16 v[132:135], a[24:27], a[116:119], v[132:135]
    buffer_load_dwordx4 a[16:19], v2, s[20:23], s34 offen offset:0
    v_mfma_f32_16x16x32_bf16 v[136:139], a[24:27], a[120:123], v[136:139]
    buffer_load_dwordx4 a[20:23], v2, s[20:23], s34 offen offset:1024
    v_mfma_f32_16x16x32_bf16 v[140:143], a[24:27], a[124:127], v[140:143]
    s_waitcnt lgkmcnt(0)
    v_mfma_f32_16x16x32_bf16 v[240:243], a[28:31], a[128:131], v[240:243]
    buffer_load_dwordx4 a[24:27], v2, s[20:23], s34 offen offset:2048
    v_mfma_f32_16x16x32_bf16 v[244:247], a[28:31], a[132:135], v[244:247]
    ds_read_b128 a[112:115], v0 offset:128
    ds_read_b128 a[116:119], v0 offset:26752
    v_mfma_f32_16x16x32_bf16 v[248:251], a[28:31], a[136:139], v[248:251]
    ds_read_b128 a[120:123], v1 offset:128
    ds_read_b128 a[124:127], v1 offset:26752
    v_mfma_f32_16x16x32_bf16 v[252:255], a[28:31], a[140:143], v[252:255]
    v_mfma_f32_16x16x32_bf16 v[48:51], a[32:35], a[128:131], v[48:51]
    buffer_load_dwordx4 a[28:31], v2, s[20:23], s34 offen offset:3072
    v_mfma_f32_16x16x32_bf16 v[52:55], a[32:35], a[132:135], v[52:55]
    v_mfma_f32_16x16x32_bf16 v[56:59], a[32:35], a[136:139], v[56:59]
    v_mfma_f32_16x16x32_bf16 v[60:63], a[32:35], a[140:143], v[60:63]
    v_mfma_f32_16x16x32_bf16 v[64:67], a[36:39], a[128:131], v[64:67]
    s_mov_b32 s34, 36864
    v_mfma_f32_16x16x32_bf16 v[68:71], a[36:39], a[132:135], v[68:71]
    buffer_load_dwordx4 a[32:35], v2, s[20:23], s34 offen offset:0
    v_mfma_f32_16x16x32_bf16 v[72:75], a[36:39], a[136:139], v[72:75]
    v_mfma_f32_16x16x32_bf16 v[76:79], a[36:39], a[140:143], v[76:79]
    v_mfma_f32_16x16x32_bf16 v[80:83], a[40:43], a[128:131], v[80:83]
    buffer_load_dwordx4 a[36:39], v2, s[20:23], s34 offen offset:1024
    v_mfma_f32_16x16x32_bf16 v[84:87], a[40:43], a[132:135], v[84:87]
    v_mfma_f32_16x16x32_bf16 v[88:91], a[40:43], a[136:139], v[88:91]
    v_mfma_f32_16x16x32_bf16 v[92:95], a[40:43], a[140:143], v[92:95]
    v_mfma_f32_16x16x32_bf16 v[96:99], a[44:47], a[128:131], v[96:99]
    buffer_load_dwordx4 a[40:43], v2, s[20:23], s34 offen offset:2048
    v_mfma_f32_16x16x32_bf16 v[100:103], a[44:47], a[132:135], v[100:103]
    v_mfma_f32_16x16x32_bf16 v[104:107], a[44:47], a[136:139], v[104:107]
    v_mfma_f32_16x16x32_bf16 v[108:111], a[44:47], a[140:143], v[108:111]
    v_mfma_f32_16x16x32_bf16 v[112:115], a[48:51], a[128:131], v[112:115]
    buffer_load_dwordx4 a[44:47], v2, s[20:23], s34 offen offset:3072
    v_mfma_f32_16x16x32_bf16 v[116:119], a[48:51], a[132:135], v[116:119]
    v_mfma_f32_16x16x32_bf16 v[120:123], a[48:51], a[136:139], v[120:123]
    v_mfma_f32_16x16x32_bf16 v[124:127], a[48:51], a[140:143], v[124:127]
    s_waitcnt vmcnt(20)
    v_mfma_f32_16x16x32_bf16 v[128:131], a[52:55], a[128:131], v[128:131]
    s_mov_b32 s34, 40960
    v_mfma_f32_16x16x32_bf16 v[132:135], a[52:55], a[132:135], v[132:135]
    buffer_load_dwordx4 a[48:51], v2, s[20:23], s34 offen offset:0
    v_mfma_f32_16x16x32_bf16 v[136:139], a[52:55], a[136:139], v[136:139]
    v_mfma_f32_16x16x32_bf16 v[140:143], a[52:55], a[140:143], v[140:143]
    s_waitcnt lgkmcnt(0)
    v_mfma_f32_16x16x32_bf16 v[240:243], a[56:59], a[112:115], v[240:243]
    buffer_load_dwordx4 a[52:55], v2, s[20:23], s34 offen offset:1024
    v_mfma_f32_16x16x32_bf16 v[244:247], a[56:59], a[116:119], v[244:247]
    ds_read_b128 a[128:131], v0 offset:384
    ds_read_b128 a[132:135], v0 offset:27008
    v_mfma_f32_16x16x32_bf16 v[248:251], a[56:59], a[120:123], v[248:251]
    ds_read_b128 a[136:139], v1 offset:384
    ds_read_b128 a[140:143], v1 offset:27008
    v_mfma_f32_16x16x32_bf16 v[252:255], a[56:59], a[124:127], v[252:255]
    s_mul_i32 s44, s32, 384
    v_mfma_f32_16x16x32_bf16 v[48:51], a[60:63], a[112:115], v[48:51]
    buffer_load_dwordx4 a[56:59], v2, s[20:23], s34 offen offset:2048
    v_mfma_f32_16x16x32_bf16 v[52:55], a[60:63], a[116:119], v[52:55]
    v_mfma_f32_16x16x32_bf16 v[56:59], a[60:63], a[120:123], v[56:59]
    v_mfma_f32_16x16x32_bf16 v[60:63], a[60:63], a[124:127], v[60:63]
    v_mfma_f32_16x16x32_bf16 v[64:67], a[64:67], a[112:115], v[64:67]
    buffer_load_dwordx4 a[60:63], v2, s[20:23], s34 offen offset:3072
    v_mfma_f32_16x16x32_bf16 v[68:71], a[64:67], a[116:119], v[68:71]
    v_mfma_f32_16x16x32_bf16 v[72:75], a[64:67], a[120:123], v[72:75]
    v_mfma_f32_16x16x32_bf16 v[76:79], a[64:67], a[124:127], v[76:79]
    v_mfma_f32_16x16x32_bf16 v[80:83], a[68:71], a[112:115], v[80:83]
    s_mov_b32 s34, 45056
    v_add_u32 v14, s44, v0
    v_mfma_f32_16x16x32_bf16 v[84:87], a[68:71], a[116:119], v[84:87]
    buffer_load_dwordx4 a[64:67], v2, s[20:23], s34 offen offset:0
    v_mfma_f32_16x16x32_bf16 v[88:91], a[68:71], a[120:123], v[88:91]
    v_mfma_f32_16x16x32_bf16 v[92:95], a[68:71], a[124:127], v[92:95]
    v_mfma_f32_16x16x32_bf16 v[96:99], a[72:75], a[112:115], v[96:99]
    buffer_load_dwordx4 a[68:71], v2, s[20:23], s34 offen offset:1024
    v_mfma_f32_16x16x32_bf16 v[100:103], a[72:75], a[116:119], v[100:103]
    v_mfma_f32_16x16x32_bf16 v[104:107], a[72:75], a[120:123], v[104:107]
    v_mfma_f32_16x16x32_bf16 v[108:111], a[72:75], a[124:127], v[108:111]
    v_mfma_f32_16x16x32_bf16 v[112:115], a[76:79], a[112:115], v[112:115]
    buffer_load_dwordx4 a[72:75], v2, s[20:23], s34 offen offset:2048
    v_mfma_f32_16x16x32_bf16 v[116:119], a[76:79], a[116:119], v[116:119]
    v_mfma_f32_16x16x32_bf16 v[120:123], a[76:79], a[120:123], v[120:123]
    v_mfma_f32_16x16x32_bf16 v[124:127], a[76:79], a[124:127], v[124:127]
    s_waitcnt vmcnt(20)
    v_mfma_f32_16x16x32_bf16 v[128:131], a[80:83], a[112:115], v[128:131]
    buffer_load_dwordx4 a[76:79], v2, s[20:23], s34 offen offset:3072
    v_mfma_f32_16x16x32_bf16 v[132:135], a[80:83], a[116:119], v[132:135]
    v_add_u32 v15, s44, v1
    v_mfma_f32_16x16x32_bf16 v[136:139], a[80:83], a[120:123], v[136:139]
    v_mfma_f32_16x16x32_bf16 v[140:143], a[80:83], a[124:127], v[140:143]
    s_waitcnt lgkmcnt(0)
    v_mfma_f32_16x16x32_bf16 v[240:243], a[84:87], a[128:131], v[240:243]
    s_mov_b32 s34, 49152
    v_mfma_f32_16x16x32_bf16 v[244:247], a[84:87], a[132:135], v[244:247]
    ds_read_b128 a[112:115], v46 offset:384
    ds_read_b128 a[116:119], v46 offset:27008
    v_mfma_f32_16x16x32_bf16 v[248:251], a[84:87], a[136:139], v[248:251]
    ds_read_b128 a[120:123], v47 offset:384
    ds_read_b128 a[124:127], v47 offset:27008
    v_mfma_f32_16x16x32_bf16 v[252:255], a[84:87], a[140:143], v[252:255]
    buffer_load_dwordx4 a[80:83], v2, s[20:23], s34 offen offset:0
    v_mfma_f32_16x16x32_bf16 v[48:51], a[88:91], a[128:131], v[48:51]
    buffer_load_dwordx4 a[84:87], v2, s[20:23], s34 offen offset:1024
    v_mfma_f32_16x16x32_bf16 v[52:55], a[88:91], a[132:135], v[52:55]
    buffer_load_dwordx4 v[144:147], v12, s[24:27], 0 offen offset:384
    v_mfma_f32_16x16x32_bf16 v[56:59], a[88:91], a[136:139], v[56:59]
    v_mfma_f32_16x16x32_bf16 v[60:63], a[88:91], a[140:143], v[60:63]
    v_mfma_f32_16x16x32_bf16 v[64:67], a[92:95], a[128:131], v[64:67]
    buffer_load_dwordx4 a[88:91], v2, s[20:23], s34 offen offset:2048
    v_mfma_f32_16x16x32_bf16 v[68:71], a[92:95], a[132:135], v[68:71]
    v_add_u32 v16, s44, v46
    v_mfma_f32_16x16x32_bf16 v[72:75], a[92:95], a[136:139], v[72:75]
    buffer_load_dwordx4 v[160:163], v12, s[24:27], 0 offen offset:448
    v_mfma_f32_16x16x32_bf16 v[76:79], a[92:95], a[140:143], v[76:79]
    v_mfma_f32_16x16x32_bf16 v[80:83], a[96:99], a[128:131], v[80:83]
    buffer_load_dwordx4 a[92:95], v2, s[20:23], s34 offen offset:3072
    v_mfma_f32_16x16x32_bf16 v[84:87], a[96:99], a[132:135], v[84:87]
    v_mfma_f32_16x16x32_bf16 v[88:91], a[96:99], a[136:139], v[88:91]
    v_mfma_f32_16x16x32_bf16 v[92:95], a[96:99], a[140:143], v[92:95]
    v_mfma_f32_16x16x32_bf16 v[96:99], a[100:103], a[128:131], v[96:99]
    s_mov_b32 s34, 53248
    v_mfma_f32_16x16x32_bf16 v[100:103], a[100:103], a[132:135], v[100:103]
    buffer_load_dwordx4 a[96:99], v2, s[20:23], s34 offen offset:0
    v_mfma_f32_16x16x32_bf16 v[104:107], a[100:103], a[136:139], v[104:107]
    buffer_load_dwordx4 v[176:179], v12, s[24:27], 0 offen offset:512
    v_mfma_f32_16x16x32_bf16 v[108:111], a[100:103], a[140:143], v[108:111]
    v_mfma_f32_16x16x32_bf16 v[112:115], a[104:107], a[128:131], v[112:115]
    buffer_load_dwordx4 a[100:103], v2, s[20:23], s34 offen offset:1024
    v_mfma_f32_16x16x32_bf16 v[116:119], a[104:107], a[132:135], v[116:119]
    v_add_u32 v17, s44, v47
    v_mfma_f32_16x16x32_bf16 v[120:123], a[104:107], a[136:139], v[120:123]
    v_mfma_f32_16x16x32_bf16 v[124:127], a[104:107], a[140:143], v[124:127]
    s_waitcnt vmcnt(23)
    v_mfma_f32_16x16x32_bf16 v[128:131], a[108:111], a[128:131], v[128:131]
    buffer_load_dwordx4 a[104:107], v2, s[20:23], s34 offen offset:2048
    v_mfma_f32_16x16x32_bf16 v[132:135], a[108:111], a[132:135], v[132:135]
    v_mfma_f32_16x16x32_bf16 v[136:139], a[108:111], a[136:139], v[136:139]
    v_mfma_f32_16x16x32_bf16 v[140:143], a[108:111], a[140:143], v[140:143]
    s_waitcnt lgkmcnt(0)
    v_mfma_f32_16x16x32_bf16 v[240:243], a[0:3], a[112:115], v[240:243]
    buffer_load_dwordx4 a[108:111], v2, s[20:23], s34 offen offset:3072
    v_mfma_f32_16x16x32_bf16 v[244:247], a[0:3], a[116:119], v[244:247]
    ds_read_b128 a[128:131], v0 offset:512
    ds_read_b128 a[132:135], v0 offset:27136
    v_mfma_f32_16x16x32_bf16 v[248:251], a[0:3], a[120:123], v[248:251]
    ds_read_b128 a[136:139], v1 offset:512
    ds_read_b128 a[140:143], v1 offset:27136
    v_mfma_f32_16x16x32_bf16 v[252:255], a[0:3], a[124:127], v[252:255]
    buffer_load_dwordx4 v[192:195], v12, s[24:27], 0 offen offset:576
    v_mfma_f32_16x16x32_bf16 v[48:51], a[4:7], a[112:115], v[48:51]
    s_mov_b32 s34, 57344
    v_mfma_f32_16x16x32_bf16 v[52:55], a[4:7], a[116:119], v[52:55]
    buffer_load_dwordx4 a[0:3], v2, s[20:23], s34 offen offset:0
    v_mfma_f32_16x16x32_bf16 v[56:59], a[4:7], a[120:123], v[56:59]
    s_cmp_ge_u32 s32, 2
    v_mfma_f32_16x16x32_bf16 v[60:63], a[4:7], a[124:127], v[60:63]
    v_mfma_f32_16x16x32_bf16 v[64:67], a[8:11], a[112:115], v[64:67]
    buffer_load_dwordx4 a[4:7], v2, s[20:23], s34 offen offset:1024
    v_mfma_f32_16x16x32_bf16 v[68:71], a[8:11], a[116:119], v[68:71]
    buffer_load_dwordx4 v[208:211], v12, s[24:27], 0 offen offset:640
    v_mfma_f32_16x16x32_bf16 v[72:75], a[8:11], a[120:123], v[72:75]
    v_mfma_f32_16x16x32_bf16 v[76:79], a[8:11], a[124:127], v[76:79]
    v_mfma_f32_16x16x32_bf16 v[80:83], a[12:15], a[112:115], v[80:83]
    buffer_load_dwordx4 a[8:11], v2, s[20:23], s34 offen offset:2048
    v_mfma_f32_16x16x32_bf16 v[84:87], a[12:15], a[116:119], v[84:87]
    v_mfma_f32_16x16x32_bf16 v[88:91], a[12:15], a[120:123], v[88:91]
    v_mfma_f32_16x16x32_bf16 v[92:95], a[12:15], a[124:127], v[92:95]
    v_mfma_f32_16x16x32_bf16 v[96:99], a[16:19], a[112:115], v[96:99]
    buffer_load_dwordx4 a[12:15], v2, s[20:23], s34 offen offset:3072
    v_mfma_f32_16x16x32_bf16 v[100:103], a[16:19], a[116:119], v[100:103]
    s_cselect_b64 vcc, -1, 0
    v_mfma_f32_16x16x32_bf16 v[104:107], a[16:19], a[120:123], v[104:107]
    buffer_load_dwordx4 v[224:227], v12, s[24:27], 0 offen offset:704
    v_mfma_f32_16x16x32_bf16 v[108:111], a[16:19], a[124:127], v[108:111]
    v_mfma_f32_16x16x32_bf16 v[112:115], a[20:23], a[112:115], v[112:115]
    s_mov_b32 s34, 61440
    v_mfma_f32_16x16x32_bf16 v[116:119], a[20:23], a[116:119], v[116:119]
    buffer_load_dwordx4 a[16:19], v2, s[20:23], s34 offen offset:0
    v_mfma_f32_16x16x32_bf16 v[120:123], a[20:23], a[120:123], v[120:123]
    v_mfma_f32_16x16x32_bf16 v[124:127], a[20:23], a[124:127], v[124:127]
    s_waitcnt vmcnt(26)
    v_mfma_f32_16x16x32_bf16 v[128:131], a[24:27], a[112:115], v[128:131]
    buffer_load_dwordx4 a[20:23], v2, s[20:23], s34 offen offset:1024
    v_mfma_f32_16x16x32_bf16 v[132:135], a[24:27], a[116:119], v[132:135]
    v_mfma_f32_16x16x32_bf16 v[136:139], a[24:27], a[120:123], v[136:139]
    v_mfma_f32_16x16x32_bf16 v[140:143], a[24:27], a[124:127], v[140:143]
    s_waitcnt lgkmcnt(0)
    v_mfma_f32_16x16x32_bf16 v[240:243], a[28:31], a[128:131], v[240:243]
    buffer_load_dwordx4 a[24:27], v2, s[20:23], s34 offen offset:2048
    v_mfma_f32_16x16x32_bf16 v[244:247], a[28:31], a[132:135], v[244:247]
    ds_read_b128 a[112:115], v0 offset:768
    ds_read_b128 a[116:119], v0 offset:27392
    v_mfma_f32_16x16x32_bf16 v[248:251], a[28:31], a[136:139], v[248:251]
    ds_read_b128 a[120:123], v1 offset:768
    ds_read_b128 a[124:127], v1 offset:27392
    v_mfma_f32_16x16x32_bf16 v[252:255], a[28:31], a[140:143], v[252:255]
    v_cndmask_b32 v18, v0, v46, vcc
    v_mfma_f32_16x16x32_bf16 v[48:51], a[32:35], a[128:131], v[48:51]
    buffer_load_dwordx4 a[28:31], v2, s[20:23], s34 offen offset:3072
    v_mfma_f32_16x16x32_bf16 v[52:55], a[32:35], a[132:135], v[52:55]
    v_mfma_f32_16x16x32_bf16 v[56:59], a[32:35], a[136:139], v[56:59]
    v_mfma_f32_16x16x32_bf16 v[60:63], a[32:35], a[140:143], v[60:63]
    v_mfma_f32_16x16x32_bf16 v[64:67], a[36:39], a[128:131], v[64:67]
    s_mov_b32 s34, 65536
    v_mfma_f32_16x16x32_bf16 v[68:71], a[36:39], a[132:135], v[68:71]
    buffer_load_dwordx4 a[32:35], v2, s[20:23], s34 offen offset:0
    v_mfma_f32_16x16x32_bf16 v[72:75], a[36:39], a[136:139], v[72:75]
    v_mfma_f32_16x16x32_bf16 v[76:79], a[36:39], a[140:143], v[76:79]
    v_mfma_f32_16x16x32_bf16 v[80:83], a[40:43], a[128:131], v[80:83]
    buffer_load_dwordx4 a[36:39], v2, s[20:23], s34 offen offset:1024
    v_mfma_f32_16x16x32_bf16 v[84:87], a[40:43], a[132:135], v[84:87]
    v_mfma_f32_16x16x32_bf16 v[88:91], a[40:43], a[136:139], v[88:91]
    v_cndmask_b32 v19, v1, v47, vcc
    v_mfma_f32_16x16x32_bf16 v[92:95], a[40:43], a[140:143], v[92:95]
    v_mfma_f32_16x16x32_bf16 v[96:99], a[44:47], a[128:131], v[96:99]
    buffer_load_dwordx4 a[40:43], v2, s[20:23], s34 offen offset:2048
    v_mfma_f32_16x16x32_bf16 v[100:103], a[44:47], a[132:135], v[100:103]
    v_mfma_f32_16x16x32_bf16 v[104:107], a[44:47], a[136:139], v[104:107]
    v_mfma_f32_16x16x32_bf16 v[108:111], a[44:47], a[140:143], v[108:111]
    v_mfma_f32_16x16x32_bf16 v[112:115], a[48:51], a[128:131], v[112:115]
    buffer_load_dwordx4 a[44:47], v2, s[20:23], s34 offen offset:3072
    v_mfma_f32_16x16x32_bf16 v[116:119], a[48:51], a[132:135], v[116:119]
    v_mfma_f32_16x16x32_bf16 v[120:123], a[48:51], a[136:139], v[120:123]
    v_mfma_f32_16x16x32_bf16 v[124:127], a[48:51], a[140:143], v[124:127]
    s_waitcnt vmcnt(26)
    v_mfma_f32_16x16x32_bf16 v[128:131], a[52:55], a[128:131], v[128:131]
    s_mov_b32 s34, 69632
    v_mfma_f32_16x16x32_bf16 v[132:135], a[52:55], a[132:135], v[132:135]
    buffer_load_dwordx4 a[48:51], v2, s[20:23], s34 offen offset:0
    v_mfma_f32_16x16x32_bf16 v[136:139], a[52:55], a[136:139], v[136:139]
    s_and_b32 s44, s32, 1
    v_mfma_f32_16x16x32_bf16 v[140:143], a[52:55], a[140:143], v[140:143]
    s_waitcnt lgkmcnt(0)
    v_mfma_f32_16x16x32_bf16 v[240:243], a[56:59], a[112:115], v[240:243]
    buffer_load_dwordx4 a[52:55], v2, s[20:23], s34 offen offset:1024
    v_mfma_f32_16x16x32_bf16 v[244:247], a[56:59], a[116:119], v[244:247]
    ds_read_b128 a[128:131], v46 offset:768
    ds_read_b128 a[132:135], v46 offset:27392
    v_mfma_f32_16x16x32_bf16 v[248:251], a[56:59], a[120:123], v[248:251]
    ds_read_b128 a[136:139], v47 offset:768
    ds_read_b128 a[140:143], v47 offset:27392
    v_mfma_f32_16x16x32_bf16 v[252:255], a[56:59], a[124:127], v[252:255]
    v_mfma_f32_16x16x32_bf16 v[48:51], a[60:63], a[112:115], v[48:51]
    buffer_load_dwordx4 a[56:59], v2, s[20:23], s34 offen offset:2048
    v_mfma_f32_16x16x32_bf16 v[52:55], a[60:63], a[116:119], v[52:55]
    v_mfma_f32_16x16x32_bf16 v[56:59], a[60:63], a[120:123], v[56:59]
    v_mfma_f32_16x16x32_bf16 v[60:63], a[60:63], a[124:127], v[60:63]
    v_mfma_f32_16x16x32_bf16 v[64:67], a[64:67], a[112:115], v[64:67]
    buffer_load_dwordx4 a[60:63], v2, s[20:23], s34 offen offset:3072
    v_mfma_f32_16x16x32_bf16 v[68:71], a[64:67], a[116:119], v[68:71]
    v_mfma_f32_16x16x32_bf16 v[72:75], a[64:67], a[120:123], v[72:75]
    s_lshl_b32 s44, s44, 3
    v_mfma_f32_16x16x32_bf16 v[76:79], a[64:67], a[124:127], v[76:79]
    v_mfma_f32_16x16x32_bf16 v[80:83], a[68:71], a[112:115], v[80:83]
    s_mov_b32 s34, 73728
    v_mfma_f32_16x16x32_bf16 v[84:87], a[68:71], a[116:119], v[84:87]
    buffer_load_dwordx4 a[64:67], v2, s[20:23], s34 offen offset:0
    v_mfma_f32_16x16x32_bf16 v[88:91], a[68:71], a[120:123], v[88:91]
    v_mfma_f32_16x16x32_bf16 v[92:95], a[68:71], a[124:127], v[92:95]
    v_mfma_f32_16x16x32_bf16 v[96:99], a[72:75], a[112:115], v[96:99]
    buffer_load_dwordx4 a[68:71], v2, s[20:23], s34 offen offset:1024
    v_mfma_f32_16x16x32_bf16 v[100:103], a[72:75], a[116:119], v[100:103]
    v_mfma_f32_16x16x32_bf16 v[104:107], a[72:75], a[120:123], v[104:107]
    v_mfma_f32_16x16x32_bf16 v[108:111], a[72:75], a[124:127], v[108:111]
    v_mfma_f32_16x16x32_bf16 v[112:115], a[76:79], a[112:115], v[112:115]
    buffer_load_dwordx4 a[72:75], v2, s[20:23], s34 offen offset:2048
    v_mfma_f32_16x16x32_bf16 v[116:119], a[76:79], a[116:119], v[116:119]
    v_mfma_f32_16x16x32_bf16 v[120:123], a[76:79], a[120:123], v[120:123]
    v_mfma_f32_16x16x32_bf16 v[124:127], a[76:79], a[124:127], v[124:127]
    v_add_u32 v18, s44, v18
    s_waitcnt vmcnt(31)
    v_mfma_f32_16x16x32_bf16 v[128:131], a[80:83], a[112:115], v[128:131]
    buffer_load_dwordx4 a[76:79], v2, s[20:23], s34 offen offset:3072
    v_mfma_f32_16x16x32_bf16 v[132:135], a[80:83], a[116:119], v[132:135]
    v_mfma_f32_16x16x32_bf16 v[136:139], a[80:83], a[120:123], v[136:139]
    v_mfma_f32_16x16x32_bf16 v[140:143], a[80:83], a[124:127], v[140:143]
    s_waitcnt lgkmcnt(0)
    v_mfma_f32_16x16x32_bf16 v[240:243], a[84:87], a[128:131], v[240:243]
    s_mov_b32 s34, 77824
    v_mfma_f32_16x16x32_bf16 v[244:247], a[84:87], a[132:135], v[244:247]
    ds_read_b128 a[112:115], v0 offset:896
    ds_read_b128 a[116:119], v0 offset:27520
    v_mfma_f32_16x16x32_bf16 v[248:251], a[84:87], a[136:139], v[248:251]
    ds_read_b128 a[120:123], v1 offset:896
    ds_read_b128 a[124:127], v1 offset:27520
    v_mfma_f32_16x16x32_bf16 v[252:255], a[84:87], a[140:143], v[252:255]
    buffer_load_dwordx4 a[80:83], v2, s[20:23], s34 offen offset:0
    s_waitcnt vmcnt(31)
    v_mfma_f32_16x16x32_bf16 v[48:51], a[88:91], a[128:131], v[48:51]
    buffer_load_dwordx4 a[84:87], v2, s[20:23], s34 offen offset:1024
    v_mfma_f32_16x16x32_bf16 v[52:55], a[88:91], a[132:135], v[52:55]
    v_mfma_f32_16x16x32_bf16 v[56:59], a[88:91], a[136:139], v[56:59]
    v_mfma_f32_16x16x32_bf16 v[60:63], a[88:91], a[140:143], v[60:63]
    v_add_u32 v19, s44, v19
    s_waitcnt vmcnt(29)
    v_mfma_f32_16x16x32_bf16 v[64:67], a[92:95], a[128:131], v[64:67]
    buffer_load_dwordx4 a[88:91], v2, s[20:23], s34 offen offset:2048
    v_mfma_f32_16x16x32_bf16 v[68:71], a[92:95], a[132:135], v[68:71]
    v_mfma_f32_16x16x32_bf16 v[72:75], a[92:95], a[136:139], v[72:75]
    v_mfma_f32_16x16x32_bf16 v[76:79], a[92:95], a[140:143], v[76:79]
    v_mfma_f32_16x16x32_bf16 v[80:83], a[96:99], a[128:131], v[80:83]
    buffer_load_dwordx4 a[92:95], v2, s[20:23], s34 offen offset:3072
    v_mfma_f32_16x16x32_bf16 v[84:87], a[96:99], a[132:135], v[84:87]
    v_mfma_f32_16x16x32_bf16 v[88:91], a[96:99], a[136:139], v[88:91]
    v_mfma_f32_16x16x32_bf16 v[92:95], a[96:99], a[140:143], v[92:95]
    s_waitcnt vmcnt(27)
    v_mfma_f32_16x16x32_bf16 v[96:99], a[100:103], a[128:131], v[96:99]
    s_mov_b32 s34, 81920
    v_mfma_f32_16x16x32_bf16 v[100:103], a[100:103], a[132:135], v[100:103]
    buffer_load_dwordx4 a[96:99], v2, s[20:23], s34 offen offset:0
    v_mfma_f32_16x16x32_bf16 v[104:107], a[100:103], a[136:139], v[104:107]
    v_mfma_f32_16x16x32_bf16 v[108:111], a[100:103], a[140:143], v[108:111]
    ds_read_b64 a[240:241], v18 offset:1536
    v_mfma_f32_16x16x32_bf16 v[112:115], a[104:107], a[128:131], v[112:115]
    buffer_load_dwordx4 a[100:103], v2, s[20:23], s34 offen offset:1024
    v_mfma_f32_16x16x32_bf16 v[116:119], a[104:107], a[132:135], v[116:119]
    v_mfma_f32_16x16x32_bf16 v[120:123], a[104:107], a[136:139], v[120:123]
    v_mfma_f32_16x16x32_bf16 v[124:127], a[104:107], a[140:143], v[124:127]
    v_mfma_f32_16x16x32_bf16 v[128:131], a[108:111], a[128:131], v[128:131]
    buffer_load_dwordx4 a[104:107], v2, s[20:23], s34 offen offset:2048
    v_mfma_f32_16x16x32_bf16 v[132:135], a[108:111], a[132:135], v[132:135]
    v_mfma_f32_16x16x32_bf16 v[136:139], a[108:111], a[136:139], v[136:139]
    v_mfma_f32_16x16x32_bf16 v[140:143], a[108:111], a[140:143], v[140:143]
    s_waitcnt vmcnt(27) lgkmcnt(1)
    v_mfma_f32_16x16x32_bf16 v[240:243], a[0:3], a[112:115], v[240:243]
    buffer_load_dwordx4 a[108:111], v2, s[20:23], s34 offen offset:3072
    v_mfma_f32_16x16x32_bf16 v[244:247], a[0:3], a[116:119], v[244:247]
    ds_read_b128 a[128:131], v0 offset:1152
    ds_read_b128 a[132:135], v0 offset:27776
    v_mfma_f32_16x16x32_bf16 v[248:251], a[0:3], a[120:123], v[248:251]
    ds_read_b128 a[136:139], v1 offset:1152
    ds_read_b128 a[140:143], v1 offset:27776
    v_mfma_f32_16x16x32_bf16 v[252:255], a[0:3], a[124:127], v[252:255]
    v_mfma_f32_16x16x32_bf16 v[48:51], a[4:7], a[112:115], v[48:51]
    s_mov_b32 s34, 86016
    v_mfma_f32_16x16x32_bf16 v[52:55], a[4:7], a[116:119], v[52:55]
    buffer_load_dwordx4 a[0:3], v2, s[20:23], s34 offen offset:0
    v_mfma_f32_16x16x32_bf16 v[56:59], a[4:7], a[120:123], v[56:59]
    ds_read_b64 a[242:243], v18 offset:28160
    v_mfma_f32_16x16x32_bf16 v[60:63], a[4:7], a[124:127], v[60:63]
    s_waitcnt vmcnt(26)
    v_mfma_f32_16x16x32_bf16 v[64:67], a[8:11], a[112:115], v[64:67]
    buffer_load_dwordx4 a[4:7], v2, s[20:23], s34 offen offset:1024
    v_mfma_f32_16x16x32_bf16 v[68:71], a[8:11], a[116:119], v[68:71]
    v_mfma_f32_16x16x32_bf16 v[72:75], a[8:11], a[120:123], v[72:75]
    v_mfma_f32_16x16x32_bf16 v[76:79], a[8:11], a[124:127], v[76:79]
    v_mfma_f32_16x16x32_bf16 v[80:83], a[12:15], a[112:115], v[80:83]
    buffer_load_dwordx4 a[8:11], v2, s[20:23], s34 offen offset:2048
    v_mfma_f32_16x16x32_bf16 v[84:87], a[12:15], a[116:119], v[84:87]
    v_mfma_f32_16x16x32_bf16 v[88:91], a[12:15], a[120:123], v[88:91]
    v_mfma_f32_16x16x32_bf16 v[92:95], a[12:15], a[124:127], v[92:95]
    s_waitcnt vmcnt(20)
    v_mfma_f32_16x16x32_bf16 v[96:99], a[16:19], a[112:115], v[96:99]
    buffer_load_dwordx4 a[12:15], v2, s[20:23], s34 offen offset:3072
    v_mfma_f32_16x16x32_bf16 v[100:103], a[16:19], a[116:119], v[100:103]
    ds_read_b64 a[244:245], v19 offset:1536
    v_mfma_f32_16x16x32_bf16 v[104:107], a[16:19], a[120:123], v[104:107]
    v_mfma_f32_16x16x32_bf16 v[108:111], a[16:19], a[124:127], v[108:111]
    v_mfma_f32_16x16x32_bf16 v[112:115], a[20:23], a[112:115], v[112:115]
    s_mov_b32 s34, 90112
    v_mfma_f32_16x16x32_bf16 v[116:119], a[20:23], a[116:119], v[116:119]
    buffer_load_dwordx4 a[16:19], v2, s[20:23], s34 offen offset:0
    v_mfma_f32_16x16x32_bf16 v[120:123], a[20:23], a[120:123], v[120:123]
    v_mfma_f32_16x16x32_bf16 v[124:127], a[20:23], a[124:127], v[124:127]
    v_mfma_f32_16x16x32_bf16 v[128:131], a[24:27], a[112:115], v[128:131]
    buffer_load_dwordx4 a[20:23], v2, s[20:23], s34 offen offset:1024
    v_mfma_f32_16x16x32_bf16 v[132:135], a[24:27], a[116:119], v[132:135]
    v_mfma_f32_16x16x32_bf16 v[136:139], a[24:27], a[120:123], v[136:139]
    v_mfma_f32_16x16x32_bf16 v[140:143], a[24:27], a[124:127], v[140:143]
    s_waitcnt lgkmcnt(2)
    v_mfma_f32_16x16x32_bf16 v[240:243], a[28:31], a[128:131], v[240:243]
    buffer_load_dwordx4 a[24:27], v2, s[20:23], s34 offen offset:2048
    v_mfma_f32_16x16x32_bf16 v[244:247], a[28:31], a[132:135], v[244:247]
    ds_read_b128 a[112:115], v46 offset:1152
    ds_read_b128 a[116:119], v46 offset:27776
    v_mfma_f32_16x16x32_bf16 v[248:251], a[28:31], a[136:139], v[248:251]
    ds_read_b128 a[120:123], v47 offset:1152
    ds_read_b128 a[124:127], v47 offset:27776
    v_mfma_f32_16x16x32_bf16 v[252:255], a[28:31], a[140:143], v[252:255]
    ds_read_b64 a[246:247], v19 offset:28160
    v_mfma_f32_16x16x32_bf16 v[48:51], a[32:35], a[128:131], v[48:51]
    buffer_load_dwordx4 a[28:31], v2, s[20:23], s34 offen offset:3072
    v_mfma_f32_16x16x32_bf16 v[52:55], a[32:35], a[132:135], v[52:55]
    v_mfma_f32_16x16x32_bf16 v[56:59], a[32:35], a[136:139], v[56:59]
    v_mfma_f32_16x16x32_bf16 v[60:63], a[32:35], a[140:143], v[60:63]
    v_mfma_f32_16x16x32_bf16 v[64:67], a[36:39], a[128:131], v[64:67]
    s_mov_b32 s34, 94208
    v_mfma_f32_16x16x32_bf16 v[68:71], a[36:39], a[132:135], v[68:71]
    buffer_load_dwordx4 a[32:35], v2, s[20:23], s34 offen offset:0
    v_mfma_f32_16x16x32_bf16 v[72:75], a[36:39], a[136:139], v[72:75]
    v_mfma_f32_16x16x32_bf16 v[76:79], a[36:39], a[140:143], v[76:79]
    v_mfma_f32_16x16x32_bf16 v[80:83], a[40:43], a[128:131], v[80:83]
    buffer_load_dwordx4 a[36:39], v2, s[20:23], s34 offen offset:1024
    v_mfma_f32_16x16x32_bf16 v[84:87], a[40:43], a[132:135], v[84:87]
    ds_read_b128 a[144:147], v14 offset:0
    v_mfma_f32_16x16x32_bf16 v[88:91], a[40:43], a[136:139], v[88:91]
    v_mfma_f32_16x16x32_bf16 v[92:95], a[40:43], a[140:143], v[92:95]
    s_waitcnt vmcnt(20)
    v_mfma_f32_16x16x32_bf16 v[96:99], a[44:47], a[128:131], v[96:99]
    buffer_load_dwordx4 a[40:43], v2, s[20:23], s34 offen offset:2048
    v_mfma_f32_16x16x32_bf16 v[100:103], a[44:47], a[132:135], v[100:103]
    v_mfma_f32_16x16x32_bf16 v[104:107], a[44:47], a[136:139], v[104:107]
    v_mfma_f32_16x16x32_bf16 v[108:111], a[44:47], a[140:143], v[108:111]
    v_mfma_f32_16x16x32_bf16 v[112:115], a[48:51], a[128:131], v[112:115]
    buffer_load_dwordx4 a[44:47], v2, s[20:23], s34 offen offset:3072
    v_mfma_f32_16x16x32_bf16 v[116:119], a[48:51], a[132:135], v[116:119]
    v_mfma_f32_16x16x32_bf16 v[120:123], a[48:51], a[136:139], v[120:123]
    v_mfma_f32_16x16x32_bf16 v[124:127], a[48:51], a[140:143], v[124:127]
    v_mfma_f32_16x16x32_bf16 v[128:131], a[52:55], a[128:131], v[128:131]
    s_mov_b32 s34, 98304
    v_mfma_f32_16x16x32_bf16 v[132:135], a[52:55], a[132:135], v[132:135]
    buffer_load_dwordx4 a[48:51], v2, s[20:23], s34 offen offset:0
    v_mfma_f32_16x16x32_bf16 v[136:139], a[52:55], a[136:139], v[136:139]
    ds_read_b128 a[148:151], v14 offset:26624
    v_mfma_f32_16x16x32_bf16 v[140:143], a[52:55], a[140:143], v[140:143]
    s_waitcnt lgkmcnt(3)
    v_mfma_f32_16x16x32_bf16 v[240:243], a[56:59], a[112:115], v[240:243]
    buffer_load_dwordx4 a[52:55], v2, s[20:23], s34 offen offset:1024
    v_mfma_f32_16x16x32_bf16 v[244:247], a[56:59], a[116:119], v[244:247]
    ds_read_b128 a[128:131], v0 offset:1280
    ds_read_b128 a[132:135], v0 offset:27904
    v_mfma_f32_16x16x32_bf16 v[248:251], a[56:59], a[120:123], v[248:251]
    ds_read_b128 a[136:139], v1 offset:1280
    ds_read_b128 a[140:143], v1 offset:27904
    v_mfma_f32_16x16x32_bf16 v[252:255], a[56:59], a[124:127], v[252:255]
    v_add_f32 v156, 1.0, v144
    v_add_f32 v157, 1.0, v145
    v_mfma_f32_16x16x32_bf16 v[48:51], a[60:63], a[112:115], v[48:51]
    buffer_load_dwordx4 a[56:59], v2, s[20:23], s34 offen offset:2048
    v_mfma_f32_16x16x32_bf16 v[52:55], a[60:63], a[116:119], v[52:55]
    v_mfma_f32_16x16x32_bf16 v[56:59], a[60:63], a[120:123], v[56:59]
    v_mfma_f32_16x16x32_bf16 v[60:63], a[60:63], a[124:127], v[60:63]
    v_add_f32 v158, 1.0, v146
    v_mfma_f32_16x16x32_bf16 v[64:67], a[64:67], a[112:115], v[64:67]
    buffer_load_dwordx4 a[60:63], v2, s[20:23], s34 offen offset:3072
    v_mfma_f32_16x16x32_bf16 v[68:71], a[64:67], a[116:119], v[68:71]
    ds_read_b128 a[152:155], v15 offset:0
    v_mfma_f32_16x16x32_bf16 v[72:75], a[64:67], a[120:123], v[72:75]
    v_add_f32 v159, 1.0, v147
    v_mfma_f32_16x16x32_bf16 v[76:79], a[64:67], a[124:127], v[76:79]
    v_mfma_f32_16x16x32_bf16 v[80:83], a[68:71], a[112:115], v[80:83]
    s_mov_b32 s34, 102400
    v_mfma_f32_16x16x32_bf16 v[84:87], a[68:71], a[116:119], v[84:87]
    buffer_load_dwordx4 a[64:67], v2, s[20:23], s34 offen offset:0
    v_mfma_f32_16x16x32_bf16 v[88:91], a[68:71], a[120:123], v[88:91]
    v_add_f32 v152, 1.0, v144
    v_mfma_f32_16x16x32_bf16 v[92:95], a[68:71], a[124:127], v[92:95]
    s_waitcnt vmcnt(20)
    v_mfma_f32_16x16x32_bf16 v[96:99], a[72:75], a[112:115], v[96:99]
    buffer_load_dwordx4 a[68:71], v2, s[20:23], s34 offen offset:1024
    v_mfma_f32_16x16x32_bf16 v[100:103], a[72:75], a[116:119], v[100:103]
    v_add_f32 v153, 1.0, v145
    v_mfma_f32_16x16x32_bf16 v[104:107], a[72:75], a[120:123], v[104:107]
    v_mfma_f32_16x16x32_bf16 v[108:111], a[72:75], a[124:127], v[108:111]
    v_mfma_f32_16x16x32_bf16 v[112:115], a[76:79], a[112:115], v[112:115]
    buffer_load_dwordx4 a[72:75], v2, s[20:23], s34 offen offset:2048
    v_mfma_f32_16x16x32_bf16 v[116:119], a[76:79], a[116:119], v[116:119]
    ds_read_b128 a[156:159], v15 offset:26624
    v_mfma_f32_16x16x32_bf16 v[120:123], a[76:79], a[120:123], v[120:123]
    v_add_f32 v154, 1.0, v146
    v_mfma_f32_16x16x32_bf16 v[124:127], a[76:79], a[124:127], v[124:127]
    v_mfma_f32_16x16x32_bf16 v[128:131], a[80:83], a[112:115], v[128:131]
    buffer_load_dwordx4 a[76:79], v2, s[20:23], s34 offen offset:3072
    v_mfma_f32_16x16x32_bf16 v[132:135], a[80:83], a[116:119], v[132:135]
    v_add_f32 v155, 1.0, v147
    v_mfma_f32_16x16x32_bf16 v[136:139], a[80:83], a[120:123], v[136:139]
    v_mfma_f32_16x16x32_bf16 v[140:143], a[80:83], a[124:127], v[140:143]
    s_waitcnt lgkmcnt(2)
    v_mfma_f32_16x16x32_bf16 v[240:243], a[84:87], a[128:131], v[240:243]
    s_mov_b32 s34, 106496
    v_add_f32 v148, 1.0, v144
    v_mfma_f32_16x16x32_bf16 v[244:247], a[84:87], a[132:135], v[244:247]
    ds_read_b128 a[112:115], v0 offset:1536
    ds_read_b128 a[116:119], v0 offset:28160
    v_mfma_f32_16x16x32_bf16 v[248:251], a[84:87], a[136:139], v[248:251]
    ds_read_b128 a[120:123], v1 offset:1536
    ds_read_b128 a[124:127], v1 offset:28160
    v_mfma_f32_16x16x32_bf16 v[252:255], a[84:87], a[140:143], v[252:255]
    buffer_load_dwordx4 a[80:83], v2, s[20:23], s34 offen offset:0
    v_mfma_f32_16x16x32_bf16 v[48:51], a[88:91], a[128:131], v[48:51]
    buffer_load_dwordx4 a[84:87], v2, s[20:23], s34 offen offset:1024
    v_mfma_f32_16x16x32_bf16 v[52:55], a[88:91], a[132:135], v[52:55]
    v_add_f32 v149, 1.0, v145
    v_mfma_f32_16x16x32_bf16 v[56:59], a[88:91], a[136:139], v[56:59]
    ds_read_b128 a[160:163], v16 offset:0
    v_mfma_f32_16x16x32_bf16 v[60:63], a[88:91], a[140:143], v[60:63]
    v_add_f32 v150, 1.0, v146
    v_mfma_f32_16x16x32_bf16 v[64:67], a[92:95], a[128:131], v[64:67]
    buffer_load_dwordx4 a[88:91], v2, s[20:23], s34 offen offset:2048
    v_mfma_f32_16x16x32_bf16 v[68:71], a[92:95], a[132:135], v[68:71]
    v_mfma_f32_16x16x32_bf16 v[72:75], a[92:95], a[136:139], v[72:75]
    v_add_f32 v151, 1.0, v147
    v_mfma_f32_16x16x32_bf16 v[76:79], a[92:95], a[140:143], v[76:79]
    v_mfma_f32_16x16x32_bf16 v[80:83], a[96:99], a[128:131], v[80:83]
    buffer_load_dwordx4 a[92:95], v2, s[20:23], s34 offen offset:3072
    v_mfma_f32_16x16x32_bf16 v[84:87], a[96:99], a[132:135], v[84:87]
    v_mfma_f32_16x16x32_bf16 v[88:91], a[96:99], a[136:139], v[88:91]
    v_add_f32 v144, 1.0, v144
    v_mfma_f32_16x16x32_bf16 v[92:95], a[96:99], a[140:143], v[92:95]
    s_waitcnt vmcnt(20)
    v_mfma_f32_16x16x32_bf16 v[96:99], a[100:103], a[128:131], v[96:99]
    s_mov_b32 s34, 110592
    v_mfma_f32_16x16x32_bf16 v[100:103], a[100:103], a[132:135], v[100:103]
    buffer_load_dwordx4 a[96:99], v2, s[20:23], s34 offen offset:0
    v_mfma_f32_16x16x32_bf16 v[104:107], a[100:103], a[136:139], v[104:107]
    ds_read_b128 a[164:167], v16 offset:26624
    v_mfma_f32_16x16x32_bf16 v[108:111], a[100:103], a[140:143], v[108:111]
    v_add_f32 v145, 1.0, v145
    v_mfma_f32_16x16x32_bf16 v[112:115], a[104:107], a[128:131], v[112:115]
    buffer_load_dwordx4 a[100:103], v2, s[20:23], s34 offen offset:1024
    v_mfma_f32_16x16x32_bf16 v[116:119], a[104:107], a[132:135], v[116:119]
    v_add_f32 v146, 1.0, v146
    v_mfma_f32_16x16x32_bf16 v[120:123], a[104:107], a[136:139], v[120:123]
    v_mfma_f32_16x16x32_bf16 v[124:127], a[104:107], a[140:143], v[124:127]
    v_mfma_f32_16x16x32_bf16 v[128:131], a[108:111], a[128:131], v[128:131]
    buffer_load_dwordx4 a[104:107], v2, s[20:23], s34 offen offset:2048
    v_mfma_f32_16x16x32_bf16 v[132:135], a[108:111], a[132:135], v[132:135]
    v_add_f32 v147, 1.0, v147
    v_mfma_f32_16x16x32_bf16 v[136:139], a[108:111], a[136:139], v[136:139]
    v_mfma_f32_16x16x32_bf16 v[140:143], a[108:111], a[140:143], v[140:143]
    s_waitcnt lgkmcnt(2)
    v_mfma_f32_16x16x32_bf16 v[240:243], a[0:3], a[112:115], v[240:243]
    buffer_load_dwordx4 a[108:111], v2, s[20:23], s34 offen offset:3072
    v_mfma_f32_16x16x32_bf16 v[244:247], a[0:3], a[116:119], v[244:247]
    ds_read_b128 a[128:131], v46 offset:1536
    ds_read_b128 a[132:135], v46 offset:28160
    v_mfma_f32_16x16x32_bf16 v[248:251], a[0:3], a[120:123], v[248:251]
    ds_read_b128 a[136:139], v47 offset:1536
    ds_read_b128 a[140:143], v47 offset:28160
    v_mfma_f32_16x16x32_bf16 v[252:255], a[0:3], a[124:127], v[252:255]
    ds_read_b128 a[168:171], v17 offset:0
    v_mfma_f32_16x16x32_bf16 v[48:51], a[4:7], a[112:115], v[48:51]
    s_mov_b32 s34, 114688
    v_add_f32 v172, 1.0, v160
    v_mfma_f32_16x16x32_bf16 v[52:55], a[4:7], a[116:119], v[52:55]
    buffer_load_dwordx4 a[0:3], v2, s[20:23], s34 offen offset:0
    v_mfma_f32_16x16x32_bf16 v[56:59], a[4:7], a[120:123], v[56:59]
    v_add_f32 v173, 1.0, v161
    v_mfma_f32_16x16x32_bf16 v[60:63], a[4:7], a[124:127], v[60:63]
    v_add_f32 v174, 1.0, v162
    v_mfma_f32_16x16x32_bf16 v[64:67], a[8:11], a[112:115], v[64:67]
    buffer_load_dwordx4 a[4:7], v2, s[20:23], s34 offen offset:1024
    v_mfma_f32_16x16x32_bf16 v[68:71], a[8:11], a[116:119], v[68:71]
    v_mfma_f32_16x16x32_bf16 v[72:75], a[8:11], a[120:123], v[72:75]
    v_add_f32 v175, 1.0, v163
    v_mfma_f32_16x16x32_bf16 v[76:79], a[8:11], a[124:127], v[76:79]
    v_mfma_f32_16x16x32_bf16 v[80:83], a[12:15], a[112:115], v[80:83]
    buffer_load_dwordx4 a[8:11], v2, s[20:23], s34 offen offset:2048
    v_mfma_f32_16x16x32_bf16 v[84:87], a[12:15], a[116:119], v[84:87]
    v_mfma_f32_16x16x32_bf16 v[88:91], a[12:15], a[120:123], v[88:91]
    v_add_f32 v168, 1.0, v160
    v_mfma_f32_16x16x32_bf16 v[92:95], a[12:15], a[124:127], v[92:95]
    ds_read_b128 a[172:175], v17 offset:26624
    s_waitcnt vmcnt(20)
    v_mfma_f32_16x16x32_bf16 v[96:99], a[16:19], a[112:115], v[96:99]
    buffer_load_dwordx4 a[12:15], v2, s[20:23], s34 offen offset:3072
    v_mfma_f32_16x16x32_bf16 v[100:103], a[16:19], a[116:119], v[100:103]
    v_add_f32 v169, 1.0, v161
    v_mfma_f32_16x16x32_bf16 v[104:107], a[16:19], a[120:123], v[104:107]
    v_mfma_f32_16x16x32_bf16 v[108:111], a[16:19], a[124:127], v[108:111]
    v_mfma_f32_16x16x32_bf16 v[112:115], a[20:23], a[112:115], v[112:115]
    s_mov_b32 s34, 118784
    v_mfma_f32_16x16x32_bf16 v[116:119], a[20:23], a[116:119], v[116:119]
    buffer_load_dwordx4 a[16:19], v2, s[20:23], s34 offen offset:0
    v_mfma_f32_16x16x32_bf16 v[120:123], a[20:23], a[120:123], v[120:123]
    v_add_f32 v170, 1.0, v162
    v_mfma_f32_16x16x32_bf16 v[124:127], a[20:23], a[124:127], v[124:127]
    v_mfma_f32_16x16x32_bf16 v[128:131], a[24:27], a[112:115], v[128:131]
    buffer_load_dwordx4 a[20:23], v2, s[20:23], s34 offen offset:1024
    v_mfma_f32_16x16x32_bf16 v[132:135], a[24:27], a[116:119], v[132:135]
    v_add_f32 v171, 1.0, v163
    v_mfma_f32_16x16x32_bf16 v[136:139], a[24:27], a[120:123], v[136:139]
    v_mfma_f32_16x16x32_bf16 v[140:143], a[24:27], a[124:127], v[140:143]
    ds_read_b128 a[176:179], v14 offset:128
    s_waitcnt lgkmcnt(3)
    v_mfma_f32_16x16x32_bf16 v[240:243], a[28:31], a[128:131], v[240:243]
    buffer_load_dwordx4 a[24:27], v2, s[20:23], s34 offen offset:2048
    v_mfma_f32_16x16x32_bf16 v[244:247], a[28:31], a[132:135], v[244:247]
    ds_read_b128 a[112:115], v46 offset:128
    ds_read_b128 a[116:119], v46 offset:26752
    v_mfma_f32_16x16x32_bf16 v[248:251], a[28:31], a[136:139], v[248:251]
    ds_read_b128 a[120:123], v47 offset:128
    ds_read_b128 a[124:127], v47 offset:26752
    v_mfma_f32_16x16x32_bf16 v[252:255], a[28:31], a[140:143], v[252:255]
    v_add_f32 v164, 1.0, v160
    v_add_f32 v165, 1.0, v161
    v_mfma_f32_16x16x32_bf16 v[48:51], a[32:35], a[128:131], v[48:51]
    buffer_load_dwordx4 a[28:31], v2, s[20:23], s34 offen offset:3072
    v_mfma_f32_16x16x32_bf16 v[52:55], a[32:35], a[132:135], v[52:55]
    v_mfma_f32_16x16x32_bf16 v[56:59], a[32:35], a[136:139], v[56:59]
    v_mfma_f32_16x16x32_bf16 v[60:63], a[32:35], a[140:143], v[60:63]
    v_add_f32 v166, 1.0, v162
    v_mfma_f32_16x16x32_bf16 v[64:67], a[36:39], a[128:131], v[64:67]
    s_mov_b32 s34, 122880
    v_mfma_f32_16x16x32_bf16 v[68:71], a[36:39], a[132:135], v[68:71]
    buffer_load_dwordx4 a[32:35], v2, s[20:23], s34 offen offset:0
    v_mfma_f32_16x16x32_bf16 v[72:75], a[36:39], a[136:139], v[72:75]
    v_add_f32 v167, 1.0, v163
    v_mfma_f32_16x16x32_bf16 v[76:79], a[36:39], a[140:143], v[76:79]
    ds_read_b128 a[180:183], v14 offset:26752
    v_mfma_f32_16x16x32_bf16 v[80:83], a[40:43], a[128:131], v[80:83]
    buffer_load_dwordx4 a[36:39], v2, s[20:23], s34 offen offset:1024
    v_mfma_f32_16x16x32_bf16 v[84:87], a[40:43], a[132:135], v[84:87]
    v_mfma_f32_16x16x32_bf16 v[88:91], a[40:43], a[136:139], v[88:91]
    v_add_f32 v160, 1.0, v160
    v_mfma_f32_16x16x32_bf16 v[92:95], a[40:43], a[140:143], v[92:95]
    s_waitcnt vmcnt(20)
    v_mfma_f32_16x16x32_bf16 v[96:99], a[44:47], a[128:131], v[96:99]
    buffer_load_dwordx4 a[40:43], v2, s[20:23], s34 offen offset:2048
    v_mfma_f32_16x16x32_bf16 v[100:103], a[44:47], a[132:135], v[100:103]
    v_add_f32 v161, 1.0, v161
    v_mfma_f32_16x16x32_bf16 v[104:107], a[44:47], a[136:139], v[104:107]
    v_mfma_f32_16x16x32_bf16 v[108:111], a[44:47], a[140:143], v[108:111]
    v_mfma_f32_16x16x32_bf16 v[112:115], a[48:51], a[128:131], v[112:115]
    buffer_load_dwordx4 a[44:47], v2, s[20:23], s34 offen offset:3072
    v_mfma_f32_16x16x32_bf16 v[116:119], a[48:51], a[132:135], v[116:119]
    v_add_f32 v162, 1.0, v162
    v_mfma_f32_16x16x32_bf16 v[120:123], a[48:51], a[136:139], v[120:123]
    v_mfma_f32_16x16x32_bf16 v[124:127], a[48:51], a[140:143], v[124:127]
    ds_read_b128 a[184:187], v15 offset:128
    v_mfma_f32_16x16x32_bf16 v[128:131], a[52:55], a[128:131], v[128:131]
    s_mov_b32 s34, 126976
    v_add_f32 v163, 1.0, v163
    v_mfma_f32_16x16x32_bf16 v[132:135], a[52:55], a[132:135], v[132:135]
    buffer_load_dwordx4 a[48:51], v2, s[20:23], s34 offen offset:0
    v_mfma_f32_16x16x32_bf16 v[136:139], a[52:55], a[136:139], v[136:139]
    v_mfma_f32_16x16x32_bf16 v[140:143], a[52:55], a[140:143], v[140:143]
    s_waitcnt lgkmcnt(2)
    v_mfma_f32_16x16x32_bf16 v[240:243], a[56:59], a[112:115], v[240:243]
    buffer_load_dwordx4 a[52:55], v2, s[20:23], s34 offen offset:1024
    v_mfma_f32_16x16x32_bf16 v[244:247], a[56:59], a[116:119], v[244:247]
    ds_read_b128 a[128:131], v0 offset:256
    ds_read_b128 a[132:135], v0 offset:26880
    v_mfma_f32_16x16x32_bf16 v[248:251], a[56:59], a[120:123], v[248:251]
    ds_read_b128 a[136:139], v1 offset:256
    ds_read_b128 a[140:143], v1 offset:26880
    v_mfma_f32_16x16x32_bf16 v[252:255], a[56:59], a[124:127], v[252:255]
    v_add_f32 v188, 1.0, v176
    v_add_f32 v189, 1.0, v177
    v_mfma_f32_16x16x32_bf16 v[48:51], a[60:63], a[112:115], v[48:51]
    buffer_load_dwordx4 a[56:59], v2, s[20:23], s34 offen offset:2048
    v_mfma_f32_16x16x32_bf16 v[52:55], a[60:63], a[116:119], v[52:55]
    v_mfma_f32_16x16x32_bf16 v[56:59], a[60:63], a[120:123], v[56:59]
    v_mfma_f32_16x16x32_bf16 v[60:63], a[60:63], a[124:127], v[60:63]
    v_add_f32 v190, 1.0, v178
    v_mfma_f32_16x16x32_bf16 v[64:67], a[64:67], a[112:115], v[64:67]
    buffer_load_dwordx4 a[60:63], v2, s[20:23], s34 offen offset:3072
    v_mfma_f32_16x16x32_bf16 v[68:71], a[64:67], a[116:119], v[68:71]
    ds_read_b128 a[188:191], v15 offset:26752
    v_mfma_f32_16x16x32_bf16 v[72:75], a[64:67], a[120:123], v[72:75]
    v_add_f32 v191, 1.0, v179
    v_mfma_f32_16x16x32_bf16 v[76:79], a[64:67], a[124:127], v[76:79]
    v_mfma_f32_16x16x32_bf16 v[80:83], a[68:71], a[112:115], v[80:83]
    s_mov_b32 s34, 131072
    v_mfma_f32_16x16x32_bf16 v[84:87], a[68:71], a[116:119], v[84:87]
    buffer_load_dwordx4 a[64:67], v2, s[20:23], s34 offen offset:0
    v_mfma_f32_16x16x32_bf16 v[88:91], a[68:71], a[120:123], v[88:91]
    v_add_f32 v184, 1.0, v176
    v_mfma_f32_16x16x32_bf16 v[92:95], a[68:71], a[124:127], v[92:95]
    s_waitcnt vmcnt(20)
    v_mfma_f32_16x16x32_bf16 v[96:99], a[72:75], a[112:115], v[96:99]
    buffer_load_dwordx4 a[68:71], v2, s[20:23], s34 offen offset:1024
    v_mfma_f32_16x16x32_bf16 v[100:103], a[72:75], a[116:119], v[100:103]
    v_add_f32 v185, 1.0, v177
    v_mfma_f32_16x16x32_bf16 v[104:107], a[72:75], a[120:123], v[104:107]
    v_mfma_f32_16x16x32_bf16 v[108:111], a[72:75], a[124:127], v[108:111]
    v_mfma_f32_16x16x32_bf16 v[112:115], a[76:79], a[112:115], v[112:115]
    buffer_load_dwordx4 a[72:75], v2, s[20:23], s34 offen offset:2048
    v_mfma_f32_16x16x32_bf16 v[116:119], a[76:79], a[116:119], v[116:119]
    ds_read_b128 a[192:195], v16 offset:128
    v_mfma_f32_16x16x32_bf16 v[120:123], a[76:79], a[120:123], v[120:123]
    v_add_f32 v186, 1.0, v178
    v_mfma_f32_16x16x32_bf16 v[124:127], a[76:79], a[124:127], v[124:127]
    v_mfma_f32_16x16x32_bf16 v[128:131], a[80:83], a[112:115], v[128:131]
    buffer_load_dwordx4 a[76:79], v2, s[20:23], s34 offen offset:3072
    v_mfma_f32_16x16x32_bf16 v[132:135], a[80:83], a[116:119], v[132:135]
    v_add_f32 v187, 1.0, v179
    v_mfma_f32_16x16x32_bf16 v[136:139], a[80:83], a[120:123], v[136:139]
    v_mfma_f32_16x16x32_bf16 v[140:143], a[80:83], a[124:127], v[140:143]
    s_waitcnt lgkmcnt(2)
    v_mfma_f32_16x16x32_bf16 v[240:243], a[84:87], a[128:131], v[240:243]
    s_mov_b32 s34, 135168
    v_add_f32 v180, 1.0, v176
    v_mfma_f32_16x16x32_bf16 v[244:247], a[84:87], a[132:135], v[244:247]
    ds_read_b128 a[112:115], v46 offset:256
    ds_read_b128 a[116:119], v46 offset:26880
    v_mfma_f32_16x16x32_bf16 v[248:251], a[84:87], a[136:139], v[248:251]
    ds_read_b128 a[120:123], v47 offset:256
    ds_read_b128 a[124:127], v47 offset:26880
    v_mfma_f32_16x16x32_bf16 v[252:255], a[84:87], a[140:143], v[252:255]
    buffer_load_dwordx4 a[80:83], v2, s[20:23], s34 offen offset:0
    v_mfma_f32_16x16x32_bf16 v[48:51], a[88:91], a[128:131], v[48:51]
    buffer_load_dwordx4 a[84:87], v2, s[20:23], s34 offen offset:1024
    v_mfma_f32_16x16x32_bf16 v[52:55], a[88:91], a[132:135], v[52:55]
    ds_read_b128 a[196:199], v16 offset:26752
    v_mfma_f32_16x16x32_bf16 v[56:59], a[88:91], a[136:139], v[56:59]
    v_add_f32 v181, 1.0, v177
    v_mfma_f32_16x16x32_bf16 v[60:63], a[88:91], a[140:143], v[60:63]
    v_add_f32 v182, 1.0, v178
    v_mfma_f32_16x16x32_bf16 v[64:67], a[92:95], a[128:131], v[64:67]
    buffer_load_dwordx4 a[88:91], v2, s[20:23], s34 offen offset:2048
    v_mfma_f32_16x16x32_bf16 v[68:71], a[92:95], a[132:135], v[68:71]
    v_mfma_f32_16x16x32_bf16 v[72:75], a[92:95], a[136:139], v[72:75]
    v_add_f32 v183, 1.0, v179
    v_mfma_f32_16x16x32_bf16 v[76:79], a[92:95], a[140:143], v[76:79]
    v_mfma_f32_16x16x32_bf16 v[80:83], a[96:99], a[128:131], v[80:83]
    buffer_load_dwordx4 a[92:95], v2, s[20:23], s34 offen offset:3072
    v_mfma_f32_16x16x32_bf16 v[84:87], a[96:99], a[132:135], v[84:87]
    v_mfma_f32_16x16x32_bf16 v[88:91], a[96:99], a[136:139], v[88:91]
    v_add_f32 v176, 1.0, v176
    v_mfma_f32_16x16x32_bf16 v[92:95], a[96:99], a[140:143], v[92:95]
    s_waitcnt vmcnt(20)
    v_mfma_f32_16x16x32_bf16 v[96:99], a[100:103], a[128:131], v[96:99]
    s_mov_b32 s34, 139264
    v_mfma_f32_16x16x32_bf16 v[100:103], a[100:103], a[132:135], v[100:103]
    buffer_load_dwordx4 a[96:99], v2, s[20:23], s34 offen offset:0
    v_mfma_f32_16x16x32_bf16 v[104:107], a[100:103], a[136:139], v[104:107]
    ds_read_b128 a[200:203], v17 offset:128
    v_mfma_f32_16x16x32_bf16 v[108:111], a[100:103], a[140:143], v[108:111]
    v_add_f32 v177, 1.0, v177
    v_mfma_f32_16x16x32_bf16 v[112:115], a[104:107], a[128:131], v[112:115]
    buffer_load_dwordx4 a[100:103], v2, s[20:23], s34 offen offset:1024
    v_mfma_f32_16x16x32_bf16 v[116:119], a[104:107], a[132:135], v[116:119]
    v_add_f32 v178, 1.0, v178
    v_mfma_f32_16x16x32_bf16 v[120:123], a[104:107], a[136:139], v[120:123]
    v_mfma_f32_16x16x32_bf16 v[124:127], a[104:107], a[140:143], v[124:127]
    v_mfma_f32_16x16x32_bf16 v[128:131], a[108:111], a[128:131], v[128:131]
    buffer_load_dwordx4 a[104:107], v2, s[20:23], s34 offen offset:2048
    v_mfma_f32_16x16x32_bf16 v[132:135], a[108:111], a[132:135], v[132:135]
    v_add_f32 v179, 1.0, v179
    v_mfma_f32_16x16x32_bf16 v[136:139], a[108:111], a[136:139], v[136:139]
    v_mfma_f32_16x16x32_bf16 v[140:143], a[108:111], a[140:143], v[140:143]
    s_waitcnt lgkmcnt(2)
    v_mfma_f32_16x16x32_bf16 v[240:243], a[0:3], a[112:115], v[240:243]
    buffer_load_dwordx4 a[108:111], v2, s[20:23], s34 offen offset:3072
    v_mfma_f32_16x16x32_bf16 v[244:247], a[0:3], a[116:119], v[244:247]
    ds_read_b128 a[128:131], v46 offset:512
    ds_read_b128 a[132:135], v46 offset:27136
    v_mfma_f32_16x16x32_bf16 v[248:251], a[0:3], a[120:123], v[248:251]
    ds_read_b128 a[136:139], v47 offset:512
    ds_read_b128 a[140:143], v47 offset:27136
    v_mfma_f32_16x16x32_bf16 v[252:255], a[0:3], a[124:127], v[252:255]
    ds_read_b128 a[204:207], v17 offset:26752
    v_mfma_f32_16x16x32_bf16 v[48:51], a[4:7], a[112:115], v[48:51]
    s_mov_b32 s34, 143360
    v_add_f32 v204, 1.0, v192
    v_mfma_f32_16x16x32_bf16 v[52:55], a[4:7], a[116:119], v[52:55]
    buffer_load_dwordx4 a[0:3], v2, s[20:23], s34 offen offset:0
    v_mfma_f32_16x16x32_bf16 v[56:59], a[4:7], a[120:123], v[56:59]
    v_add_f32 v205, 1.0, v193
    v_mfma_f32_16x16x32_bf16 v[60:63], a[4:7], a[124:127], v[60:63]
    v_add_f32 v206, 1.0, v194
    v_mfma_f32_16x16x32_bf16 v[64:67], a[8:11], a[112:115], v[64:67]
    buffer_load_dwordx4 a[4:7], v2, s[20:23], s34 offen offset:1024
    v_mfma_f32_16x16x32_bf16 v[68:71], a[8:11], a[116:119], v[68:71]
    v_mfma_f32_16x16x32_bf16 v[72:75], a[8:11], a[120:123], v[72:75]
    v_add_f32 v207, 1.0, v195
    v_mfma_f32_16x16x32_bf16 v[76:79], a[8:11], a[124:127], v[76:79]
    v_mfma_f32_16x16x32_bf16 v[80:83], a[12:15], a[112:115], v[80:83]
    buffer_load_dwordx4 a[8:11], v2, s[20:23], s34 offen offset:2048
    v_mfma_f32_16x16x32_bf16 v[84:87], a[12:15], a[116:119], v[84:87]
    ds_read_b128 a[208:211], v14 offset:256
    v_mfma_f32_16x16x32_bf16 v[88:91], a[12:15], a[120:123], v[88:91]
    v_add_f32 v200, 1.0, v192
    v_mfma_f32_16x16x32_bf16 v[92:95], a[12:15], a[124:127], v[92:95]
    s_waitcnt vmcnt(20)
    v_mfma_f32_16x16x32_bf16 v[96:99], a[16:19], a[112:115], v[96:99]
    buffer_load_dwordx4 a[12:15], v2, s[20:23], s34 offen offset:3072
    v_mfma_f32_16x16x32_bf16 v[100:103], a[16:19], a[116:119], v[100:103]
    v_add_f32 v201, 1.0, v193
    v_mfma_f32_16x16x32_bf16 v[104:107], a[16:19], a[120:123], v[104:107]
    v_mfma_f32_16x16x32_bf16 v[108:111], a[16:19], a[124:127], v[108:111]
    v_mfma_f32_16x16x32_bf16 v[112:115], a[20:23], a[112:115], v[112:115]
    s_mov_b32 s34, 147456
    v_mfma_f32_16x16x32_bf16 v[116:119], a[20:23], a[116:119], v[116:119]
    buffer_load_dwordx4 a[16:19], v2, s[20:23], s34 offen offset:0
    v_mfma_f32_16x16x32_bf16 v[120:123], a[20:23], a[120:123], v[120:123]
    v_add_f32 v202, 1.0, v194
    v_mfma_f32_16x16x32_bf16 v[124:127], a[20:23], a[124:127], v[124:127]
    v_mfma_f32_16x16x32_bf16 v[128:131], a[24:27], a[112:115], v[128:131]
    buffer_load_dwordx4 a[20:23], v2, s[20:23], s34 offen offset:1024
    v_mfma_f32_16x16x32_bf16 v[132:135], a[24:27], a[116:119], v[132:135]
    ds_read_b128 a[212:215], v14 offset:26880
    v_mfma_f32_16x16x32_bf16 v[136:139], a[24:27], a[120:123], v[136:139]
    v_add_f32 v203, 1.0, v195
    v_mfma_f32_16x16x32_bf16 v[140:143], a[24:27], a[124:127], v[140:143]
    s_waitcnt lgkmcnt(3)
    v_mfma_f32_16x16x32_bf16 v[240:243], a[28:31], a[128:131], v[240:243]
    buffer_load_dwordx4 a[24:27], v2, s[20:23], s34 offen offset:2048
    v_mfma_f32_16x16x32_bf16 v[244:247], a[28:31], a[132:135], v[244:247]
    ds_read_b128 a[112:115], v0 offset:640
    ds_read_b128 a[116:119], v0 offset:27264
    v_mfma_f32_16x16x32_bf16 v[248:251], a[28:31], a[136:139], v[248:251]
    ds_read_b128 a[120:123], v1 offset:640
    ds_read_b128 a[124:127], v1 offset:27264
    v_mfma_f32_16x16x32_bf16 v[252:255], a[28:31], a[140:143], v[252:255]
    v_add_f32 v196, 1.0, v192
    v_add_f32 v197, 1.0, v193
    v_mfma_f32_16x16x32_bf16 v[48:51], a[32:35], a[128:131], v[48:51]
    buffer_load_dwordx4 a[28:31], v2, s[20:23], s34 offen offset:3072
    v_mfma_f32_16x16x32_bf16 v[52:55], a[32:35], a[132:135], v[52:55]
    v_mfma_f32_16x16x32_bf16 v[56:59], a[32:35], a[136:139], v[56:59]
    v_mfma_f32_16x16x32_bf16 v[60:63], a[32:35], a[140:143], v[60:63]
    v_add_f32 v198, 1.0, v194
    v_mfma_f32_16x16x32_bf16 v[64:67], a[36:39], a[128:131], v[64:67]
    s_mov_b32 s34, 151552
    v_mfma_f32_16x16x32_bf16 v[68:71], a[36:39], a[132:135], v[68:71]
    buffer_load_dwordx4 a[32:35], v2, s[20:23], s34 offen offset:0
    v_mfma_f32_16x16x32_bf16 v[72:75], a[36:39], a[136:139], v[72:75]
    ds_read_b128 a[216:219], v15 offset:256
    v_mfma_f32_16x16x32_bf16 v[76:79], a[36:39], a[140:143], v[76:79]
    v_add_f32 v199, 1.0, v195
    v_mfma_f32_16x16x32_bf16 v[80:83], a[40:43], a[128:131], v[80:83]
    buffer_load_dwordx4 a[36:39], v2, s[20:23], s34 offen offset:1024
    v_mfma_f32_16x16x32_bf16 v[84:87], a[40:43], a[132:135], v[84:87]
    v_mfma_f32_16x16x32_bf16 v[88:91], a[40:43], a[136:139], v[88:91]
    v_add_f32 v192, 1.0, v192
    v_mfma_f32_16x16x32_bf16 v[92:95], a[40:43], a[140:143], v[92:95]
    s_waitcnt vmcnt(20)
    v_mfma_f32_16x16x32_bf16 v[96:99], a[44:47], a[128:131], v[96:99]
    buffer_load_dwordx4 a[40:43], v2, s[20:23], s34 offen offset:2048
    v_mfma_f32_16x16x32_bf16 v[100:103], a[44:47], a[132:135], v[100:103]
    v_add_f32 v193, 1.0, v193
    v_mfma_f32_16x16x32_bf16 v[104:107], a[44:47], a[136:139], v[104:107]
    v_mfma_f32_16x16x32_bf16 v[108:111], a[44:47], a[140:143], v[108:111]
    v_mfma_f32_16x16x32_bf16 v[112:115], a[48:51], a[128:131], v[112:115]
    buffer_load_dwordx4 a[44:47], v2, s[20:23], s34 offen offset:3072
    v_mfma_f32_16x16x32_bf16 v[116:119], a[48:51], a[132:135], v[116:119]
    v_add_f32 v194, 1.0, v194
    v_mfma_f32_16x16x32_bf16 v[120:123], a[48:51], a[136:139], v[120:123]
    ds_read_b128 a[220:223], v15 offset:26880
    v_mfma_f32_16x16x32_bf16 v[124:127], a[48:51], a[140:143], v[124:127]
    v_mfma_f32_16x16x32_bf16 v[128:131], a[52:55], a[128:131], v[128:131]
    s_mov_b32 s34, 155648
    v_add_f32 v195, 1.0, v195
    v_mfma_f32_16x16x32_bf16 v[132:135], a[52:55], a[132:135], v[132:135]
    buffer_load_dwordx4 a[48:51], v2, s[20:23], s34 offen offset:0
    v_mfma_f32_16x16x32_bf16 v[136:139], a[52:55], a[136:139], v[136:139]
    v_mfma_f32_16x16x32_bf16 v[140:143], a[52:55], a[140:143], v[140:143]
    s_waitcnt lgkmcnt(2)
    v_mfma_f32_16x16x32_bf16 v[240:243], a[56:59], a[112:115], v[240:243]
    buffer_load_dwordx4 a[52:55], v2, s[20:23], s34 offen offset:1024
    v_mfma_f32_16x16x32_bf16 v[244:247], a[56:59], a[116:119], v[244:247]
    ds_read_b128 a[128:131], v46 offset:640
    ds_read_b128 a[132:135], v46 offset:27264
    v_mfma_f32_16x16x32_bf16 v[248:251], a[56:59], a[120:123], v[248:251]
    ds_read_b128 a[136:139], v47 offset:640
    ds_read_b128 a[140:143], v47 offset:27264
    v_mfma_f32_16x16x32_bf16 v[252:255], a[56:59], a[124:127], v[252:255]
    v_add_f32 v220, 1.0, v208
    v_add_f32 v221, 1.0, v209
    v_mfma_f32_16x16x32_bf16 v[48:51], a[60:63], a[112:115], v[48:51]
    buffer_load_dwordx4 a[56:59], v2, s[20:23], s34 offen offset:2048
    v_mfma_f32_16x16x32_bf16 v[52:55], a[60:63], a[116:119], v[52:55]
    v_mfma_f32_16x16x32_bf16 v[56:59], a[60:63], a[120:123], v[56:59]
    ds_read_b128 a[224:227], v16 offset:256
    v_mfma_f32_16x16x32_bf16 v[60:63], a[60:63], a[124:127], v[60:63]
    v_add_f32 v222, 1.0, v210
    v_mfma_f32_16x16x32_bf16 v[64:67], a[64:67], a[112:115], v[64:67]
    buffer_load_dwordx4 a[60:63], v2, s[20:23], s34 offen offset:3072
    v_mfma_f32_16x16x32_bf16 v[68:71], a[64:67], a[116:119], v[68:71]
    v_mfma_f32_16x16x32_bf16 v[72:75], a[64:67], a[120:123], v[72:75]
    v_add_f32 v223, 1.0, v211
    v_mfma_f32_16x16x32_bf16 v[76:79], a[64:67], a[124:127], v[76:79]
    v_mfma_f32_16x16x32_bf16 v[80:83], a[68:71], a[112:115], v[80:83]
    s_mov_b32 s34, 159744
    v_mfma_f32_16x16x32_bf16 v[84:87], a[68:71], a[116:119], v[84:87]
    buffer_load_dwordx4 a[64:67], v2, s[20:23], s34 offen offset:0
    v_mfma_f32_16x16x32_bf16 v[88:91], a[68:71], a[120:123], v[88:91]
    v_add_f32 v216, 1.0, v208
    v_mfma_f32_16x16x32_bf16 v[92:95], a[68:71], a[124:127], v[92:95]
    s_waitcnt vmcnt(20)
    v_mfma_f32_16x16x32_bf16 v[96:99], a[72:75], a[112:115], v[96:99]
    buffer_load_dwordx4 a[68:71], v2, s[20:23], s34 offen offset:1024
    v_mfma_f32_16x16x32_bf16 v[100:103], a[72:75], a[116:119], v[100:103]
    v_add_f32 v217, 1.0, v209
    v_mfma_f32_16x16x32_bf16 v[104:107], a[72:75], a[120:123], v[104:107]
    v_mfma_f32_16x16x32_bf16 v[108:111], a[72:75], a[124:127], v[108:111]
    ds_read_b128 a[228:231], v16 offset:26880
    v_mfma_f32_16x16x32_bf16 v[112:115], a[76:79], a[112:115], v[112:115]
    buffer_load_dwordx4 a[72:75], v2, s[20:23], s34 offen offset:2048
    v_mfma_f32_16x16x32_bf16 v[116:119], a[76:79], a[116:119], v[116:119]
    v_add_f32 v218, 1.0, v210
    v_mfma_f32_16x16x32_bf16 v[120:123], a[76:79], a[120:123], v[120:123]
    v_mfma_f32_16x16x32_bf16 v[124:127], a[76:79], a[124:127], v[124:127]
    v_mfma_f32_16x16x32_bf16 v[128:131], a[80:83], a[112:115], v[128:131]
    buffer_load_dwordx4 a[76:79], v2, s[20:23], s34 offen offset:3072
    v_mfma_f32_16x16x32_bf16 v[132:135], a[80:83], a[116:119], v[132:135]
    v_add_f32 v219, 1.0, v211
    v_mfma_f32_16x16x32_bf16 v[136:139], a[80:83], a[120:123], v[136:139]
    v_mfma_f32_16x16x32_bf16 v[140:143], a[80:83], a[124:127], v[140:143]
    s_waitcnt lgkmcnt(2)
    v_mfma_f32_16x16x32_bf16 v[240:243], a[84:87], a[128:131], v[240:243]
    s_mov_b32 s34, 163840
    v_add_f32 v212, 1.0, v208
    v_mfma_f32_16x16x32_bf16 v[244:247], a[84:87], a[132:135], v[244:247]
    ds_read_b128 a[112:115], v46 offset:896
    ds_read_b128 a[116:119], v46 offset:27520
    v_mfma_f32_16x16x32_bf16 v[248:251], a[84:87], a[136:139], v[248:251]
    ds_read_b128 a[120:123], v47 offset:896
    ds_read_b128 a[124:127], v47 offset:27520
    v_mfma_f32_16x16x32_bf16 v[252:255], a[84:87], a[140:143], v[252:255]
    buffer_load_dwordx4 a[80:83], v2, s[20:23], s34 offen offset:0
    v_mfma_f32_16x16x32_bf16 v[48:51], a[88:91], a[128:131], v[48:51]
    buffer_load_dwordx4 a[84:87], v2, s[20:23], s34 offen offset:1024
    v_mfma_f32_16x16x32_bf16 v[52:55], a[88:91], a[132:135], v[52:55]
    ds_read_b128 a[232:235], v17 offset:256
    v_mfma_f32_16x16x32_bf16 v[56:59], a[88:91], a[136:139], v[56:59]
    v_add_f32 v213, 1.0, v209
    v_mfma_f32_16x16x32_bf16 v[60:63], a[88:91], a[140:143], v[60:63]
    v_add_f32 v214, 1.0, v210
    v_mfma_f32_16x16x32_bf16 v[64:67], a[92:95], a[128:131], v[64:67]
    buffer_load_dwordx4 a[88:91], v2, s[20:23], s34 offen offset:2048
    v_mfma_f32_16x16x32_bf16 v[68:71], a[92:95], a[132:135], v[68:71]
    v_mfma_f32_16x16x32_bf16 v[72:75], a[92:95], a[136:139], v[72:75]
    v_add_f32 v215, 1.0, v211
    v_mfma_f32_16x16x32_bf16 v[76:79], a[92:95], a[140:143], v[76:79]
    v_mfma_f32_16x16x32_bf16 v[80:83], a[96:99], a[128:131], v[80:83]
    buffer_load_dwordx4 a[92:95], v2, s[20:23], s34 offen offset:3072
    v_mfma_f32_16x16x32_bf16 v[84:87], a[96:99], a[132:135], v[84:87]
    v_mfma_f32_16x16x32_bf16 v[88:91], a[96:99], a[136:139], v[88:91]
    v_add_f32 v208, 1.0, v208
    v_mfma_f32_16x16x32_bf16 v[92:95], a[96:99], a[140:143], v[92:95]
    ds_read_b128 a[236:239], v17 offset:26880
    s_waitcnt vmcnt(20)
    v_mfma_f32_16x16x32_bf16 v[96:99], a[100:103], a[128:131], v[96:99]
    s_mov_b32 s34, 167936
    v_mfma_f32_16x16x32_bf16 v[100:103], a[100:103], a[132:135], v[100:103]
    buffer_load_dwordx4 a[96:99], v2, s[20:23], s34 offen offset:0
    v_mfma_f32_16x16x32_bf16 v[104:107], a[100:103], a[136:139], v[104:107]
    v_add_f32 v209, 1.0, v209
    v_mfma_f32_16x16x32_bf16 v[108:111], a[100:103], a[140:143], v[108:111]
    v_mfma_f32_16x16x32_bf16 v[112:115], a[104:107], a[128:131], v[112:115]
    buffer_load_dwordx4 a[100:103], v2, s[20:23], s34 offen offset:1024
    v_mfma_f32_16x16x32_bf16 v[116:119], a[104:107], a[132:135], v[116:119]
    v_add_f32 v210, 1.0, v210
    v_mfma_f32_16x16x32_bf16 v[120:123], a[104:107], a[136:139], v[120:123]
    v_mfma_f32_16x16x32_bf16 v[124:127], a[104:107], a[140:143], v[124:127]
    v_mfma_f32_16x16x32_bf16 v[128:131], a[108:111], a[128:131], v[128:131]
    buffer_load_dwordx4 a[104:107], v2, s[20:23], s34 offen offset:2048
    v_mfma_f32_16x16x32_bf16 v[132:135], a[108:111], a[132:135], v[132:135]
    v_add_f32 v211, 1.0, v211
    v_mfma_f32_16x16x32_bf16 v[136:139], a[108:111], a[136:139], v[136:139]
    v_mfma_f32_16x16x32_bf16 v[140:143], a[108:111], a[140:143], v[140:143]
    s_waitcnt lgkmcnt(2)
    v_mfma_f32_16x16x32_bf16 v[240:243], a[0:3], a[112:115], v[240:243]
    buffer_load_dwordx4 a[108:111], v2, s[20:23], s34 offen offset:3072
    v_mfma_f32_16x16x32_bf16 v[244:247], a[0:3], a[116:119], v[244:247]
    ds_read_b128 a[128:131], v0 offset:1024
    ds_read_b128 a[132:135], v0 offset:27648
    v_mfma_f32_16x16x32_bf16 v[248:251], a[0:3], a[120:123], v[248:251]
    ds_read_b128 a[136:139], v1 offset:1024
    ds_read_b128 a[140:143], v1 offset:27648
    v_mfma_f32_16x16x32_bf16 v[252:255], a[0:3], a[124:127], v[252:255]
    v_add_f32 v236, 1.0, v224
    v_add_f32 v237, 1.0, v225
    v_mfma_f32_16x16x32_bf16 v[48:51], a[4:7], a[112:115], v[48:51]
    s_mov_b32 s34, 172032
    v_mfma_f32_16x16x32_bf16 v[52:55], a[4:7], a[116:119], v[52:55]
    buffer_load_dwordx4 a[0:3], v2, s[20:23], s34 offen offset:0
    v_mfma_f32_16x16x32_bf16 v[56:59], a[4:7], a[120:123], v[56:59]
    v_mfma_f32_16x16x32_bf16 v[60:63], a[4:7], a[124:127], v[60:63]
    v_add_f32 v238, 1.0, v226
    v_mfma_f32_16x16x32_bf16 v[64:67], a[8:11], a[112:115], v[64:67]
    buffer_load_dwordx4 a[4:7], v2, s[20:23], s34 offen offset:1024
    v_mfma_f32_16x16x32_bf16 v[68:71], a[8:11], a[116:119], v[68:71]
    v_mfma_f32_16x16x32_bf16 v[72:75], a[8:11], a[120:123], v[72:75]
    v_add_f32 v239, 1.0, v227
    v_mfma_f32_16x16x32_bf16 v[76:79], a[8:11], a[124:127], v[76:79]
    v_mfma_f32_16x16x32_bf16 v[80:83], a[12:15], a[112:115], v[80:83]
    buffer_load_dwordx4 a[8:11], v2, s[20:23], s34 offen offset:2048
    v_mfma_f32_16x16x32_bf16 v[84:87], a[12:15], a[116:119], v[84:87]
    v_mfma_f32_16x16x32_bf16 v[88:91], a[12:15], a[120:123], v[88:91]
    v_add_f32 v232, 1.0, v224
    v_mfma_f32_16x16x32_bf16 v[92:95], a[12:15], a[124:127], v[92:95]
    s_waitcnt vmcnt(20)
    v_mfma_f32_16x16x32_bf16 v[96:99], a[16:19], a[112:115], v[96:99]
    buffer_load_dwordx4 a[12:15], v2, s[20:23], s34 offen offset:3072
    v_mfma_f32_16x16x32_bf16 v[100:103], a[16:19], a[116:119], v[100:103]
    v_add_f32 v233, 1.0, v225
    v_mfma_f32_16x16x32_bf16 v[104:107], a[16:19], a[120:123], v[104:107]
    v_mfma_f32_16x16x32_bf16 v[108:111], a[16:19], a[124:127], v[108:111]
    v_mfma_f32_16x16x32_bf16 v[112:115], a[20:23], a[112:115], v[112:115]
    s_mov_b32 s34, 176128
    v_mfma_f32_16x16x32_bf16 v[116:119], a[20:23], a[116:119], v[116:119]
    buffer_load_dwordx4 a[16:19], v2, s[20:23], s34 offen offset:0
    v_mfma_f32_16x16x32_bf16 v[120:123], a[20:23], a[120:123], v[120:123]
    v_add_f32 v234, 1.0, v226
    v_mfma_f32_16x16x32_bf16 v[124:127], a[20:23], a[124:127], v[124:127]
    v_mfma_f32_16x16x32_bf16 v[128:131], a[24:27], a[112:115], v[128:131]
    buffer_load_dwordx4 a[20:23], v2, s[20:23], s34 offen offset:1024
    v_mfma_f32_16x16x32_bf16 v[132:135], a[24:27], a[116:119], v[132:135]
    v_add_f32 v235, 1.0, v227
    v_mfma_f32_16x16x32_bf16 v[136:139], a[24:27], a[120:123], v[136:139]
    v_mfma_f32_16x16x32_bf16 v[140:143], a[24:27], a[124:127], v[140:143]
    s_waitcnt lgkmcnt(0)
    v_mfma_f32_16x16x32_bf16 v[240:243], a[28:31], a[128:131], v[240:243]
    buffer_load_dwordx4 a[24:27], v2, s[20:23], s34 offen offset:2048
    v_mfma_f32_16x16x32_bf16 v[244:247], a[28:31], a[132:135], v[244:247]
    ds_read_b128 a[112:115], v46 offset:1024
    ds_read_b128 a[116:119], v46 offset:27648
    v_mfma_f32_16x16x32_bf16 v[248:251], a[28:31], a[136:139], v[248:251]
    ds_read_b128 a[120:123], v47 offset:1024
    ds_read_b128 a[124:127], v47 offset:27648
    v_mfma_f32_16x16x32_bf16 v[252:255], a[28:31], a[140:143], v[252:255]
    v_add_f32 v228, 1.0, v224
    v_add_f32 v229, 1.0, v225
    v_mfma_f32_16x16x32_bf16 v[48:51], a[32:35], a[128:131], v[48:51]
    buffer_load_dwordx4 a[28:31], v2, s[20:23], s34 offen offset:3072
    v_mfma_f32_16x16x32_bf16 v[52:55], a[32:35], a[132:135], v[52:55]
    v_mfma_f32_16x16x32_bf16 v[56:59], a[32:35], a[136:139], v[56:59]
    v_mfma_f32_16x16x32_bf16 v[60:63], a[32:35], a[140:143], v[60:63]
    v_add_f32 v230, 1.0, v226
    v_mfma_f32_16x16x32_bf16 v[64:67], a[36:39], a[128:131], v[64:67]
    s_mov_b32 s34, 180224
    v_mfma_f32_16x16x32_bf16 v[68:71], a[36:39], a[132:135], v[68:71]
    buffer_load_dwordx4 a[32:35], v2, s[20:23], s34 offen offset:0
    v_mfma_f32_16x16x32_bf16 v[72:75], a[36:39], a[136:139], v[72:75]
    v_add_f32 v231, 1.0, v227
    v_mfma_f32_16x16x32_bf16 v[76:79], a[36:39], a[140:143], v[76:79]
    v_mfma_f32_16x16x32_bf16 v[80:83], a[40:43], a[128:131], v[80:83]
    buffer_load_dwordx4 a[36:39], v2, s[20:23], s34 offen offset:1024
    v_mfma_f32_16x16x32_bf16 v[84:87], a[40:43], a[132:135], v[84:87]
    v_mfma_f32_16x16x32_bf16 v[88:91], a[40:43], a[136:139], v[88:91]
    v_add_f32 v224, 1.0, v224
    v_mfma_f32_16x16x32_bf16 v[92:95], a[40:43], a[140:143], v[92:95]
    s_waitcnt vmcnt(20)
    v_mfma_f32_16x16x32_bf16 v[96:99], a[44:47], a[128:131], v[96:99]
    buffer_load_dwordx4 a[40:43], v2, s[20:23], s34 offen offset:2048
    v_mfma_f32_16x16x32_bf16 v[100:103], a[44:47], a[132:135], v[100:103]
    v_add_f32 v225, 1.0, v225
    v_mfma_f32_16x16x32_bf16 v[104:107], a[44:47], a[136:139], v[104:107]
    v_mfma_f32_16x16x32_bf16 v[108:111], a[44:47], a[140:143], v[108:111]
    v_mfma_f32_16x16x32_bf16 v[112:115], a[48:51], a[128:131], v[112:115]
    buffer_load_dwordx4 a[44:47], v2, s[20:23], s34 offen offset:3072
    v_mfma_f32_16x16x32_bf16 v[116:119], a[48:51], a[132:135], v[116:119]
    v_add_f32 v226, 1.0, v226
    v_mfma_f32_16x16x32_bf16 v[120:123], a[48:51], a[136:139], v[120:123]
    v_mfma_f32_16x16x32_bf16 v[124:127], a[48:51], a[140:143], v[124:127]
    v_mfma_f32_16x16x32_bf16 v[128:131], a[52:55], a[128:131], v[128:131]
    s_mov_b32 s34, 184320
    v_add_f32 v227, 1.0, v227
    v_mfma_f32_16x16x32_bf16 v[132:135], a[52:55], a[132:135], v[132:135]
    buffer_load_dwordx4 a[48:51], v2, s[20:23], s34 offen offset:0
    v_mfma_f32_16x16x32_bf16 v[136:139], a[52:55], a[136:139], v[136:139]
    v_mfma_f32_16x16x32_bf16 v[140:143], a[52:55], a[140:143], v[140:143]
    s_waitcnt lgkmcnt(0)
    v_mfma_f32_16x16x32_bf16 v[240:243], a[56:59], a[112:115], v[240:243]
    buffer_load_dwordx4 a[52:55], v2, s[20:23], s34 offen offset:1024
    v_mfma_f32_16x16x32_bf16 v[244:247], a[56:59], a[116:119], v[244:247]
    ds_read_b128 a[128:131], v46 offset:1280
    ds_read_b128 a[132:135], v46 offset:27904
    v_mfma_f32_16x16x32_bf16 v[248:251], a[56:59], a[120:123], v[248:251]
    ds_read_b128 a[136:139], v47 offset:1280
    ds_read_b128 a[140:143], v47 offset:27904
    v_mfma_f32_16x16x32_bf16 v[252:255], a[56:59], a[124:127], v[252:255]
    v_mfma_f32_16x16x32_bf16 v[48:51], a[60:63], a[112:115], v[48:51]
    buffer_load_dwordx4 a[56:59], v2, s[20:23], s34 offen offset:2048
    v_mfma_f32_16x16x32_bf16 v[52:55], a[60:63], a[116:119], v[52:55]
    v_mfma_f32_16x16x32_bf16 v[56:59], a[60:63], a[120:123], v[56:59]
    v_mfma_f32_16x16x32_bf16 v[60:63], a[60:63], a[124:127], v[60:63]
    v_mfma_f32_16x16x32_bf16 v[64:67], a[64:67], a[112:115], v[64:67]
    buffer_load_dwordx4 a[60:63], v2, s[20:23], s34 offen offset:3072
    v_mfma_f32_16x16x32_bf16 v[68:71], a[64:67], a[116:119], v[68:71]
    v_mfma_f32_16x16x32_bf16 v[72:75], a[64:67], a[120:123], v[72:75]
    v_mfma_f32_16x16x32_bf16 v[76:79], a[64:67], a[124:127], v[76:79]
    v_mfma_f32_16x16x32_bf16 v[80:83], a[68:71], a[112:115], v[80:83]
    s_mov_b32 s34, 188416
    v_mfma_f32_16x16x32_bf16 v[84:87], a[68:71], a[116:119], v[84:87]
    buffer_load_dwordx4 a[64:67], v2, s[20:23], s34 offen offset:0
    v_mfma_f32_16x16x32_bf16 v[88:91], a[68:71], a[120:123], v[88:91]
    v_mfma_f32_16x16x32_bf16 v[92:95], a[68:71], a[124:127], v[92:95]
    s_waitcnt vmcnt(20)
    v_mfma_f32_16x16x32_bf16 v[96:99], a[72:75], a[112:115], v[96:99]
    buffer_load_dwordx4 a[68:71], v2, s[20:23], s34 offen offset:1024
    v_mfma_f32_16x16x32_bf16 v[100:103], a[72:75], a[116:119], v[100:103]
    v_mfma_f32_16x16x32_bf16 v[104:107], a[72:75], a[120:123], v[104:107]
    v_mfma_f32_16x16x32_bf16 v[108:111], a[72:75], a[124:127], v[108:111]
    v_mfma_f32_16x16x32_bf16 v[112:115], a[76:79], a[112:115], v[112:115]
    buffer_load_dwordx4 a[72:75], v2, s[20:23], s34 offen offset:2048
    v_mfma_f32_16x16x32_bf16 v[116:119], a[76:79], a[116:119], v[116:119]
    v_mfma_f32_16x16x32_bf16 v[120:123], a[76:79], a[120:123], v[120:123]
    v_mfma_f32_16x16x32_bf16 v[124:127], a[76:79], a[124:127], v[124:127]
    v_mfma_f32_16x16x32_bf16 v[128:131], a[80:83], a[112:115], v[128:131]
    buffer_load_dwordx4 a[76:79], v2, s[20:23], s34 offen offset:3072
    v_mfma_f32_16x16x32_bf16 v[132:135], a[80:83], a[116:119], v[132:135]
    v_mfma_f32_16x16x32_bf16 v[136:139], a[80:83], a[120:123], v[136:139]
    v_mfma_f32_16x16x32_bf16 v[140:143], a[80:83], a[124:127], v[140:143]
    s_waitcnt lgkmcnt(0)
    v_mfma_f32_16x16x32_bf16 v[240:243], a[84:87], a[128:131], v[240:243]
    s_mov_b32 s34, 192512
    v_mfma_f32_16x16x32_bf16 v[244:247], a[84:87], a[132:135], v[244:247]
    ds_read_b128 a[112:115], v0 offset:1408
    ds_read_b128 a[116:119], v0 offset:28032
    v_mfma_f32_16x16x32_bf16 v[248:251], a[84:87], a[136:139], v[248:251]
    ds_read_b128 a[120:123], v1 offset:1408
    ds_read_b128 a[124:127], v1 offset:28032
    v_mfma_f32_16x16x32_bf16 v[252:255], a[84:87], a[140:143], v[252:255]
    buffer_load_dwordx4 a[80:83], v2, s[20:23], s34 offen offset:0
    v_mfma_f32_16x16x32_bf16 v[48:51], a[88:91], a[128:131], v[48:51]
    buffer_load_dwordx4 a[84:87], v2, s[20:23], s34 offen offset:1024
    v_mfma_f32_16x16x32_bf16 v[52:55], a[88:91], a[132:135], v[52:55]
    v_mfma_f32_16x16x32_bf16 v[56:59], a[88:91], a[136:139], v[56:59]
    v_mfma_f32_16x16x32_bf16 v[60:63], a[88:91], a[140:143], v[60:63]
    v_mfma_f32_16x16x32_bf16 v[64:67], a[92:95], a[128:131], v[64:67]
    buffer_load_dwordx4 a[88:91], v2, s[20:23], s34 offen offset:2048
    v_mfma_f32_16x16x32_bf16 v[68:71], a[92:95], a[132:135], v[68:71]
    v_mfma_f32_16x16x32_bf16 v[72:75], a[92:95], a[136:139], v[72:75]
    v_mfma_f32_16x16x32_bf16 v[76:79], a[92:95], a[140:143], v[76:79]
    v_mfma_f32_16x16x32_bf16 v[80:83], a[96:99], a[128:131], v[80:83]
    buffer_load_dwordx4 a[92:95], v2, s[20:23], s34 offen offset:3072
    v_mfma_f32_16x16x32_bf16 v[84:87], a[96:99], a[132:135], v[84:87]
    v_mfma_f32_16x16x32_bf16 v[88:91], a[96:99], a[136:139], v[88:91]
    v_mfma_f32_16x16x32_bf16 v[92:95], a[96:99], a[140:143], v[92:95]
    s_waitcnt vmcnt(20)
    v_mfma_f32_16x16x32_bf16 v[96:99], a[100:103], a[128:131], v[96:99]
    s_mov_b32 s34, 196608
    v_mfma_f32_16x16x32_bf16 v[100:103], a[100:103], a[132:135], v[100:103]
    buffer_load_dwordx4 a[96:99], v2, s[20:23], s34 offen offset:0
    v_mfma_f32_16x16x32_bf16 v[104:107], a[100:103], a[136:139], v[104:107]
    v_mfma_f32_16x16x32_bf16 v[108:111], a[100:103], a[140:143], v[108:111]
    v_mfma_f32_16x16x32_bf16 v[112:115], a[104:107], a[128:131], v[112:115]
    buffer_load_dwordx4 a[100:103], v2, s[20:23], s34 offen offset:1024
    v_mfma_f32_16x16x32_bf16 v[116:119], a[104:107], a[132:135], v[116:119]
    v_mfma_f32_16x16x32_bf16 v[120:123], a[104:107], a[136:139], v[120:123]
    v_mfma_f32_16x16x32_bf16 v[124:127], a[104:107], a[140:143], v[124:127]
    v_mfma_f32_16x16x32_bf16 v[128:131], a[108:111], a[128:131], v[128:131]
    buffer_load_dwordx4 a[104:107], v2, s[20:23], s34 offen offset:2048
    v_mfma_f32_16x16x32_bf16 v[132:135], a[108:111], a[132:135], v[132:135]
    v_mfma_f32_16x16x32_bf16 v[136:139], a[108:111], a[136:139], v[136:139]
    v_mfma_f32_16x16x32_bf16 v[140:143], a[108:111], a[140:143], v[140:143]
    s_waitcnt lgkmcnt(0)
    v_mfma_f32_16x16x32_bf16 v[240:243], a[0:3], a[112:115], v[240:243]
    buffer_load_dwordx4 a[108:111], v2, s[20:23], s34 offen offset:3072
    v_mfma_f32_16x16x32_bf16 v[244:247], a[0:3], a[116:119], v[244:247]
    ds_read_b128 a[128:131], v46 offset:1408
    ds_read_b128 a[132:135], v46 offset:28032
    v_mfma_f32_16x16x32_bf16 v[248:251], a[0:3], a[120:123], v[248:251]
    ds_read_b128 a[136:139], v47 offset:1408
    ds_read_b128 a[140:143], v47 offset:28032
    v_mfma_f32_16x16x32_bf16 v[252:255], a[0:3], a[124:127], v[252:255]
    v_mfma_f32_16x16x32_bf16 v[48:51], a[4:7], a[112:115], v[48:51]
    s_mov_b32 s34, 200704
    v_mfma_f32_16x16x32_bf16 v[52:55], a[4:7], a[116:119], v[52:55]
    buffer_load_dwordx4 a[0:3], v2, s[20:23], s34 offen offset:0
    v_mfma_f32_16x16x32_bf16 v[56:59], a[4:7], a[120:123], v[56:59]
    v_mfma_f32_16x16x32_bf16 v[60:63], a[4:7], a[124:127], v[60:63]
    v_mfma_f32_16x16x32_bf16 v[64:67], a[8:11], a[112:115], v[64:67]
    buffer_load_dwordx4 a[4:7], v2, s[20:23], s34 offen offset:1024
    v_mfma_f32_16x16x32_bf16 v[68:71], a[8:11], a[116:119], v[68:71]
    v_mfma_f32_16x16x32_bf16 v[72:75], a[8:11], a[120:123], v[72:75]
    v_mfma_f32_16x16x32_bf16 v[76:79], a[8:11], a[124:127], v[76:79]
    v_mfma_f32_16x16x32_bf16 v[80:83], a[12:15], a[112:115], v[80:83]
    buffer_load_dwordx4 a[8:11], v2, s[20:23], s34 offen offset:2048
    v_mfma_f32_16x16x32_bf16 v[84:87], a[12:15], a[116:119], v[84:87]
    v_mfma_f32_16x16x32_bf16 v[88:91], a[12:15], a[120:123], v[88:91]
    v_mfma_f32_16x16x32_bf16 v[92:95], a[12:15], a[124:127], v[92:95]
    s_waitcnt vmcnt(20)
    v_mfma_f32_16x16x32_bf16 v[96:99], a[16:19], a[112:115], v[96:99]
    buffer_load_dwordx4 a[12:15], v2, s[20:23], s34 offen offset:3072
    v_mfma_f32_16x16x32_bf16 v[100:103], a[16:19], a[116:119], v[100:103]
    v_mfma_f32_16x16x32_bf16 v[104:107], a[16:19], a[120:123], v[104:107]
    v_mfma_f32_16x16x32_bf16 v[108:111], a[16:19], a[124:127], v[108:111]
    v_mfma_f32_16x16x32_bf16 v[112:115], a[20:23], a[112:115], v[112:115]
    s_mov_b32 s34, 204800
    v_mfma_f32_16x16x32_bf16 v[116:119], a[20:23], a[116:119], v[116:119]
    buffer_load_dwordx4 a[16:19], v2, s[20:23], s34 offen offset:0
    v_mfma_f32_16x16x32_bf16 v[120:123], a[20:23], a[120:123], v[120:123]
    v_mfma_f32_16x16x32_bf16 v[124:127], a[20:23], a[124:127], v[124:127]
    v_mfma_f32_16x16x32_bf16 v[128:131], a[24:27], a[112:115], v[128:131]
    buffer_load_dwordx4 a[20:23], v2, s[20:23], s34 offen offset:1024
    v_mfma_f32_16x16x32_bf16 v[132:135], a[24:27], a[116:119], v[132:135]
    v_mfma_f32_16x16x32_bf16 v[136:139], a[24:27], a[120:123], v[136:139]
    v_mfma_f32_16x16x32_bf16 v[140:143], a[24:27], a[124:127], v[140:143]
    s_waitcnt lgkmcnt(0)
    v_mfma_f32_16x16x32_bf16 v[240:243], a[28:31], a[128:131], v[240:243]
    buffer_load_dwordx4 a[24:27], v2, s[20:23], s34 offen offset:2048
    v_mfma_f32_16x16x32_bf16 v[244:247], a[28:31], a[132:135], v[244:247]
    ds_read_b128 a[112:115], v0 offset:0
    ds_read_b128 a[116:119], v0 offset:26624
    v_mfma_f32_16x16x32_bf16 v[248:251], a[28:31], a[136:139], v[248:251]
    ds_read_b128 a[120:123], v1 offset:0
    ds_read_b128 a[124:127], v1 offset:26624
    v_mfma_f32_16x16x32_bf16 v[252:255], a[28:31], a[140:143], v[252:255]
    v_mfma_f32_16x16x32_bf16 v[48:51], a[32:35], a[128:131], v[48:51]
    buffer_load_dwordx4 a[28:31], v2, s[20:23], s34 offen offset:3072
    v_mfma_f32_16x16x32_bf16 v[52:55], a[32:35], a[132:135], v[52:55]
    v_mfma_f32_16x16x32_bf16 v[56:59], a[32:35], a[136:139], v[56:59]
    v_mfma_f32_16x16x32_bf16 v[60:63], a[32:35], a[140:143], v[60:63]
    v_mfma_f32_16x16x32_bf16 v[64:67], a[36:39], a[128:131], v[64:67]
    s_mov_b32 s34, 208896
    v_mfma_f32_16x16x32_bf16 v[68:71], a[36:39], a[132:135], v[68:71]
    buffer_load_dwordx4 a[32:35], v2, s[20:23], s34 offen offset:0
    v_mfma_f32_16x16x32_bf16 v[72:75], a[36:39], a[136:139], v[72:75]
    v_mfma_f32_16x16x32_bf16 v[76:79], a[36:39], a[140:143], v[76:79]
    v_mfma_f32_16x16x32_bf16 v[80:83], a[40:43], a[128:131], v[80:83]
    buffer_load_dwordx4 a[36:39], v2, s[20:23], s34 offen offset:1024
    v_mfma_f32_16x16x32_bf16 v[84:87], a[40:43], a[132:135], v[84:87]
    v_mfma_f32_16x16x32_bf16 v[88:91], a[40:43], a[136:139], v[88:91]
    v_mfma_f32_16x16x32_bf16 v[92:95], a[40:43], a[140:143], v[92:95]
    s_waitcnt vmcnt(20)
    v_mfma_f32_16x16x32_bf16 v[96:99], a[44:47], a[128:131], v[96:99]
    buffer_load_dwordx4 a[40:43], v2, s[20:23], s34 offen offset:2048
    v_mfma_f32_16x16x32_bf16 v[100:103], a[44:47], a[132:135], v[100:103]
    v_mfma_f32_16x16x32_bf16 v[104:107], a[44:47], a[136:139], v[104:107]
    v_mfma_f32_16x16x32_bf16 v[108:111], a[44:47], a[140:143], v[108:111]
    v_mfma_f32_16x16x32_bf16 v[112:115], a[48:51], a[128:131], v[112:115]
    buffer_load_dwordx4 a[44:47], v2, s[20:23], s34 offen offset:3072
    v_mfma_f32_16x16x32_bf16 v[116:119], a[48:51], a[132:135], v[116:119]
    v_mfma_f32_16x16x32_bf16 v[120:123], a[48:51], a[136:139], v[120:123]
    v_mfma_f32_16x16x32_bf16 v[124:127], a[48:51], a[140:143], v[124:127]
    v_mfma_f32_16x16x32_bf16 v[128:131], a[52:55], a[128:131], v[128:131]
    s_mov_b32 s34, 212992
    v_mfma_f32_16x16x32_bf16 v[132:135], a[52:55], a[132:135], v[132:135]
    buffer_load_dwordx4 a[48:51], v2, s[20:23], s34 offen offset:0
    v_mfma_f32_16x16x32_bf16 v[136:139], a[52:55], a[136:139], v[136:139]
    v_mfma_f32_16x16x32_bf16 v[140:143], a[52:55], a[140:143], v[140:143]
    s_waitcnt lgkmcnt(0)
    v_mfma_f32_16x16x32_bf16 v[144:147], a[56:59], a[112:115], v[144:147]
    buffer_load_dwordx4 a[52:55], v2, s[20:23], s34 offen offset:1024
    v_mfma_f32_16x16x32_bf16 v[148:151], a[56:59], a[116:119], v[148:151]
    ds_read_b128 a[128:131], v46 offset:0
    ds_read_b128 a[132:135], v46 offset:26624
    v_mfma_f32_16x16x32_bf16 v[152:155], a[56:59], a[120:123], v[152:155]
    ds_read_b128 a[136:139], v47 offset:0
    ds_read_b128 a[140:143], v47 offset:26624
    v_mfma_f32_16x16x32_bf16 v[156:159], a[56:59], a[124:127], v[156:159]
    v_mfma_f32_16x16x32_bf16 v[160:163], a[60:63], a[112:115], v[160:163]
    buffer_load_dwordx4 a[56:59], v2, s[20:23], s34 offen offset:2048
    v_mfma_f32_16x16x32_bf16 v[164:167], a[60:63], a[116:119], v[164:167]
    v_mfma_f32_16x16x32_bf16 v[168:171], a[60:63], a[120:123], v[168:171]
    v_mfma_f32_16x16x32_bf16 v[172:175], a[60:63], a[124:127], v[172:175]
    v_mfma_f32_16x16x32_bf16 v[176:179], a[64:67], a[112:115], v[176:179]
    buffer_load_dwordx4 a[60:63], v2, s[20:23], s34 offen offset:3072
    v_mfma_f32_16x16x32_bf16 v[180:183], a[64:67], a[116:119], v[180:183]
    v_mfma_f32_16x16x32_bf16 v[184:187], a[64:67], a[120:123], v[184:187]
    buffer_load_dwordx4 v[30:33], v12, s[24:27], 0 offen offset:1600
    v_mfma_f32_16x16x32_bf16 v[188:191], a[64:67], a[124:127], v[188:191]
    buffer_load_dwordx4 v[38:41], v12, s[24:27], 0 offen offset:832
    v_mfma_f32_16x16x32_bf16 v[192:195], a[68:71], a[112:115], v[192:195]
    s_mov_b32 s34, 217088
    v_mfma_f32_16x16x32_bf16 v[196:199], a[68:71], a[116:119], v[196:199]
    buffer_load_dwordx4 a[64:67], v2, s[20:23], s34 offen offset:0
    v_mfma_f32_16x16x32_bf16 v[200:203], a[68:71], a[120:123], v[200:203]
    buffer_load_dwordx4 v[42:45], v12, s[24:27], 0 offen offset:896
    v_mfma_f32_16x16x32_bf16 v[204:207], a[68:71], a[124:127], v[204:207]
    v_accvgpr_read_b32 v14, a240
    v_accvgpr_read_b32 v15, a241
    s_waitcnt vmcnt(23)
    v_mfma_f32_16x16x32_bf16 v[208:211], a[72:75], a[112:115], v[208:211]
    buffer_load_dwordx4 a[68:71], v2, s[20:23], s34 offen offset:1024
    v_mfma_f32_16x16x32_bf16 v[212:215], a[72:75], a[116:119], v[212:215]
    v_lshlrev_b32 v18, 16, v14
    v_and_b32 v19, 0xffff0000, v14
    v_mfma_f32_16x16x32_bf16 v[216:219], a[72:75], a[120:123], v[216:219]
    v_lshlrev_b32 v20, 16, v15
    v_mfma_f32_16x16x32_bf16 v[220:223], a[72:75], a[124:127], v[220:223]
    v_and_b32 v21, 0xffff0000, v15
    v_mfma_f32_16x16x32_bf16 v[224:227], a[76:79], a[112:115], v[224:227]
    buffer_load_dwordx4 a[72:75], v2, s[20:23], s34 offen offset:2048
    v_mfma_f32_16x16x32_bf16 v[228:231], a[76:79], a[116:119], v[228:231]
    v_mul_f32 v18, v18, v240
    v_mfma_f32_16x16x32_bf16 v[232:235], a[76:79], a[120:123], v[232:235]
    v_mul_f32 v19, v19, v241
    v_mfma_f32_16x16x32_bf16 v[236:239], a[76:79], a[124:127], v[236:239]
    v_mul_f32 v20, v20, v242
    s_waitcnt lgkmcnt(0)
    v_mfma_f32_16x16x32_bf16 v[144:147], a[80:83], a[128:131], v[144:147]
    buffer_load_dwordx4 a[76:79], v2, s[20:23], s34 offen offset:3072
    v_mfma_f32_16x16x32_bf16 v[148:151], a[80:83], a[132:135], v[148:151]
    ds_read_b128 a[112:115], v0 offset:128
    ds_read_b128 a[116:119], v0 offset:26752
    v_mfma_f32_16x16x32_bf16 v[152:155], a[80:83], a[136:139], v[152:155]
    ds_read_b128 a[120:123], v1 offset:128
    ds_read_b128 a[124:127], v1 offset:26752
    v_mfma_f32_16x16x32_bf16 v[156:159], a[80:83], a[140:143], v[156:159]
    v_mul_f32 v21, v21, v243
    v_cvt_pk_bf16_f32 v14, v18, v19
    v_mfma_f32_16x16x32_bf16 v[160:163], a[84:87], a[128:131], v[160:163]
    s_mov_b32 s34, 221184
    v_cvt_pk_bf16_f32 v15, v20, v21
    v_mfma_f32_16x16x32_bf16 v[164:167], a[84:87], a[132:135], v[164:167]
    buffer_load_dwordx4 a[80:83], v2, s[20:23], s34 offen offset:0
    v_mfma_f32_16x16x32_bf16 v[168:171], a[84:87], a[136:139], v[168:171]
    ds_write_b64 v8, v[14:15] offset:0
    v_mfma_f32_16x16x32_bf16 v[172:175], a[84:87], a[140:143], v[172:175]
    s_waitcnt vmcnt(7)
    v_add_f32 v240, v240, v30
    v_add_f32 v241, v241, v31
    v_mfma_f32_16x16x32_bf16 v[176:179], a[88:91], a[128:131], v[176:179]
    buffer_load_dwordx4 a[84:87], v2, s[20:23], s34 offen offset:1024
    v_mfma_f32_16x16x32_bf16 v[180:183], a[88:91], a[132:135], v[180:183]
    v_add_f32 v242, v242, v32
    v_add_f32 v243, v243, v33
    v_mfma_f32_16x16x32_bf16 v[184:187], a[88:91], a[136:139], v[184:187]
    v_accvgpr_read_b32 v22, a242
    v_mfma_f32_16x16x32_bf16 v[188:191], a[88:91], a[140:143], v[188:191]
    v_accvgpr_read_b32 v23, a243
    v_mfma_f32_16x16x32_bf16 v[192:195], a[92:95], a[128:131], v[192:195]
    buffer_load_dwordx4 a[88:91], v2, s[20:23], s34 offen offset:2048
    v_mfma_f32_16x16x32_bf16 v[196:199], a[92:95], a[132:135], v[196:199]
    v_lshlrev_b32 v26, 16, v22
    v_and_b32 v27, 0xffff0000, v22
    v_mfma_f32_16x16x32_bf16 v[200:203], a[92:95], a[136:139], v[200:203]
    v_lshlrev_b32 v28, 16, v23
    v_mfma_f32_16x16x32_bf16 v[204:207], a[92:95], a[140:143], v[204:207]
    v_mfma_f32_16x16x32_bf16 v[208:211], a[96:99], a[128:131], v[208:211]
    buffer_load_dwordx4 a[92:95], v2, s[20:23], s34 offen offset:3072
    v_mfma_f32_16x16x32_bf16 v[212:215], a[96:99], a[132:135], v[212:215]
    v_and_b32 v29, 0xffff0000, v23
    v_mul_f32 v26, v26, v244
    v_mfma_f32_16x16x32_bf16 v[216:219], a[96:99], a[136:139], v[216:219]
    v_mul_f32 v27, v27, v245
    v_mfma_f32_16x16x32_bf16 v[220:223], a[96:99], a[140:143], v[220:223]
    v_mul_f32 v28, v28, v246
    v_mfma_f32_16x16x32_bf16 v[224:227], a[100:103], a[128:131], v[224:227]
    s_mov_b32 s34, 225280
    v_mul_f32 v29, v29, v247
    v_mfma_f32_16x16x32_bf16 v[228:231], a[100:103], a[132:135], v[228:231]
    buffer_load_dwordx4 a[96:99], v2, s[20:23], s34 offen offset:0
    v_mfma_f32_16x16x32_bf16 v[232:235], a[100:103], a[136:139], v[232:235]
    v_cvt_pk_bf16_f32 v22, v26, v27
    v_mfma_f32_16x16x32_bf16 v[236:239], a[100:103], a[140:143], v[236:239]
    v_cvt_pk_bf16_f32 v23, v28, v29
    s_waitcnt lgkmcnt(1)
    v_mfma_f32_16x16x32_bf16 v[144:147], a[104:107], a[112:115], v[144:147]
    buffer_load_dwordx4 a[100:103], v2, s[20:23], s34 offen offset:1024
    v_mfma_f32_16x16x32_bf16 v[148:151], a[104:107], a[116:119], v[148:151]
    ds_read_b128 a[128:131], v0 offset:384
    ds_read_b128 a[132:135], v0 offset:27008
    v_mfma_f32_16x16x32_bf16 v[152:155], a[104:107], a[120:123], v[152:155]
    ds_read_b128 a[136:139], v1 offset:384
    ds_read_b128 a[140:143], v1 offset:27008
    v_mfma_f32_16x16x32_bf16 v[156:159], a[104:107], a[124:127], v[156:159]
    ds_write_b64 v8, v[22:23] offset:1024
    v_mfma_f32_16x16x32_bf16 v[160:163], a[108:111], a[112:115], v[160:163]
    buffer_load_dwordx4 a[104:107], v2, s[20:23], s34 offen offset:2048
    v_mfma_f32_16x16x32_bf16 v[164:167], a[108:111], a[116:119], v[164:167]
    v_add_f32 v244, v244, v30
    v_add_f32 v245, v245, v31
    v_mfma_f32_16x16x32_bf16 v[168:171], a[108:111], a[120:123], v[168:171]
    v_add_f32 v246, v246, v32
    v_add_f32 v247, v247, v33
    v_mfma_f32_16x16x32_bf16 v[172:175], a[108:111], a[124:127], v[172:175]
    v_accvgpr_read_b32 v14, a244
    v_accvgpr_read_b32 v15, a245
    v_mfma_f32_16x16x32_bf16 v[176:179], a[0:3], a[112:115], v[176:179]
    buffer_load_dwordx4 a[108:111], v2, s[20:23], s34 offen offset:3072
    v_mfma_f32_16x16x32_bf16 v[180:183], a[0:3], a[116:119], v[180:183]
    v_lshlrev_b32 v18, 16, v14
    v_mfma_f32_16x16x32_bf16 v[184:187], a[0:3], a[120:123], v[184:187]
    v_and_b32 v19, 0xffff0000, v14
    v_mfma_f32_16x16x32_bf16 v[188:191], a[0:3], a[124:127], v[188:191]
    v_lshlrev_b32 v20, 16, v15
    v_mfma_f32_16x16x32_bf16 v[192:195], a[4:7], a[112:115], v[192:195]
    s_mov_b32 s34, 229376
    v_and_b32 v21, 0xffff0000, v15
    v_mfma_f32_16x16x32_bf16 v[196:199], a[4:7], a[116:119], v[196:199]
    buffer_load_dwordx4 a[0:3], v2, s[20:23], s34 offen offset:0
    v_mfma_f32_16x16x32_bf16 v[200:203], a[4:7], a[120:123], v[200:203]
    v_mul_f32 v18, v18, v248
    v_mul_f32 v19, v19, v249
    v_mfma_f32_16x16x32_bf16 v[204:207], a[4:7], a[124:127], v[204:207]
    v_mfma_f32_16x16x32_bf16 v[208:211], a[8:11], a[112:115], v[208:211]
    buffer_load_dwordx4 a[4:7], v2, s[20:23], s34 offen offset:1024
    v_mfma_f32_16x16x32_bf16 v[212:215], a[8:11], a[116:119], v[212:215]
    v_mul_f32 v20, v20, v250
    v_mul_f32 v21, v21, v251
    v_mfma_f32_16x16x32_bf16 v[216:219], a[8:11], a[120:123], v[216:219]
    v_cvt_pk_bf16_f32 v14, v18, v19
    v_mfma_f32_16x16x32_bf16 v[220:223], a[8:11], a[124:127], v[220:223]
    v_cvt_pk_bf16_f32 v15, v20, v21
    v_mfma_f32_16x16x32_bf16 v[224:227], a[12:15], a[112:115], v[224:227]
    buffer_load_dwordx4 a[8:11], v2, s[20:23], s34 offen offset:2048
    v_mfma_f32_16x16x32_bf16 v[228:231], a[12:15], a[116:119], v[228:231]
    ds_write_b64 v8, v[14:15] offset:2048
    v_mfma_f32_16x16x32_bf16 v[232:235], a[12:15], a[120:123], v[232:235]
    v_add_f32 v248, v248, v30
    v_mfma_f32_16x16x32_bf16 v[236:239], a[12:15], a[124:127], v[236:239]
    v_add_f32 v249, v249, v31
    s_waitcnt lgkmcnt(2)
    v_mfma_f32_16x16x32_bf16 v[144:147], a[16:19], a[128:131], v[144:147]
    buffer_load_dwordx4 a[12:15], v2, s[20:23], s34 offen offset:3072
    v_mfma_f32_16x16x32_bf16 v[148:151], a[16:19], a[132:135], v[148:151]
    ds_read_b128 a[112:115], v46 offset:384
    ds_read_b128 a[116:119], v46 offset:27008
    v_mfma_f32_16x16x32_bf16 v[152:155], a[16:19], a[136:139], v[152:155]
    ds_read_b128 a[120:123], v47 offset:384
    ds_read_b128 a[124:127], v47 offset:27008
    v_mfma_f32_16x16x32_bf16 v[156:159], a[16:19], a[140:143], v[156:159]
    v_add_f32 v250, v250, v32
    v_add_f32 v251, v251, v33
    v_mfma_f32_16x16x32_bf16 v[160:163], a[20:23], a[128:131], v[160:163]
    s_mov_b32 s34, 233472
    v_accvgpr_read_b32 v22, a246
    v_mfma_f32_16x16x32_bf16 v[164:167], a[20:23], a[132:135], v[164:167]
    buffer_load_dwordx4 a[16:19], v2, s[20:23], s34 offen offset:0
    v_mfma_f32_16x16x32_bf16 v[168:171], a[20:23], a[136:139], v[168:171]
    v_accvgpr_read_b32 v23, a247
    v_lshlrev_b32 v26, 16, v22
    v_mfma_f32_16x16x32_bf16 v[172:175], a[20:23], a[140:143], v[172:175]
    v_and_b32 v27, 0xffff0000, v22
    v_lshlrev_b32 v28, 16, v23
    v_mfma_f32_16x16x32_bf16 v[176:179], a[24:27], a[128:131], v[176:179]
    buffer_load_dwordx4 a[20:23], v2, s[20:23], s34 offen offset:1024
    v_mfma_f32_16x16x32_bf16 v[180:183], a[24:27], a[132:135], v[180:183]
    v_and_b32 v29, 0xffff0000, v23
    v_mfma_f32_16x16x32_bf16 v[184:187], a[24:27], a[136:139], v[184:187]
    v_mul_f32 v26, v26, v252
    v_mfma_f32_16x16x32_bf16 v[188:191], a[24:27], a[140:143], v[188:191]
    v_mul_f32 v27, v27, v253
    v_mfma_f32_16x16x32_bf16 v[192:195], a[28:31], a[128:131], v[192:195]
    buffer_load_dwordx4 a[24:27], v2, s[20:23], s34 offen offset:2048
    v_mfma_f32_16x16x32_bf16 v[196:199], a[28:31], a[132:135], v[196:199]
    v_mul_f32 v28, v28, v254
    v_mul_f32 v29, v29, v255
    v_mfma_f32_16x16x32_bf16 v[200:203], a[28:31], a[136:139], v[200:203]
    v_cvt_pk_bf16_f32 v22, v26, v27
    v_mfma_f32_16x16x32_bf16 v[204:207], a[28:31], a[140:143], v[204:207]
    v_mfma_f32_16x16x32_bf16 v[208:211], a[32:35], a[128:131], v[208:211]
    buffer_load_dwordx4 a[28:31], v2, s[20:23], s34 offen offset:3072
    v_mfma_f32_16x16x32_bf16 v[212:215], a[32:35], a[132:135], v[212:215]
    v_cvt_pk_bf16_f32 v23, v28, v29
    v_mfma_f32_16x16x32_bf16 v[216:219], a[32:35], a[136:139], v[216:219]
    ds_write_b64 v8, v[22:23] offset:3072
    v_mfma_f32_16x16x32_bf16 v[220:223], a[32:35], a[140:143], v[220:223]
    v_add_f32 v252, v252, v30
    v_add_f32 v253, v253, v31
    v_mfma_f32_16x16x32_bf16 v[224:227], a[36:39], a[128:131], v[224:227]
    s_mov_b32 s34, 237568
    v_add_f32 v254, v254, v32
    v_mfma_f32_16x16x32_bf16 v[228:231], a[36:39], a[132:135], v[228:231]
    buffer_load_dwordx4 a[32:35], v2, s[20:23], s34 offen offset:0
    v_mfma_f32_16x16x32_bf16 v[232:235], a[36:39], a[136:139], v[232:235]
    v_add_f32 v255, v255, v33
    v_mfma_f32_16x16x32_bf16 v[236:239], a[36:39], a[140:143], v[236:239]
    buffer_load_dwordx4 v[30:33], v12, s[24:27], 0 offen offset:960
    s_waitcnt lgkmcnt(1)
    v_mfma_f32_16x16x32_bf16 v[144:147], a[40:43], a[112:115], v[144:147]
    buffer_load_dwordx4 a[36:39], v2, s[20:23], s34 offen offset:1024
    v_mfma_f32_16x16x32_bf16 v[148:151], a[40:43], a[116:119], v[148:151]
    ds_read_b128 a[128:131], v0 offset:512
    ds_read_b128 a[132:135], v0 offset:27136
    v_mfma_f32_16x16x32_bf16 v[152:155], a[40:43], a[120:123], v[152:155]
    ds_read_b128 a[136:139], v1 offset:512
    ds_read_b128 a[140:143], v1 offset:27136
    v_mfma_f32_16x16x32_bf16 v[156:159], a[40:43], a[124:127], v[156:159]
    buffer_load_dwordx4 v[34:37], v12, s[24:27], 0 offen offset:1024
    v_mfma_f32_16x16x32_bf16 v[160:163], a[44:47], a[112:115], v[160:163]
    buffer_load_dwordx4 a[40:43], v2, s[20:23], s34 offen offset:2048
    v_mfma_f32_16x16x32_bf16 v[164:167], a[44:47], a[116:119], v[164:167]
    v_accvgpr_read_b32 v14, a144
    v_accvgpr_read_b32 v15, a145
    v_mfma_f32_16x16x32_bf16 v[168:171], a[44:47], a[120:123], v[168:171]
    v_accvgpr_read_b32 v16, a146
    v_accvgpr_read_b32 v17, a147
    v_mfma_f32_16x16x32_bf16 v[172:175], a[44:47], a[124:127], v[172:175]
    v_lshlrev_b32 v18, 16, v14
    v_and_b32 v19, 0xffff0000, v14
    v_mfma_f32_16x16x32_bf16 v[176:179], a[48:51], a[112:115], v[176:179]
    buffer_load_dwordx4 a[44:47], v2, s[20:23], s34 offen offset:3072
    v_mfma_f32_16x16x32_bf16 v[180:183], a[48:51], a[116:119], v[180:183]
    v_lshlrev_b32 v20, 16, v15
    v_mfma_f32_16x16x32_bf16 v[184:187], a[48:51], a[120:123], v[184:187]
    v_and_b32 v21, 0xffff0000, v15
    v_mfma_f32_16x16x32_bf16 v[188:191], a[48:51], a[124:127], v[188:191]
    v_mul_f32 v18, v18, v48
    v_mfma_f32_16x16x32_bf16 v[192:195], a[52:55], a[112:115], v[192:195]
    s_mov_b32 s34, 241664
    v_mul_f32 v19, v19, v49
    v_mfma_f32_16x16x32_bf16 v[196:199], a[52:55], a[116:119], v[196:199]
    buffer_load_dwordx4 a[48:51], v2, s[20:23], s34 offen offset:0
    v_mfma_f32_16x16x32_bf16 v[200:203], a[52:55], a[120:123], v[200:203]
    v_mul_f32 v20, v20, v50
    v_mul_f32 v21, v21, v51
    v_mfma_f32_16x16x32_bf16 v[204:207], a[52:55], a[124:127], v[204:207]
    v_mfma_f32_16x16x32_bf16 v[208:211], a[56:59], a[112:115], v[208:211]
    buffer_load_dwordx4 a[52:55], v2, s[20:23], s34 offen offset:1024
    v_mfma_f32_16x16x32_bf16 v[212:215], a[56:59], a[116:119], v[212:215]
    v_cvt_pk_bf16_f32 v14, v18, v19
    v_cvt_pk_bf16_f32 v15, v20, v21
    v_mfma_f32_16x16x32_bf16 v[216:219], a[56:59], a[120:123], v[216:219]
    v_lshlrev_b32 v18, 16, v16
    v_mfma_f32_16x16x32_bf16 v[220:223], a[56:59], a[124:127], v[220:223]
    v_and_b32 v19, 0xffff0000, v16
    v_mfma_f32_16x16x32_bf16 v[224:227], a[60:63], a[112:115], v[224:227]
    buffer_load_dwordx4 a[56:59], v2, s[20:23], s34 offen offset:2048
    v_mfma_f32_16x16x32_bf16 v[228:231], a[60:63], a[116:119], v[228:231]
    v_lshlrev_b32 v20, 16, v17
    v_mfma_f32_16x16x32_bf16 v[232:235], a[60:63], a[120:123], v[232:235]
    v_and_b32 v21, 0xffff0000, v17
    v_mfma_f32_16x16x32_bf16 v[236:239], a[60:63], a[124:127], v[236:239]
    v_mul_f32 v18, v18, v64
    s_waitcnt vmcnt(29) lgkmcnt(0)
    v_mfma_f32_16x16x32_bf16 v[144:147], a[64:67], a[128:131], v[144:147]
    buffer_load_dwordx4 a[60:63], v2, s[20:23], s34 offen offset:3072
    v_mfma_f32_16x16x32_bf16 v[148:151], a[64:67], a[132:135], v[148:151]
    ds_read_b128 a[112:115], v0 offset:768
    ds_read_b128 a[116:119], v0 offset:27392
    v_mfma_f32_16x16x32_bf16 v[152:155], a[64:67], a[136:139], v[152:155]
    ds_read_b128 a[120:123], v1 offset:768
    ds_read_b128 a[124:127], v1 offset:27392
    v_mfma_f32_16x16x32_bf16 v[156:159], a[64:67], a[140:143], v[156:159]
    v_mul_f32 v19, v19, v65
    v_mul_f32 v20, v20, v66
    s_waitcnt vmcnt(22)
    v_mfma_f32_16x16x32_bf16 v[160:163], a[68:71], a[128:131], v[160:163]
    s_mov_b32 s34, 245760
    v_mul_f32 v21, v21, v67
    v_mfma_f32_16x16x32_bf16 v[164:167], a[68:71], a[132:135], v[164:167]
    buffer_load_dwordx4 a[64:67], v2, s[20:23], s34 offen offset:0
    v_mfma_f32_16x16x32_bf16 v[168:171], a[68:71], a[136:139], v[168:171]
    v_cvt_pk_bf16_f32 v16, v18, v19
    v_cvt_pk_bf16_f32 v17, v20, v21
    v_mfma_f32_16x16x32_bf16 v[172:175], a[68:71], a[140:143], v[172:175]
    ds_write_b128 v6, v[14:17] offset:0
    v_mfma_f32_16x16x32_bf16 v[176:179], a[72:75], a[128:131], v[176:179]
    buffer_load_dwordx4 a[68:71], v2, s[20:23], s34 offen offset:1024
    v_mfma_f32_16x16x32_bf16 v[180:183], a[72:75], a[132:135], v[180:183]
    v_add_f32 v48, v48, v38
    v_add_f32 v49, v49, v39
    v_mfma_f32_16x16x32_bf16 v[184:187], a[72:75], a[136:139], v[184:187]
    v_add_f32 v50, v50, v40
    v_mfma_f32_16x16x32_bf16 v[188:191], a[72:75], a[140:143], v[188:191]
    v_add_f32 v51, v51, v41
    v_mfma_f32_16x16x32_bf16 v[192:195], a[76:79], a[128:131], v[192:195]
    buffer_load_dwordx4 a[72:75], v2, s[20:23], s34 offen offset:2048
    v_mfma_f32_16x16x32_bf16 v[196:199], a[76:79], a[132:135], v[196:199]
    v_add_f32 v64, v64, v42
    v_add_f32 v65, v65, v43
    v_mfma_f32_16x16x32_bf16 v[200:203], a[76:79], a[136:139], v[200:203]
    v_add_f32 v66, v66, v44
    v_mfma_f32_16x16x32_bf16 v[204:207], a[76:79], a[140:143], v[204:207]
    v_mfma_f32_16x16x32_bf16 v[208:211], a[80:83], a[128:131], v[208:211]
    buffer_load_dwordx4 a[76:79], v2, s[20:23], s34 offen offset:3072
    v_mfma_f32_16x16x32_bf16 v[212:215], a[80:83], a[132:135], v[212:215]
    v_add_f32 v67, v67, v45
    v_accvgpr_read_b32 v22, a148
    v_mfma_f32_16x16x32_bf16 v[216:219], a[80:83], a[136:139], v[216:219]
    v_accvgpr_read_b32 v23, a149
    v_mfma_f32_16x16x32_bf16 v[220:223], a[80:83], a[140:143], v[220:223]
    v_accvgpr_read_b32 v24, a150
    v_mfma_f32_16x16x32_bf16 v[224:227], a[84:87], a[128:131], v[224:227]
    s_mov_b32 s34, 249856
    v_accvgpr_read_b32 v25, a151
    v_mfma_f32_16x16x32_bf16 v[228:231], a[84:87], a[132:135], v[228:231]
    buffer_load_dwordx4 a[80:83], v2, s[20:23], s34 offen offset:0
    v_mfma_f32_16x16x32_bf16 v[232:235], a[84:87], a[136:139], v[232:235]
    v_lshlrev_b32 v26, 16, v22
    v_mfma_f32_16x16x32_bf16 v[236:239], a[84:87], a[140:143], v[236:239]
    v_and_b32 v27, 0xffff0000, v22
    s_waitcnt lgkmcnt(1)
    v_mfma_f32_16x16x32_bf16 v[144:147], a[88:91], a[112:115], v[144:147]
    buffer_load_dwordx4 a[84:87], v2, s[20:23], s34 offen offset:1024
    v_mfma_f32_16x16x32_bf16 v[148:151], a[88:91], a[116:119], v[148:151]
    ds_read_b128 a[128:131], v46 offset:768
    ds_read_b128 a[132:135], v46 offset:27392
    v_mfma_f32_16x16x32_bf16 v[152:155], a[88:91], a[120:123], v[152:155]
    ds_read_b128 a[136:139], v47 offset:768
    ds_read_b128 a[140:143], v47 offset:27392
    v_mfma_f32_16x16x32_bf16 v[156:159], a[88:91], a[124:127], v[156:159]
    v_lshlrev_b32 v28, 16, v23
    v_and_b32 v29, 0xffff0000, v23
    v_mfma_f32_16x16x32_bf16 v[160:163], a[92:95], a[112:115], v[160:163]
    buffer_load_dwordx4 a[88:91], v2, s[20:23], s34 offen offset:2048
    v_mfma_f32_16x16x32_bf16 v[164:167], a[92:95], a[116:119], v[164:167]
    v_mul_f32 v26, v26, v52
    v_mul_f32 v27, v27, v53
    v_mfma_f32_16x16x32_bf16 v[168:171], a[92:95], a[120:123], v[168:171]
    v_mul_f32 v28, v28, v54
    v_mul_f32 v29, v29, v55
    v_mfma_f32_16x16x32_bf16 v[172:175], a[92:95], a[124:127], v[172:175]
    v_cvt_pk_bf16_f32 v22, v26, v27
    s_waitcnt vmcnt(22)
    v_mfma_f32_16x16x32_bf16 v[176:179], a[96:99], a[112:115], v[176:179]
    buffer_load_dwordx4 a[92:95], v2, s[20:23], s34 offen offset:3072
    v_mfma_f32_16x16x32_bf16 v[180:183], a[96:99], a[116:119], v[180:183]
    v_cvt_pk_bf16_f32 v23, v28, v29
    v_mfma_f32_16x16x32_bf16 v[184:187], a[96:99], a[120:123], v[184:187]
    v_lshlrev_b32 v26, 16, v24
    v_mfma_f32_16x16x32_bf16 v[188:191], a[96:99], a[124:127], v[188:191]
    v_and_b32 v27, 0xffff0000, v24
    v_mfma_f32_16x16x32_bf16 v[192:195], a[100:103], a[112:115], v[192:195]
    s_mov_b32 s34, 253952
    v_lshlrev_b32 v28, 16, v25
    v_mfma_f32_16x16x32_bf16 v[196:199], a[100:103], a[116:119], v[196:199]
    buffer_load_dwordx4 a[96:99], v2, s[20:23], s34 offen offset:0
    v_mfma_f32_16x16x32_bf16 v[200:203], a[100:103], a[120:123], v[200:203]
    v_and_b32 v29, 0xffff0000, v25
    v_mfma_f32_16x16x32_bf16 v[204:207], a[100:103], a[124:127], v[204:207]
    v_mul_f32 v26, v26, v68
    v_mfma_f32_16x16x32_bf16 v[208:211], a[104:107], a[112:115], v[208:211]
    buffer_load_dwordx4 a[100:103], v2, s[20:23], s34 offen offset:1024
    v_mfma_f32_16x16x32_bf16 v[212:215], a[104:107], a[116:119], v[212:215]
    v_mul_f32 v27, v27, v69
    v_mul_f32 v28, v28, v70
    v_mfma_f32_16x16x32_bf16 v[216:219], a[104:107], a[120:123], v[216:219]
    v_mul_f32 v29, v29, v71
    v_mfma_f32_16x16x32_bf16 v[220:223], a[104:107], a[124:127], v[220:223]
    v_cvt_pk_bf16_f32 v24, v26, v27
    v_mfma_f32_16x16x32_bf16 v[224:227], a[108:111], a[112:115], v[224:227]
    buffer_load_dwordx4 a[104:107], v2, s[20:23], s34 offen offset:2048
    v_mfma_f32_16x16x32_bf16 v[228:231], a[108:111], a[116:119], v[228:231]
    v_cvt_pk_bf16_f32 v25, v28, v29
    v_mfma_f32_16x16x32_bf16 v[232:235], a[108:111], a[120:123], v[232:235]
    ds_write_b128 v6, v[22:25] offset:1024
    v_mfma_f32_16x16x32_bf16 v[236:239], a[108:111], a[124:127], v[236:239]
    v_add_f32 v52, v52, v38
    s_waitcnt lgkmcnt(1)
    v_mfma_f32_16x16x32_bf16 v[144:147], a[0:3], a[128:131], v[144:147]
    buffer_load_dwordx4 a[108:111], v2, s[20:23], s34 offen offset:3072
    v_mfma_f32_16x16x32_bf16 v[148:151], a[0:3], a[132:135], v[148:151]
    ds_read_b128 a[112:115], v0 offset:896
    ds_read_b128 a[116:119], v0 offset:27520
    v_mfma_f32_16x16x32_bf16 v[152:155], a[0:3], a[136:139], v[152:155]
    ds_read_b128 a[120:123], v1 offset:896
    ds_read_b128 a[124:127], v1 offset:27520
    v_mfma_f32_16x16x32_bf16 v[156:159], a[0:3], a[140:143], v[156:159]
    v_add_f32 v53, v53, v39
    v_add_f32 v54, v54, v40
    v_mfma_f32_16x16x32_bf16 v[160:163], a[4:7], a[128:131], v[160:163]
    s_mov_b32 s34, 258048
    v_add_f32 v55, v55, v41
    v_mfma_f32_16x16x32_bf16 v[164:167], a[4:7], a[132:135], v[164:167]
    buffer_load_dwordx4 a[0:3], v2, s[20:23], s34 offen offset:0
    v_mfma_f32_16x16x32_bf16 v[168:171], a[4:7], a[136:139], v[168:171]
    v_add_f32 v68, v68, v42
    v_add_f32 v69, v69, v43
    v_mfma_f32_16x16x32_bf16 v[172:175], a[4:7], a[140:143], v[172:175]
    v_add_f32 v70, v70, v44
    v_add_f32 v71, v71, v45
    v_mfma_f32_16x16x32_bf16 v[176:179], a[8:11], a[128:131], v[176:179]
    buffer_load_dwordx4 a[4:7], v2, s[20:23], s34 offen offset:1024
    v_mfma_f32_16x16x32_bf16 v[180:183], a[8:11], a[132:135], v[180:183]
    v_accvgpr_read_b32 v14, a152
    v_mfma_f32_16x16x32_bf16 v[184:187], a[8:11], a[136:139], v[184:187]
    v_accvgpr_read_b32 v15, a153
    v_mfma_f32_16x16x32_bf16 v[188:191], a[8:11], a[140:143], v[188:191]
    v_accvgpr_read_b32 v16, a154
    s_waitcnt vmcnt(23)
    v_mfma_f32_16x16x32_bf16 v[192:195], a[12:15], a[128:131], v[192:195]
    buffer_load_dwordx4 a[8:11], v2, s[20:23], s34 offen offset:2048
    v_mfma_f32_16x16x32_bf16 v[196:199], a[12:15], a[132:135], v[196:199]
    v_accvgpr_read_b32 v17, a155
    v_lshlrev_b32 v18, 16, v14
    v_mfma_f32_16x16x32_bf16 v[200:203], a[12:15], a[136:139], v[200:203]
    v_mfma_f32_16x16x32_bf16 v[204:207], a[12:15], a[140:143], v[204:207]
    v_and_b32 v19, 0xffff0000, v14
    v_mfma_f32_16x16x32_bf16 v[208:211], a[16:19], a[128:131], v[208:211]
    buffer_load_dwordx4 a[12:15], v2, s[20:23], s34 offen offset:3072
    v_mfma_f32_16x16x32_bf16 v[212:215], a[16:19], a[132:135], v[212:215]
    v_lshlrev_b32 v20, 16, v15
    v_and_b32 v21, 0xffff0000, v15
    v_mfma_f32_16x16x32_bf16 v[216:219], a[16:19], a[136:139], v[216:219]
    v_mul_f32 v18, v18, v56
    v_mfma_f32_16x16x32_bf16 v[220:223], a[16:19], a[140:143], v[220:223]
    v_mul_f32 v19, v19, v57
    v_mfma_f32_16x16x32_bf16 v[224:227], a[20:23], a[128:131], v[224:227]
    s_mov_b32 s34, 262144
    v_mfma_f32_16x16x32_bf16 v[228:231], a[20:23], a[132:135], v[228:231]
    buffer_load_dwordx4 a[16:19], v2, s[20:23], s34 offen offset:0
    v_mfma_f32_16x16x32_bf16 v[232:235], a[20:23], a[136:139], v[232:235]
    v_mul_f32 v20, v20, v58
    v_mul_f32 v21, v21, v59
    v_mfma_f32_16x16x32_bf16 v[236:239], a[20:23], a[140:143], v[236:239]
    v_cvt_pk_bf16_f32 v14, v18, v19
    s_waitcnt lgkmcnt(0)
    v_mfma_f32_16x16x32_bf16 v[144:147], a[24:27], a[112:115], v[144:147]
    buffer_load_dwordx4 a[20:23], v2, s[20:23], s34 offen offset:1024
    v_mfma_f32_16x16x32_bf16 v[148:151], a[24:27], a[116:119], v[148:151]
    ds_read_b128 a[128:131], v0 offset:1152
    ds_read_b128 a[132:135], v0 offset:27776
    v_mfma_f32_16x16x32_bf16 v[152:155], a[24:27], a[120:123], v[152:155]
    ds_read_b128 a[136:139], v1 offset:1152
    ds_read_b128 a[140:143], v1 offset:27776
    v_mfma_f32_16x16x32_bf16 v[156:159], a[24:27], a[124:127], v[156:159]
    v_cvt_pk_bf16_f32 v15, v20, v21
    v_lshlrev_b32 v18, 16, v16
    v_mfma_f32_16x16x32_bf16 v[160:163], a[28:31], a[112:115], v[160:163]
    buffer_load_dwordx4 a[24:27], v2, s[20:23], s34 offen offset:2048
    v_mfma_f32_16x16x32_bf16 v[164:167], a[28:31], a[116:119], v[164:167]
    v_and_b32 v19, 0xffff0000, v16
    v_lshlrev_b32 v20, 16, v17
    v_mfma_f32_16x16x32_bf16 v[168:171], a[28:31], a[120:123], v[168:171]
    v_and_b32 v21, 0xffff0000, v17
    v_mul_f32 v18, v18, v72
    v_mfma_f32_16x16x32_bf16 v[172:175], a[28:31], a[124:127], v[172:175]
    v_mul_f32 v19, v19, v73
    v_mfma_f32_16x16x32_bf16 v[176:179], a[32:35], a[112:115], v[176:179]
    buffer_load_dwordx4 a[28:31], v2, s[20:23], s34 offen offset:3072
    v_mfma_f32_16x16x32_bf16 v[180:183], a[32:35], a[116:119], v[180:183]
    v_mul_f32 v20, v20, v74
    v_mfma_f32_16x16x32_bf16 v[184:187], a[32:35], a[120:123], v[184:187]
    v_mul_f32 v21, v21, v75
    v_mfma_f32_16x16x32_bf16 v[188:191], a[32:35], a[124:127], v[188:191]
    v_cvt_pk_bf16_f32 v16, v18, v19
    s_waitcnt vmcnt(27)
    v_mfma_f32_16x16x32_bf16 v[192:195], a[36:39], a[112:115], v[192:195]
    s_mov_b32 s34, 266240
    v_cvt_pk_bf16_f32 v17, v20, v21
    v_mfma_f32_16x16x32_bf16 v[196:199], a[36:39], a[116:119], v[196:199]
    buffer_load_dwordx4 a[32:35], v2, s[20:23], s34 offen offset:0
    v_mfma_f32_16x16x32_bf16 v[200:203], a[36:39], a[120:123], v[200:203]
    ds_write_b128 v6, v[14:17] offset:2048
    v_mfma_f32_16x16x32_bf16 v[204:207], a[36:39], a[124:127], v[204:207]
    v_add_f32 v56, v56, v38
    s_waitcnt vmcnt(20)
    v_mfma_f32_16x16x32_bf16 v[208:211], a[40:43], a[112:115], v[208:211]
    buffer_load_dwordx4 a[36:39], v2, s[20:23], s34 offen offset:1024
    v_mfma_f32_16x16x32_bf16 v[212:215], a[40:43], a[116:119], v[212:215]
    v_add_f32 v57, v57, v39
    v_add_f32 v58, v58, v40
    v_mfma_f32_16x16x32_bf16 v[216:219], a[40:43], a[120:123], v[216:219]
    v_add_f32 v59, v59, v41
    v_mfma_f32_16x16x32_bf16 v[220:223], a[40:43], a[124:127], v[220:223]
    v_add_f32 v72, v72, v42
    v_mfma_f32_16x16x32_bf16 v[224:227], a[44:47], a[112:115], v[224:227]
    buffer_load_dwordx4 a[40:43], v2, s[20:23], s34 offen offset:2048
    v_mfma_f32_16x16x32_bf16 v[228:231], a[44:47], a[116:119], v[228:231]
    v_add_f32 v73, v73, v43
    v_mfma_f32_16x16x32_bf16 v[232:235], a[44:47], a[120:123], v[232:235]
    v_add_f32 v74, v74, v44
    v_mfma_f32_16x16x32_bf16 v[236:239], a[44:47], a[124:127], v[236:239]
    v_add_f32 v75, v75, v45
    s_waitcnt lgkmcnt(1)
    v_mfma_f32_16x16x32_bf16 v[144:147], a[48:51], a[128:131], v[144:147]
    buffer_load_dwordx4 a[44:47], v2, s[20:23], s34 offen offset:3072
    v_mfma_f32_16x16x32_bf16 v[148:151], a[48:51], a[132:135], v[148:151]
    ds_read_b128 a[112:115], v46 offset:1152
    ds_read_b128 a[116:119], v46 offset:27776
    v_mfma_f32_16x16x32_bf16 v[152:155], a[48:51], a[136:139], v[152:155]
    ds_read_b128 a[120:123], v47 offset:1152
    ds_read_b128 a[124:127], v47 offset:27776
    v_mfma_f32_16x16x32_bf16 v[156:159], a[48:51], a[140:143], v[156:159]
    v_accvgpr_read_b32 v22, a156
    v_accvgpr_read_b32 v23, a157
    v_mfma_f32_16x16x32_bf16 v[160:163], a[52:55], a[128:131], v[160:163]
    s_mov_b32 s34, 270336
    v_accvgpr_read_b32 v24, a158
    v_mfma_f32_16x16x32_bf16 v[164:167], a[52:55], a[132:135], v[164:167]
    buffer_load_dwordx4 a[48:51], v2, s[20:23], s34 offen offset:0
    v_mfma_f32_16x16x32_bf16 v[168:171], a[52:55], a[136:139], v[168:171]
    v_accvgpr_read_b32 v25, a159
    v_lshlrev_b32 v26, 16, v22
    v_mfma_f32_16x16x32_bf16 v[172:175], a[52:55], a[140:143], v[172:175]
    v_and_b32 v27, 0xffff0000, v22
    v_lshlrev_b32 v28, 16, v23
    v_mfma_f32_16x16x32_bf16 v[176:179], a[56:59], a[128:131], v[176:179]
    buffer_load_dwordx4 a[52:55], v2, s[20:23], s34 offen offset:1024
    v_mfma_f32_16x16x32_bf16 v[180:183], a[56:59], a[132:135], v[180:183]
    v_and_b32 v29, 0xffff0000, v23
    v_mfma_f32_16x16x32_bf16 v[184:187], a[56:59], a[136:139], v[184:187]
    v_mul_f32 v26, v26, v60
    v_mfma_f32_16x16x32_bf16 v[188:191], a[56:59], a[140:143], v[188:191]
    v_mul_f32 v27, v27, v61
    v_mfma_f32_16x16x32_bf16 v[192:195], a[60:63], a[128:131], v[192:195]
    buffer_load_dwordx4 a[56:59], v2, s[20:23], s34 offen offset:2048
    v_mfma_f32_16x16x32_bf16 v[196:199], a[60:63], a[132:135], v[196:199]
    v_mul_f32 v28, v28, v62
    v_mul_f32 v29, v29, v63
    v_mfma_f32_16x16x32_bf16 v[200:203], a[60:63], a[136:139], v[200:203]
    v_mfma_f32_16x16x32_bf16 v[204:207], a[60:63], a[140:143], v[204:207]
    v_cvt_pk_bf16_f32 v22, v26, v27
    v_mfma_f32_16x16x32_bf16 v[208:211], a[64:67], a[128:131], v[208:211]
    buffer_load_dwordx4 a[60:63], v2, s[20:23], s34 offen offset:3072
    v_mfma_f32_16x16x32_bf16 v[212:215], a[64:67], a[132:135], v[212:215]
    v_cvt_pk_bf16_f32 v23, v28, v29
    v_lshlrev_b32 v26, 16, v24
    v_mfma_f32_16x16x32_bf16 v[216:219], a[64:67], a[136:139], v[216:219]
    v_and_b32 v27, 0xffff0000, v24
    v_mfma_f32_16x16x32_bf16 v[220:223], a[64:67], a[140:143], v[220:223]
    v_lshlrev_b32 v28, 16, v25
    s_waitcnt vmcnt(20)
    v_mfma_f32_16x16x32_bf16 v[224:227], a[68:71], a[128:131], v[224:227]
    s_mov_b32 s34, 274432
    v_mfma_f32_16x16x32_bf16 v[228:231], a[68:71], a[132:135], v[228:231]
    buffer_load_dwordx4 a[64:67], v2, s[20:23], s34 offen offset:0
    v_mfma_f32_16x16x32_bf16 v[232:235], a[68:71], a[136:139], v[232:235]
    v_and_b32 v29, 0xffff0000, v25
    v_mul_f32 v26, v26, v76
    v_mfma_f32_16x16x32_bf16 v[236:239], a[68:71], a[140:143], v[236:239]
    v_mul_f32 v27, v27, v77
    s_waitcnt lgkmcnt(0)
    v_mfma_f32_16x16x32_bf16 v[144:147], a[72:75], a[112:115], v[144:147]
    buffer_load_dwordx4 a[68:71], v2, s[20:23], s34 offen offset:1024
    v_mfma_f32_16x16x32_bf16 v[148:151], a[72:75], a[116:119], v[148:151]
    ds_read_b128 a[128:131], v0 offset:1280
    ds_read_b128 a[132:135], v0 offset:27904
    v_mfma_f32_16x16x32_bf16 v[152:155], a[72:75], a[120:123], v[152:155]
    ds_read_b128 a[136:139], v1 offset:1280
    ds_read_b128 a[140:143], v1 offset:27904
    v_mfma_f32_16x16x32_bf16 v[156:159], a[72:75], a[124:127], v[156:159]
    v_mul_f32 v28, v28, v78
    v_mul_f32 v29, v29, v79
    v_mfma_f32_16x16x32_bf16 v[160:163], a[76:79], a[112:115], v[160:163]
    buffer_load_dwordx4 a[72:75], v2, s[20:23], s34 offen offset:2048
    v_mfma_f32_16x16x32_bf16 v[164:167], a[76:79], a[116:119], v[164:167]
    v_cvt_pk_bf16_f32 v24, v26, v27
    v_cvt_pk_bf16_f32 v25, v28, v29
    v_mfma_f32_16x16x32_bf16 v[168:171], a[76:79], a[120:123], v[168:171]
    ds_write_b128 v6, v[22:25] offset:3072
    v_mfma_f32_16x16x32_bf16 v[172:175], a[76:79], a[124:127], v[172:175]
    v_add_f32 v60, v60, v38
    v_add_f32 v61, v61, v39
    v_mfma_f32_16x16x32_bf16 v[176:179], a[80:83], a[112:115], v[176:179]
    buffer_load_dwordx4 a[76:79], v2, s[20:23], s34 offen offset:3072
    v_mfma_f32_16x16x32_bf16 v[180:183], a[80:83], a[116:119], v[180:183]
    v_add_f32 v62, v62, v40
    v_mfma_f32_16x16x32_bf16 v[184:187], a[80:83], a[120:123], v[184:187]
    v_add_f32 v63, v63, v41
    v_mfma_f32_16x16x32_bf16 v[188:191], a[80:83], a[124:127], v[188:191]
    v_add_f32 v76, v76, v42
    v_mfma_f32_16x16x32_bf16 v[192:195], a[84:87], a[112:115], v[192:195]
    s_mov_b32 s34, 278528
    v_add_f32 v77, v77, v43
    v_mfma_f32_16x16x32_bf16 v[196:199], a[84:87], a[116:119], v[196:199]
    buffer_load_dwordx4 a[80:83], v2, s[20:23], s34 offen offset:0
    v_mfma_f32_16x16x32_bf16 v[200:203], a[84:87], a[120:123], v[200:203]
    v_add_f32 v78, v78, v44
    v_mfma_f32_16x16x32_bf16 v[204:207], a[84:87], a[124:127], v[204:207]
    v_add_f32 v79, v79, v45
    v_mfma_f32_16x16x32_bf16 v[208:211], a[88:91], a[112:115], v[208:211]
    buffer_load_dwordx4 a[84:87], v2, s[20:23], s34 offen offset:1024
    v_mfma_f32_16x16x32_bf16 v[212:215], a[88:91], a[116:119], v[212:215]
    buffer_load_dwordx4 v[38:41], v12, s[24:27], 0 offen offset:1088
    v_mfma_f32_16x16x32_bf16 v[216:219], a[88:91], a[120:123], v[216:219]
    buffer_load_dwordx4 v[42:45], v12, s[24:27], 0 offen offset:1152
    v_mfma_f32_16x16x32_bf16 v[220:223], a[88:91], a[124:127], v[220:223]
    v_accvgpr_read_b32 v14, a160
    v_accvgpr_read_b32 v15, a161
    v_mfma_f32_16x16x32_bf16 v[224:227], a[92:95], a[112:115], v[224:227]
    buffer_load_dwordx4 a[88:91], v2, s[20:23], s34 offen offset:2048
    v_mfma_f32_16x16x32_bf16 v[228:231], a[92:95], a[116:119], v[228:231]
    v_accvgpr_read_b32 v16, a162
    v_mfma_f32_16x16x32_bf16 v[232:235], a[92:95], a[120:123], v[232:235]
    v_accvgpr_read_b32 v17, a163
    v_mfma_f32_16x16x32_bf16 v[236:239], a[92:95], a[124:127], v[236:239]
    v_lshlrev_b32 v18, 16, v14
    s_waitcnt vmcnt(22) lgkmcnt(1)
    v_mfma_f32_16x16x32_bf16 v[144:147], a[96:99], a[128:131], v[144:147]
    buffer_load_dwordx4 a[92:95], v2, s[20:23], s34 offen offset:3072
    v_mfma_f32_16x16x32_bf16 v[148:151], a[96:99], a[132:135], v[148:151]
    ds_read_b128 a[112:115], v0 offset:1536
    ds_read_b128 a[116:119], v0 offset:28160
    v_mfma_f32_16x16x32_bf16 v[152:155], a[96:99], a[136:139], v[152:155]
    ds_read_b128 a[120:123], v1 offset:1536
    ds_read_b128 a[124:127], v1 offset:28160
    v_mfma_f32_16x16x32_bf16 v[156:159], a[96:99], a[140:143], v[156:159]
    v_and_b32 v19, 0xffff0000, v14
    v_lshlrev_b32 v20, 16, v15
    v_mfma_f32_16x16x32_bf16 v[160:163], a[100:103], a[128:131], v[160:163]
    s_mov_b32 s34, 282624
    v_and_b32 v21, 0xffff0000, v15
    v_mfma_f32_16x16x32_bf16 v[164:167], a[100:103], a[132:135], v[164:167]
    buffer_load_dwordx4 a[96:99], v2, s[20:23], s34 offen offset:0
    v_mfma_f32_16x16x32_bf16 v[168:171], a[100:103], a[136:139], v[168:171]
    v_mul_f32 v18, v18, v80
    v_mul_f32 v19, v19, v81
    v_mfma_f32_16x16x32_bf16 v[172:175], a[100:103], a[140:143], v[172:175]
    v_mul_f32 v20, v20, v82
    v_mul_f32 v21, v21, v83
    v_mfma_f32_16x16x32_bf16 v[176:179], a[104:107], a[128:131], v[176:179]
    buffer_load_dwordx4 a[100:103], v2, s[20:23], s34 offen offset:1024
    v_mfma_f32_16x16x32_bf16 v[180:183], a[104:107], a[132:135], v[180:183]
    v_cvt_pk_bf16_f32 v14, v18, v19
    v_mfma_f32_16x16x32_bf16 v[184:187], a[104:107], a[136:139], v[184:187]
    v_cvt_pk_bf16_f32 v15, v20, v21
    v_mfma_f32_16x16x32_bf16 v[188:191], a[104:107], a[140:143], v[188:191]
    v_lshlrev_b32 v18, 16, v16
    v_mfma_f32_16x16x32_bf16 v[192:195], a[108:111], a[128:131], v[192:195]
    buffer_load_dwordx4 a[104:107], v2, s[20:23], s34 offen offset:2048
    v_mfma_f32_16x16x32_bf16 v[196:199], a[108:111], a[132:135], v[196:199]
    v_and_b32 v19, 0xffff0000, v16
    v_lshlrev_b32 v20, 16, v17
    v_mfma_f32_16x16x32_bf16 v[200:203], a[108:111], a[136:139], v[200:203]
    v_mfma_f32_16x16x32_bf16 v[204:207], a[108:111], a[140:143], v[204:207]
    v_and_b32 v21, 0xffff0000, v17
    v_mfma_f32_16x16x32_bf16 v[208:211], a[0:3], a[128:131], v[208:211]
    buffer_load_dwordx4 a[108:111], v2, s[20:23], s34 offen offset:3072
    v_mfma_f32_16x16x32_bf16 v[212:215], a[0:3], a[132:135], v[212:215]
    v_mul_f32 v18, v18, v96
    v_mul_f32 v19, v19, v97
    v_mfma_f32_16x16x32_bf16 v[216:219], a[0:3], a[136:139], v[216:219]
    v_mul_f32 v20, v20, v98
    v_mfma_f32_16x16x32_bf16 v[220:223], a[0:3], a[140:143], v[220:223]
    v_mul_f32 v21, v21, v99
    v_mfma_f32_16x16x32_bf16 v[224:227], a[4:7], a[128:131], v[224:227]
    s_mov_b32 s34, 286720
    v_mfma_f32_16x16x32_bf16 v[228:231], a[4:7], a[132:135], v[228:231]
    buffer_load_dwordx4 a[0:3], v2, s[20:23], s34 offen offset:0
    v_mfma_f32_16x16x32_bf16 v[232:235], a[4:7], a[136:139], v[232:235]
    v_cvt_pk_bf16_f32 v16, v18, v19
    v_cvt_pk_bf16_f32 v17, v20, v21
    v_mfma_f32_16x16x32_bf16 v[236:239], a[4:7], a[140:143], v[236:239]
    ds_write_b128 v6, v[14:17] offset:4096
    s_waitcnt lgkmcnt(1)
    v_mfma_f32_16x16x32_bf16 v[144:147], a[8:11], a[112:115], v[144:147]
    buffer_load_dwordx4 a[4:7], v2, s[20:23], s34 offen offset:1024
    v_mfma_f32_16x16x32_bf16 v[148:151], a[8:11], a[116:119], v[148:151]
    ds_read_b128 a[128:131], v46 offset:1536
    ds_read_b128 a[132:135], v46 offset:28160
    v_mfma_f32_16x16x32_bf16 v[152:155], a[8:11], a[120:123], v[152:155]
    ds_read_b128 a[136:139], v47 offset:1536
    ds_read_b128 a[140:143], v47 offset:28160
    v_mfma_f32_16x16x32_bf16 v[156:159], a[8:11], a[124:127], v[156:159]
    v_add_f32 v80, v80, v30
    v_add_f32 v81, v81, v31
    s_waitcnt vmcnt(22)
    v_mfma_f32_16x16x32_bf16 v[160:163], a[12:15], a[112:115], v[160:163]
    buffer_load_dwordx4 a[8:11], v2, s[20:23], s34 offen offset:2048
    v_mfma_f32_16x16x32_bf16 v[164:167], a[12:15], a[116:119], v[164:167]
    v_add_f32 v82, v82, v32
    v_add_f32 v83, v83, v33
    v_mfma_f32_16x16x32_bf16 v[168:171], a[12:15], a[120:123], v[168:171]
    v_add_f32 v96, v96, v34
    v_add_f32 v97, v97, v35
    v_mfma_f32_16x16x32_bf16 v[172:175], a[12:15], a[124:127], v[172:175]
    v_mfma_f32_16x16x32_bf16 v[176:179], a[16:19], a[112:115], v[176:179]
    buffer_load_dwordx4 a[12:15], v2, s[20:23], s34 offen offset:3072
    v_mfma_f32_16x16x32_bf16 v[180:183], a[16:19], a[116:119], v[180:183]
    v_add_f32 v98, v98, v36
    v_add_f32 v99, v99, v37
    v_mfma_f32_16x16x32_bf16 v[184:187], a[16:19], a[120:123], v[184:187]
    v_accvgpr_read_b32 v22, a164
    v_mfma_f32_16x16x32_bf16 v[188:191], a[16:19], a[124:127], v[188:191]
    v_accvgpr_read_b32 v23, a165
    v_mfma_f32_16x16x32_bf16 v[192:195], a[20:23], a[112:115], v[192:195]
    s_mov_b32 s34, 290816
    v_accvgpr_read_b32 v24, a166
    v_mfma_f32_16x16x32_bf16 v[196:199], a[20:23], a[116:119], v[196:199]
    buffer_load_dwordx4 a[16:19], v2, s[20:23], s34 offen offset:0
    v_mfma_f32_16x16x32_bf16 v[200:203], a[20:23], a[120:123], v[200:203]
    v_accvgpr_read_b32 v25, a167
    v_mfma_f32_16x16x32_bf16 v[204:207], a[20:23], a[124:127], v[204:207]
    v_lshlrev_b32 v26, 16, v22
    v_mfma_f32_16x16x32_bf16 v[208:211], a[24:27], a[112:115], v[208:211]
    buffer_load_dwordx4 a[20:23], v2, s[20:23], s34 offen offset:1024
    v_mfma_f32_16x16x32_bf16 v[212:215], a[24:27], a[116:119], v[212:215]
    v_and_b32 v27, 0xffff0000, v22
    v_lshlrev_b32 v28, 16, v23
    v_mfma_f32_16x16x32_bf16 v[216:219], a[24:27], a[120:123], v[216:219]
    v_and_b32 v29, 0xffff0000, v23
    v_mfma_f32_16x16x32_bf16 v[220:223], a[24:27], a[124:127], v[220:223]
    v_mfma_f32_16x16x32_bf16 v[224:227], a[28:31], a[112:115], v[224:227]
    buffer_load_dwordx4 a[24:27], v2, s[20:23], s34 offen offset:2048
    v_mfma_f32_16x16x32_bf16 v[228:231], a[28:31], a[116:119], v[228:231]
    v_mul_f32 v26, v26, v84
    v_mul_f32 v27, v27, v85
    v_mfma_f32_16x16x32_bf16 v[232:235], a[28:31], a[120:123], v[232:235]
    v_mul_f32 v28, v28, v86
    v_mfma_f32_16x16x32_bf16 v[236:239], a[28:31], a[124:127], v[236:239]
    v_mul_f32 v29, v29, v87
    s_waitcnt lgkmcnt(0)
    v_mfma_f32_16x16x32_bf16 v[144:147], a[32:35], a[128:131], v[144:147]
    buffer_load_dwordx4 a[28:31], v2, s[20:23], s34 offen offset:3072
    v_mfma_f32_16x16x32_bf16 v[148:151], a[32:35], a[132:135], v[148:151]
    ds_read_b128 a[112:115], v46 offset:128
    ds_read_b128 a[116:119], v46 offset:26752
    v_mfma_f32_16x16x32_bf16 v[152:155], a[32:35], a[136:139], v[152:155]
    ds_read_b128 a[120:123], v47 offset:128
    ds_read_b128 a[124:127], v47 offset:26752
    v_mfma_f32_16x16x32_bf16 v[156:159], a[32:35], a[140:143], v[156:159]
    v_cvt_pk_bf16_f32 v22, v26, v27
    v_cvt_pk_bf16_f32 v23, v28, v29
    v_mfma_f32_16x16x32_bf16 v[160:163], a[36:39], a[128:131], v[160:163]
    s_mov_b32 s34, 294912
    v_lshlrev_b32 v26, 16, v24
    v_mfma_f32_16x16x32_bf16 v[164:167], a[36:39], a[132:135], v[164:167]
    buffer_load_dwordx4 a[32:35], v2, s[20:23], s34 offen offset:0
    v_mfma_f32_16x16x32_bf16 v[168:171], a[36:39], a[136:139], v[168:171]
    v_and_b32 v27, 0xffff0000, v24
    v_lshlrev_b32 v28, 16, v25
    v_mfma_f32_16x16x32_bf16 v[172:175], a[36:39], a[140:143], v[172:175]
    v_and_b32 v29, 0xffff0000, v25
    s_waitcnt vmcnt(22)
    v_mfma_f32_16x16x32_bf16 v[176:179], a[40:43], a[128:131], v[176:179]
    buffer_load_dwordx4 a[36:39], v2, s[20:23], s34 offen offset:1024
    v_mfma_f32_16x16x32_bf16 v[180:183], a[40:43], a[132:135], v[180:183]
    v_mul_f32 v26, v26, v100
    v_mul_f32 v27, v27, v101
    v_mfma_f32_16x16x32_bf16 v[184:187], a[40:43], a[136:139], v[184:187]
    v_mul_f32 v28, v28, v102
    v_mfma_f32_16x16x32_bf16 v[188:191], a[40:43], a[140:143], v[188:191]
    v_mul_f32 v29, v29, v103
    v_mfma_f32_16x16x32_bf16 v[192:195], a[44:47], a[128:131], v[192:195]
    buffer_load_dwordx4 a[40:43], v2, s[20:23], s34 offen offset:2048
    v_mfma_f32_16x16x32_bf16 v[196:199], a[44:47], a[132:135], v[196:199]
    v_cvt_pk_bf16_f32 v24, v26, v27
    v_mfma_f32_16x16x32_bf16 v[200:203], a[44:47], a[136:139], v[200:203]
    v_cvt_pk_bf16_f32 v25, v28, v29
    v_mfma_f32_16x16x32_bf16 v[204:207], a[44:47], a[140:143], v[204:207]
    ds_write_b128 v6, v[22:25] offset:5120
    v_mfma_f32_16x16x32_bf16 v[208:211], a[48:51], a[128:131], v[208:211]
    buffer_load_dwordx4 a[44:47], v2, s[20:23], s34 offen offset:3072
    v_mfma_f32_16x16x32_bf16 v[212:215], a[48:51], a[132:135], v[212:215]
    v_add_f32 v84, v84, v30
    v_add_f32 v85, v85, v31
    v_mfma_f32_16x16x32_bf16 v[216:219], a[48:51], a[136:139], v[216:219]
    v_add_f32 v86, v86, v32
    v_mfma_f32_16x16x32_bf16 v[220:223], a[48:51], a[140:143], v[220:223]
    v_mfma_f32_16x16x32_bf16 v[224:227], a[52:55], a[128:131], v[224:227]
    s_mov_b32 s34, 299008
    v_add_f32 v87, v87, v33
    v_mfma_f32_16x16x32_bf16 v[228:231], a[52:55], a[132:135], v[228:231]
    buffer_load_dwordx4 a[48:51], v2, s[20:23], s34 offen offset:0
    v_mfma_f32_16x16x32_bf16 v[232:235], a[52:55], a[136:139], v[232:235]
    v_add_f32 v100, v100, v34
    v_add_f32 v101, v101, v35
    v_mfma_f32_16x16x32_bf16 v[236:239], a[52:55], a[140:143], v[236:239]
    v_add_f32 v102, v102, v36
    s_waitcnt lgkmcnt(1)
    v_mfma_f32_16x16x32_bf16 v[144:147], a[56:59], a[112:115], v[144:147]
    buffer_load_dwordx4 a[52:55], v2, s[20:23], s34 offen offset:1024
    v_mfma_f32_16x16x32_bf16 v[148:151], a[56:59], a[116:119], v[148:151]
    ds_read_b128 a[128:131], v0 offset:256
    ds_read_b128 a[132:135], v0 offset:26880
    v_mfma_f32_16x16x32_bf16 v[152:155], a[56:59], a[120:123], v[152:155]
    ds_read_b128 a[136:139], v1 offset:256
    ds_read_b128 a[140:143], v1 offset:26880
    v_mfma_f32_16x16x32_bf16 v[156:159], a[56:59], a[124:127], v[156:159]
    v_add_f32 v103, v103, v37
    v_accvgpr_read_b32 v14, a168
    v_mfma_f32_16x16x32_bf16 v[160:163], a[60:63], a[112:115], v[160:163]
    buffer_load_dwordx4 a[56:59], v2, s[20:23], s34 offen offset:2048
    v_mfma_f32_16x16x32_bf16 v[164:167], a[60:63], a[116:119], v[164:167]
    v_accvgpr_read_b32 v15, a169
    v_accvgpr_read_b32 v16, a170
    v_mfma_f32_16x16x32_bf16 v[168:171], a[60:63], a[120:123], v[168:171]
    v_accvgpr_read_b32 v17, a171
    v_lshlrev_b32 v18, 16, v14
    v_mfma_f32_16x16x32_bf16 v[172:175], a[60:63], a[124:127], v[172:175]
    v_mfma_f32_16x16x32_bf16 v[176:179], a[64:67], a[112:115], v[176:179]
    buffer_load_dwordx4 a[60:63], v2, s[20:23], s34 offen offset:3072
    v_mfma_f32_16x16x32_bf16 v[180:183], a[64:67], a[116:119], v[180:183]
    v_and_b32 v19, 0xffff0000, v14
    v_lshlrev_b32 v20, 16, v15
    v_mfma_f32_16x16x32_bf16 v[184:187], a[64:67], a[120:123], v[184:187]
    v_and_b32 v21, 0xffff0000, v15
    v_mfma_f32_16x16x32_bf16 v[188:191], a[64:67], a[124:127], v[188:191]
    v_mul_f32 v18, v18, v88
    s_waitcnt vmcnt(24)
    v_mfma_f32_16x16x32_bf16 v[192:195], a[68:71], a[112:115], v[192:195]
    s_mov_b32 s34, 303104
    v_mul_f32 v19, v19, v89
    v_mfma_f32_16x16x32_bf16 v[196:199], a[68:71], a[116:119], v[196:199]
    buffer_load_dwordx4 a[64:67], v2, s[20:23], s34 offen offset:0
    v_mfma_f32_16x16x32_bf16 v[200:203], a[68:71], a[120:123], v[200:203]
    v_mul_f32 v20, v20, v90
    v_mfma_f32_16x16x32_bf16 v[204:207], a[68:71], a[124:127], v[204:207]
    v_mul_f32 v21, v21, v91
    v_mfma_f32_16x16x32_bf16 v[208:211], a[72:75], a[112:115], v[208:211]
    buffer_load_dwordx4 a[68:71], v2, s[20:23], s34 offen offset:1024
    v_mfma_f32_16x16x32_bf16 v[212:215], a[72:75], a[116:119], v[212:215]
    v_cvt_pk_bf16_f32 v14, v18, v19
    v_cvt_pk_bf16_f32 v15, v20, v21
    v_mfma_f32_16x16x32_bf16 v[216:219], a[72:75], a[120:123], v[216:219]
    v_lshlrev_b32 v18, 16, v16
    v_mfma_f32_16x16x32_bf16 v[220:223], a[72:75], a[124:127], v[220:223]
    v_mfma_f32_16x16x32_bf16 v[224:227], a[76:79], a[112:115], v[224:227]
    buffer_load_dwordx4 a[72:75], v2, s[20:23], s34 offen offset:2048
    v_mfma_f32_16x16x32_bf16 v[228:231], a[76:79], a[116:119], v[228:231]
    v_and_b32 v19, 0xffff0000, v16
    v_lshlrev_b32 v20, 16, v17
    v_mfma_f32_16x16x32_bf16 v[232:235], a[76:79], a[120:123], v[232:235]
    v_and_b32 v21, 0xffff0000, v17
    v_mfma_f32_16x16x32_bf16 v[236:239], a[76:79], a[124:127], v[236:239]
    v_mul_f32 v18, v18, v104
    s_waitcnt lgkmcnt(0)
    v_mfma_f32_16x16x32_bf16 v[144:147], a[80:83], a[128:131], v[144:147]
    buffer_load_dwordx4 a[76:79], v2, s[20:23], s34 offen offset:3072
    v_mfma_f32_16x16x32_bf16 v[148:151], a[80:83], a[132:135], v[148:151]
    ds_read_b128 a[112:115], v46 offset:256
    ds_read_b128 a[116:119], v46 offset:26880
    v_mfma_f32_16x16x32_bf16 v[152:155], a[80:83], a[136:139], v[152:155]
    ds_read_b128 a[120:123], v47 offset:256
    ds_read_b128 a[124:127], v47 offset:26880
    v_mfma_f32_16x16x32_bf16 v[156:159], a[80:83], a[140:143], v[156:159]
    v_mul_f32 v19, v19, v105
    v_mul_f32 v20, v20, v106
    v_mfma_f32_16x16x32_bf16 v[160:163], a[84:87], a[128:131], v[160:163]
    s_mov_b32 s34, 307200
    v_mul_f32 v21, v21, v107
    v_mfma_f32_16x16x32_bf16 v[164:167], a[84:87], a[132:135], v[164:167]
    buffer_load_dwordx4 a[80:83], v2, s[20:23], s34 offen offset:0
    v_mfma_f32_16x16x32_bf16 v[168:171], a[84:87], a[136:139], v[168:171]
    v_cvt_pk_bf16_f32 v16, v18, v19
    v_cvt_pk_bf16_f32 v17, v20, v21
    v_mfma_f32_16x16x32_bf16 v[172:175], a[84:87], a[140:143], v[172:175]
    ds_write_b128 v6, v[14:17] offset:6144
    s_waitcnt vmcnt(20)
    v_mfma_f32_16x16x32_bf16 v[176:179], a[88:91], a[128:131], v[176:179]
    buffer_load_dwordx4 a[84:87], v2, s[20:23], s34 offen offset:1024
    v_mfma_f32_16x16x32_bf16 v[180:183], a[88:91], a[132:135], v[180:183]
    v_add_f32 v88, v88, v30
    v_add_f32 v89, v89, v31
    v_mfma_f32_16x16x32_bf16 v[184:187], a[88:91], a[136:139], v[184:187]
    v_add_f32 v90, v90, v32
    v_mfma_f32_16x16x32_bf16 v[188:191], a[88:91], a[140:143], v[188:191]
    v_add_f32 v91, v91, v33
    v_mfma_f32_16x16x32_bf16 v[192:195], a[92:95], a[128:131], v[192:195]
    buffer_load_dwordx4 a[88:91], v2, s[20:23], s34 offen offset:2048
    v_mfma_f32_16x16x32_bf16 v[196:199], a[92:95], a[132:135], v[196:199]
    v_add_f32 v104, v104, v34
    v_mfma_f32_16x16x32_bf16 v[200:203], a[92:95], a[136:139], v[200:203]
    v_add_f32 v105, v105, v35
    v_mfma_f32_16x16x32_bf16 v[204:207], a[92:95], a[140:143], v[204:207]
    v_add_f32 v106, v106, v36
    v_mfma_f32_16x16x32_bf16 v[208:211], a[96:99], a[128:131], v[208:211]
    buffer_load_dwordx4 a[92:95], v2, s[20:23], s34 offen offset:3072
    v_mfma_f32_16x16x32_bf16 v[212:215], a[96:99], a[132:135], v[212:215]
    v_add_f32 v107, v107, v37
    v_accvgpr_read_b32 v22, a172
    v_mfma_f32_16x16x32_bf16 v[216:219], a[96:99], a[136:139], v[216:219]
    v_accvgpr_read_b32 v23, a173
    v_mfma_f32_16x16x32_bf16 v[220:223], a[96:99], a[140:143], v[220:223]
    v_mfma_f32_16x16x32_bf16 v[224:227], a[100:103], a[128:131], v[224:227]
    s_mov_b32 s34, 311296
    v_accvgpr_read_b32 v24, a174
    v_mfma_f32_16x16x32_bf16 v[228:231], a[100:103], a[132:135], v[228:231]
    buffer_load_dwordx4 a[96:99], v2, s[20:23], s34 offen offset:0
    v_mfma_f32_16x16x32_bf16 v[232:235], a[100:103], a[136:139], v[232:235]
    v_accvgpr_read_b32 v25, a175
    v_lshlrev_b32 v26, 16, v22
    v_mfma_f32_16x16x32_bf16 v[236:239], a[100:103], a[140:143], v[236:239]
    v_and_b32 v27, 0xffff0000, v22
    s_waitcnt lgkmcnt(1)
    v_mfma_f32_16x16x32_bf16 v[144:147], a[104:107], a[112:115], v[144:147]
    buffer_load_dwordx4 a[100:103], v2, s[20:23], s34 offen offset:1024
    v_mfma_f32_16x16x32_bf16 v[148:151], a[104:107], a[116:119], v[148:151]
    ds_read_b128 a[128:131], v46 offset:512
    ds_read_b128 a[132:135], v46 offset:27136
    v_mfma_f32_16x16x32_bf16 v[152:155], a[104:107], a[120:123], v[152:155]
    ds_read_b128 a[136:139], v47 offset:512
    ds_read_b128 a[140:143], v47 offset:27136
    v_mfma_f32_16x16x32_bf16 v[156:159], a[104:107], a[124:127], v[156:159]
    v_lshlrev_b32 v28, 16, v23
    v_and_b32 v29, 0xffff0000, v23
    v_mfma_f32_16x16x32_bf16 v[160:163], a[108:111], a[112:115], v[160:163]
    buffer_load_dwordx4 a[104:107], v2, s[20:23], s34 offen offset:2048
    v_mfma_f32_16x16x32_bf16 v[164:167], a[108:111], a[116:119], v[164:167]
    v_mul_f32 v26, v26, v92
    v_mul_f32 v27, v27, v93
    v_mfma_f32_16x16x32_bf16 v[168:171], a[108:111], a[120:123], v[168:171]
    v_mul_f32 v28, v28, v94
    v_mul_f32 v29, v29, v95
    v_mfma_f32_16x16x32_bf16 v[172:175], a[108:111], a[124:127], v[172:175]
    v_mfma_f32_16x16x32_bf16 v[176:179], a[0:3], a[112:115], v[176:179]
    buffer_load_dwordx4 a[108:111], v2, s[20:23], s34 offen offset:3072
    v_mfma_f32_16x16x32_bf16 v[180:183], a[0:3], a[116:119], v[180:183]
    v_cvt_pk_bf16_f32 v22, v26, v27
    v_cvt_pk_bf16_f32 v23, v28, v29
    v_mfma_f32_16x16x32_bf16 v[184:187], a[0:3], a[120:123], v[184:187]
    v_lshlrev_b32 v26, 16, v24
    v_mfma_f32_16x16x32_bf16 v[188:191], a[0:3], a[124:127], v[188:191]
    v_and_b32 v27, 0xffff0000, v24
    s_waitcnt vmcnt(20)
    v_mfma_f32_16x16x32_bf16 v[192:195], a[4:7], a[112:115], v[192:195]
    s_mov_b32 s34, 315392
    v_lshlrev_b32 v28, 16, v25
    v_mfma_f32_16x16x32_bf16 v[196:199], a[4:7], a[116:119], v[196:199]
    buffer_load_dwordx4 a[0:3], v2, s[20:23], s34 offen offset:0
    v_mfma_f32_16x16x32_bf16 v[200:203], a[4:7], a[120:123], v[200:203]
    v_and_b32 v29, 0xffff0000, v25
    v_mfma_f32_16x16x32_bf16 v[204:207], a[4:7], a[124:127], v[204:207]
    v_mul_f32 v26, v26, v108
    v_mfma_f32_16x16x32_bf16 v[208:211], a[8:11], a[112:115], v[208:211]
    buffer_load_dwordx4 a[4:7], v2, s[20:23], s34 offen offset:1024
    v_mfma_f32_16x16x32_bf16 v[212:215], a[8:11], a[116:119], v[212:215]
    v_mul_f32 v27, v27, v109
    v_mul_f32 v28, v28, v110
    v_mfma_f32_16x16x32_bf16 v[216:219], a[8:11], a[120:123], v[216:219]
    v_mul_f32 v29, v29, v111
    v_mfma_f32_16x16x32_bf16 v[220:223], a[8:11], a[124:127], v[220:223]
    v_mfma_f32_16x16x32_bf16 v[224:227], a[12:15], a[112:115], v[224:227]
    buffer_load_dwordx4 a[8:11], v2, s[20:23], s34 offen offset:2048
    v_mfma_f32_16x16x32_bf16 v[228:231], a[12:15], a[116:119], v[228:231]
    v_cvt_pk_bf16_f32 v24, v26, v27
    v_cvt_pk_bf16_f32 v25, v28, v29
    v_mfma_f32_16x16x32_bf16 v[232:235], a[12:15], a[120:123], v[232:235]
    ds_write_b128 v6, v[22:25] offset:7168
    v_mfma_f32_16x16x32_bf16 v[236:239], a[12:15], a[124:127], v[236:239]
    v_add_f32 v92, v92, v30
    s_waitcnt lgkmcnt(1)
    v_mfma_f32_16x16x32_bf16 v[144:147], a[16:19], a[128:131], v[144:147]
    buffer_load_dwordx4 a[12:15], v2, s[20:23], s34 offen offset:3072
    v_mfma_f32_16x16x32_bf16 v[148:151], a[16:19], a[132:135], v[148:151]
    ds_read_b128 a[112:115], v0 offset:640
    ds_read_b128 a[116:119], v0 offset:27264
    v_mfma_f32_16x16x32_bf16 v[152:155], a[16:19], a[136:139], v[152:155]
    ds_read_b128 a[120:123], v1 offset:640
    ds_read_b128 a[124:127], v1 offset:27264
    v_mfma_f32_16x16x32_bf16 v[156:159], a[16:19], a[140:143], v[156:159]
    v_add_f32 v93, v93, v31
    v_add_f32 v94, v94, v32
    v_mfma_f32_16x16x32_bf16 v[160:163], a[20:23], a[128:131], v[160:163]
    s_mov_b32 s34, 319488
    v_add_f32 v95, v95, v33
    v_mfma_f32_16x16x32_bf16 v[164:167], a[20:23], a[132:135], v[164:167]
    buffer_load_dwordx4 a[16:19], v2, s[20:23], s34 offen offset:0
    v_mfma_f32_16x16x32_bf16 v[168:171], a[20:23], a[136:139], v[168:171]
    v_add_f32 v108, v108, v34
    v_add_f32 v109, v109, v35
    v_mfma_f32_16x16x32_bf16 v[172:175], a[20:23], a[140:143], v[172:175]
    v_add_f32 v110, v110, v36
    v_mfma_f32_16x16x32_bf16 v[176:179], a[24:27], a[128:131], v[176:179]
    buffer_load_dwordx4 a[20:23], v2, s[20:23], s34 offen offset:1024
    v_mfma_f32_16x16x32_bf16 v[180:183], a[24:27], a[132:135], v[180:183]
    v_add_f32 v111, v111, v37
    v_accvgpr_read_b32 v14, a176
    v_mfma_f32_16x16x32_bf16 v[184:187], a[24:27], a[136:139], v[184:187]
    v_accvgpr_read_b32 v15, a177
    v_mfma_f32_16x16x32_bf16 v[188:191], a[24:27], a[140:143], v[188:191]
    v_accvgpr_read_b32 v16, a178
    v_mfma_f32_16x16x32_bf16 v[192:195], a[28:31], a[128:131], v[192:195]
    buffer_load_dwordx4 a[24:27], v2, s[20:23], s34 offen offset:2048
    v_mfma_f32_16x16x32_bf16 v[196:199], a[28:31], a[132:135], v[196:199]
    v_accvgpr_read_b32 v17, a179
    v_mfma_f32_16x16x32_bf16 v[200:203], a[28:31], a[136:139], v[200:203]
    v_lshlrev_b32 v18, 16, v14
    v_mfma_f32_16x16x32_bf16 v[204:207], a[28:31], a[140:143], v[204:207]
    v_and_b32 v19, 0xffff0000, v14
    s_waitcnt vmcnt(20)
    v_mfma_f32_16x16x32_bf16 v[208:211], a[32:35], a[128:131], v[208:211]
    buffer_load_dwordx4 a[28:31], v2, s[20:23], s34 offen offset:3072
    v_mfma_f32_16x16x32_bf16 v[212:215], a[32:35], a[132:135], v[212:215]
    v_lshlrev_b32 v20, 16, v15
    v_and_b32 v21, 0xffff0000, v15
    v_mfma_f32_16x16x32_bf16 v[216:219], a[32:35], a[136:139], v[216:219]
    v_mul_f32 v18, v18, v112
    v_mfma_f32_16x16x32_bf16 v[220:223], a[32:35], a[140:143], v[220:223]
    v_mfma_f32_16x16x32_bf16 v[224:227], a[36:39], a[128:131], v[224:227]
    s_mov_b32 s34, 323584
    v_mul_f32 v19, v19, v113
    v_mfma_f32_16x16x32_bf16 v[228:231], a[36:39], a[132:135], v[228:231]
    buffer_load_dwordx4 a[32:35], v2, s[20:23], s34 offen offset:0
    v_mfma_f32_16x16x32_bf16 v[232:235], a[36:39], a[136:139], v[232:235]
    v_mul_f32 v20, v20, v114
    v_mul_f32 v21, v21, v115
    v_mfma_f32_16x16x32_bf16 v[236:239], a[36:39], a[140:143], v[236:239]
    v_cvt_pk_bf16_f32 v14, v18, v19
    s_waitcnt lgkmcnt(0)
    v_mfma_f32_16x16x32_bf16 v[144:147], a[40:43], a[112:115], v[144:147]
    buffer_load_dwordx4 a[36:39], v2, s[20:23], s34 offen offset:1024
    v_mfma_f32_16x16x32_bf16 v[148:151], a[40:43], a[116:119], v[148:151]
    ds_read_b128 a[128:131], v46 offset:640
    ds_read_b128 a[132:135], v46 offset:27264
    v_mfma_f32_16x16x32_bf16 v[152:155], a[40:43], a[120:123], v[152:155]
    ds_read_b128 a[136:139], v47 offset:640
    ds_read_b128 a[140:143], v47 offset:27264
    v_mfma_f32_16x16x32_bf16 v[156:159], a[40:43], a[124:127], v[156:159]
    v_cvt_pk_bf16_f32 v15, v20, v21
    v_lshlrev_b32 v18, 16, v16
    v_mfma_f32_16x16x32_bf16 v[160:163], a[44:47], a[112:115], v[160:163]
    buffer_load_dwordx4 a[40:43], v2, s[20:23], s34 offen offset:2048
    v_mfma_f32_16x16x32_bf16 v[164:167], a[44:47], a[116:119], v[164:167]
    v_and_b32 v19, 0xffff0000, v16
    v_lshlrev_b32 v20, 16, v17
    v_mfma_f32_16x16x32_bf16 v[168:171], a[44:47], a[120:123], v[168:171]
    v_and_b32 v21, 0xffff0000, v17
    v_mfma_f32_16x16x32_bf16 v[172:175], a[44:47], a[124:127], v[172:175]
    v_mul_f32 v18, v18, v128
    v_mfma_f32_16x16x32_bf16 v[176:179], a[48:51], a[112:115], v[176:179]
    buffer_load_dwordx4 a[44:47], v2, s[20:23], s34 offen offset:3072
    v_mfma_f32_16x16x32_bf16 v[180:183], a[48:51], a[116:119], v[180:183]
    v_mul_f32 v19, v19, v129
    v_mul_f32 v20, v20, v130
    v_mfma_f32_16x16x32_bf16 v[184:187], a[48:51], a[120:123], v[184:187]
    v_mul_f32 v21, v21, v131
    v_mfma_f32_16x16x32_bf16 v[188:191], a[48:51], a[124:127], v[188:191]
    v_cvt_pk_bf16_f32 v16, v18, v19
    v_mfma_f32_16x16x32_bf16 v[192:195], a[52:55], a[112:115], v[192:195]
    s_mov_b32 s34, 327680
    v_mfma_f32_16x16x32_bf16 v[196:199], a[52:55], a[116:119], v[196:199]
    buffer_load_dwordx4 a[48:51], v2, s[20:23], s34 offen offset:0
    v_mfma_f32_16x16x32_bf16 v[200:203], a[52:55], a[120:123], v[200:203]
    v_cvt_pk_bf16_f32 v17, v20, v21
    v_mfma_f32_16x16x32_bf16 v[204:207], a[52:55], a[124:127], v[204:207]
    ds_write_b128 v6, v[14:17] offset:8192
    v_mfma_f32_16x16x32_bf16 v[208:211], a[56:59], a[112:115], v[208:211]
    buffer_load_dwordx4 a[52:55], v2, s[20:23], s34 offen offset:1024
    v_mfma_f32_16x16x32_bf16 v[212:215], a[56:59], a[116:119], v[212:215]
    v_add_f32 v112, v112, v38
    v_add_f32 v113, v113, v39
    v_mfma_f32_16x16x32_bf16 v[216:219], a[56:59], a[120:123], v[216:219]
    v_add_f32 v114, v114, v40
    v_mfma_f32_16x16x32_bf16 v[220:223], a[56:59], a[124:127], v[220:223]
    v_add_f32 v115, v115, v41
    s_waitcnt vmcnt(20)
    v_mfma_f32_16x16x32_bf16 v[224:227], a[60:63], a[112:115], v[224:227]
    buffer_load_dwordx4 a[56:59], v2, s[20:23], s34 offen offset:2048
    v_mfma_f32_16x16x32_bf16 v[228:231], a[60:63], a[116:119], v[228:231]
    v_add_f32 v128, v128, v42
    v_add_f32 v129, v129, v43
    v_mfma_f32_16x16x32_bf16 v[232:235], a[60:63], a[120:123], v[232:235]
    v_add_f32 v130, v130, v44
    v_mfma_f32_16x16x32_bf16 v[236:239], a[60:63], a[124:127], v[236:239]
    v_add_f32 v131, v131, v45
    s_waitcnt lgkmcnt(1)
    v_mfma_f32_16x16x32_bf16 v[144:147], a[64:67], a[128:131], v[144:147]
    buffer_load_dwordx4 a[60:63], v2, s[20:23], s34 offen offset:3072
    v_mfma_f32_16x16x32_bf16 v[148:151], a[64:67], a[132:135], v[148:151]
    ds_read_b128 a[112:115], v46 offset:896
    ds_read_b128 a[116:119], v46 offset:27520
    v_mfma_f32_16x16x32_bf16 v[152:155], a[64:67], a[136:139], v[152:155]
    ds_read_b128 a[120:123], v47 offset:896
    ds_read_b128 a[124:127], v47 offset:27520
    v_mfma_f32_16x16x32_bf16 v[156:159], a[64:67], a[140:143], v[156:159]
    v_accvgpr_read_b32 v22, a180
    v_accvgpr_read_b32 v23, a181
    v_mfma_f32_16x16x32_bf16 v[160:163], a[68:71], a[128:131], v[160:163]
    s_mov_b32 s34, 331776
    v_accvgpr_read_b32 v24, a182
    v_mfma_f32_16x16x32_bf16 v[164:167], a[68:71], a[132:135], v[164:167]
    buffer_load_dwordx4 a[64:67], v2, s[20:23], s34 offen offset:0
    v_mfma_f32_16x16x32_bf16 v[168:171], a[68:71], a[136:139], v[168:171]
    v_accvgpr_read_b32 v25, a183
    v_lshlrev_b32 v26, 16, v22
    v_mfma_f32_16x16x32_bf16 v[172:175], a[68:71], a[140:143], v[172:175]
    v_and_b32 v27, 0xffff0000, v22
    v_mfma_f32_16x16x32_bf16 v[176:179], a[72:75], a[128:131], v[176:179]
    buffer_load_dwordx4 a[68:71], v2, s[20:23], s34 offen offset:1024
    v_mfma_f32_16x16x32_bf16 v[180:183], a[72:75], a[132:135], v[180:183]
    v_lshlrev_b32 v28, 16, v23
    v_and_b32 v29, 0xffff0000, v23
    v_mfma_f32_16x16x32_bf16 v[184:187], a[72:75], a[136:139], v[184:187]
    v_mul_f32 v26, v26, v116
    v_mfma_f32_16x16x32_bf16 v[188:191], a[72:75], a[140:143], v[188:191]
    v_mul_f32 v27, v27, v117
    v_mfma_f32_16x16x32_bf16 v[192:195], a[76:79], a[128:131], v[192:195]
    buffer_load_dwordx4 a[72:75], v2, s[20:23], s34 offen offset:2048
    v_mfma_f32_16x16x32_bf16 v[196:199], a[76:79], a[132:135], v[196:199]
    v_mul_f32 v28, v28, v118
    v_mfma_f32_16x16x32_bf16 v[200:203], a[76:79], a[136:139], v[200:203]
    v_mul_f32 v29, v29, v119
    v_mfma_f32_16x16x32_bf16 v[204:207], a[76:79], a[140:143], v[204:207]
    v_cvt_pk_bf16_f32 v22, v26, v27
    v_mfma_f32_16x16x32_bf16 v[208:211], a[80:83], a[128:131], v[208:211]
    buffer_load_dwordx4 a[76:79], v2, s[20:23], s34 offen offset:3072
    v_mfma_f32_16x16x32_bf16 v[212:215], a[80:83], a[132:135], v[212:215]
    v_cvt_pk_bf16_f32 v23, v28, v29
    v_lshlrev_b32 v26, 16, v24
    v_mfma_f32_16x16x32_bf16 v[216:219], a[80:83], a[136:139], v[216:219]
    v_mfma_f32_16x16x32_bf16 v[220:223], a[80:83], a[140:143], v[220:223]
    v_and_b32 v27, 0xffff0000, v24
    v_mfma_f32_16x16x32_bf16 v[224:227], a[84:87], a[128:131], v[224:227]
    s_mov_b32 s34, 335872
    v_lshlrev_b32 v28, 16, v25
    v_mfma_f32_16x16x32_bf16 v[228:231], a[84:87], a[132:135], v[228:231]
    buffer_load_dwordx4 a[80:83], v2, s[20:23], s34 offen offset:0
    v_mfma_f32_16x16x32_bf16 v[232:235], a[84:87], a[136:139], v[232:235]
    v_and_b32 v29, 0xffff0000, v25
    v_mul_f32 v26, v26, v132
    v_mfma_f32_16x16x32_bf16 v[236:239], a[84:87], a[140:143], v[236:239]
    v_mul_f32 v27, v27, v133
    s_waitcnt vmcnt(20) lgkmcnt(0)
    v_mfma_f32_16x16x32_bf16 v[144:147], a[88:91], a[112:115], v[144:147]
    buffer_load_dwordx4 a[84:87], v2, s[20:23], s34 offen offset:1024
    v_mfma_f32_16x16x32_bf16 v[148:151], a[88:91], a[116:119], v[148:151]
    ds_read_b128 a[128:131], v0 offset:1024
    ds_read_b128 a[132:135], v0 offset:27648
    v_mfma_f32_16x16x32_bf16 v[152:155], a[88:91], a[120:123], v[152:155]
    ds_read_b128 a[136:139], v1 offset:1024
    ds_read_b128 a[140:143], v1 offset:27648
    v_mfma_f32_16x16x32_bf16 v[156:159], a[88:91], a[124:127], v[156:159]
    v_mul_f32 v28, v28, v134
    v_mul_f32 v29, v29, v135
    v_mfma_f32_16x16x32_bf16 v[160:163], a[92:95], a[112:115], v[160:163]
    buffer_load_dwordx4 a[88:91], v2, s[20:23], s34 offen offset:2048
    v_mfma_f32_16x16x32_bf16 v[164:167], a[92:95], a[116:119], v[164:167]
    v_cvt_pk_bf16_f32 v24, v26, v27
    v_cvt_pk_bf16_f32 v25, v28, v29
    v_mfma_f32_16x16x32_bf16 v[168:171], a[92:95], a[120:123], v[168:171]
    ds_write_b128 v6, v[22:25] offset:9216
    v_mfma_f32_16x16x32_bf16 v[172:175], a[92:95], a[124:127], v[172:175]
    v_add_f32 v116, v116, v38
    v_mfma_f32_16x16x32_bf16 v[176:179], a[96:99], a[112:115], v[176:179]
    buffer_load_dwordx4 a[92:95], v2, s[20:23], s34 offen offset:3072
    v_mfma_f32_16x16x32_bf16 v[180:183], a[96:99], a[116:119], v[180:183]
    v_add_f32 v117, v117, v39
    v_add_f32 v118, v118, v40
    v_mfma_f32_16x16x32_bf16 v[184:187], a[96:99], a[120:123], v[184:187]
    v_add_f32 v119, v119, v41
    v_mfma_f32_16x16x32_bf16 v[188:191], a[96:99], a[124:127], v[188:191]
    v_add_f32 v132, v132, v42
    v_mfma_f32_16x16x32_bf16 v[192:195], a[100:103], a[112:115], v[192:195]
    s_mov_b32 s34, 339968
    v_mfma_f32_16x16x32_bf16 v[196:199], a[100:103], a[116:119], v[196:199]
    buffer_load_dwordx4 a[96:99], v2, s[20:23], s34 offen offset:0
    v_mfma_f32_16x16x32_bf16 v[200:203], a[100:103], a[120:123], v[200:203]
    v_add_f32 v133, v133, v43
    v_add_f32 v134, v134, v44
    v_mfma_f32_16x16x32_bf16 v[204:207], a[100:103], a[124:127], v[204:207]
    v_add_f32 v135, v135, v45
    v_mfma_f32_16x16x32_bf16 v[208:211], a[104:107], a[112:115], v[208:211]
    buffer_load_dwordx4 a[100:103], v2, s[20:23], s34 offen offset:1024
    v_mfma_f32_16x16x32_bf16 v[212:215], a[104:107], a[116:119], v[212:215]
    v_accvgpr_read_b32 v14, a184
    v_accvgpr_read_b32 v15, a185
    v_mfma_f32_16x16x32_bf16 v[216:219], a[104:107], a[120:123], v[216:219]
    v_mfma_f32_16x16x32_bf16 v[220:223], a[104:107], a[124:127], v[220:223]
    v_accvgpr_read_b32 v16, a186
    v_mfma_f32_16x16x32_bf16 v[224:227], a[108:111], a[112:115], v[224:227]
    buffer_load_dwordx4 a[104:107], v2, s[20:23], s34 offen offset:2048
    v_mfma_f32_16x16x32_bf16 v[228:231], a[108:111], a[116:119], v[228:231]
    v_accvgpr_read_b32 v17, a187
    v_lshlrev_b32 v18, 16, v14
    v_mfma_f32_16x16x32_bf16 v[232:235], a[108:111], a[120:123], v[232:235]
    v_and_b32 v19, 0xffff0000, v14
    v_mfma_f32_16x16x32_bf16 v[236:239], a[108:111], a[124:127], v[236:239]
    v_lshlrev_b32 v20, 16, v15
    s_waitcnt lgkmcnt(1)
    v_mfma_f32_16x16x32_bf16 v[144:147], a[0:3], a[128:131], v[144:147]
    buffer_load_dwordx4 a[108:111], v2, s[20:23], s34 offen offset:3072
    v_mfma_f32_16x16x32_bf16 v[148:151], a[0:3], a[132:135], v[148:151]
    ds_read_b128 a[112:115], v46 offset:1024
    ds_read_b128 a[116:119], v46 offset:27648
    v_mfma_f32_16x16x32_bf16 v[152:155], a[0:3], a[136:139], v[152:155]
    ds_read_b128 a[120:123], v47 offset:1024
    ds_read_b128 a[124:127], v47 offset:27648
    v_mfma_f32_16x16x32_bf16 v[156:159], a[0:3], a[140:143], v[156:159]
    v_and_b32 v21, 0xffff0000, v15
    v_mul_f32 v18, v18, v120
    s_waitcnt vmcnt(20)
    v_mfma_f32_16x16x32_bf16 v[160:163], a[4:7], a[128:131], v[160:163]
    s_mov_b32 s34, 344064
    v_mul_f32 v19, v19, v121
    v_mfma_f32_16x16x32_bf16 v[164:167], a[4:7], a[132:135], v[164:167]
    buffer_load_dwordx4 a[0:3], v2, s[20:23], s34 offen offset:0
    v_mfma_f32_16x16x32_bf16 v[168:171], a[4:7], a[136:139], v[168:171]
    v_mul_f32 v20, v20, v122
    v_mul_f32 v21, v21, v123
    v_mfma_f32_16x16x32_bf16 v[172:175], a[4:7], a[140:143], v[172:175]
    v_cvt_pk_bf16_f32 v14, v18, v19
    v_mfma_f32_16x16x32_bf16 v[176:179], a[8:11], a[128:131], v[176:179]
    buffer_load_dwordx4 a[4:7], v2, s[20:23], s34 offen offset:1024
    v_mfma_f32_16x16x32_bf16 v[180:183], a[8:11], a[132:135], v[180:183]
    v_cvt_pk_bf16_f32 v15, v20, v21
    v_lshlrev_b32 v18, 16, v16
    v_mfma_f32_16x16x32_bf16 v[184:187], a[8:11], a[136:139], v[184:187]
    v_and_b32 v19, 0xffff0000, v16
    v_mfma_f32_16x16x32_bf16 v[188:191], a[8:11], a[140:143], v[188:191]
    v_lshlrev_b32 v20, 16, v17
    v_mfma_f32_16x16x32_bf16 v[192:195], a[12:15], a[128:131], v[192:195]
    buffer_load_dwordx4 a[8:11], v2, s[20:23], s34 offen offset:2048
    v_mfma_f32_16x16x32_bf16 v[196:199], a[12:15], a[132:135], v[196:199]
    v_and_b32 v21, 0xffff0000, v17
    v_mfma_f32_16x16x32_bf16 v[200:203], a[12:15], a[136:139], v[200:203]
    v_mul_f32 v18, v18, v136
    v_mfma_f32_16x16x32_bf16 v[204:207], a[12:15], a[140:143], v[204:207]
    v_mul_f32 v19, v19, v137
    v_mfma_f32_16x16x32_bf16 v[208:211], a[16:19], a[128:131], v[208:211]
    buffer_load_dwordx4 a[12:15], v2, s[20:23], s34 offen offset:3072
    v_mfma_f32_16x16x32_bf16 v[212:215], a[16:19], a[132:135], v[212:215]
    v_mul_f32 v20, v20, v138
    v_mul_f32 v21, v21, v139
    v_mfma_f32_16x16x32_bf16 v[216:219], a[16:19], a[136:139], v[216:219]
    v_mfma_f32_16x16x32_bf16 v[220:223], a[16:19], a[140:143], v[220:223]
    v_cvt_pk_bf16_f32 v16, v18, v19
    v_mfma_f32_16x16x32_bf16 v[224:227], a[20:23], a[128:131], v[224:227]
    s_mov_b32 s34, 348160
    v_cvt_pk_bf16_f32 v17, v20, v21
    v_mfma_f32_16x16x32_bf16 v[228:231], a[20:23], a[132:135], v[228:231]
    buffer_load_dwordx4 a[16:19], v2, s[20:23], s34 offen offset:0
    v_mfma_f32_16x16x32_bf16 v[232:235], a[20:23], a[136:139], v[232:235]
    ds_write_b128 v6, v[14:17] offset:10240
    v_mfma_f32_16x16x32_bf16 v[236:239], a[20:23], a[140:143], v[236:239]
    v_add_f32 v120, v120, v38
    v_add_f32 v121, v121, v39
    s_waitcnt lgkmcnt(1)
    v_mfma_f32_16x16x32_bf16 v[144:147], a[24:27], a[112:115], v[144:147]
    buffer_load_dwordx4 a[20:23], v2, s[20:23], s34 offen offset:1024
    v_mfma_f32_16x16x32_bf16 v[148:151], a[24:27], a[116:119], v[148:151]
    ds_read_b128 a[128:131], v46 offset:1280
    ds_read_b128 a[132:135], v46 offset:27904
    v_mfma_f32_16x16x32_bf16 v[152:155], a[24:27], a[120:123], v[152:155]
    ds_read_b128 a[136:139], v47 offset:1280
    ds_read_b128 a[140:143], v47 offset:27904
    v_mfma_f32_16x16x32_bf16 v[156:159], a[24:27], a[124:127], v[156:159]
    v_add_f32 v122, v122, v40
    v_add_f32 v123, v123, v41
    v_mfma_f32_16x16x32_bf16 v[160:163], a[28:31], a[112:115], v[160:163]
    buffer_load_dwordx4 a[24:27], v2, s[20:23], s34 offen offset:2048
    v_mfma_f32_16x16x32_bf16 v[164:167], a[28:31], a[116:119], v[164:167]
    v_add_f32 v136, v136, v42
    v_add_f32 v137, v137, v43
    v_mfma_f32_16x16x32_bf16 v[168:171], a[28:31], a[120:123], v[168:171]
    v_add_f32 v138, v138, v44
    v_mfma_f32_16x16x32_bf16 v[172:175], a[28:31], a[124:127], v[172:175]
    v_add_f32 v139, v139, v45
    s_waitcnt vmcnt(20)
    v_mfma_f32_16x16x32_bf16 v[176:179], a[32:35], a[112:115], v[176:179]
    buffer_load_dwordx4 a[28:31], v2, s[20:23], s34 offen offset:3072
    v_mfma_f32_16x16x32_bf16 v[180:183], a[32:35], a[116:119], v[180:183]
    v_accvgpr_read_b32 v22, a188
    v_accvgpr_read_b32 v23, a189
    v_mfma_f32_16x16x32_bf16 v[184:187], a[32:35], a[120:123], v[184:187]
    v_accvgpr_read_b32 v24, a190
    v_mfma_f32_16x16x32_bf16 v[188:191], a[32:35], a[124:127], v[188:191]
    v_accvgpr_read_b32 v25, a191
    v_mfma_f32_16x16x32_bf16 v[192:195], a[36:39], a[112:115], v[192:195]
    s_mov_b32 s34, 352256
    v_mfma_f32_16x16x32_bf16 v[196:199], a[36:39], a[116:119], v[196:199]
    buffer_load_dwordx4 a[32:35], v2, s[20:23], s34 offen offset:0
    v_mfma_f32_16x16x32_bf16 v[200:203], a[36:39], a[120:123], v[200:203]
    v_lshlrev_b32 v26, 16, v22
    v_and_b32 v27, 0xffff0000, v22
    v_mfma_f32_16x16x32_bf16 v[204:207], a[36:39], a[124:127], v[204:207]
    v_lshlrev_b32 v28, 16, v23
    v_mfma_f32_16x16x32_bf16 v[208:211], a[40:43], a[112:115], v[208:211]
    buffer_load_dwordx4 a[36:39], v2, s[20:23], s34 offen offset:1024
    v_mfma_f32_16x16x32_bf16 v[212:215], a[40:43], a[116:119], v[212:215]
    v_and_b32 v29, 0xffff0000, v23
    v_mul_f32 v26, v26, v124
    v_mfma_f32_16x16x32_bf16 v[216:219], a[40:43], a[120:123], v[216:219]
    v_mfma_f32_16x16x32_bf16 v[220:223], a[40:43], a[124:127], v[220:223]
    v_mul_f32 v27, v27, v125
    v_mfma_f32_16x16x32_bf16 v[224:227], a[44:47], a[112:115], v[224:227]
    buffer_load_dwordx4 a[40:43], v2, s[20:23], s34 offen offset:2048
    v_mfma_f32_16x16x32_bf16 v[228:231], a[44:47], a[116:119], v[228:231]
    v_mul_f32 v28, v28, v126
    v_mul_f32 v29, v29, v127
    v_mfma_f32_16x16x32_bf16 v[232:235], a[44:47], a[120:123], v[232:235]
    v_cvt_pk_bf16_f32 v22, v26, v27
    v_mfma_f32_16x16x32_bf16 v[236:239], a[44:47], a[124:127], v[236:239]
    v_cvt_pk_bf16_f32 v23, v28, v29
    s_waitcnt lgkmcnt(0)
    v_mfma_f32_16x16x32_bf16 v[144:147], a[48:51], a[128:131], v[144:147]
    buffer_load_dwordx4 a[44:47], v2, s[20:23], s34 offen offset:3072
    v_mfma_f32_16x16x32_bf16 v[148:151], a[48:51], a[132:135], v[148:151]
    ds_read_b128 a[112:115], v0 offset:1408
    ds_read_b128 a[116:119], v0 offset:28032
    v_mfma_f32_16x16x32_bf16 v[152:155], a[48:51], a[136:139], v[152:155]
    ds_read_b128 a[120:123], v1 offset:1408
    ds_read_b128 a[124:127], v1 offset:28032
    v_mfma_f32_16x16x32_bf16 v[156:159], a[48:51], a[140:143], v[156:159]
    v_lshlrev_b32 v26, 16, v24
    v_and_b32 v27, 0xffff0000, v24
    v_mfma_f32_16x16x32_bf16 v[160:163], a[52:55], a[128:131], v[160:163]
    s_mov_b32 s34, 356352
    v_lshlrev_b32 v28, 16, v25
    v_mfma_f32_16x16x32_bf16 v[164:167], a[52:55], a[132:135], v[164:167]
    buffer_load_dwordx4 a[48:51], v2, s[20:23], s34 offen offset:0
    v_mfma_f32_16x16x32_bf16 v[168:171], a[52:55], a[136:139], v[168:171]
    v_and_b32 v29, 0xffff0000, v25
    v_mul_f32 v26, v26, v140
    v_mfma_f32_16x16x32_bf16 v[172:175], a[52:55], a[140:143], v[172:175]
    v_mul_f32 v27, v27, v141
    v_mfma_f32_16x16x32_bf16 v[176:179], a[56:59], a[128:131], v[176:179]
    buffer_load_dwordx4 a[52:55], v2, s[20:23], s34 offen offset:1024
    v_mfma_f32_16x16x32_bf16 v[180:183], a[56:59], a[132:135], v[180:183]
    v_mul_f32 v28, v28, v142
    v_mul_f32 v29, v29, v143
    v_mfma_f32_16x16x32_bf16 v[184:187], a[56:59], a[136:139], v[184:187]
    v_cvt_pk_bf16_f32 v24, v26, v27
    v_mfma_f32_16x16x32_bf16 v[188:191], a[56:59], a[140:143], v[188:191]
    v_cvt_pk_bf16_f32 v25, v28, v29
    s_waitcnt vmcnt(20)
    v_mfma_f32_16x16x32_bf16 v[192:195], a[60:63], a[128:131], v[192:195]
    buffer_load_dwordx4 a[56:59], v2, s[20:23], s34 offen offset:2048
    v_mfma_f32_16x16x32_bf16 v[196:199], a[60:63], a[132:135], v[196:199]
    ds_write_b128 v6, v[22:25] offset:11264
    v_mfma_f32_16x16x32_bf16 v[200:203], a[60:63], a[136:139], v[200:203]
    v_add_f32 v124, v124, v38
    v_mfma_f32_16x16x32_bf16 v[204:207], a[60:63], a[140:143], v[204:207]
    v_add_f32 v125, v125, v39
    v_mfma_f32_16x16x32_bf16 v[208:211], a[64:67], a[128:131], v[208:211]
    buffer_load_dwordx4 a[60:63], v2, s[20:23], s34 offen offset:3072
    v_mfma_f32_16x16x32_bf16 v[212:215], a[64:67], a[132:135], v[212:215]
    v_add_f32 v126, v126, v40
    v_add_f32 v127, v127, v41
    v_mfma_f32_16x16x32_bf16 v[216:219], a[64:67], a[136:139], v[216:219]
    buffer_load_dwordx4 v[30:33], v12, s[24:27], 0 offen offset:1216
    v_mfma_f32_16x16x32_bf16 v[220:223], a[64:67], a[140:143], v[220:223]
    v_add_f32 v140, v140, v42
    v_mfma_f32_16x16x32_bf16 v[224:227], a[68:71], a[128:131], v[224:227]
    s_mov_b32 s34, 360448
    v_add_f32 v141, v141, v43
    v_mfma_f32_16x16x32_bf16 v[228:231], a[68:71], a[132:135], v[228:231]
    buffer_load_dwordx4 a[64:67], v2, s[20:23], s34 offen offset:0
    v_mfma_f32_16x16x32_bf16 v[232:235], a[68:71], a[136:139], v[232:235]
    v_add_f32 v142, v142, v44
    v_add_f32 v143, v143, v45
    v_mfma_f32_16x16x32_bf16 v[236:239], a[68:71], a[140:143], v[236:239]
    buffer_load_dwordx4 v[34:37], v12, s[24:27], 0 offen offset:1280
    s_waitcnt lgkmcnt(1)
    v_mfma_f32_16x16x32_bf16 v[144:147], a[72:75], a[112:115], v[144:147]
    buffer_load_dwordx4 a[68:71], v2, s[20:23], s34 offen offset:1024
    v_mfma_f32_16x16x32_bf16 v[148:151], a[72:75], a[116:119], v[148:151]
    ds_read_b128 a[128:131], v46 offset:1408
    ds_read_b128 a[132:135], v46 offset:28032
    v_mfma_f32_16x16x32_bf16 v[152:155], a[72:75], a[120:123], v[152:155]
    ds_read_b128 a[136:139], v47 offset:1408
    ds_read_b128 a[140:143], v47 offset:28032
    v_mfma_f32_16x16x32_bf16 v[156:159], a[72:75], a[124:127], v[156:159]
    v_mfma_f32_16x16x32_bf16 v[160:163], a[76:79], a[112:115], v[160:163]
    buffer_load_dwordx4 a[72:75], v2, s[20:23], s34 offen offset:2048
    v_mfma_f32_16x16x32_bf16 v[164:167], a[76:79], a[116:119], v[164:167]
    v_mfma_f32_16x16x32_bf16 v[168:171], a[76:79], a[120:123], v[168:171]
    v_mfma_f32_16x16x32_bf16 v[172:175], a[76:79], a[124:127], v[172:175]
    v_mfma_f32_16x16x32_bf16 v[176:179], a[80:83], a[112:115], v[176:179]
    buffer_load_dwordx4 a[76:79], v2, s[20:23], s34 offen offset:3072
    v_mfma_f32_16x16x32_bf16 v[180:183], a[80:83], a[116:119], v[180:183]
    v_mfma_f32_16x16x32_bf16 v[184:187], a[80:83], a[120:123], v[184:187]
    v_mfma_f32_16x16x32_bf16 v[188:191], a[80:83], a[124:127], v[188:191]
    v_mfma_f32_16x16x32_bf16 v[192:195], a[84:87], a[112:115], v[192:195]
    s_mov_b32 s34, 364544
    v_mfma_f32_16x16x32_bf16 v[196:199], a[84:87], a[116:119], v[196:199]
    buffer_load_dwordx4 a[80:83], v2, s[20:23], s34 offen offset:0
    v_mfma_f32_16x16x32_bf16 v[200:203], a[84:87], a[120:123], v[200:203]
    v_mfma_f32_16x16x32_bf16 v[204:207], a[84:87], a[124:127], v[204:207]
    s_waitcnt vmcnt(22)
    v_mfma_f32_16x16x32_bf16 v[208:211], a[88:91], a[112:115], v[208:211]
    buffer_load_dwordx4 a[84:87], v2, s[20:23], s34 offen offset:1024
    v_mfma_f32_16x16x32_bf16 v[212:215], a[88:91], a[116:119], v[212:215]
    v_mfma_f32_16x16x32_bf16 v[216:219], a[88:91], a[120:123], v[216:219]
    v_mfma_f32_16x16x32_bf16 v[220:223], a[88:91], a[124:127], v[220:223]
    v_mfma_f32_16x16x32_bf16 v[224:227], a[92:95], a[112:115], v[224:227]
    buffer_load_dwordx4 a[88:91], v2, s[20:23], s34 offen offset:2048
    v_mfma_f32_16x16x32_bf16 v[228:231], a[92:95], a[116:119], v[228:231]
    v_mfma_f32_16x16x32_bf16 v[232:235], a[92:95], a[120:123], v[232:235]
    v_mfma_f32_16x16x32_bf16 v[236:239], a[92:95], a[124:127], v[236:239]
    s_waitcnt lgkmcnt(0)
    s_barrier
    v_mfma_f32_16x16x32_bf16 v[144:147], a[96:99], a[128:131], v[144:147]
    buffer_load_dwordx4 a[92:95], v2, s[20:23], s34 offen offset:3072
    v_mfma_f32_16x16x32_bf16 v[148:151], a[96:99], a[132:135], v[148:151]
    ds_read_b128 a[112:115], v3 offset:0
    ds_read_b128 a[116:119], v3 offset:1024
    v_mfma_f32_16x16x32_bf16 v[152:155], a[96:99], a[136:139], v[152:155]
    ds_read_b128 a[120:123], v3 offset:2048
    ds_read_b128 a[124:127], v3 offset:3072
    v_mfma_f32_16x16x32_bf16 v[156:159], a[96:99], a[140:143], v[156:159]
    v_mfma_f32_16x16x32_bf16 v[160:163], a[100:103], a[128:131], v[160:163]
    s_mov_b32 s34, 368640
    v_mfma_f32_16x16x32_bf16 v[164:167], a[100:103], a[132:135], v[164:167]
    buffer_load_dwordx4 a[96:99], v2, s[20:23], s34 offen offset:0
    v_mfma_f32_16x16x32_bf16 v[168:171], a[100:103], a[136:139], v[168:171]
    v_mfma_f32_16x16x32_bf16 v[172:175], a[100:103], a[140:143], v[172:175]
    v_mfma_f32_16x16x32_bf16 v[176:179], a[104:107], a[128:131], v[176:179]
    buffer_load_dwordx4 a[100:103], v2, s[20:23], s34 offen offset:1024
    v_mfma_f32_16x16x32_bf16 v[180:183], a[104:107], a[132:135], v[180:183]
    v_mfma_f32_16x16x32_bf16 v[184:187], a[104:107], a[136:139], v[184:187]
    v_mfma_f32_16x16x32_bf16 v[188:191], a[104:107], a[140:143], v[188:191]
    v_mfma_f32_16x16x32_bf16 v[192:195], a[108:111], a[128:131], v[192:195]
    buffer_load_dwordx4 a[104:107], v2, s[20:23], s34 offen offset:2048
    v_mfma_f32_16x16x32_bf16 v[196:199], a[108:111], a[132:135], v[196:199]
    v_mfma_f32_16x16x32_bf16 v[200:203], a[108:111], a[136:139], v[200:203]
    v_mfma_f32_16x16x32_bf16 v[204:207], a[108:111], a[140:143], v[204:207]
    v_mfma_f32_16x16x32_bf16 v[208:211], a[0:3], a[128:131], v[208:211]
    buffer_load_dwordx4 a[108:111], v2, s[20:23], s34 offen offset:3072
    v_mfma_f32_16x16x32_bf16 v[212:215], a[0:3], a[132:135], v[212:215]
    v_mfma_f32_16x16x32_bf16 v[216:219], a[0:3], a[136:139], v[216:219]
    v_mfma_f32_16x16x32_bf16 v[220:223], a[0:3], a[140:143], v[220:223]
    s_waitcnt vmcnt(22)
    v_mfma_f32_16x16x32_bf16 v[224:227], a[4:7], a[128:131], v[224:227]
    s_mov_b32 s34, 372736
    v_mfma_f32_16x16x32_bf16 v[228:231], a[4:7], a[132:135], v[228:231]
    buffer_load_dwordx4 a[0:3], v2, s[20:23], s34 offen offset:0
    v_mfma_f32_16x16x32_bf16 v[232:235], a[4:7], a[136:139], v[232:235]
    v_mfma_f32_16x16x32_bf16 v[236:239], a[4:7], a[140:143], v[236:239]
    s_waitcnt lgkmcnt(0)
    v_mfma_f32_16x16x32_bf16 v[240:243], a[8:11], a[112:115], v[240:243]
    buffer_load_dwordx4 a[4:7], v2, s[20:23], s34 offen offset:1024
    v_mfma_f32_16x16x32_bf16 v[244:247], a[8:11], a[116:119], v[244:247]
    ds_read_b128 a[128:131], v3 offset:4096
    ds_read_b128 a[132:135], v3 offset:5120
    v_mfma_f32_16x16x32_bf16 v[248:251], a[8:11], a[120:123], v[248:251]
    ds_read_b128 a[136:139], v3 offset:6144
    ds_read_b128 a[140:143], v3 offset:7168
    v_mfma_f32_16x16x32_bf16 v[252:255], a[8:11], a[124:127], v[252:255]
    v_mfma_f32_16x16x32_bf16 v[48:51], a[12:15], a[112:115], v[48:51]
    buffer_load_dwordx4 a[8:11], v2, s[20:23], s34 offen offset:2048
    v_mfma_f32_16x16x32_bf16 v[52:55], a[12:15], a[116:119], v[52:55]
    v_mfma_f32_16x16x32_bf16 v[56:59], a[12:15], a[120:123], v[56:59]
    v_mfma_f32_16x16x32_bf16 v[60:63], a[12:15], a[124:127], v[60:63]
    v_mfma_f32_16x16x32_bf16 v[64:67], a[16:19], a[112:115], v[64:67]
    buffer_load_dwordx4 a[12:15], v2, s[20:23], s34 offen offset:3072
    v_mfma_f32_16x16x32_bf16 v[68:71], a[16:19], a[116:119], v[68:71]
    v_mfma_f32_16x16x32_bf16 v[72:75], a[16:19], a[120:123], v[72:75]
    buffer_load_dwordx4 v[38:41], v12, s[24:27], 0 offen offset:1344
    v_mfma_f32_16x16x32_bf16 v[76:79], a[16:19], a[124:127], v[76:79]
    buffer_load_dwordx4 v[42:45], v12, s[24:27], 0 offen offset:1408
    v_mfma_f32_16x16x32_bf16 v[80:83], a[20:23], a[112:115], v[80:83]
    s_mov_b32 s34, 376832
    v_accvgpr_read_b32 v14, a192
    v_mfma_f32_16x16x32_bf16 v[84:87], a[20:23], a[116:119], v[84:87]
    buffer_load_dwordx4 a[16:19], v2, s[20:23], s34 offen offset:0
    v_mfma_f32_16x16x32_bf16 v[88:91], a[20:23], a[120:123], v[88:91]
    v_accvgpr_read_b32 v15, a193
    v_accvgpr_read_b32 v16, a194
    v_mfma_f32_16x16x32_bf16 v[92:95], a[20:23], a[124:127], v[92:95]
    v_accvgpr_read_b32 v17, a195
    v_lshlrev_b32 v18, 16, v14
    v_mfma_f32_16x16x32_bf16 v[96:99], a[24:27], a[112:115], v[96:99]
    buffer_load_dwordx4 a[20:23], v2, s[20:23], s34 offen offset:1024
    v_mfma_f32_16x16x32_bf16 v[100:103], a[24:27], a[116:119], v[100:103]
    v_and_b32 v19, 0xffff0000, v14
    v_lshlrev_b32 v20, 16, v15
    v_mfma_f32_16x16x32_bf16 v[104:107], a[24:27], a[120:123], v[104:107]
    v_and_b32 v21, 0xffff0000, v15
    v_mul_f32 v18, v18, v144
    v_mfma_f32_16x16x32_bf16 v[108:111], a[24:27], a[124:127], v[108:111]
    v_mul_f32 v19, v19, v145
    v_mul_f32 v20, v20, v146
    v_mfma_f32_16x16x32_bf16 v[112:115], a[28:31], a[112:115], v[112:115]
    buffer_load_dwordx4 a[24:27], v2, s[20:23], s34 offen offset:2048
    v_mfma_f32_16x16x32_bf16 v[116:119], a[28:31], a[116:119], v[116:119]
    v_mul_f32 v21, v21, v147
    v_cvt_pk_bf16_f32 v14, v18, v19
    v_mfma_f32_16x16x32_bf16 v[120:123], a[28:31], a[120:123], v[120:123]
    v_cvt_pk_bf16_f32 v15, v20, v21
    v_mfma_f32_16x16x32_bf16 v[124:127], a[28:31], a[124:127], v[124:127]
    v_lshlrev_b32 v18, 16, v16
    v_and_b32 v19, 0xffff0000, v16
    s_waitcnt vmcnt(24)
    v_mfma_f32_16x16x32_bf16 v[128:131], a[32:35], a[112:115], v[128:131]
    buffer_load_dwordx4 a[28:31], v2, s[20:23], s34 offen offset:3072
    v_mfma_f32_16x16x32_bf16 v[132:135], a[32:35], a[116:119], v[132:135]
    v_lshlrev_b32 v20, 16, v17
    v_and_b32 v21, 0xffff0000, v17
    v_mfma_f32_16x16x32_bf16 v[136:139], a[32:35], a[120:123], v[136:139]
    v_mul_f32 v18, v18, v160
    v_mfma_f32_16x16x32_bf16 v[140:143], a[32:35], a[124:127], v[140:143]
    v_mul_f32 v19, v19, v161
    v_mul_f32 v20, v20, v162
    s_waitcnt lgkmcnt(0)
    v_mfma_f32_16x16x32_bf16 v[240:243], a[36:39], a[128:131], v[240:243]
    s_mov_b32 s34, 380928
    v_mul_f32 v21, v21, v163
    v_mfma_f32_16x16x32_bf16 v[244:247], a[36:39], a[132:135], v[244:247]
    ds_read_b128 a[112:115], v3 offset:8192
    ds_read_b128 a[116:119], v3 offset:9216
    v_mfma_f32_16x16x32_bf16 v[248:251], a[36:39], a[136:139], v[248:251]
    ds_read_b128 a[120:123], v3 offset:10240
    ds_read_b128 a[124:127], v3 offset:11264
    v_mfma_f32_16x16x32_bf16 v[252:255], a[36:39], a[140:143], v[252:255]
    buffer_load_dwordx4 a[32:35], v2, s[20:23], s34 offen offset:0
    v_mfma_f32_16x16x32_bf16 v[48:51], a[40:43], a[128:131], v[48:51]
    buffer_load_dwordx4 a[36:39], v2, s[20:23], s34 offen offset:1024
    v_mfma_f32_16x16x32_bf16 v[52:55], a[40:43], a[132:135], v[52:55]
    v_cvt_pk_bf16_f32 v16, v18, v19
    v_cvt_pk_bf16_f32 v17, v20, v21
    v_mfma_f32_16x16x32_bf16 v[56:59], a[40:43], a[136:139], v[56:59]
    ds_write_b128 v9, v[14:17] offset:0
    v_mfma_f32_16x16x32_bf16 v[60:63], a[40:43], a[140:143], v[60:63]
    s_waitcnt vmcnt(24)
    v_add_f32 v144, v144, v30
    v_add_f32 v145, v145, v31
    v_mfma_f32_16x16x32_bf16 v[64:67], a[44:47], a[128:131], v[64:67]
    buffer_load_dwordx4 a[40:43], v2, s[20:23], s34 offen offset:2048
    v_mfma_f32_16x16x32_bf16 v[68:71], a[44:47], a[132:135], v[68:71]
    v_add_f32 v146, v146, v32
    v_add_f32 v147, v147, v33
    v_mfma_f32_16x16x32_bf16 v[72:75], a[44:47], a[136:139], v[72:75]
    s_waitcnt vmcnt(19)
    v_add_f32 v160, v160, v34
    v_add_f32 v161, v161, v35
    v_mfma_f32_16x16x32_bf16 v[76:79], a[44:47], a[140:143], v[76:79]
    v_add_f32 v162, v162, v36
    v_add_f32 v163, v163, v37
    v_mfma_f32_16x16x32_bf16 v[80:83], a[48:51], a[128:131], v[80:83]
    buffer_load_dwordx4 a[44:47], v2, s[20:23], s34 offen offset:3072
    v_mfma_f32_16x16x32_bf16 v[84:87], a[48:51], a[132:135], v[84:87]
    v_accvgpr_read_b32 v22, a196
    v_accvgpr_read_b32 v23, a197
    v_mfma_f32_16x16x32_bf16 v[88:91], a[48:51], a[136:139], v[88:91]
    v_accvgpr_read_b32 v24, a198
    v_accvgpr_read_b32 v25, a199
    v_mfma_f32_16x16x32_bf16 v[92:95], a[48:51], a[140:143], v[92:95]
    v_lshlrev_b32 v26, 16, v22
    v_and_b32 v27, 0xffff0000, v22
    v_mfma_f32_16x16x32_bf16 v[96:99], a[52:55], a[128:131], v[96:99]
    s_mov_b32 s34, 385024
    v_lshlrev_b32 v28, 16, v23
    v_mfma_f32_16x16x32_bf16 v[100:103], a[52:55], a[132:135], v[100:103]
    buffer_load_dwordx4 a[48:51], v2, s[20:23], s34 offen offset:0
    v_mfma_f32_16x16x32_bf16 v[104:107], a[52:55], a[136:139], v[104:107]
    v_and_b32 v29, 0xffff0000, v23
    v_mul_f32 v26, v26, v148
    v_mfma_f32_16x16x32_bf16 v[108:111], a[52:55], a[140:143], v[108:111]
    v_mul_f32 v27, v27, v149
    v_mul_f32 v28, v28, v150
    v_mfma_f32_16x16x32_bf16 v[112:115], a[56:59], a[128:131], v[112:115]
    buffer_load_dwordx4 a[52:55], v2, s[20:23], s34 offen offset:1024
    v_mfma_f32_16x16x32_bf16 v[116:119], a[56:59], a[132:135], v[116:119]
    v_mul_f32 v29, v29, v151
    v_cvt_pk_bf16_f32 v22, v26, v27
    v_mfma_f32_16x16x32_bf16 v[120:123], a[56:59], a[136:139], v[120:123]
    v_cvt_pk_bf16_f32 v23, v28, v29
    v_lshlrev_b32 v26, 16, v24
    v_mfma_f32_16x16x32_bf16 v[124:127], a[56:59], a[140:143], v[124:127]
    v_and_b32 v27, 0xffff0000, v24
    v_lshlrev_b32 v28, 16, v25
    v_mfma_f32_16x16x32_bf16 v[128:131], a[60:63], a[128:131], v[128:131]
    buffer_load_dwordx4 a[56:59], v2, s[20:23], s34 offen offset:2048
    v_mfma_f32_16x16x32_bf16 v[132:135], a[60:63], a[132:135], v[132:135]
    v_and_b32 v29, 0xffff0000, v25
    v_mul_f32 v26, v26, v164
    v_mfma_f32_16x16x32_bf16 v[136:139], a[60:63], a[136:139], v[136:139]
    v_mul_f32 v27, v27, v165
    v_mul_f32 v28, v28, v166
    v_mfma_f32_16x16x32_bf16 v[140:143], a[60:63], a[140:143], v[140:143]
    v_mul_f32 v29, v29, v167
    s_waitcnt lgkmcnt(1)
    v_mfma_f32_16x16x32_bf16 v[240:243], a[64:67], a[112:115], v[240:243]
    buffer_load_dwordx4 a[60:63], v2, s[20:23], s34 offen offset:3072
    v_mfma_f32_16x16x32_bf16 v[244:247], a[64:67], a[116:119], v[244:247]
    ds_read_b128 a[128:131], v3 offset:12288
    ds_read_b128 a[132:135], v3 offset:13312
    v_mfma_f32_16x16x32_bf16 v[248:251], a[64:67], a[120:123], v[248:251]
    ds_read_b128 a[136:139], v3 offset:14336
    ds_read_b128 a[140:143], v3 offset:15360
    v_mfma_f32_16x16x32_bf16 v[252:255], a[64:67], a[124:127], v[252:255]
    v_cvt_pk_bf16_f32 v24, v26, v27
    v_cvt_pk_bf16_f32 v25, v28, v29
    v_mfma_f32_16x16x32_bf16 v[48:51], a[68:71], a[112:115], v[48:51]
    s_mov_b32 s34, 389120
    v_mfma_f32_16x16x32_bf16 v[52:55], a[68:71], a[116:119], v[52:55]
    buffer_load_dwordx4 a[64:67], v2, s[20:23], s34 offen offset:0
    v_mfma_f32_16x16x32_bf16 v[56:59], a[68:71], a[120:123], v[56:59]
    ds_write_b128 v9, v[22:25] offset:1024
    v_mfma_f32_16x16x32_bf16 v[60:63], a[68:71], a[124:127], v[60:63]
    v_add_f32 v148, v148, v30
    v_add_f32 v149, v149, v31
    v_mfma_f32_16x16x32_bf16 v[64:67], a[72:75], a[112:115], v[64:67]
    buffer_load_dwordx4 a[68:71], v2, s[20:23], s34 offen offset:1024
    v_mfma_f32_16x16x32_bf16 v[68:71], a[72:75], a[116:119], v[68:71]
    v_add_f32 v150, v150, v32
    v_add_f32 v151, v151, v33
    v_mfma_f32_16x16x32_bf16 v[72:75], a[72:75], a[120:123], v[72:75]
    v_add_f32 v164, v164, v34
    v_add_f32 v165, v165, v35
    v_mfma_f32_16x16x32_bf16 v[76:79], a[72:75], a[124:127], v[76:79]
    v_add_f32 v166, v166, v36
    v_add_f32 v167, v167, v37
    v_mfma_f32_16x16x32_bf16 v[80:83], a[76:79], a[112:115], v[80:83]
    buffer_load_dwordx4 a[72:75], v2, s[20:23], s34 offen offset:2048
    v_mfma_f32_16x16x32_bf16 v[84:87], a[76:79], a[116:119], v[84:87]
    v_accvgpr_read_b32 v14, a200
    v_accvgpr_read_b32 v15, a201
    v_mfma_f32_16x16x32_bf16 v[88:91], a[76:79], a[120:123], v[88:91]
    v_accvgpr_read_b32 v16, a202
    v_accvgpr_read_b32 v17, a203
    v_mfma_f32_16x16x32_bf16 v[92:95], a[76:79], a[124:127], v[92:95]
    v_lshlrev_b32 v18, 16, v14
    v_and_b32 v19, 0xffff0000, v14
    v_mfma_f32_16x16x32_bf16 v[96:99], a[80:83], a[112:115], v[96:99]
    buffer_load_dwordx4 a[76:79], v2, s[20:23], s34 offen offset:3072
    v_mfma_f32_16x16x32_bf16 v[100:103], a[80:83], a[116:119], v[100:103]
    v_lshlrev_b32 v20, 16, v15
    v_and_b32 v21, 0xffff0000, v15
    v_mfma_f32_16x16x32_bf16 v[104:107], a[80:83], a[120:123], v[104:107]
    v_mul_f32 v18, v18, v152
    v_mul_f32 v19, v19, v153
    v_mfma_f32_16x16x32_bf16 v[108:111], a[80:83], a[124:127], v[108:111]
    v_mul_f32 v20, v20, v154
    v_mul_f32 v21, v21, v155
    v_mfma_f32_16x16x32_bf16 v[112:115], a[84:87], a[112:115], v[112:115]
    s_mov_b32 s34, 393216
    v_cvt_pk_bf16_f32 v14, v18, v19
    v_mfma_f32_16x16x32_bf16 v[116:119], a[84:87], a[116:119], v[116:119]
    buffer_load_dwordx4 a[80:83], v2, s[20:23], s34 offen offset:0
    v_mfma_f32_16x16x32_bf16 v[120:123], a[84:87], a[120:123], v[120:123]
    v_cvt_pk_bf16_f32 v15, v20, v21
    v_lshlrev_b32 v18, 16, v16
    v_mfma_f32_16x16x32_bf16 v[124:127], a[84:87], a[124:127], v[124:127]
    v_and_b32 v19, 0xffff0000, v16
    v_lshlrev_b32 v20, 16, v17
    s_waitcnt vmcnt(22)
    v_mfma_f32_16x16x32_bf16 v[128:131], a[88:91], a[112:115], v[128:131]
    buffer_load_dwordx4 a[84:87], v2, s[20:23], s34 offen offset:1024
    v_mfma_f32_16x16x32_bf16 v[132:135], a[88:91], a[116:119], v[132:135]
    v_and_b32 v21, 0xffff0000, v17
    v_mul_f32 v18, v18, v168
    v_mfma_f32_16x16x32_bf16 v[136:139], a[88:91], a[120:123], v[136:139]
    v_mul_f32 v19, v19, v169
    v_mul_f32 v20, v20, v170
    v_mfma_f32_16x16x32_bf16 v[140:143], a[88:91], a[124:127], v[140:143]
    v_mul_f32 v21, v21, v171
    v_cvt_pk_bf16_f32 v16, v18, v19
    s_waitcnt lgkmcnt(1)
    v_mfma_f32_16x16x32_bf16 v[240:243], a[92:95], a[128:131], v[240:243]
    buffer_load_dwordx4 a[88:91], v2, s[20:23], s34 offen offset:2048
    v_mfma_f32_16x16x32_bf16 v[244:247], a[92:95], a[132:135], v[244:247]
    ds_read_b128 a[112:115], v3 offset:16384
    ds_read_b128 a[116:119], v3 offset:17408
    v_mfma_f32_16x16x32_bf16 v[248:251], a[92:95], a[136:139], v[248:251]
    ds_read_b128 a[120:123], v3 offset:18432
    ds_read_b128 a[124:127], v3 offset:19456
    v_mfma_f32_16x16x32_bf16 v[252:255], a[92:95], a[140:143], v[252:255]
    v_cvt_pk_bf16_f32 v17, v20, v21
    v_mfma_f32_16x16x32_bf16 v[48:51], a[96:99], a[128:131], v[48:51]
    buffer_load_dwordx4 a[92:95], v2, s[20:23], s34 offen offset:3072
    v_mfma_f32_16x16x32_bf16 v[52:55], a[96:99], a[132:135], v[52:55]
    ds_write_b128 v9, v[14:17] offset:2048
    v_mfma_f32_16x16x32_bf16 v[56:59], a[96:99], a[136:139], v[56:59]
    v_add_f32 v152, v152, v30
    v_add_f32 v153, v153, v31
    v_mfma_f32_16x16x32_bf16 v[60:63], a[96:99], a[140:143], v[60:63]
    v_add_f32 v154, v154, v32
    v_add_f32 v155, v155, v33
    v_mfma_f32_16x16x32_bf16 v[64:67], a[100:103], a[128:131], v[64:67]
    s_mov_b32 s34, 397312
    v_add_f32 v168, v168, v34
    v_mfma_f32_16x16x32_bf16 v[68:71], a[100:103], a[132:135], v[68:71]
    buffer_load_dwordx4 a[96:99], v2, s[20:23], s34 offen offset:0
    v_mfma_f32_16x16x32_bf16 v[72:75], a[100:103], a[136:139], v[72:75]
    v_add_f32 v169, v169, v35
    v_add_f32 v170, v170, v36
    v_mfma_f32_16x16x32_bf16 v[76:79], a[100:103], a[140:143], v[76:79]
    v_add_f32 v171, v171, v37
    v_accvgpr_read_b32 v22, a204
    v_mfma_f32_16x16x32_bf16 v[80:83], a[104:107], a[128:131], v[80:83]
    buffer_load_dwordx4 a[100:103], v2, s[20:23], s34 offen offset:1024
    v_mfma_f32_16x16x32_bf16 v[84:87], a[104:107], a[132:135], v[84:87]
    v_accvgpr_read_b32 v23, a205
    v_accvgpr_read_b32 v24, a206
    v_mfma_f32_16x16x32_bf16 v[88:91], a[104:107], a[136:139], v[88:91]
    v_accvgpr_read_b32 v25, a207
    v_lshlrev_b32 v26, 16, v22
    v_mfma_f32_16x16x32_bf16 v[92:95], a[104:107], a[140:143], v[92:95]
    v_and_b32 v27, 0xffff0000, v22
    v_lshlrev_b32 v28, 16, v23
    v_mfma_f32_16x16x32_bf16 v[96:99], a[108:111], a[128:131], v[96:99]
    buffer_load_dwordx4 a[104:107], v2, s[20:23], s34 offen offset:2048
    v_mfma_f32_16x16x32_bf16 v[100:103], a[108:111], a[132:135], v[100:103]
    v_and_b32 v29, 0xffff0000, v23
    v_mul_f32 v26, v26, v156
    v_mfma_f32_16x16x32_bf16 v[104:107], a[108:111], a[136:139], v[104:107]
    v_mul_f32 v27, v27, v157
    v_mul_f32 v28, v28, v158
    v_mfma_f32_16x16x32_bf16 v[108:111], a[108:111], a[140:143], v[108:111]
    v_mul_f32 v29, v29, v159
    v_cvt_pk_bf16_f32 v22, v26, v27
    v_mfma_f32_16x16x32_bf16 v[112:115], a[0:3], a[128:131], v[112:115]
    buffer_load_dwordx4 a[108:111], v2, s[20:23], s34 offen offset:3072
    v_mfma_f32_16x16x32_bf16 v[116:119], a[0:3], a[132:135], v[116:119]
    v_cvt_pk_bf16_f32 v23, v28, v29
    v_lshlrev_b32 v26, 16, v24
    v_mfma_f32_16x16x32_bf16 v[120:123], a[0:3], a[136:139], v[120:123]
    v_and_b32 v27, 0xffff0000, v24
    v_lshlrev_b32 v28, 16, v25
    v_mfma_f32_16x16x32_bf16 v[124:127], a[0:3], a[140:143], v[124:127]
    v_and_b32 v29, 0xffff0000, v25
    v_mul_f32 v26, v26, v172
    s_waitcnt vmcnt(26)
    v_mfma_f32_16x16x32_bf16 v[128:131], a[4:7], a[128:131], v[128:131]
    s_mov_b32 s34, 401408
    v_mul_f32 v27, v27, v173
    v_mfma_f32_16x16x32_bf16 v[132:135], a[4:7], a[132:135], v[132:135]
    buffer_load_dwordx4 a[0:3], v2, s[20:23], s34 offen offset:0
    v_mfma_f32_16x16x32_bf16 v[136:139], a[4:7], a[136:139], v[136:139]
    v_mul_f32 v28, v28, v174
    v_mul_f32 v29, v29, v175
    v_mfma_f32_16x16x32_bf16 v[140:143], a[4:7], a[140:143], v[140:143]
    v_cvt_pk_bf16_f32 v24, v26, v27
    v_cvt_pk_bf16_f32 v25, v28, v29
    s_waitcnt lgkmcnt(1)
    v_mfma_f32_16x16x32_bf16 v[240:243], a[8:11], a[112:115], v[240:243]
    buffer_load_dwordx4 a[4:7], v2, s[20:23], s34 offen offset:1024
    v_mfma_f32_16x16x32_bf16 v[244:247], a[8:11], a[116:119], v[244:247]
    ds_read_b128 a[128:131], v3 offset:20480
    ds_read_b128 a[132:135], v3 offset:21504
    v_mfma_f32_16x16x32_bf16 v[248:251], a[8:11], a[120:123], v[248:251]
    ds_read_b128 a[136:139], v3 offset:22528
    ds_read_b128 a[140:143], v3 offset:23552
    v_mfma_f32_16x16x32_bf16 v[252:255], a[8:11], a[124:127], v[252:255]
    ds_write_b128 v9, v[22:25] offset:3072
    v_mfma_f32_16x16x32_bf16 v[48:51], a[12:15], a[112:115], v[48:51]
    buffer_load_dwordx4 a[8:11], v2, s[20:23], s34 offen offset:2048
    v_mfma_f32_16x16x32_bf16 v[52:55], a[12:15], a[116:119], v[52:55]
    v_add_f32 v156, v156, v30
    v_add_f32 v157, v157, v31
    v_mfma_f32_16x16x32_bf16 v[56:59], a[12:15], a[120:123], v[56:59]
    v_add_f32 v158, v158, v32
    v_add_f32 v159, v159, v33
    v_mfma_f32_16x16x32_bf16 v[60:63], a[12:15], a[124:127], v[60:63]
    v_add_f32 v172, v172, v34
    v_add_f32 v173, v173, v35
    s_waitcnt vmcnt(20)
    v_mfma_f32_16x16x32_bf16 v[64:67], a[16:19], a[112:115], v[64:67]
    buffer_load_dwordx4 a[12:15], v2, s[20:23], s34 offen offset:3072
    v_mfma_f32_16x16x32_bf16 v[68:71], a[16:19], a[116:119], v[68:71]
    v_add_f32 v174, v174, v36
    v_add_f32 v175, v175, v37
    v_mfma_f32_16x16x32_bf16 v[72:75], a[16:19], a[120:123], v[72:75]
    buffer_load_dwordx4 v[30:33], v12, s[24:27], 0 offen offset:1472
    v_mfma_f32_16x16x32_bf16 v[76:79], a[16:19], a[124:127], v[76:79]
    buffer_load_dwordx4 v[34:37], v12, s[24:27], 0 offen offset:1536
    v_mfma_f32_16x16x32_bf16 v[80:83], a[20:23], a[112:115], v[80:83]
    s_mov_b32 s34, 405504
    v_accvgpr_read_b32 v14, a208
    v_mfma_f32_16x16x32_bf16 v[84:87], a[20:23], a[116:119], v[84:87]
    buffer_load_dwordx4 a[16:19], v2, s[20:23], s34 offen offset:0
    v_mfma_f32_16x16x32_bf16 v[88:91], a[20:23], a[120:123], v[88:91]
    v_accvgpr_read_b32 v15, a209
    v_accvgpr_read_b32 v16, a210
    v_mfma_f32_16x16x32_bf16 v[92:95], a[20:23], a[124:127], v[92:95]
    v_accvgpr_read_b32 v17, a211
    v_lshlrev_b32 v18, 16, v14
    v_mfma_f32_16x16x32_bf16 v[96:99], a[24:27], a[112:115], v[96:99]
    buffer_load_dwordx4 a[20:23], v2, s[20:23], s34 offen offset:1024
    v_mfma_f32_16x16x32_bf16 v[100:103], a[24:27], a[116:119], v[100:103]
    v_and_b32 v19, 0xffff0000, v14
    v_lshlrev_b32 v20, 16, v15
    v_mfma_f32_16x16x32_bf16 v[104:107], a[24:27], a[120:123], v[104:107]
    v_and_b32 v21, 0xffff0000, v15
    v_mul_f32 v18, v18, v176
    v_mfma_f32_16x16x32_bf16 v[108:111], a[24:27], a[124:127], v[108:111]
    v_mul_f32 v19, v19, v177
    v_mul_f32 v20, v20, v178
    v_mfma_f32_16x16x32_bf16 v[112:115], a[28:31], a[112:115], v[112:115]
    buffer_load_dwordx4 a[24:27], v2, s[20:23], s34 offen offset:2048
    v_mfma_f32_16x16x32_bf16 v[116:119], a[28:31], a[116:119], v[116:119]
    v_mul_f32 v21, v21, v179
    v_cvt_pk_bf16_f32 v14, v18, v19
    v_mfma_f32_16x16x32_bf16 v[120:123], a[28:31], a[120:123], v[120:123]
    v_cvt_pk_bf16_f32 v15, v20, v21
    v_lshlrev_b32 v18, 16, v16
    v_mfma_f32_16x16x32_bf16 v[124:127], a[28:31], a[124:127], v[124:127]
    v_and_b32 v19, 0xffff0000, v16
    v_lshlrev_b32 v20, 16, v17
    v_mfma_f32_16x16x32_bf16 v[128:131], a[32:35], a[112:115], v[128:131]
    buffer_load_dwordx4 a[28:31], v2, s[20:23], s34 offen offset:3072
    v_mfma_f32_16x16x32_bf16 v[132:135], a[32:35], a[116:119], v[132:135]
    v_and_b32 v21, 0xffff0000, v17
    v_mul_f32 v18, v18, v192
    v_mfma_f32_16x16x32_bf16 v[136:139], a[32:35], a[120:123], v[136:139]
    v_mul_f32 v19, v19, v193
    v_mul_f32 v20, v20, v194
    v_mfma_f32_16x16x32_bf16 v[140:143], a[32:35], a[124:127], v[140:143]
    v_mul_f32 v21, v21, v195
    v_cvt_pk_bf16_f32 v16, v18, v19
    s_waitcnt lgkmcnt(1)
    v_mfma_f32_16x16x32_bf16 v[240:243], a[36:39], a[128:131], v[240:243]
    s_mov_b32 s34, 409600
    v_cvt_pk_bf16_f32 v17, v20, v21
    v_mfma_f32_16x16x32_bf16 v[244:247], a[36:39], a[132:135], v[244:247]
    ds_read_b128 a[112:115], v3 offset:24576
    ds_read_b128 a[116:119], v3 offset:25600
    v_mfma_f32_16x16x32_bf16 v[248:251], a[36:39], a[136:139], v[248:251]
    ds_read_b128 a[120:123], v3 offset:26624
    ds_read_b128 a[124:127], v3 offset:27648
    v_mfma_f32_16x16x32_bf16 v[252:255], a[36:39], a[140:143], v[252:255]
    buffer_load_dwordx4 a[32:35], v2, s[20:23], s34 offen offset:0
    v_mfma_f32_16x16x32_bf16 v[48:51], a[40:43], a[128:131], v[48:51]
    buffer_load_dwordx4 a[36:39], v2, s[20:23], s34 offen offset:1024
    v_mfma_f32_16x16x32_bf16 v[52:55], a[40:43], a[132:135], v[52:55]
    ds_write_b128 v9, v[14:17] offset:4096
    v_mfma_f32_16x16x32_bf16 v[56:59], a[40:43], a[136:139], v[56:59]
    v_add_f32 v176, v176, v38
    v_add_f32 v177, v177, v39
    v_mfma_f32_16x16x32_bf16 v[60:63], a[40:43], a[140:143], v[60:63]
    v_add_f32 v178, v178, v40
    v_add_f32 v179, v179, v41
    s_waitcnt vmcnt(22)
    v_mfma_f32_16x16x32_bf16 v[64:67], a[44:47], a[128:131], v[64:67]
    buffer_load_dwordx4 a[40:43], v2, s[20:23], s34 offen offset:2048
    v_mfma_f32_16x16x32_bf16 v[68:71], a[44:47], a[132:135], v[68:71]
    v_add_f32 v192, v192, v42
    v_add_f32 v193, v193, v43
    v_mfma_f32_16x16x32_bf16 v[72:75], a[44:47], a[136:139], v[72:75]
    v_add_f32 v194, v194, v44
    v_add_f32 v195, v195, v45
    v_mfma_f32_16x16x32_bf16 v[76:79], a[44:47], a[140:143], v[76:79]
    v_accvgpr_read_b32 v22, a212
    v_accvgpr_read_b32 v23, a213
    v_mfma_f32_16x16x32_bf16 v[80:83], a[48:51], a[128:131], v[80:83]
    buffer_load_dwordx4 a[44:47], v2, s[20:23], s34 offen offset:3072
    v_mfma_f32_16x16x32_bf16 v[84:87], a[48:51], a[132:135], v[84:87]
    v_accvgpr_read_b32 v24, a214
    v_accvgpr_read_b32 v25, a215
    v_mfma_f32_16x16x32_bf16 v[88:91], a[48:51], a[136:139], v[88:91]
    v_lshlrev_b32 v26, 16, v22
    v_and_b32 v27, 0xffff0000, v22
    v_mfma_f32_16x16x32_bf16 v[92:95], a[48:51], a[140:143], v[92:95]
    v_lshlrev_b32 v28, 16, v23
    v_and_b32 v29, 0xffff0000, v23
    v_mfma_f32_16x16x32_bf16 v[96:99], a[52:55], a[128:131], v[96:99]
    s_mov_b32 s34, 413696
    v_mul_f32 v26, v26, v180
    v_mfma_f32_16x16x32_bf16 v[100:103], a[52:55], a[132:135], v[100:103]
    buffer_load_dwordx4 a[48:51], v2, s[20:23], s34 offen offset:0
    v_mfma_f32_16x16x32_bf16 v[104:107], a[52:55], a[136:139], v[104:107]
    v_mul_f32 v27, v27, v181
    v_mul_f32 v28, v28, v182
    v_mfma_f32_16x16x32_bf16 v[108:111], a[52:55], a[140:143], v[108:111]
    v_mul_f32 v29, v29, v183
    v_cvt_pk_bf16_f32 v22, v26, v27
    v_mfma_f32_16x16x32_bf16 v[112:115], a[56:59], a[128:131], v[112:115]
    buffer_load_dwordx4 a[52:55], v2, s[20:23], s34 offen offset:1024
    v_mfma_f32_16x16x32_bf16 v[116:119], a[56:59], a[132:135], v[116:119]
    v_cvt_pk_bf16_f32 v23, v28, v29
    v_lshlrev_b32 v26, 16, v24
    v_mfma_f32_16x16x32_bf16 v[120:123], a[56:59], a[136:139], v[120:123]
    v_and_b32 v27, 0xffff0000, v24
    v_lshlrev_b32 v28, 16, v25
    v_mfma_f32_16x16x32_bf16 v[124:127], a[56:59], a[140:143], v[124:127]
    v_and_b32 v29, 0xffff0000, v25
    v_mul_f32 v26, v26, v196
    v_mfma_f32_16x16x32_bf16 v[128:131], a[60:63], a[128:131], v[128:131]
    buffer_load_dwordx4 a[56:59], v2, s[20:23], s34 offen offset:2048
    v_mfma_f32_16x16x32_bf16 v[132:135], a[60:63], a[132:135], v[132:135]
    v_mul_f32 v27, v27, v197
    v_mul_f32 v28, v28, v198
    v_mfma_f32_16x16x32_bf16 v[136:139], a[60:63], a[136:139], v[136:139]
    v_mul_f32 v29, v29, v199
    v_cvt_pk_bf16_f32 v24, v26, v27
    v_mfma_f32_16x16x32_bf16 v[140:143], a[60:63], a[140:143], v[140:143]
    v_cvt_pk_bf16_f32 v25, v28, v29
    s_waitcnt lgkmcnt(1)
    v_mfma_f32_16x16x32_bf16 v[240:243], a[64:67], a[112:115], v[240:243]
    buffer_load_dwordx4 a[60:63], v2, s[20:23], s34 offen offset:3072
    v_mfma_f32_16x16x32_bf16 v[244:247], a[64:67], a[116:119], v[244:247]
    ds_read_b128 a[128:131], v3 offset:28672
    ds_read_b128 a[132:135], v3 offset:29696
    v_mfma_f32_16x16x32_bf16 v[248:251], a[64:67], a[120:123], v[248:251]
    ds_read_b128 a[136:139], v3 offset:30720
    ds_read_b128 a[140:143], v3 offset:31744
    v_mfma_f32_16x16x32_bf16 v[252:255], a[64:67], a[124:127], v[252:255]
    ds_write_b128 v9, v[22:25] offset:5120
    v_mfma_f32_16x16x32_bf16 v[48:51], a[68:71], a[112:115], v[48:51]
    s_mov_b32 s34, 417792
    v_add_f32 v180, v180, v38
    v_mfma_f32_16x16x32_bf16 v[52:55], a[68:71], a[116:119], v[52:55]
    buffer_load_dwordx4 a[64:67], v2, s[20:23], s34 offen offset:0
    v_mfma_f32_16x16x32_bf16 v[56:59], a[68:71], a[120:123], v[56:59]
    v_add_f32 v181, v181, v39
    v_add_f32 v182, v182, v40
    v_mfma_f32_16x16x32_bf16 v[60:63], a[68:71], a[124:127], v[60:63]
    v_add_f32 v183, v183, v41
    v_add_f32 v196, v196, v42
    s_waitcnt vmcnt(22)
    v_mfma_f32_16x16x32_bf16 v[64:67], a[72:75], a[112:115], v[64:67]
    buffer_load_dwordx4 a[68:71], v2, s[20:23], s34 offen offset:1024
    v_mfma_f32_16x16x32_bf16 v[68:71], a[72:75], a[116:119], v[68:71]
    v_add_f32 v197, v197, v43
    v_add_f32 v198, v198, v44
    v_mfma_f32_16x16x32_bf16 v[72:75], a[72:75], a[120:123], v[72:75]
    v_add_f32 v199, v199, v45
    v_accvgpr_read_b32 v14, a216
    v_mfma_f32_16x16x32_bf16 v[76:79], a[72:75], a[124:127], v[76:79]
    v_accvgpr_read_b32 v15, a217
    v_accvgpr_read_b32 v16, a218
    v_mfma_f32_16x16x32_bf16 v[80:83], a[76:79], a[112:115], v[80:83]
    buffer_load_dwordx4 a[72:75], v2, s[20:23], s34 offen offset:2048
    v_mfma_f32_16x16x32_bf16 v[84:87], a[76:79], a[116:119], v[84:87]
    v_accvgpr_read_b32 v17, a219
    v_lshlrev_b32 v18, 16, v14
    v_mfma_f32_16x16x32_bf16 v[88:91], a[76:79], a[120:123], v[88:91]
    v_and_b32 v19, 0xffff0000, v14
    v_lshlrev_b32 v20, 16, v15
    v_mfma_f32_16x16x32_bf16 v[92:95], a[76:79], a[124:127], v[92:95]
    v_and_b32 v21, 0xffff0000, v15
    v_mul_f32 v18, v18, v184
    v_mfma_f32_16x16x32_bf16 v[96:99], a[80:83], a[112:115], v[96:99]
    buffer_load_dwordx4 a[76:79], v2, s[20:23], s34 offen offset:3072
    v_mfma_f32_16x16x32_bf16 v[100:103], a[80:83], a[116:119], v[100:103]
    v_mul_f32 v19, v19, v185
    v_mul_f32 v20, v20, v186
    v_mfma_f32_16x16x32_bf16 v[104:107], a[80:83], a[120:123], v[104:107]
    v_mul_f32 v21, v21, v187
    v_cvt_pk_bf16_f32 v14, v18, v19
    v_mfma_f32_16x16x32_bf16 v[108:111], a[80:83], a[124:127], v[108:111]
    v_cvt_pk_bf16_f32 v15, v20, v21
    v_lshlrev_b32 v18, 16, v16
    v_mfma_f32_16x16x32_bf16 v[112:115], a[84:87], a[112:115], v[112:115]
    s_mov_b32 s34, 421888
    v_and_b32 v19, 0xffff0000, v16
    v_mfma_f32_16x16x32_bf16 v[116:119], a[84:87], a[116:119], v[116:119]
    buffer_load_dwordx4 a[80:83], v2, s[20:23], s34 offen offset:0
    v_mfma_f32_16x16x32_bf16 v[120:123], a[84:87], a[120:123], v[120:123]
    v_lshlrev_b32 v20, 16, v17
    v_and_b32 v21, 0xffff0000, v17
    v_mfma_f32_16x16x32_bf16 v[124:127], a[84:87], a[124:127], v[124:127]
    v_mul_f32 v18, v18, v200
    v_mul_f32 v19, v19, v201
    v_mfma_f32_16x16x32_bf16 v[128:131], a[88:91], a[112:115], v[128:131]
    buffer_load_dwordx4 a[84:87], v2, s[20:23], s34 offen offset:1024
    v_mfma_f32_16x16x32_bf16 v[132:135], a[88:91], a[116:119], v[132:135]
    v_mul_f32 v20, v20, v202
    v_mul_f32 v21, v21, v203
    v_mfma_f32_16x16x32_bf16 v[136:139], a[88:91], a[120:123], v[136:139]
    v_cvt_pk_bf16_f32 v16, v18, v19
    v_cvt_pk_bf16_f32 v17, v20, v21
    v_mfma_f32_16x16x32_bf16 v[140:143], a[88:91], a[124:127], v[140:143]
    ds_write_b128 v9, v[14:17] offset:6144
    s_waitcnt lgkmcnt(2)
    v_mfma_f32_16x16x32_bf16 v[240:243], a[92:95], a[128:131], v[240:243]
    buffer_load_dwordx4 a[88:91], v2, s[20:23], s34 offen offset:2048
    v_mfma_f32_16x16x32_bf16 v[244:247], a[92:95], a[132:135], v[244:247]
    ds_read_b128 a[112:115], v3 offset:32768
    ds_read_b128 a[116:119], v3 offset:33792
    v_mfma_f32_16x16x32_bf16 v[248:251], a[92:95], a[136:139], v[248:251]
    ds_read_b128 a[120:123], v3 offset:34816
    ds_read_b128 a[124:127], v3 offset:35840
    v_mfma_f32_16x16x32_bf16 v[252:255], a[92:95], a[140:143], v[252:255]
    v_add_f32 v184, v184, v38
    v_add_f32 v185, v185, v39
    v_mfma_f32_16x16x32_bf16 v[48:51], a[96:99], a[128:131], v[48:51]
    buffer_load_dwordx4 a[92:95], v2, s[20:23], s34 offen offset:3072
    v_mfma_f32_16x16x32_bf16 v[52:55], a[96:99], a[132:135], v[52:55]
    v_add_f32 v186, v186, v40
    v_add_f32 v187, v187, v41
    v_mfma_f32_16x16x32_bf16 v[56:59], a[96:99], a[136:139], v[56:59]
    v_add_f32 v200, v200, v42
    v_add_f32 v201, v201, v43
    v_mfma_f32_16x16x32_bf16 v[60:63], a[96:99], a[140:143], v[60:63]
    v_add_f32 v202, v202, v44
    v_add_f32 v203, v203, v45
    s_waitcnt vmcnt(22)
    v_mfma_f32_16x16x32_bf16 v[64:67], a[100:103], a[128:131], v[64:67]
    s_mov_b32 s34, 425984
    v_accvgpr_read_b32 v22, a220
    v_mfma_f32_16x16x32_bf16 v[68:71], a[100:103], a[132:135], v[68:71]
    buffer_load_dwordx4 a[96:99], v2, s[20:23], s34 offen offset:0
    v_mfma_f32_16x16x32_bf16 v[72:75], a[100:103], a[136:139], v[72:75]
    v_accvgpr_read_b32 v23, a221
    v_accvgpr_read_b32 v24, a222
    v_mfma_f32_16x16x32_bf16 v[76:79], a[100:103], a[140:143], v[76:79]
    v_accvgpr_read_b32 v25, a223
    v_lshlrev_b32 v26, 16, v22
    v_mfma_f32_16x16x32_bf16 v[80:83], a[104:107], a[128:131], v[80:83]
    buffer_load_dwordx4 a[100:103], v2, s[20:23], s34 offen offset:1024
    v_mfma_f32_16x16x32_bf16 v[84:87], a[104:107], a[132:135], v[84:87]
    v_and_b32 v27, 0xffff0000, v22
    v_lshlrev_b32 v28, 16, v23
    v_mfma_f32_16x16x32_bf16 v[88:91], a[104:107], a[136:139], v[88:91]
    v_and_b32 v29, 0xffff0000, v23
    v_mul_f32 v26, v26, v188
    v_mfma_f32_16x16x32_bf16 v[92:95], a[104:107], a[140:143], v[92:95]
    v_mul_f32 v27, v27, v189
    v_mul_f32 v28, v28, v190
    v_mfma_f32_16x16x32_bf16 v[96:99], a[108:111], a[128:131], v[96:99]
    buffer_load_dwordx4 a[104:107], v2, s[20:23], s34 offen offset:2048
    v_mfma_f32_16x16x32_bf16 v[100:103], a[108:111], a[132:135], v[100:103]
    v_mul_f32 v29, v29, v191
    v_cvt_pk_bf16_f32 v22, v26, v27
    v_mfma_f32_16x16x32_bf16 v[104:107], a[108:111], a[136:139], v[104:107]
    v_cvt_pk_bf16_f32 v23, v28, v29
    v_lshlrev_b32 v26, 16, v24
    v_mfma_f32_16x16x32_bf16 v[108:111], a[108:111], a[140:143], v[108:111]
    v_and_b32 v27, 0xffff0000, v24
    v_lshlrev_b32 v28, 16, v25
    v_mfma_f32_16x16x32_bf16 v[112:115], a[0:3], a[128:131], v[112:115]
    buffer_load_dwordx4 a[108:111], v2, s[20:23], s34 offen offset:3072
    v_mfma_f32_16x16x32_bf16 v[116:119], a[0:3], a[132:135], v[116:119]
    v_and_b32 v29, 0xffff0000, v25
    v_mul_f32 v26, v26, v204
    v_mfma_f32_16x16x32_bf16 v[120:123], a[0:3], a[136:139], v[120:123]
    v_mul_f32 v27, v27, v205
    v_mul_f32 v28, v28, v206
    v_mfma_f32_16x16x32_bf16 v[124:127], a[0:3], a[140:143], v[124:127]
    v_mul_f32 v29, v29, v207
    v_cvt_pk_bf16_f32 v24, v26, v27
    v_mfma_f32_16x16x32_bf16 v[128:131], a[4:7], a[128:131], v[128:131]
    s_mov_b32 s34, 430080
    v_cvt_pk_bf16_f32 v25, v28, v29
    v_mfma_f32_16x16x32_bf16 v[132:135], a[4:7], a[132:135], v[132:135]
    buffer_load_dwordx4 a[0:3], v2, s[20:23], s34 offen offset:0
    v_mfma_f32_16x16x32_bf16 v[136:139], a[4:7], a[136:139], v[136:139]
    ds_write_b128 v9, v[22:25] offset:7168
    v_mfma_f32_16x16x32_bf16 v[140:143], a[4:7], a[140:143], v[140:143]
    v_add_f32 v188, v188, v38
    v_add_f32 v189, v189, v39
    s_waitcnt lgkmcnt(1)
    v_mfma_f32_16x16x32_bf16 v[240:243], a[8:11], a[112:115], v[240:243]
    buffer_load_dwordx4 a[4:7], v2, s[20:23], s34 offen offset:1024
    v_mfma_f32_16x16x32_bf16 v[244:247], a[8:11], a[116:119], v[244:247]
    ds_read_b128 a[128:131], v3 offset:36864
    ds_read_b128 a[132:135], v3 offset:37888
    v_mfma_f32_16x16x32_bf16 v[248:251], a[8:11], a[120:123], v[248:251]
    ds_read_b128 a[136:139], v3 offset:38912
    ds_read_b128 a[140:143], v3 offset:39936
    v_mfma_f32_16x16x32_bf16 v[252:255], a[8:11], a[124:127], v[252:255]
    v_add_f32 v190, v190, v40
    v_add_f32 v191, v191, v41
    v_mfma_f32_16x16x32_bf16 v[48:51], a[12:15], a[112:115], v[48:51]
    buffer_load_dwordx4 a[8:11], v2, s[20:23], s34 offen offset:2048
    v_mfma_f32_16x16x32_bf16 v[52:55], a[12:15], a[116:119], v[52:55]
    v_add_f32 v204, v204, v42
    v_add_f32 v205, v205, v43
    v_mfma_f32_16x16x32_bf16 v[56:59], a[12:15], a[120:123], v[56:59]
    v_add_f32 v206, v206, v44
    v_add_f32 v207, v207, v45
    v_mfma_f32_16x16x32_bf16 v[60:63], a[12:15], a[124:127], v[60:63]
    v_accvgpr_read_b32 v14, a224
    v_accvgpr_read_b32 v15, a225
    s_waitcnt vmcnt(20)
    v_mfma_f32_16x16x32_bf16 v[64:67], a[16:19], a[112:115], v[64:67]
    buffer_load_dwordx4 a[12:15], v2, s[20:23], s34 offen offset:3072
    v_mfma_f32_16x16x32_bf16 v[68:71], a[16:19], a[116:119], v[68:71]
    v_accvgpr_read_b32 v16, a226
    v_accvgpr_read_b32 v17, a227
    v_mfma_f32_16x16x32_bf16 v[72:75], a[16:19], a[120:123], v[72:75]
    v_lshlrev_b32 v18, 16, v14
    v_and_b32 v19, 0xffff0000, v14
    v_mfma_f32_16x16x32_bf16 v[76:79], a[16:19], a[124:127], v[76:79]
    v_lshlrev_b32 v20, 16, v15
    v_and_b32 v21, 0xffff0000, v15
    v_mfma_f32_16x16x32_bf16 v[80:83], a[20:23], a[112:115], v[80:83]
    s_mov_b32 s34, 434176
    v_mul_f32 v18, v18, v208
    v_mfma_f32_16x16x32_bf16 v[84:87], a[20:23], a[116:119], v[84:87]
    buffer_load_dwordx4 a[16:19], v2, s[20:23], s34 offen offset:0
    v_mfma_f32_16x16x32_bf16 v[88:91], a[20:23], a[120:123], v[88:91]
    v_mul_f32 v19, v19, v209
    v_mul_f32 v20, v20, v210
    v_mfma_f32_16x16x32_bf16 v[92:95], a[20:23], a[124:127], v[92:95]
    v_mul_f32 v21, v21, v211
    v_cvt_pk_bf16_f32 v14, v18, v19
    v_mfma_f32_16x16x32_bf16 v[96:99], a[24:27], a[112:115], v[96:99]
    buffer_load_dwordx4 a[20:23], v2, s[20:23], s34 offen offset:1024
    v_mfma_f32_16x16x32_bf16 v[100:103], a[24:27], a[116:119], v[100:103]
    v_cvt_pk_bf16_f32 v15, v20, v21
    v_lshlrev_b32 v18, 16, v16
    v_mfma_f32_16x16x32_bf16 v[104:107], a[24:27], a[120:123], v[104:107]
    v_and_b32 v19, 0xffff0000, v16
    v_lshlrev_b32 v20, 16, v17
    v_mfma_f32_16x16x32_bf16 v[108:111], a[24:27], a[124:127], v[108:111]
    v_and_b32 v21, 0xffff0000, v17
    v_mul_f32 v18, v18, v224
    v_mfma_f32_16x16x32_bf16 v[112:115], a[28:31], a[112:115], v[112:115]
    buffer_load_dwordx4 a[24:27], v2, s[20:23], s34 offen offset:2048
    v_mfma_f32_16x16x32_bf16 v[116:119], a[28:31], a[116:119], v[116:119]
    v_mul_f32 v19, v19, v225
    v_mul_f32 v20, v20, v226
    v_mfma_f32_16x16x32_bf16 v[120:123], a[28:31], a[120:123], v[120:123]
    v_mul_f32 v21, v21, v227
    v_cvt_pk_bf16_f32 v16, v18, v19
    v_mfma_f32_16x16x32_bf16 v[124:127], a[28:31], a[124:127], v[124:127]
    v_cvt_pk_bf16_f32 v17, v20, v21
    v_mfma_f32_16x16x32_bf16 v[128:131], a[32:35], a[112:115], v[128:131]
    buffer_load_dwordx4 a[28:31], v2, s[20:23], s34 offen offset:3072
    v_mfma_f32_16x16x32_bf16 v[132:135], a[32:35], a[116:119], v[132:135]
    ds_write_b128 v9, v[14:17] offset:8192
    v_mfma_f32_16x16x32_bf16 v[136:139], a[32:35], a[120:123], v[136:139]
    v_add_f32 v208, v208, v30
    v_add_f32 v209, v209, v31
    v_mfma_f32_16x16x32_bf16 v[140:143], a[32:35], a[124:127], v[140:143]
    v_add_f32 v210, v210, v32
    v_add_f32 v211, v211, v33
    s_waitcnt lgkmcnt(1)
    v_mfma_f32_16x16x32_bf16 v[240:243], a[36:39], a[128:131], v[240:243]
    s_mov_b32 s34, 438272
    v_add_f32 v224, v224, v34
    v_mfma_f32_16x16x32_bf16 v[244:247], a[36:39], a[132:135], v[244:247]
    ds_read_b128 a[112:115], v3 offset:40960
    ds_read_b128 a[116:119], v3 offset:41984
    v_mfma_f32_16x16x32_bf16 v[248:251], a[36:39], a[136:139], v[248:251]
    ds_read_b128 a[120:123], v3 offset:43008
    ds_read_b128 a[124:127], v3 offset:44032
    v_mfma_f32_16x16x32_bf16 v[252:255], a[36:39], a[140:143], v[252:255]
    buffer_load_dwordx4 a[32:35], v2, s[20:23], s34 offen offset:0
    v_mfma_f32_16x16x32_bf16 v[48:51], a[40:43], a[128:131], v[48:51]
    buffer_load_dwordx4 a[36:39], v2, s[20:23], s34 offen offset:1024
    v_mfma_f32_16x16x32_bf16 v[52:55], a[40:43], a[132:135], v[52:55]
    v_add_f32 v225, v225, v35
    v_add_f32 v226, v226, v36
    v_mfma_f32_16x16x32_bf16 v[56:59], a[40:43], a[136:139], v[56:59]
    v_add_f32 v227, v227, v37
    v_accvgpr_read_b32 v22, a228
    v_mfma_f32_16x16x32_bf16 v[60:63], a[40:43], a[140:143], v[60:63]
    v_accvgpr_read_b32 v23, a229
    v_accvgpr_read_b32 v24, a230
    s_waitcnt vmcnt(20)
    v_mfma_f32_16x16x32_bf16 v[64:67], a[44:47], a[128:131], v[64:67]
    buffer_load_dwordx4 a[40:43], v2, s[20:23], s34 offen offset:2048
    v_mfma_f32_16x16x32_bf16 v[68:71], a[44:47], a[132:135], v[68:71]
    v_accvgpr_read_b32 v25, a231
    v_lshlrev_b32 v26, 16, v22
    v_mfma_f32_16x16x32_bf16 v[72:75], a[44:47], a[136:139], v[72:75]
    v_and_b32 v27, 0xffff0000, v22
    v_lshlrev_b32 v28, 16, v23
    v_mfma_f32_16x16x32_bf16 v[76:79], a[44:47], a[140:143], v[76:79]
    v_and_b32 v29, 0xffff0000, v23
    v_mul_f32 v26, v26, v212
    v_mfma_f32_16x16x32_bf16 v[80:83], a[48:51], a[128:131], v[80:83]
    buffer_load_dwordx4 a[44:47], v2, s[20:23], s34 offen offset:3072
    v_mfma_f32_16x16x32_bf16 v[84:87], a[48:51], a[132:135], v[84:87]
    v_mul_f32 v27, v27, v213
    v_mul_f32 v28, v28, v214
    v_mfma_f32_16x16x32_bf16 v[88:91], a[48:51], a[136:139], v[88:91]
    v_mul_f32 v29, v29, v215
    v_cvt_pk_bf16_f32 v22, v26, v27
    v_mfma_f32_16x16x32_bf16 v[92:95], a[48:51], a[140:143], v[92:95]
    v_cvt_pk_bf16_f32 v23, v28, v29
    v_lshlrev_b32 v26, 16, v24
    v_mfma_f32_16x16x32_bf16 v[96:99], a[52:55], a[128:131], v[96:99]
    s_mov_b32 s34, 442368
    v_and_b32 v27, 0xffff0000, v24
    v_mfma_f32_16x16x32_bf16 v[100:103], a[52:55], a[132:135], v[100:103]
    buffer_load_dwordx4 a[48:51], v2, s[20:23], s34 offen offset:0
    v_mfma_f32_16x16x32_bf16 v[104:107], a[52:55], a[136:139], v[104:107]
    v_lshlrev_b32 v28, 16, v25
    v_and_b32 v29, 0xffff0000, v25
    v_mfma_f32_16x16x32_bf16 v[108:111], a[52:55], a[140:143], v[108:111]
    v_mul_f32 v26, v26, v228
    v_mul_f32 v27, v27, v229
    v_mfma_f32_16x16x32_bf16 v[112:115], a[56:59], a[128:131], v[112:115]
    buffer_load_dwordx4 a[52:55], v2, s[20:23], s34 offen offset:1024
    v_mfma_f32_16x16x32_bf16 v[116:119], a[56:59], a[132:135], v[116:119]
    v_mul_f32 v28, v28, v230
    v_mul_f32 v29, v29, v231
    v_mfma_f32_16x16x32_bf16 v[120:123], a[56:59], a[136:139], v[120:123]
    v_cvt_pk_bf16_f32 v24, v26, v27
    v_cvt_pk_bf16_f32 v25, v28, v29
    v_mfma_f32_16x16x32_bf16 v[124:127], a[56:59], a[140:143], v[124:127]
    ds_write_b128 v9, v[22:25] offset:9216
    v_mfma_f32_16x16x32_bf16 v[128:131], a[60:63], a[128:131], v[128:131]
    buffer_load_dwordx4 a[56:59], v2, s[20:23], s34 offen offset:2048
    v_mfma_f32_16x16x32_bf16 v[132:135], a[60:63], a[132:135], v[132:135]
    v_add_f32 v212, v212, v30
    v_add_f32 v213, v213, v31
    v_mfma_f32_16x16x32_bf16 v[136:139], a[60:63], a[136:139], v[136:139]
    v_add_f32 v214, v214, v32
    v_add_f32 v215, v215, v33
    v_mfma_f32_16x16x32_bf16 v[140:143], a[60:63], a[140:143], v[140:143]
    v_add_f32 v228, v228, v34
    v_add_f32 v229, v229, v35
    s_waitcnt lgkmcnt(1)
    v_mfma_f32_16x16x32_bf16 v[240:243], a[64:67], a[112:115], v[240:243]
    buffer_load_dwordx4 a[60:63], v2, s[20:23], s34 offen offset:3072
    v_mfma_f32_16x16x32_bf16 v[244:247], a[64:67], a[116:119], v[244:247]
    ds_read_b128 a[128:131], v3 offset:45056
    ds_read_b128 a[132:135], v3 offset:46080
    v_mfma_f32_16x16x32_bf16 v[248:251], a[64:67], a[120:123], v[248:251]
    ds_read_b128 a[136:139], v3 offset:47104
    ds_read_b128 a[140:143], v3 offset:48128
    v_mfma_f32_16x16x32_bf16 v[252:255], a[64:67], a[124:127], v[252:255]
    v_add_f32 v230, v230, v36
    v_add_f32 v231, v231, v37
    v_mfma_f32_16x16x32_bf16 v[48:51], a[68:71], a[112:115], v[48:51]
    s_mov_b32 s34, 446464
    v_accvgpr_read_b32 v14, a232
    v_mfma_f32_16x16x32_bf16 v[52:55], a[68:71], a[116:119], v[52:55]
    buffer_load_dwordx4 a[64:67], v2, s[20:23], s34 offen offset:0
    v_mfma_f32_16x16x32_bf16 v[56:59], a[68:71], a[120:123], v[56:59]
    v_accvgpr_read_b32 v15, a233
    v_accvgpr_read_b32 v16, a234
    v_mfma_f32_16x16x32_bf16 v[60:63], a[68:71], a[124:127], v[60:63]
    v_accvgpr_read_b32 v17, a235
    v_lshlrev_b32 v18, 16, v14
    s_waitcnt vmcnt(20)
    v_mfma_f32_16x16x32_bf16 v[64:67], a[72:75], a[112:115], v[64:67]
    buffer_load_dwordx4 a[68:71], v2, s[20:23], s34 offen offset:1024
    v_mfma_f32_16x16x32_bf16 v[68:71], a[72:75], a[116:119], v[68:71]
    v_and_b32 v19, 0xffff0000, v14
    v_lshlrev_b32 v20, 16, v15
    v_mfma_f32_16x16x32_bf16 v[72:75], a[72:75], a[120:123], v[72:75]
    v_and_b32 v21, 0xffff0000, v15
    v_mul_f32 v18, v18, v216
    v_mfma_f32_16x16x32_bf16 v[76:79], a[72:75], a[124:127], v[76:79]
    v_mul_f32 v19, v19, v217
    v_mul_f32 v20, v20, v218
    v_mfma_f32_16x16x32_bf16 v[80:83], a[76:79], a[112:115], v[80:83]
    buffer_load_dwordx4 a[72:75], v2, s[20:23], s34 offen offset:2048
    v_mfma_f32_16x16x32_bf16 v[84:87], a[76:79], a[116:119], v[84:87]
    v_mul_f32 v21, v21, v219
    v_cvt_pk_bf16_f32 v14, v18, v19
    v_mfma_f32_16x16x32_bf16 v[88:91], a[76:79], a[120:123], v[88:91]
    v_cvt_pk_bf16_f32 v15, v20, v21
    v_lshlrev_b32 v18, 16, v16
    v_mfma_f32_16x16x32_bf16 v[92:95], a[76:79], a[124:127], v[92:95]
    v_and_b32 v19, 0xffff0000, v16
    v_lshlrev_b32 v20, 16, v17
    v_mfma_f32_16x16x32_bf16 v[96:99], a[80:83], a[112:115], v[96:99]
    buffer_load_dwordx4 a[76:79], v2, s[20:23], s34 offen offset:3072
    v_mfma_f32_16x16x32_bf16 v[100:103], a[80:83], a[116:119], v[100:103]
    v_and_b32 v21, 0xffff0000, v17
    v_mul_f32 v18, v18, v232
    v_mfma_f32_16x16x32_bf16 v[104:107], a[80:83], a[120:123], v[104:107]
    v_mul_f32 v19, v19, v233
    v_mul_f32 v20, v20, v234
    v_mfma_f32_16x16x32_bf16 v[108:111], a[80:83], a[124:127], v[108:111]
    v_mul_f32 v21, v21, v235
    v_mfma_f32_16x16x32_bf16 v[112:115], a[84:87], a[112:115], v[112:115]
    s_mov_b32 s34, 450560
    v_cvt_pk_bf16_f32 v16, v18, v19
    v_mfma_f32_16x16x32_bf16 v[116:119], a[84:87], a[116:119], v[116:119]
    buffer_load_dwordx4 a[80:83], v2, s[20:23], s34 offen offset:0
    v_mfma_f32_16x16x32_bf16 v[120:123], a[84:87], a[120:123], v[120:123]
    v_cvt_pk_bf16_f32 v17, v20, v21
    v_mfma_f32_16x16x32_bf16 v[124:127], a[84:87], a[124:127], v[124:127]
    ds_write_b128 v9, v[14:17] offset:10240
    v_mfma_f32_16x16x32_bf16 v[128:131], a[88:91], a[112:115], v[128:131]
    buffer_load_dwordx4 a[84:87], v2, s[20:23], s34 offen offset:1024
    v_mfma_f32_16x16x32_bf16 v[132:135], a[88:91], a[116:119], v[132:135]
    v_add_f32 v216, v216, v30
    v_add_f32 v217, v217, v31
    v_mfma_f32_16x16x32_bf16 v[136:139], a[88:91], a[120:123], v[136:139]
    v_add_f32 v218, v218, v32
    v_add_f32 v219, v219, v33
    v_mfma_f32_16x16x32_bf16 v[140:143], a[88:91], a[124:127], v[140:143]
    v_add_f32 v232, v232, v34
    v_add_f32 v233, v233, v35
    s_waitcnt lgkmcnt(1)
    v_mfma_f32_16x16x32_bf16 v[240:243], a[92:95], a[128:131], v[240:243]
    buffer_load_dwordx4 a[88:91], v2, s[20:23], s34 offen offset:2048
    v_mfma_f32_16x16x32_bf16 v[244:247], a[92:95], a[132:135], v[244:247]
    ds_read_b128 a[112:115], v3 offset:49152
    ds_read_b128 a[116:119], v3 offset:50176
    v_mfma_f32_16x16x32_bf16 v[248:251], a[92:95], a[136:139], v[248:251]
    ds_read_b128 a[120:123], v3 offset:51200
    ds_read_b128 a[124:127], v3 offset:52224
    v_mfma_f32_16x16x32_bf16 v[252:255], a[92:95], a[140:143], v[252:255]
    v_add_f32 v234, v234, v36
    v_add_f32 v235, v235, v37
    v_mfma_f32_16x16x32_bf16 v[48:51], a[96:99], a[128:131], v[48:51]
    buffer_load_dwordx4 a[92:95], v2, s[20:23], s34 offen offset:3072
    v_mfma_f32_16x16x32_bf16 v[52:55], a[96:99], a[132:135], v[52:55]
    v_accvgpr_read_b32 v22, a236
    v_accvgpr_read_b32 v23, a237
    v_mfma_f32_16x16x32_bf16 v[56:59], a[96:99], a[136:139], v[56:59]
    v_accvgpr_read_b32 v24, a238
    v_accvgpr_read_b32 v25, a239
    v_mfma_f32_16x16x32_bf16 v[60:63], a[96:99], a[140:143], v[60:63]
    v_lshlrev_b32 v26, 16, v22
    v_and_b32 v27, 0xffff0000, v22
    s_waitcnt vmcnt(20)
    v_mfma_f32_16x16x32_bf16 v[64:67], a[100:103], a[128:131], v[64:67]
    s_mov_b32 s34, 454656
    v_lshlrev_b32 v28, 16, v23
    v_mfma_f32_16x16x32_bf16 v[68:71], a[100:103], a[132:135], v[68:71]
    buffer_load_dwordx4 a[96:99], v2, s[20:23], s34 offen offset:0
    v_mfma_f32_16x16x32_bf16 v[72:75], a[100:103], a[136:139], v[72:75]
    v_and_b32 v29, 0xffff0000, v23
    v_mul_f32 v26, v26, v220
    v_mfma_f32_16x16x32_bf16 v[76:79], a[100:103], a[140:143], v[76:79]
    v_mul_f32 v27, v27, v221
    v_mul_f32 v28, v28, v222
    v_mfma_f32_16x16x32_bf16 v[80:83], a[104:107], a[128:131], v[80:83]
    buffer_load_dwordx4 a[100:103], v2, s[20:23], s34 offen offset:1024
    v_mfma_f32_16x16x32_bf16 v[84:87], a[104:107], a[132:135], v[84:87]
    v_mul_f32 v29, v29, v223
    v_cvt_pk_bf16_f32 v22, v26, v27
    v_mfma_f32_16x16x32_bf16 v[88:91], a[104:107], a[136:139], v[88:91]
    v_cvt_pk_bf16_f32 v23, v28, v29
    v_lshlrev_b32 v26, 16, v24
    v_mfma_f32_16x16x32_bf16 v[92:95], a[104:107], a[140:143], v[92:95]
    v_and_b32 v27, 0xffff0000, v24
    v_lshlrev_b32 v28, 16, v25
    v_mfma_f32_16x16x32_bf16 v[96:99], a[108:111], a[128:131], v[96:99]
    buffer_load_dwordx4 a[104:107], v2, s[20:23], s34 offen offset:2048
    v_mfma_f32_16x16x32_bf16 v[100:103], a[108:111], a[132:135], v[100:103]
    v_and_b32 v29, 0xffff0000, v25
    v_mul_f32 v26, v26, v236
    v_mfma_f32_16x16x32_bf16 v[104:107], a[108:111], a[136:139], v[104:107]
    v_mul_f32 v27, v27, v237
    v_mul_f32 v28, v28, v238
    v_mfma_f32_16x16x32_bf16 v[108:111], a[108:111], a[140:143], v[108:111]
    v_mul_f32 v29, v29, v239
    v_cvt_pk_bf16_f32 v24, v26, v27
    v_mfma_f32_16x16x32_bf16 v[112:115], a[0:3], a[128:131], v[112:115]
    buffer_load_dwordx4 a[108:111], v2, s[20:23], s34 offen offset:3072
    v_mfma_f32_16x16x32_bf16 v[116:119], a[0:3], a[132:135], v[116:119]
    v_cvt_pk_bf16_f32 v25, v28, v29
    v_mfma_f32_16x16x32_bf16 v[120:123], a[0:3], a[136:139], v[120:123]
    ds_write_b128 v9, v[22:25] offset:11264
    v_mfma_f32_16x16x32_bf16 v[124:127], a[0:3], a[140:143], v[124:127]
    v_add_f32 v220, v220, v30
    v_add_f32 v221, v221, v31
    v_mfma_f32_16x16x32_bf16 v[128:131], a[4:7], a[128:131], v[128:131]
    s_mov_b32 s34, 458752
    v_add_f32 v222, v222, v32
    v_mfma_f32_16x16x32_bf16 v[132:135], a[4:7], a[132:135], v[132:135]
    buffer_load_dwordx4 a[0:3], v2, s[20:23], s34 offen offset:0
    v_mfma_f32_16x16x32_bf16 v[136:139], a[4:7], a[136:139], v[136:139]
    v_add_f32 v223, v223, v33
    v_add_f32 v236, v236, v34
    v_mfma_f32_16x16x32_bf16 v[140:143], a[4:7], a[140:143], v[140:143]
    v_add_f32 v237, v237, v35
    v_add_f32 v238, v238, v36
    s_waitcnt lgkmcnt(1)
    v_mfma_f32_16x16x32_bf16 v[240:243], a[8:11], a[112:115], v[240:243]
    buffer_load_dwordx4 a[4:7], v2, s[20:23], s34 offen offset:1024
    v_mfma_f32_16x16x32_bf16 v[244:247], a[8:11], a[116:119], v[244:247]
    ds_read_b128 a[128:131], v3 offset:53248
    ds_read_b128 a[132:135], v3 offset:54272
    v_mfma_f32_16x16x32_bf16 v[248:251], a[8:11], a[120:123], v[248:251]
    ds_read_b128 a[136:139], v3 offset:55296
    ds_read_b128 a[140:143], v3 offset:56320
    v_mfma_f32_16x16x32_bf16 v[252:255], a[8:11], a[124:127], v[252:255]
    v_add_f32 v239, v239, v37
    v_mfma_f32_16x16x32_bf16 v[48:51], a[12:15], a[112:115], v[48:51]
    buffer_load_dwordx4 a[8:11], v2, s[20:23], s34 offen offset:2048
    v_mfma_f32_16x16x32_bf16 v[52:55], a[12:15], a[116:119], v[52:55]
    v_mfma_f32_16x16x32_bf16 v[56:59], a[12:15], a[120:123], v[56:59]
    v_mfma_f32_16x16x32_bf16 v[60:63], a[12:15], a[124:127], v[60:63]
    s_waitcnt vmcnt(20)
    v_mfma_f32_16x16x32_bf16 v[64:67], a[16:19], a[112:115], v[64:67]
    buffer_load_dwordx4 a[12:15], v2, s[20:23], s34 offen offset:3072
    v_mfma_f32_16x16x32_bf16 v[68:71], a[16:19], a[116:119], v[68:71]
    v_mfma_f32_16x16x32_bf16 v[72:75], a[16:19], a[120:123], v[72:75]
    v_mfma_f32_16x16x32_bf16 v[76:79], a[16:19], a[124:127], v[76:79]
    v_mfma_f32_16x16x32_bf16 v[80:83], a[20:23], a[112:115], v[80:83]
    s_mov_b32 s34, 462848
    v_mfma_f32_16x16x32_bf16 v[84:87], a[20:23], a[116:119], v[84:87]
    buffer_load_dwordx4 a[16:19], v2, s[20:23], s34 offen offset:0
    v_mfma_f32_16x16x32_bf16 v[88:91], a[20:23], a[120:123], v[88:91]
    v_mfma_f32_16x16x32_bf16 v[92:95], a[20:23], a[124:127], v[92:95]
    v_mfma_f32_16x16x32_bf16 v[96:99], a[24:27], a[112:115], v[96:99]
    buffer_load_dwordx4 a[20:23], v2, s[20:23], s34 offen offset:1024
    v_mfma_f32_16x16x32_bf16 v[100:103], a[24:27], a[116:119], v[100:103]
    v_mfma_f32_16x16x32_bf16 v[104:107], a[24:27], a[120:123], v[104:107]
    v_mfma_f32_16x16x32_bf16 v[108:111], a[24:27], a[124:127], v[108:111]
    v_mfma_f32_16x16x32_bf16 v[112:115], a[28:31], a[112:115], v[112:115]
    buffer_load_dwordx4 a[24:27], v2, s[20:23], s34 offen offset:2048
    v_mfma_f32_16x16x32_bf16 v[116:119], a[28:31], a[116:119], v[116:119]
    v_mfma_f32_16x16x32_bf16 v[120:123], a[28:31], a[120:123], v[120:123]
    v_mfma_f32_16x16x32_bf16 v[124:127], a[28:31], a[124:127], v[124:127]
    v_mfma_f32_16x16x32_bf16 v[128:131], a[32:35], a[112:115], v[128:131]
    buffer_load_dwordx4 a[28:31], v2, s[20:23], s34 offen offset:3072
    v_mfma_f32_16x16x32_bf16 v[132:135], a[32:35], a[116:119], v[132:135]
    v_mfma_f32_16x16x32_bf16 v[136:139], a[32:35], a[120:123], v[136:139]
    v_mfma_f32_16x16x32_bf16 v[140:143], a[32:35], a[124:127], v[140:143]
    s_waitcnt lgkmcnt(0)
    s_barrier
    v_mfma_f32_16x16x32_bf16 v[240:243], a[36:39], a[128:131], v[240:243]
    s_mov_b32 s34, 466944
    v_mfma_f32_16x16x32_bf16 v[244:247], a[36:39], a[132:135], v[244:247]
    ds_read_b128 a[112:115], v4 offset:0
    ds_read_b128 a[116:119], v4 offset:1024
    v_mfma_f32_16x16x32_bf16 v[248:251], a[36:39], a[136:139], v[248:251]
    ds_read_b128 a[120:123], v4 offset:2048
    ds_read_b128 a[124:127], v4 offset:3072
    v_mfma_f32_16x16x32_bf16 v[252:255], a[36:39], a[140:143], v[252:255]
    buffer_load_dwordx4 a[32:35], v2, s[20:23], s34 offen offset:0
    v_mfma_f32_16x16x32_bf16 v[48:51], a[40:43], a[128:131], v[48:51]
    buffer_load_dwordx4 a[36:39], v2, s[20:23], s34 offen offset:1024
    v_mfma_f32_16x16x32_bf16 v[52:55], a[40:43], a[132:135], v[52:55]
    v_mfma_f32_16x16x32_bf16 v[56:59], a[40:43], a[136:139], v[56:59]
    v_mfma_f32_16x16x32_bf16 v[60:63], a[40:43], a[140:143], v[60:63]
    s_waitcnt vmcnt(20)
    v_mfma_f32_16x16x32_bf16 v[64:67], a[44:47], a[128:131], v[64:67]
    buffer_load_dwordx4 a[40:43], v2, s[20:23], s34 offen offset:2048
    v_mfma_f32_16x16x32_bf16 v[68:71], a[44:47], a[132:135], v[68:71]
    v_mfma_f32_16x16x32_bf16 v[72:75], a[44:47], a[136:139], v[72:75]
    v_mfma_f32_16x16x32_bf16 v[76:79], a[44:47], a[140:143], v[76:79]
    v_mfma_f32_16x16x32_bf16 v[80:83], a[48:51], a[128:131], v[80:83]
    buffer_load_dwordx4 a[44:47], v2, s[20:23], s34 offen offset:3072
    v_mfma_f32_16x16x32_bf16 v[84:87], a[48:51], a[132:135], v[84:87]
    v_mfma_f32_16x16x32_bf16 v[88:91], a[48:51], a[136:139], v[88:91]
    v_mfma_f32_16x16x32_bf16 v[92:95], a[48:51], a[140:143], v[92:95]
    v_mfma_f32_16x16x32_bf16 v[96:99], a[52:55], a[128:131], v[96:99]
    s_mov_b32 s34, 471040
    v_mfma_f32_16x16x32_bf16 v[100:103], a[52:55], a[132:135], v[100:103]
    buffer_load_dwordx4 a[48:51], v2, s[20:23], s34 offen offset:0
    v_mfma_f32_16x16x32_bf16 v[104:107], a[52:55], a[136:139], v[104:107]
    v_mfma_f32_16x16x32_bf16 v[108:111], a[52:55], a[140:143], v[108:111]
    v_mfma_f32_16x16x32_bf16 v[112:115], a[56:59], a[128:131], v[112:115]
    buffer_load_dwordx4 a[52:55], v2, s[20:23], s34 offen offset:1024
    v_mfma_f32_16x16x32_bf16 v[116:119], a[56:59], a[132:135], v[116:119]
    v_mfma_f32_16x16x32_bf16 v[120:123], a[56:59], a[136:139], v[120:123]
    v_mfma_f32_16x16x32_bf16 v[124:127], a[56:59], a[140:143], v[124:127]
    v_mfma_f32_16x16x32_bf16 v[128:131], a[60:63], a[128:131], v[128:131]
    buffer_load_dwordx4 a[56:59], v2, s[20:23], s34 offen offset:2048
    v_mfma_f32_16x16x32_bf16 v[132:135], a[60:63], a[132:135], v[132:135]
    v_mfma_f32_16x16x32_bf16 v[136:139], a[60:63], a[136:139], v[136:139]
    v_mfma_f32_16x16x32_bf16 v[140:143], a[60:63], a[140:143], v[140:143]
    s_waitcnt lgkmcnt(0)
    v_mfma_f32_16x16x32_bf16 v[240:243], a[64:67], a[112:115], v[240:243]
    buffer_load_dwordx4 a[60:63], v2, s[20:23], s34 offen offset:3072
    v_mfma_f32_16x16x32_bf16 v[244:247], a[64:67], a[116:119], v[244:247]
    ds_read_b128 a[128:131], v4 offset:4096
    ds_read_b128 a[132:135], v4 offset:5120
    v_mfma_f32_16x16x32_bf16 v[248:251], a[64:67], a[120:123], v[248:251]
    ds_read_b128 a[136:139], v4 offset:6144
    ds_read_b128 a[140:143], v4 offset:7168
    v_mfma_f32_16x16x32_bf16 v[252:255], a[64:67], a[124:127], v[252:255]
    v_mfma_f32_16x16x32_bf16 v[48:51], a[68:71], a[112:115], v[48:51]
    s_mov_b32 s34, 475136
    v_mfma_f32_16x16x32_bf16 v[52:55], a[68:71], a[116:119], v[52:55]
    buffer_load_dwordx4 a[64:67], v2, s[20:23], s34 offen offset:0
    v_mfma_f32_16x16x32_bf16 v[56:59], a[68:71], a[120:123], v[56:59]
    v_mfma_f32_16x16x32_bf16 v[60:63], a[68:71], a[124:127], v[60:63]
    s_waitcnt vmcnt(20)
    v_mfma_f32_16x16x32_bf16 v[64:67], a[72:75], a[112:115], v[64:67]
    buffer_load_dwordx4 a[68:71], v2, s[20:23], s34 offen offset:1024
    v_mfma_f32_16x16x32_bf16 v[68:71], a[72:75], a[116:119], v[68:71]
    v_mfma_f32_16x16x32_bf16 v[72:75], a[72:75], a[120:123], v[72:75]
    v_mfma_f32_16x16x32_bf16 v[76:79], a[72:75], a[124:127], v[76:79]
    v_mfma_f32_16x16x32_bf16 v[80:83], a[76:79], a[112:115], v[80:83]
    buffer_load_dwordx4 a[72:75], v2, s[20:23], s34 offen offset:2048
    v_mfma_f32_16x16x32_bf16 v[84:87], a[76:79], a[116:119], v[84:87]
    v_mfma_f32_16x16x32_bf16 v[88:91], a[76:79], a[120:123], v[88:91]
    v_mfma_f32_16x16x32_bf16 v[92:95], a[76:79], a[124:127], v[92:95]
    v_mfma_f32_16x16x32_bf16 v[96:99], a[80:83], a[112:115], v[96:99]
    buffer_load_dwordx4 a[76:79], v2, s[20:23], s34 offen offset:3072
    v_mfma_f32_16x16x32_bf16 v[100:103], a[80:83], a[116:119], v[100:103]
    v_mfma_f32_16x16x32_bf16 v[104:107], a[80:83], a[120:123], v[104:107]
    v_mfma_f32_16x16x32_bf16 v[108:111], a[80:83], a[124:127], v[108:111]
    v_mfma_f32_16x16x32_bf16 v[112:115], a[84:87], a[112:115], v[112:115]
    s_mov_b32 s34, 479232
    v_mfma_f32_16x16x32_bf16 v[116:119], a[84:87], a[116:119], v[116:119]
    buffer_load_dwordx4 a[80:83], v2, s[20:23], s34 offen offset:0
    v_mfma_f32_16x16x32_bf16 v[120:123], a[84:87], a[120:123], v[120:123]
    v_mfma_f32_16x16x32_bf16 v[124:127], a[84:87], a[124:127], v[124:127]
    v_mfma_f32_16x16x32_bf16 v[128:131], a[88:91], a[112:115], v[128:131]
    buffer_load_dwordx4 a[84:87], v2, s[20:23], s34 offen offset:1024
    v_mfma_f32_16x16x32_bf16 v[132:135], a[88:91], a[116:119], v[132:135]
    v_mfma_f32_16x16x32_bf16 v[136:139], a[88:91], a[120:123], v[136:139]
    v_mfma_f32_16x16x32_bf16 v[140:143], a[88:91], a[124:127], v[140:143]
    s_waitcnt lgkmcnt(0)
    v_mfma_f32_16x16x32_bf16 v[240:243], a[92:95], a[128:131], v[240:243]
    buffer_load_dwordx4 a[88:91], v2, s[20:23], s34 offen offset:2048
    v_mfma_f32_16x16x32_bf16 v[244:247], a[92:95], a[132:135], v[244:247]
    ds_read_b128 a[112:115], v4 offset:8192
    ds_read_b128 a[116:119], v4 offset:9216
    v_mfma_f32_16x16x32_bf16 v[248:251], a[92:95], a[136:139], v[248:251]
    ds_read_b128 a[120:123], v4 offset:10240
    ds_read_b128 a[124:127], v4 offset:11264
    v_mfma_f32_16x16x32_bf16 v[252:255], a[92:95], a[140:143], v[252:255]
    v_mfma_f32_16x16x32_bf16 v[48:51], a[96:99], a[128:131], v[48:51]
    buffer_load_dwordx4 a[92:95], v2, s[20:23], s34 offen offset:3072
    v_mfma_f32_16x16x32_bf16 v[52:55], a[96:99], a[132:135], v[52:55]
    v_mfma_f32_16x16x32_bf16 v[56:59], a[96:99], a[136:139], v[56:59]
    v_mfma_f32_16x16x32_bf16 v[60:63], a[96:99], a[140:143], v[60:63]
    s_waitcnt vmcnt(20)
    v_mfma_f32_16x16x32_bf16 v[64:67], a[100:103], a[128:131], v[64:67]
    s_mov_b32 s34, 483328
    v_mfma_f32_16x16x32_bf16 v[68:71], a[100:103], a[132:135], v[68:71]
    buffer_load_dwordx4 a[96:99], v2, s[20:23], s34 offen offset:0
    v_mfma_f32_16x16x32_bf16 v[72:75], a[100:103], a[136:139], v[72:75]
    v_mfma_f32_16x16x32_bf16 v[76:79], a[100:103], a[140:143], v[76:79]
    v_mfma_f32_16x16x32_bf16 v[80:83], a[104:107], a[128:131], v[80:83]
    buffer_load_dwordx4 a[100:103], v2, s[20:23], s34 offen offset:1024
    v_mfma_f32_16x16x32_bf16 v[84:87], a[104:107], a[132:135], v[84:87]
    v_mfma_f32_16x16x32_bf16 v[88:91], a[104:107], a[136:139], v[88:91]
    v_mfma_f32_16x16x32_bf16 v[92:95], a[104:107], a[140:143], v[92:95]
    v_mfma_f32_16x16x32_bf16 v[96:99], a[108:111], a[128:131], v[96:99]
    buffer_load_dwordx4 a[104:107], v2, s[20:23], s34 offen offset:2048
    v_mfma_f32_16x16x32_bf16 v[100:103], a[108:111], a[132:135], v[100:103]
    v_mfma_f32_16x16x32_bf16 v[104:107], a[108:111], a[136:139], v[104:107]
    v_mfma_f32_16x16x32_bf16 v[108:111], a[108:111], a[140:143], v[108:111]
    v_mfma_f32_16x16x32_bf16 v[112:115], a[0:3], a[128:131], v[112:115]
    buffer_load_dwordx4 a[108:111], v2, s[20:23], s34 offen offset:3072
    v_mfma_f32_16x16x32_bf16 v[116:119], a[0:3], a[132:135], v[116:119]
    v_mfma_f32_16x16x32_bf16 v[120:123], a[0:3], a[136:139], v[120:123]
    v_mfma_f32_16x16x32_bf16 v[124:127], a[0:3], a[140:143], v[124:127]
    v_mfma_f32_16x16x32_bf16 v[128:131], a[4:7], a[128:131], v[128:131]
    s_mov_b32 s34, 487424
    v_mfma_f32_16x16x32_bf16 v[132:135], a[4:7], a[132:135], v[132:135]
    buffer_load_dwordx4 a[0:3], v2, s[20:23], s34 offen offset:0
    v_mfma_f32_16x16x32_bf16 v[136:139], a[4:7], a[136:139], v[136:139]
    v_mfma_f32_16x16x32_bf16 v[140:143], a[4:7], a[140:143], v[140:143]
    s_waitcnt lgkmcnt(0)
    v_mfma_f32_16x16x32_bf16 v[240:243], a[8:11], a[112:115], v[240:243]
    buffer_load_dwordx4 a[4:7], v2, s[20:23], s34 offen offset:1024
    v_mfma_f32_16x16x32_bf16 v[244:247], a[8:11], a[116:119], v[244:247]
    ds_read_b128 a[128:131], v4 offset:12288
    ds_read_b128 a[132:135], v4 offset:13312
    v_mfma_f32_16x16x32_bf16 v[248:251], a[8:11], a[120:123], v[248:251]
    ds_read_b128 a[136:139], v4 offset:14336
    ds_read_b128 a[140:143], v4 offset:15360
    v_mfma_f32_16x16x32_bf16 v[252:255], a[8:11], a[124:127], v[252:255]
    v_mfma_f32_16x16x32_bf16 v[48:51], a[12:15], a[112:115], v[48:51]
    buffer_load_dwordx4 a[8:11], v2, s[20:23], s34 offen offset:2048
    v_mfma_f32_16x16x32_bf16 v[52:55], a[12:15], a[116:119], v[52:55]
    v_mfma_f32_16x16x32_bf16 v[56:59], a[12:15], a[120:123], v[56:59]
    v_mfma_f32_16x16x32_bf16 v[60:63], a[12:15], a[124:127], v[60:63]
    s_waitcnt vmcnt(20)
    v_mfma_f32_16x16x32_bf16 v[64:67], a[16:19], a[112:115], v[64:67]
    buffer_load_dwordx4 a[12:15], v2, s[20:23], s34 offen offset:3072
    v_mfma_f32_16x16x32_bf16 v[68:71], a[16:19], a[116:119], v[68:71]
    v_mfma_f32_16x16x32_bf16 v[72:75], a[16:19], a[120:123], v[72:75]
    v_mfma_f32_16x16x32_bf16 v[76:79], a[16:19], a[124:127], v[76:79]
    v_mfma_f32_16x16x32_bf16 v[80:83], a[20:23], a[112:115], v[80:83]
    s_mov_b32 s34, 491520
    v_mfma_f32_16x16x32_bf16 v[84:87], a[20:23], a[116:119], v[84:87]
    buffer_load_dwordx4 a[16:19], v2, s[20:23], s34 offen offset:0
    v_mfma_f32_16x16x32_bf16 v[88:91], a[20:23], a[120:123], v[88:91]
    v_mfma_f32_16x16x32_bf16 v[92:95], a[20:23], a[124:127], v[92:95]
    v_mfma_f32_16x16x32_bf16 v[96:99], a[24:27], a[112:115], v[96:99]
    buffer_load_dwordx4 a[20:23], v2, s[20:23], s34 offen offset:1024
    v_mfma_f32_16x16x32_bf16 v[100:103], a[24:27], a[116:119], v[100:103]
    v_mfma_f32_16x16x32_bf16 v[104:107], a[24:27], a[120:123], v[104:107]
    v_mfma_f32_16x16x32_bf16 v[108:111], a[24:27], a[124:127], v[108:111]
    v_mfma_f32_16x16x32_bf16 v[112:115], a[28:31], a[112:115], v[112:115]
    buffer_load_dwordx4 a[24:27], v2, s[20:23], s34 offen offset:2048
    v_mfma_f32_16x16x32_bf16 v[116:119], a[28:31], a[116:119], v[116:119]
    v_mfma_f32_16x16x32_bf16 v[120:123], a[28:31], a[120:123], v[120:123]
    v_mfma_f32_16x16x32_bf16 v[124:127], a[28:31], a[124:127], v[124:127]
    v_mfma_f32_16x16x32_bf16 v[128:131], a[32:35], a[112:115], v[128:131]
    buffer_load_dwordx4 a[28:31], v2, s[20:23], s34 offen offset:3072
    v_mfma_f32_16x16x32_bf16 v[132:135], a[32:35], a[116:119], v[132:135]
    v_mfma_f32_16x16x32_bf16 v[136:139], a[32:35], a[120:123], v[136:139]
    v_mfma_f32_16x16x32_bf16 v[140:143], a[32:35], a[124:127], v[140:143]
    s_waitcnt lgkmcnt(0)
    v_mfma_f32_16x16x32_bf16 v[240:243], a[36:39], a[128:131], v[240:243]
    s_mov_b32 s34, 495616
    v_mfma_f32_16x16x32_bf16 v[244:247], a[36:39], a[132:135], v[244:247]
    ds_read_b128 a[112:115], v4 offset:16384
    ds_read_b128 a[116:119], v4 offset:17408
    v_mfma_f32_16x16x32_bf16 v[248:251], a[36:39], a[136:139], v[248:251]
    ds_read_b128 a[120:123], v4 offset:18432
    ds_read_b128 a[124:127], v4 offset:19456
    v_mfma_f32_16x16x32_bf16 v[252:255], a[36:39], a[140:143], v[252:255]
    buffer_load_dwordx4 a[32:35], v2, s[20:23], s34 offen offset:0
    v_mfma_f32_16x16x32_bf16 v[48:51], a[40:43], a[128:131], v[48:51]
    buffer_load_dwordx4 a[36:39], v2, s[20:23], s34 offen offset:1024
    v_mfma_f32_16x16x32_bf16 v[52:55], a[40:43], a[132:135], v[52:55]
    v_mfma_f32_16x16x32_bf16 v[56:59], a[40:43], a[136:139], v[56:59]
    v_mfma_f32_16x16x32_bf16 v[60:63], a[40:43], a[140:143], v[60:63]
    s_waitcnt vmcnt(20)
    v_mfma_f32_16x16x32_bf16 v[64:67], a[44:47], a[128:131], v[64:67]
    buffer_load_dwordx4 a[40:43], v2, s[20:23], s34 offen offset:2048
    v_mfma_f32_16x16x32_bf16 v[68:71], a[44:47], a[132:135], v[68:71]
    v_mfma_f32_16x16x32_bf16 v[72:75], a[44:47], a[136:139], v[72:75]
    v_mfma_f32_16x16x32_bf16 v[76:79], a[44:47], a[140:143], v[76:79]
    v_mfma_f32_16x16x32_bf16 v[80:83], a[48:51], a[128:131], v[80:83]
    buffer_load_dwordx4 a[44:47], v2, s[20:23], s34 offen offset:3072
    v_mfma_f32_16x16x32_bf16 v[84:87], a[48:51], a[132:135], v[84:87]
    v_mfma_f32_16x16x32_bf16 v[88:91], a[48:51], a[136:139], v[88:91]
    v_mfma_f32_16x16x32_bf16 v[92:95], a[48:51], a[140:143], v[92:95]
    v_mfma_f32_16x16x32_bf16 v[96:99], a[52:55], a[128:131], v[96:99]
    s_mov_b32 s34, 499712
    v_mfma_f32_16x16x32_bf16 v[100:103], a[52:55], a[132:135], v[100:103]
    buffer_load_dwordx4 a[48:51], v2, s[20:23], s34 offen offset:0
    v_mfma_f32_16x16x32_bf16 v[104:107], a[52:55], a[136:139], v[104:107]
    v_mfma_f32_16x16x32_bf16 v[108:111], a[52:55], a[140:143], v[108:111]
    v_mfma_f32_16x16x32_bf16 v[112:115], a[56:59], a[128:131], v[112:115]
    buffer_load_dwordx4 a[52:55], v2, s[20:23], s34 offen offset:1024
    v_mfma_f32_16x16x32_bf16 v[116:119], a[56:59], a[132:135], v[116:119]
    v_mfma_f32_16x16x32_bf16 v[120:123], a[56:59], a[136:139], v[120:123]
    v_mfma_f32_16x16x32_bf16 v[124:127], a[56:59], a[140:143], v[124:127]
    v_mfma_f32_16x16x32_bf16 v[128:131], a[60:63], a[128:131], v[128:131]
    buffer_load_dwordx4 a[56:59], v2, s[20:23], s34 offen offset:2048
    v_mfma_f32_16x16x32_bf16 v[132:135], a[60:63], a[132:135], v[132:135]
    v_mfma_f32_16x16x32_bf16 v[136:139], a[60:63], a[136:139], v[136:139]
    v_mfma_f32_16x16x32_bf16 v[140:143], a[60:63], a[140:143], v[140:143]
    s_waitcnt lgkmcnt(0)
    v_mfma_f32_16x16x32_bf16 v[240:243], a[64:67], a[112:115], v[240:243]
    buffer_load_dwordx4 a[60:63], v2, s[20:23], s34 offen offset:3072
    v_mfma_f32_16x16x32_bf16 v[244:247], a[64:67], a[116:119], v[244:247]
    ds_read_b128 a[128:131], v4 offset:20480
    ds_read_b128 a[132:135], v4 offset:21504
    v_mfma_f32_16x16x32_bf16 v[248:251], a[64:67], a[120:123], v[248:251]
    ds_read_b128 a[136:139], v4 offset:22528
    ds_read_b128 a[140:143], v4 offset:23552
    v_mfma_f32_16x16x32_bf16 v[252:255], a[64:67], a[124:127], v[252:255]
    v_mfma_f32_16x16x32_bf16 v[48:51], a[68:71], a[112:115], v[48:51]
    s_mov_b32 s34, 503808
    v_mfma_f32_16x16x32_bf16 v[52:55], a[68:71], a[116:119], v[52:55]
    buffer_load_dwordx4 a[64:67], v2, s[20:23], s34 offen offset:0
    v_mfma_f32_16x16x32_bf16 v[56:59], a[68:71], a[120:123], v[56:59]
    v_mfma_f32_16x16x32_bf16 v[60:63], a[68:71], a[124:127], v[60:63]
    s_waitcnt vmcnt(20)
    v_mfma_f32_16x16x32_bf16 v[64:67], a[72:75], a[112:115], v[64:67]
    buffer_load_dwordx4 a[68:71], v2, s[20:23], s34 offen offset:1024
    v_mfma_f32_16x16x32_bf16 v[68:71], a[72:75], a[116:119], v[68:71]
    v_mfma_f32_16x16x32_bf16 v[72:75], a[72:75], a[120:123], v[72:75]
    v_mfma_f32_16x16x32_bf16 v[76:79], a[72:75], a[124:127], v[76:79]
    v_mfma_f32_16x16x32_bf16 v[80:83], a[76:79], a[112:115], v[80:83]
    buffer_load_dwordx4 a[72:75], v2, s[20:23], s34 offen offset:2048
    v_mfma_f32_16x16x32_bf16 v[84:87], a[76:79], a[116:119], v[84:87]
    v_mfma_f32_16x16x32_bf16 v[88:91], a[76:79], a[120:123], v[88:91]
    v_mfma_f32_16x16x32_bf16 v[92:95], a[76:79], a[124:127], v[92:95]
    v_mfma_f32_16x16x32_bf16 v[96:99], a[80:83], a[112:115], v[96:99]
    buffer_load_dwordx4 a[76:79], v2, s[20:23], s34 offen offset:3072
    v_mfma_f32_16x16x32_bf16 v[100:103], a[80:83], a[116:119], v[100:103]
    v_mfma_f32_16x16x32_bf16 v[104:107], a[80:83], a[120:123], v[104:107]
    v_mfma_f32_16x16x32_bf16 v[108:111], a[80:83], a[124:127], v[108:111]
    v_mfma_f32_16x16x32_bf16 v[112:115], a[84:87], a[112:115], v[112:115]
    s_mov_b32 s34, 507904
    v_mfma_f32_16x16x32_bf16 v[116:119], a[84:87], a[116:119], v[116:119]
    buffer_load_dwordx4 a[80:83], v2, s[20:23], s34 offen offset:0
    v_mfma_f32_16x16x32_bf16 v[120:123], a[84:87], a[120:123], v[120:123]
    v_mfma_f32_16x16x32_bf16 v[124:127], a[84:87], a[124:127], v[124:127]
    v_mfma_f32_16x16x32_bf16 v[128:131], a[88:91], a[112:115], v[128:131]
    buffer_load_dwordx4 a[84:87], v2, s[20:23], s34 offen offset:1024
    v_mfma_f32_16x16x32_bf16 v[132:135], a[88:91], a[116:119], v[132:135]
    v_mfma_f32_16x16x32_bf16 v[136:139], a[88:91], a[120:123], v[136:139]
    v_mfma_f32_16x16x32_bf16 v[140:143], a[88:91], a[124:127], v[140:143]
    s_waitcnt lgkmcnt(0)
    v_mfma_f32_16x16x32_bf16 v[240:243], a[92:95], a[128:131], v[240:243]
    buffer_load_dwordx4 a[88:91], v2, s[20:23], s34 offen offset:2048
    v_mfma_f32_16x16x32_bf16 v[244:247], a[92:95], a[132:135], v[244:247]
    ds_read_b128 a[112:115], v4 offset:24576
    ds_read_b128 a[116:119], v4 offset:25600
    v_mfma_f32_16x16x32_bf16 v[248:251], a[92:95], a[136:139], v[248:251]
    ds_read_b128 a[120:123], v4 offset:26624
    ds_read_b128 a[124:127], v4 offset:27648
    v_mfma_f32_16x16x32_bf16 v[252:255], a[92:95], a[140:143], v[252:255]
    v_mfma_f32_16x16x32_bf16 v[48:51], a[96:99], a[128:131], v[48:51]
    buffer_load_dwordx4 a[92:95], v2, s[20:23], s34 offen offset:3072
    v_mfma_f32_16x16x32_bf16 v[52:55], a[96:99], a[132:135], v[52:55]
    v_mfma_f32_16x16x32_bf16 v[56:59], a[96:99], a[136:139], v[56:59]
    v_mfma_f32_16x16x32_bf16 v[60:63], a[96:99], a[140:143], v[60:63]
    s_waitcnt vmcnt(20)
    v_mfma_f32_16x16x32_bf16 v[64:67], a[100:103], a[128:131], v[64:67]
    s_mov_b32 s34, 512000
    v_mfma_f32_16x16x32_bf16 v[68:71], a[100:103], a[132:135], v[68:71]
    buffer_load_dwordx4 a[96:99], v2, s[20:23], s34 offen offset:0
    v_mfma_f32_16x16x32_bf16 v[72:75], a[100:103], a[136:139], v[72:75]
    v_mfma_f32_16x16x32_bf16 v[76:79], a[100:103], a[140:143], v[76:79]
    v_mfma_f32_16x16x32_bf16 v[80:83], a[104:107], a[128:131], v[80:83]
    buffer_load_dwordx4 a[100:103], v2, s[20:23], s34 offen offset:1024
    v_mfma_f32_16x16x32_bf16 v[84:87], a[104:107], a[132:135], v[84:87]
    v_mfma_f32_16x16x32_bf16 v[88:91], a[104:107], a[136:139], v[88:91]
    v_mfma_f32_16x16x32_bf16 v[92:95], a[104:107], a[140:143], v[92:95]
    v_mfma_f32_16x16x32_bf16 v[96:99], a[108:111], a[128:131], v[96:99]
    buffer_load_dwordx4 a[104:107], v2, s[20:23], s34 offen offset:2048
    v_mfma_f32_16x16x32_bf16 v[100:103], a[108:111], a[132:135], v[100:103]
    v_mfma_f32_16x16x32_bf16 v[104:107], a[108:111], a[136:139], v[104:107]
    v_mfma_f32_16x16x32_bf16 v[108:111], a[108:111], a[140:143], v[108:111]
    v_mfma_f32_16x16x32_bf16 v[112:115], a[0:3], a[128:131], v[112:115]
    buffer_load_dwordx4 a[108:111], v2, s[20:23], s34 offen offset:3072
    v_mfma_f32_16x16x32_bf16 v[116:119], a[0:3], a[132:135], v[116:119]
    v_mfma_f32_16x16x32_bf16 v[120:123], a[0:3], a[136:139], v[120:123]
    v_mfma_f32_16x16x32_bf16 v[124:127], a[0:3], a[140:143], v[124:127]
    v_mfma_f32_16x16x32_bf16 v[128:131], a[4:7], a[128:131], v[128:131]
    s_mov_b32 s34, 516096
    v_mfma_f32_16x16x32_bf16 v[132:135], a[4:7], a[132:135], v[132:135]
    buffer_load_dwordx4 a[0:3], v2, s[20:23], s34 offen offset:0
    v_mfma_f32_16x16x32_bf16 v[136:139], a[4:7], a[136:139], v[136:139]
    v_mfma_f32_16x16x32_bf16 v[140:143], a[4:7], a[140:143], v[140:143]
    s_waitcnt lgkmcnt(0)
    v_mfma_f32_16x16x32_bf16 v[240:243], a[8:11], a[112:115], v[240:243]
    buffer_load_dwordx4 a[4:7], v2, s[20:23], s34 offen offset:1024
    v_mfma_f32_16x16x32_bf16 v[244:247], a[8:11], a[116:119], v[244:247]
    ds_read_b128 a[128:131], v4 offset:28672
    ds_read_b128 a[132:135], v4 offset:29696
    v_mfma_f32_16x16x32_bf16 v[248:251], a[8:11], a[120:123], v[248:251]
    ds_read_b128 a[136:139], v4 offset:30720
    ds_read_b128 a[140:143], v4 offset:31744
    v_mfma_f32_16x16x32_bf16 v[252:255], a[8:11], a[124:127], v[252:255]
    v_mfma_f32_16x16x32_bf16 v[48:51], a[12:15], a[112:115], v[48:51]
    buffer_load_dwordx4 a[8:11], v2, s[20:23], s34 offen offset:2048
    v_mfma_f32_16x16x32_bf16 v[52:55], a[12:15], a[116:119], v[52:55]
    v_mfma_f32_16x16x32_bf16 v[56:59], a[12:15], a[120:123], v[56:59]
    v_mfma_f32_16x16x32_bf16 v[60:63], a[12:15], a[124:127], v[60:63]
    s_waitcnt vmcnt(20)
    v_mfma_f32_16x16x32_bf16 v[64:67], a[16:19], a[112:115], v[64:67]
    buffer_load_dwordx4 a[12:15], v2, s[20:23], s34 offen offset:3072
    v_mfma_f32_16x16x32_bf16 v[68:71], a[16:19], a[116:119], v[68:71]
    v_mfma_f32_16x16x32_bf16 v[72:75], a[16:19], a[120:123], v[72:75]
    v_mfma_f32_16x16x32_bf16 v[76:79], a[16:19], a[124:127], v[76:79]
    v_mfma_f32_16x16x32_bf16 v[80:83], a[20:23], a[112:115], v[80:83]
    s_mov_b32 s34, 520192
    v_mfma_f32_16x16x32_bf16 v[84:87], a[20:23], a[116:119], v[84:87]
    buffer_load_dwordx4 a[16:19], v2, s[20:23], s34 offen offset:0
    v_mfma_f32_16x16x32_bf16 v[88:91], a[20:23], a[120:123], v[88:91]
    v_mfma_f32_16x16x32_bf16 v[92:95], a[20:23], a[124:127], v[92:95]
    v_mfma_f32_16x16x32_bf16 v[96:99], a[24:27], a[112:115], v[96:99]
    buffer_load_dwordx4 a[20:23], v2, s[20:23], s34 offen offset:1024
    v_mfma_f32_16x16x32_bf16 v[100:103], a[24:27], a[116:119], v[100:103]
    v_mfma_f32_16x16x32_bf16 v[104:107], a[24:27], a[120:123], v[104:107]
    v_mfma_f32_16x16x32_bf16 v[108:111], a[24:27], a[124:127], v[108:111]
    v_mfma_f32_16x16x32_bf16 v[112:115], a[28:31], a[112:115], v[112:115]
    buffer_load_dwordx4 a[24:27], v2, s[20:23], s34 offen offset:2048
    v_mfma_f32_16x16x32_bf16 v[116:119], a[28:31], a[116:119], v[116:119]
    v_mfma_f32_16x16x32_bf16 v[120:123], a[28:31], a[120:123], v[120:123]
    v_mfma_f32_16x16x32_bf16 v[124:127], a[28:31], a[124:127], v[124:127]
    v_mfma_f32_16x16x32_bf16 v[128:131], a[32:35], a[112:115], v[128:131]
    buffer_load_dwordx4 a[28:31], v2, s[20:23], s34 offen offset:3072
    v_mfma_f32_16x16x32_bf16 v[132:135], a[32:35], a[116:119], v[132:135]
    v_mfma_f32_16x16x32_bf16 v[136:139], a[32:35], a[120:123], v[136:139]
    v_mfma_f32_16x16x32_bf16 v[140:143], a[32:35], a[124:127], v[140:143]
    s_waitcnt lgkmcnt(0)
    v_mfma_f32_16x16x32_bf16 v[240:243], a[36:39], a[128:131], v[240:243]
    s_mov_b32 s34, 524288
    v_mfma_f32_16x16x32_bf16 v[244:247], a[36:39], a[132:135], v[244:247]
    ds_read_b128 a[112:115], v4 offset:32768
    ds_read_b128 a[116:119], v4 offset:33792
    v_mfma_f32_16x16x32_bf16 v[248:251], a[36:39], a[136:139], v[248:251]
    ds_read_b128 a[120:123], v4 offset:34816
    ds_read_b128 a[124:127], v4 offset:35840
    v_mfma_f32_16x16x32_bf16 v[252:255], a[36:39], a[140:143], v[252:255]
    buffer_load_dwordx4 a[32:35], v2, s[20:23], s34 offen offset:0
    v_mfma_f32_16x16x32_bf16 v[48:51], a[40:43], a[128:131], v[48:51]
    buffer_load_dwordx4 a[36:39], v2, s[20:23], s34 offen offset:1024
    v_mfma_f32_16x16x32_bf16 v[52:55], a[40:43], a[132:135], v[52:55]
    v_mfma_f32_16x16x32_bf16 v[56:59], a[40:43], a[136:139], v[56:59]
    v_mfma_f32_16x16x32_bf16 v[60:63], a[40:43], a[140:143], v[60:63]
    s_waitcnt vmcnt(20)
    v_mfma_f32_16x16x32_bf16 v[64:67], a[44:47], a[128:131], v[64:67]
    buffer_load_dwordx4 a[40:43], v2, s[20:23], s34 offen offset:2048
    v_mfma_f32_16x16x32_bf16 v[68:71], a[44:47], a[132:135], v[68:71]
    v_mfma_f32_16x16x32_bf16 v[72:75], a[44:47], a[136:139], v[72:75]
    v_mfma_f32_16x16x32_bf16 v[76:79], a[44:47], a[140:143], v[76:79]
    v_mfma_f32_16x16x32_bf16 v[80:83], a[48:51], a[128:131], v[80:83]
    buffer_load_dwordx4 a[44:47], v2, s[20:23], s34 offen offset:3072
    v_mfma_f32_16x16x32_bf16 v[84:87], a[48:51], a[132:135], v[84:87]
    v_mfma_f32_16x16x32_bf16 v[88:91], a[48:51], a[136:139], v[88:91]
    v_mfma_f32_16x16x32_bf16 v[92:95], a[48:51], a[140:143], v[92:95]
    v_mfma_f32_16x16x32_bf16 v[96:99], a[52:55], a[128:131], v[96:99]
    s_mov_b32 s34, 528384
    v_mfma_f32_16x16x32_bf16 v[100:103], a[52:55], a[132:135], v[100:103]
    buffer_load_dwordx4 a[48:51], v2, s[20:23], s34 offen offset:0
    v_mfma_f32_16x16x32_bf16 v[104:107], a[52:55], a[136:139], v[104:107]
    v_mfma_f32_16x16x32_bf16 v[108:111], a[52:55], a[140:143], v[108:111]
    v_mfma_f32_16x16x32_bf16 v[112:115], a[56:59], a[128:131], v[112:115]
    buffer_load_dwordx4 a[52:55], v2, s[20:23], s34 offen offset:1024
    v_mfma_f32_16x16x32_bf16 v[116:119], a[56:59], a[132:135], v[116:119]
    v_mfma_f32_16x16x32_bf16 v[120:123], a[56:59], a[136:139], v[120:123]
    v_mfma_f32_16x16x32_bf16 v[124:127], a[56:59], a[140:143], v[124:127]
    v_mfma_f32_16x16x32_bf16 v[128:131], a[60:63], a[128:131], v[128:131]
    buffer_load_dwordx4 a[56:59], v2, s[20:23], s34 offen offset:2048
    v_mfma_f32_16x16x32_bf16 v[132:135], a[60:63], a[132:135], v[132:135]
    v_mfma_f32_16x16x32_bf16 v[136:139], a[60:63], a[136:139], v[136:139]
    v_mfma_f32_16x16x32_bf16 v[140:143], a[60:63], a[140:143], v[140:143]
    s_waitcnt lgkmcnt(0)
    v_mfma_f32_16x16x32_bf16 v[240:243], a[64:67], a[112:115], v[240:243]
    buffer_load_dwordx4 a[60:63], v2, s[20:23], s34 offen offset:3072
    v_mfma_f32_16x16x32_bf16 v[244:247], a[64:67], a[116:119], v[244:247]
    ds_read_b128 a[128:131], v4 offset:36864
    ds_read_b128 a[132:135], v4 offset:37888
    v_mfma_f32_16x16x32_bf16 v[248:251], a[64:67], a[120:123], v[248:251]
    ds_read_b128 a[136:139], v4 offset:38912
    ds_read_b128 a[140:143], v4 offset:39936
    v_mfma_f32_16x16x32_bf16 v[252:255], a[64:67], a[124:127], v[252:255]
    v_mfma_f32_16x16x32_bf16 v[48:51], a[68:71], a[112:115], v[48:51]
    s_mov_b32 s34, 532480
    v_mfma_f32_16x16x32_bf16 v[52:55], a[68:71], a[116:119], v[52:55]
    buffer_load_dwordx4 a[64:67], v2, s[20:23], s34 offen offset:0
    v_mfma_f32_16x16x32_bf16 v[56:59], a[68:71], a[120:123], v[56:59]
    v_mfma_f32_16x16x32_bf16 v[60:63], a[68:71], a[124:127], v[60:63]
    s_waitcnt vmcnt(20)
    v_mfma_f32_16x16x32_bf16 v[64:67], a[72:75], a[112:115], v[64:67]
    buffer_load_dwordx4 a[68:71], v2, s[20:23], s34 offen offset:1024
    v_mfma_f32_16x16x32_bf16 v[68:71], a[72:75], a[116:119], v[68:71]
    v_mfma_f32_16x16x32_bf16 v[72:75], a[72:75], a[120:123], v[72:75]
    v_mfma_f32_16x16x32_bf16 v[76:79], a[72:75], a[124:127], v[76:79]
    v_mfma_f32_16x16x32_bf16 v[80:83], a[76:79], a[112:115], v[80:83]
    buffer_load_dwordx4 a[72:75], v2, s[20:23], s34 offen offset:2048
    v_mfma_f32_16x16x32_bf16 v[84:87], a[76:79], a[116:119], v[84:87]
    v_mfma_f32_16x16x32_bf16 v[88:91], a[76:79], a[120:123], v[88:91]
    v_mfma_f32_16x16x32_bf16 v[92:95], a[76:79], a[124:127], v[92:95]
    v_mfma_f32_16x16x32_bf16 v[96:99], a[80:83], a[112:115], v[96:99]
    buffer_load_dwordx4 a[76:79], v2, s[20:23], s34 offen offset:3072
    v_mfma_f32_16x16x32_bf16 v[100:103], a[80:83], a[116:119], v[100:103]
    v_mfma_f32_16x16x32_bf16 v[104:107], a[80:83], a[120:123], v[104:107]
    v_mfma_f32_16x16x32_bf16 v[108:111], a[80:83], a[124:127], v[108:111]
    v_mfma_f32_16x16x32_bf16 v[112:115], a[84:87], a[112:115], v[112:115]
    s_mov_b32 s34, 536576
    v_mfma_f32_16x16x32_bf16 v[116:119], a[84:87], a[116:119], v[116:119]
    buffer_load_dwordx4 a[80:83], v2, s[20:23], s34 offen offset:0
    v_mfma_f32_16x16x32_bf16 v[120:123], a[84:87], a[120:123], v[120:123]
    v_mfma_f32_16x16x32_bf16 v[124:127], a[84:87], a[124:127], v[124:127]
    v_mfma_f32_16x16x32_bf16 v[128:131], a[88:91], a[112:115], v[128:131]
    buffer_load_dwordx4 a[84:87], v2, s[20:23], s34 offen offset:1024
    v_mfma_f32_16x16x32_bf16 v[132:135], a[88:91], a[116:119], v[132:135]
    v_mfma_f32_16x16x32_bf16 v[136:139], a[88:91], a[120:123], v[136:139]
    v_mfma_f32_16x16x32_bf16 v[140:143], a[88:91], a[124:127], v[140:143]
    s_waitcnt lgkmcnt(0)
    v_mfma_f32_16x16x32_bf16 v[240:243], a[92:95], a[128:131], v[240:243]
    buffer_load_dwordx4 a[88:91], v2, s[20:23], s34 offen offset:2048
    v_mfma_f32_16x16x32_bf16 v[244:247], a[92:95], a[132:135], v[244:247]
    ds_read_b128 a[112:115], v4 offset:40960
    ds_read_b128 a[116:119], v4 offset:41984
    v_mfma_f32_16x16x32_bf16 v[248:251], a[92:95], a[136:139], v[248:251]
    ds_read_b128 a[120:123], v4 offset:43008
    ds_read_b128 a[124:127], v4 offset:44032
    v_mfma_f32_16x16x32_bf16 v[252:255], a[92:95], a[140:143], v[252:255]
    v_mfma_f32_16x16x32_bf16 v[48:51], a[96:99], a[128:131], v[48:51]
    buffer_load_dwordx4 a[92:95], v2, s[20:23], s34 offen offset:3072
    v_mfma_f32_16x16x32_bf16 v[52:55], a[96:99], a[132:135], v[52:55]
    v_mfma_f32_16x16x32_bf16 v[56:59], a[96:99], a[136:139], v[56:59]
    v_mfma_f32_16x16x32_bf16 v[60:63], a[96:99], a[140:143], v[60:63]
    s_waitcnt vmcnt(20)
    v_mfma_f32_16x16x32_bf16 v[64:67], a[100:103], a[128:131], v[64:67]
    s_mov_b32 s34, 540672
    v_mfma_f32_16x16x32_bf16 v[68:71], a[100:103], a[132:135], v[68:71]
    buffer_load_dwordx4 a[96:99], v2, s[20:23], s34 offen offset:0
    v_mfma_f32_16x16x32_bf16 v[72:75], a[100:103], a[136:139], v[72:75]
    v_mfma_f32_16x16x32_bf16 v[76:79], a[100:103], a[140:143], v[76:79]
    v_mfma_f32_16x16x32_bf16 v[80:83], a[104:107], a[128:131], v[80:83]
    buffer_load_dwordx4 a[100:103], v2, s[20:23], s34 offen offset:1024
    v_mfma_f32_16x16x32_bf16 v[84:87], a[104:107], a[132:135], v[84:87]
    v_mfma_f32_16x16x32_bf16 v[88:91], a[104:107], a[136:139], v[88:91]
    v_mfma_f32_16x16x32_bf16 v[92:95], a[104:107], a[140:143], v[92:95]
    v_mfma_f32_16x16x32_bf16 v[96:99], a[108:111], a[128:131], v[96:99]
    buffer_load_dwordx4 a[104:107], v2, s[20:23], s34 offen offset:2048
    v_mfma_f32_16x16x32_bf16 v[100:103], a[108:111], a[132:135], v[100:103]
    v_mfma_f32_16x16x32_bf16 v[104:107], a[108:111], a[136:139], v[104:107]
    v_mfma_f32_16x16x32_bf16 v[108:111], a[108:111], a[140:143], v[108:111]
    v_mfma_f32_16x16x32_bf16 v[112:115], a[0:3], a[128:131], v[112:115]
    buffer_load_dwordx4 a[108:111], v2, s[20:23], s34 offen offset:3072
    v_mfma_f32_16x16x32_bf16 v[116:119], a[0:3], a[132:135], v[116:119]
    v_mfma_f32_16x16x32_bf16 v[120:123], a[0:3], a[136:139], v[120:123]
    v_mfma_f32_16x16x32_bf16 v[124:127], a[0:3], a[140:143], v[124:127]
    v_mfma_f32_16x16x32_bf16 v[128:131], a[4:7], a[128:131], v[128:131]
    s_mov_b32 s34, 544768
    v_mfma_f32_16x16x32_bf16 v[132:135], a[4:7], a[132:135], v[132:135]
    buffer_load_dwordx4 a[0:3], v2, s[20:23], s34 offen offset:0
    v_mfma_f32_16x16x32_bf16 v[136:139], a[4:7], a[136:139], v[136:139]
    v_mfma_f32_16x16x32_bf16 v[140:143], a[4:7], a[140:143], v[140:143]
    s_waitcnt lgkmcnt(0)
    v_mfma_f32_16x16x32_bf16 v[240:243], a[8:11], a[112:115], v[240:243]
    buffer_load_dwordx4 a[4:7], v2, s[20:23], s34 offen offset:1024
    v_mfma_f32_16x16x32_bf16 v[244:247], a[8:11], a[116:119], v[244:247]
    ds_read_b128 a[128:131], v4 offset:45056
    ds_read_b128 a[132:135], v4 offset:46080
    v_mfma_f32_16x16x32_bf16 v[248:251], a[8:11], a[120:123], v[248:251]
    ds_read_b128 a[136:139], v4 offset:47104
    ds_read_b128 a[140:143], v4 offset:48128
    v_mfma_f32_16x16x32_bf16 v[252:255], a[8:11], a[124:127], v[252:255]
    v_mfma_f32_16x16x32_bf16 v[48:51], a[12:15], a[112:115], v[48:51]
    buffer_load_dwordx4 a[8:11], v2, s[20:23], s34 offen offset:2048
    v_mfma_f32_16x16x32_bf16 v[52:55], a[12:15], a[116:119], v[52:55]
    v_mfma_f32_16x16x32_bf16 v[56:59], a[12:15], a[120:123], v[56:59]
    v_mfma_f32_16x16x32_bf16 v[60:63], a[12:15], a[124:127], v[60:63]
    s_waitcnt vmcnt(20)
    v_mfma_f32_16x16x32_bf16 v[64:67], a[16:19], a[112:115], v[64:67]
    buffer_load_dwordx4 a[12:15], v2, s[20:23], s34 offen offset:3072
    v_mfma_f32_16x16x32_bf16 v[68:71], a[16:19], a[116:119], v[68:71]
    v_mfma_f32_16x16x32_bf16 v[72:75], a[16:19], a[120:123], v[72:75]
    v_mfma_f32_16x16x32_bf16 v[76:79], a[16:19], a[124:127], v[76:79]
    v_mfma_f32_16x16x32_bf16 v[80:83], a[20:23], a[112:115], v[80:83]
    s_mov_b32 s34, 548864
    v_mfma_f32_16x16x32_bf16 v[84:87], a[20:23], a[116:119], v[84:87]
    buffer_load_dwordx4 a[16:19], v2, s[20:23], s34 offen offset:0
    v_mfma_f32_16x16x32_bf16 v[88:91], a[20:23], a[120:123], v[88:91]
    v_mfma_f32_16x16x32_bf16 v[92:95], a[20:23], a[124:127], v[92:95]
    v_mfma_f32_16x16x32_bf16 v[96:99], a[24:27], a[112:115], v[96:99]
    buffer_load_dwordx4 a[20:23], v2, s[20:23], s34 offen offset:1024
    v_mfma_f32_16x16x32_bf16 v[100:103], a[24:27], a[116:119], v[100:103]
    v_mfma_f32_16x16x32_bf16 v[104:107], a[24:27], a[120:123], v[104:107]
    v_mfma_f32_16x16x32_bf16 v[108:111], a[24:27], a[124:127], v[108:111]
    v_mfma_f32_16x16x32_bf16 v[112:115], a[28:31], a[112:115], v[112:115]
    buffer_load_dwordx4 a[24:27], v2, s[20:23], s34 offen offset:2048
    v_mfma_f32_16x16x32_bf16 v[116:119], a[28:31], a[116:119], v[116:119]
    v_mfma_f32_16x16x32_bf16 v[120:123], a[28:31], a[120:123], v[120:123]
    v_mfma_f32_16x16x32_bf16 v[124:127], a[28:31], a[124:127], v[124:127]
    v_mfma_f32_16x16x32_bf16 v[128:131], a[32:35], a[112:115], v[128:131]
    buffer_load_dwordx4 a[28:31], v2, s[20:23], s34 offen offset:3072
    v_mfma_f32_16x16x32_bf16 v[132:135], a[32:35], a[116:119], v[132:135]
    v_mfma_f32_16x16x32_bf16 v[136:139], a[32:35], a[120:123], v[136:139]
    v_mfma_f32_16x16x32_bf16 v[140:143], a[32:35], a[124:127], v[140:143]
    s_waitcnt lgkmcnt(0)
    v_mfma_f32_16x16x32_bf16 v[240:243], a[36:39], a[128:131], v[240:243]
    s_mov_b32 s34, 552960
    v_mfma_f32_16x16x32_bf16 v[244:247], a[36:39], a[132:135], v[244:247]
    ds_read_b128 a[112:115], v3 offset:0
    ds_read_b128 a[116:119], v3 offset:1024
    v_mfma_f32_16x16x32_bf16 v[248:251], a[36:39], a[136:139], v[248:251]
    ds_read_b128 a[120:123], v3 offset:2048
    ds_read_b128 a[124:127], v3 offset:3072
    v_mfma_f32_16x16x32_bf16 v[252:255], a[36:39], a[140:143], v[252:255]
    buffer_load_dwordx4 a[32:35], v2, s[20:23], s34 offen offset:0
    v_mfma_f32_16x16x32_bf16 v[48:51], a[40:43], a[128:131], v[48:51]
    buffer_load_dwordx4 a[36:39], v2, s[20:23], s34 offen offset:1024
    v_mfma_f32_16x16x32_bf16 v[52:55], a[40:43], a[132:135], v[52:55]
    v_mfma_f32_16x16x32_bf16 v[56:59], a[40:43], a[136:139], v[56:59]
    v_mfma_f32_16x16x32_bf16 v[60:63], a[40:43], a[140:143], v[60:63]
    s_waitcnt vmcnt(20)
    v_mfma_f32_16x16x32_bf16 v[64:67], a[44:47], a[128:131], v[64:67]
    buffer_load_dwordx4 a[40:43], v2, s[20:23], s34 offen offset:2048
    v_mfma_f32_16x16x32_bf16 v[68:71], a[44:47], a[132:135], v[68:71]
    v_mfma_f32_16x16x32_bf16 v[72:75], a[44:47], a[136:139], v[72:75]
    v_mfma_f32_16x16x32_bf16 v[76:79], a[44:47], a[140:143], v[76:79]
    v_mfma_f32_16x16x32_bf16 v[80:83], a[48:51], a[128:131], v[80:83]
    buffer_load_dwordx4 a[44:47], v2, s[20:23], s34 offen offset:3072
    v_mfma_f32_16x16x32_bf16 v[84:87], a[48:51], a[132:135], v[84:87]
    v_mfma_f32_16x16x32_bf16 v[88:91], a[48:51], a[136:139], v[88:91]
    v_mfma_f32_16x16x32_bf16 v[92:95], a[48:51], a[140:143], v[92:95]
    v_mfma_f32_16x16x32_bf16 v[96:99], a[52:55], a[128:131], v[96:99]
    s_mov_b32 s34, 557056
    v_mfma_f32_16x16x32_bf16 v[100:103], a[52:55], a[132:135], v[100:103]
    buffer_load_dwordx4 a[48:51], v2, s[20:23], s34 offen offset:0
    v_mfma_f32_16x16x32_bf16 v[104:107], a[52:55], a[136:139], v[104:107]
    v_mfma_f32_16x16x32_bf16 v[108:111], a[52:55], a[140:143], v[108:111]
    v_mfma_f32_16x16x32_bf16 v[112:115], a[56:59], a[128:131], v[112:115]
    buffer_load_dwordx4 a[52:55], v2, s[20:23], s34 offen offset:1024
    v_mfma_f32_16x16x32_bf16 v[116:119], a[56:59], a[132:135], v[116:119]
    v_mfma_f32_16x16x32_bf16 v[120:123], a[56:59], a[136:139], v[120:123]
    v_mfma_f32_16x16x32_bf16 v[124:127], a[56:59], a[140:143], v[124:127]
    v_mfma_f32_16x16x32_bf16 v[128:131], a[60:63], a[128:131], v[128:131]
    buffer_load_dwordx4 a[56:59], v2, s[20:23], s34 offen offset:2048
    v_mfma_f32_16x16x32_bf16 v[132:135], a[60:63], a[132:135], v[132:135]
    v_mfma_f32_16x16x32_bf16 v[136:139], a[60:63], a[136:139], v[136:139]
    v_mfma_f32_16x16x32_bf16 v[140:143], a[60:63], a[140:143], v[140:143]
    s_waitcnt lgkmcnt(0)
    v_mfma_f32_16x16x32_bf16 v[144:147], a[64:67], a[112:115], v[144:147]
    buffer_load_dwordx4 a[60:63], v2, s[20:23], s34 offen offset:3072
    v_mfma_f32_16x16x32_bf16 v[148:151], a[64:67], a[116:119], v[148:151]
    ds_read_b128 a[128:131], v3 offset:4096
    ds_read_b128 a[132:135], v3 offset:5120
    v_mfma_f32_16x16x32_bf16 v[152:155], a[64:67], a[120:123], v[152:155]
    ds_read_b128 a[136:139], v3 offset:6144
    ds_read_b128 a[140:143], v3 offset:7168
    v_mfma_f32_16x16x32_bf16 v[156:159], a[64:67], a[124:127], v[156:159]
    v_mfma_f32_16x16x32_bf16 v[160:163], a[68:71], a[112:115], v[160:163]
    s_mov_b32 s34, 561152
    v_mfma_f32_16x16x32_bf16 v[164:167], a[68:71], a[116:119], v[164:167]
    buffer_load_dwordx4 a[64:67], v2, s[20:23], s34 offen offset:0
    v_mfma_f32_16x16x32_bf16 v[168:171], a[68:71], a[120:123], v[168:171]
    v_mfma_f32_16x16x32_bf16 v[172:175], a[68:71], a[124:127], v[172:175]
    s_waitcnt vmcnt(20)
    v_mfma_f32_16x16x32_bf16 v[176:179], a[72:75], a[112:115], v[176:179]
    buffer_load_dwordx4 a[68:71], v2, s[20:23], s34 offen offset:1024
    v_mfma_f32_16x16x32_bf16 v[180:183], a[72:75], a[116:119], v[180:183]
    v_mfma_f32_16x16x32_bf16 v[184:187], a[72:75], a[120:123], v[184:187]
    buffer_load_dwordx4 v[38:41], v12, s[24:27], 0 offen offset:2432
    v_mfma_f32_16x16x32_bf16 v[188:191], a[72:75], a[124:127], v[188:191]
    buffer_load_dwordx4 v[30:33], v12, s[24:27], 0 offen offset:1664
    v_mfma_f32_16x16x32_bf16 v[192:195], a[76:79], a[112:115], v[192:195]
    buffer_load_dwordx4 a[72:75], v2, s[20:23], s34 offen offset:2048
    v_mfma_f32_16x16x32_bf16 v[196:199], a[76:79], a[116:119], v[196:199]
    buffer_load_dwordx4 v[34:37], v12, s[24:27], 0 offen offset:1728
    v_mfma_f32_16x16x32_bf16 v[200:203], a[76:79], a[120:123], v[200:203]
    v_accvgpr_read_b32 v14, a240
    v_accvgpr_read_b32 v15, a241
    v_mfma_f32_16x16x32_bf16 v[204:207], a[76:79], a[124:127], v[204:207]
    v_mfma_f32_16x16x32_bf16 v[208:211], a[80:83], a[112:115], v[208:211]
    buffer_load_dwordx4 a[76:79], v2, s[20:23], s34 offen offset:3072
    v_mfma_f32_16x16x32_bf16 v[212:215], a[80:83], a[116:119], v[212:215]
    v_lshlrev_b32 v18, 16, v14
    v_and_b32 v19, 0xffff0000, v14
    v_mfma_f32_16x16x32_bf16 v[216:219], a[80:83], a[120:123], v[216:219]
    v_lshlrev_b32 v20, 16, v15
    v_mfma_f32_16x16x32_bf16 v[220:223], a[80:83], a[124:127], v[220:223]
    v_and_b32 v21, 0xffff0000, v15
    v_mfma_f32_16x16x32_bf16 v[224:227], a[84:87], a[112:115], v[224:227]
    s_mov_b32 s34, 565248
    v_mul_f32 v18, v18, v240
    v_mfma_f32_16x16x32_bf16 v[228:231], a[84:87], a[116:119], v[228:231]
    buffer_load_dwordx4 a[80:83], v2, s[20:23], s34 offen offset:0
    v_mfma_f32_16x16x32_bf16 v[232:235], a[84:87], a[120:123], v[232:235]
    v_mul_f32 v19, v19, v241
    v_mfma_f32_16x16x32_bf16 v[236:239], a[84:87], a[124:127], v[236:239]
    v_mul_f32 v20, v20, v242
    s_waitcnt lgkmcnt(0)
    v_mfma_f32_16x16x32_bf16 v[144:147], a[88:91], a[128:131], v[144:147]
    buffer_load_dwordx4 a[84:87], v2, s[20:23], s34 offen offset:1024
    v_mfma_f32_16x16x32_bf16 v[148:151], a[88:91], a[132:135], v[148:151]
    ds_read_b128 a[112:115], v3 offset:8192
    ds_read_b128 a[116:119], v3 offset:9216
    v_mfma_f32_16x16x32_bf16 v[152:155], a[88:91], a[136:139], v[152:155]
    ds_read_b128 a[120:123], v3 offset:10240
    ds_read_b128 a[124:127], v3 offset:11264
    v_mfma_f32_16x16x32_bf16 v[156:159], a[88:91], a[140:143], v[156:159]
    v_mul_f32 v21, v21, v243
    v_cvt_pk_bf16_f32 v14, v18, v19
    v_mfma_f32_16x16x32_bf16 v[160:163], a[92:95], a[128:131], v[160:163]
    buffer_load_dwordx4 a[88:91], v2, s[20:23], s34 offen offset:2048
    v_mfma_f32_16x16x32_bf16 v[164:167], a[92:95], a[132:135], v[164:167]
    v_cvt_pk_bf16_f32 v15, v20, v21
    v_mfma_f32_16x16x32_bf16 v[168:171], a[92:95], a[136:139], v[168:171]
    ds_write_b64 v7, v[14:15] offset:0
    v_mfma_f32_16x16x32_bf16 v[172:175], a[92:95], a[140:143], v[172:175]
    s_waitcnt vmcnt(7)
    v_add_f32 v240, v240, v38
    v_add_f32 v241, v241, v39
    v_mfma_f32_16x16x32_bf16 v[176:179], a[96:99], a[128:131], v[176:179]
    buffer_load_dwordx4 a[92:95], v2, s[20:23], s34 offen offset:3072
    v_mfma_f32_16x16x32_bf16 v[180:183], a[96:99], a[132:135], v[180:183]
    v_add_f32 v242, v242, v40
    v_add_f32 v243, v243, v41
    v_mfma_f32_16x16x32_bf16 v[184:187], a[96:99], a[136:139], v[184:187]
    v_accvgpr_read_b32 v22, a242
    v_mfma_f32_16x16x32_bf16 v[188:191], a[96:99], a[140:143], v[188:191]
    v_accvgpr_read_b32 v23, a243
    v_mfma_f32_16x16x32_bf16 v[192:195], a[100:103], a[128:131], v[192:195]
    s_mov_b32 s34, 569344
    v_lshlrev_b32 v26, 16, v22
    v_mfma_f32_16x16x32_bf16 v[196:199], a[100:103], a[132:135], v[196:199]
    buffer_load_dwordx4 a[96:99], v2, s[20:23], s34 offen offset:0
    v_mfma_f32_16x16x32_bf16 v[200:203], a[100:103], a[136:139], v[200:203]
    v_and_b32 v27, 0xffff0000, v22
    v_lshlrev_b32 v28, 16, v23
    v_mfma_f32_16x16x32_bf16 v[204:207], a[100:103], a[140:143], v[204:207]
    v_mfma_f32_16x16x32_bf16 v[208:211], a[104:107], a[128:131], v[208:211]
    buffer_load_dwordx4 a[100:103], v2, s[20:23], s34 offen offset:1024
    v_mfma_f32_16x16x32_bf16 v[212:215], a[104:107], a[132:135], v[212:215]
    v_and_b32 v29, 0xffff0000, v23
    v_mul_f32 v26, v26, v244
    v_mfma_f32_16x16x32_bf16 v[216:219], a[104:107], a[136:139], v[216:219]
    v_mul_f32 v27, v27, v245
    v_mfma_f32_16x16x32_bf16 v[220:223], a[104:107], a[140:143], v[220:223]
    v_mul_f32 v28, v28, v246
    v_mfma_f32_16x16x32_bf16 v[224:227], a[108:111], a[128:131], v[224:227]
    buffer_load_dwordx4 a[104:107], v2, s[20:23], s34 offen offset:2048
    v_mfma_f32_16x16x32_bf16 v[228:231], a[108:111], a[132:135], v[228:231]
    v_mul_f32 v29, v29, v247
    v_mfma_f32_16x16x32_bf16 v[232:235], a[108:111], a[136:139], v[232:235]
    v_cvt_pk_bf16_f32 v22, v26, v27
    v_mfma_f32_16x16x32_bf16 v[236:239], a[108:111], a[140:143], v[236:239]
    v_cvt_pk_bf16_f32 v23, v28, v29
    s_waitcnt lgkmcnt(1)
    v_mfma_f32_16x16x32_bf16 v[144:147], a[0:3], a[112:115], v[144:147]
    buffer_load_dwordx4 a[108:111], v2, s[20:23], s34 offen offset:3072
    v_mfma_f32_16x16x32_bf16 v[148:151], a[0:3], a[116:119], v[148:151]
    ds_read_b128 a[128:131], v3 offset:12288
    ds_read_b128 a[132:135], v3 offset:13312
    v_mfma_f32_16x16x32_bf16 v[152:155], a[0:3], a[120:123], v[152:155]
    ds_read_b128 a[136:139], v3 offset:14336
    ds_read_b128 a[140:143], v3 offset:15360
    v_mfma_f32_16x16x32_bf16 v[156:159], a[0:3], a[124:127], v[156:159]
    ds_write_b64 v7, v[22:23] offset:1024
    v_mfma_f32_16x16x32_bf16 v[160:163], a[4:7], a[112:115], v[160:163]
    s_mov_b32 s34, 573440
    v_add_f32 v244, v244, v38
    v_mfma_f32_16x16x32_bf16 v[164:167], a[4:7], a[116:119], v[164:167]
    buffer_load_dwordx4 a[0:3], v2, s[20:23], s34 offen offset:0
    v_mfma_f32_16x16x32_bf16 v[168:171], a[4:7], a[120:123], v[168:171]
    v_add_f32 v245, v245, v39
    v_add_f32 v246, v246, v40
    v_mfma_f32_16x16x32_bf16 v[172:175], a[4:7], a[124:127], v[172:175]
    v_add_f32 v247, v247, v41
    v_accvgpr_read_b32 v14, a244
    v_mfma_f32_16x16x32_bf16 v[176:179], a[8:11], a[112:115], v[176:179]
    buffer_load_dwordx4 a[4:7], v2, s[20:23], s34 offen offset:1024
    v_mfma_f32_16x16x32_bf16 v[180:183], a[8:11], a[116:119], v[180:183]
    v_accvgpr_read_b32 v15, a245
    v_lshlrev_b32 v18, 16, v14
    v_mfma_f32_16x16x32_bf16 v[184:187], a[8:11], a[120:123], v[184:187]
    v_and_b32 v19, 0xffff0000, v14
    v_mfma_f32_16x16x32_bf16 v[188:191], a[8:11], a[124:127], v[188:191]
    v_lshlrev_b32 v20, 16, v15
    v_mfma_f32_16x16x32_bf16 v[192:195], a[12:15], a[112:115], v[192:195]
    buffer_load_dwordx4 a[8:11], v2, s[20:23], s34 offen offset:2048
    v_mfma_f32_16x16x32_bf16 v[196:199], a[12:15], a[116:119], v[196:199]
    v_and_b32 v21, 0xffff0000, v15
    v_mul_f32 v18, v18, v248
    v_mfma_f32_16x16x32_bf16 v[200:203], a[12:15], a[120:123], v[200:203]
    v_mul_f32 v19, v19, v249
    v_mfma_f32_16x16x32_bf16 v[204:207], a[12:15], a[124:127], v[204:207]
    v_mfma_f32_16x16x32_bf16 v[208:211], a[16:19], a[112:115], v[208:211]
    buffer_load_dwordx4 a[12:15], v2, s[20:23], s34 offen offset:3072
    v_mfma_f32_16x16x32_bf16 v[212:215], a[16:19], a[116:119], v[212:215]
    v_mul_f32 v20, v20, v250
    v_mul_f32 v21, v21, v251
    v_mfma_f32_16x16x32_bf16 v[216:219], a[16:19], a[120:123], v[216:219]
    v_cvt_pk_bf16_f32 v14, v18, v19
    v_mfma_f32_16x16x32_bf16 v[220:223], a[16:19], a[124:127], v[220:223]
    v_cvt_pk_bf16_f32 v15, v20, v21
    v_mfma_f32_16x16x32_bf16 v[224:227], a[20:23], a[112:115], v[224:227]
    s_mov_b32 s34, 577536
    v_mfma_f32_16x16x32_bf16 v[228:231], a[20:23], a[116:119], v[228:231]
    buffer_load_dwordx4 a[16:19], v2, s[20:23], s34 offen offset:0
    v_mfma_f32_16x16x32_bf16 v[232:235], a[20:23], a[120:123], v[232:235]
    ds_write_b64 v7, v[14:15] offset:2048
    v_mfma_f32_16x16x32_bf16 v[236:239], a[20:23], a[124:127], v[236:239]
    v_add_f32 v248, v248, v38
    v_add_f32 v249, v249, v39
    s_waitcnt lgkmcnt(2)
    v_mfma_f32_16x16x32_bf16 v[144:147], a[24:27], a[128:131], v[144:147]
    buffer_load_dwordx4 a[20:23], v2, s[20:23], s34 offen offset:1024
    v_mfma_f32_16x16x32_bf16 v[148:151], a[24:27], a[132:135], v[148:151]
    ds_read_b128 a[112:115], v3 offset:16384
    ds_read_b128 a[116:119], v3 offset:17408
    v_mfma_f32_16x16x32_bf16 v[152:155], a[24:27], a[136:139], v[152:155]
    ds_read_b128 a[120:123], v3 offset:18432
    ds_read_b128 a[124:127], v3 offset:19456
    v_mfma_f32_16x16x32_bf16 v[156:159], a[24:27], a[140:143], v[156:159]
    v_add_f32 v250, v250, v40
    v_add_f32 v251, v251, v41
    v_mfma_f32_16x16x32_bf16 v[160:163], a[28:31], a[128:131], v[160:163]
    buffer_load_dwordx4 a[24:27], v2, s[20:23], s34 offen offset:2048
    v_mfma_f32_16x16x32_bf16 v[164:167], a[28:31], a[132:135], v[164:167]
    v_accvgpr_read_b32 v22, a246
    v_accvgpr_read_b32 v23, a247
    v_mfma_f32_16x16x32_bf16 v[168:171], a[28:31], a[136:139], v[168:171]
    v_lshlrev_b32 v26, 16, v22
    v_and_b32 v27, 0xffff0000, v22
    v_mfma_f32_16x16x32_bf16 v[172:175], a[28:31], a[140:143], v[172:175]
    v_lshlrev_b32 v28, 16, v23
    v_mfma_f32_16x16x32_bf16 v[176:179], a[32:35], a[128:131], v[176:179]
    buffer_load_dwordx4 a[28:31], v2, s[20:23], s34 offen offset:3072
    v_mfma_f32_16x16x32_bf16 v[180:183], a[32:35], a[132:135], v[180:183]
    v_and_b32 v29, 0xffff0000, v23
    v_mfma_f32_16x16x32_bf16 v[184:187], a[32:35], a[136:139], v[184:187]
    v_mul_f32 v26, v26, v252
    v_mfma_f32_16x16x32_bf16 v[188:191], a[32:35], a[140:143], v[188:191]
    v_mul_f32 v27, v27, v253
    v_mfma_f32_16x16x32_bf16 v[192:195], a[36:39], a[128:131], v[192:195]
    s_mov_b32 s34, 581632
    v_mul_f32 v28, v28, v254
    v_mfma_f32_16x16x32_bf16 v[196:199], a[36:39], a[132:135], v[196:199]
    buffer_load_dwordx4 a[32:35], v2, s[20:23], s34 offen offset:0
    v_mfma_f32_16x16x32_bf16 v[200:203], a[36:39], a[136:139], v[200:203]
    v_mul_f32 v29, v29, v255
    v_cvt_pk_bf16_f32 v22, v26, v27
    v_mfma_f32_16x16x32_bf16 v[204:207], a[36:39], a[140:143], v[204:207]
    v_mfma_f32_16x16x32_bf16 v[208:211], a[40:43], a[128:131], v[208:211]
    buffer_load_dwordx4 a[36:39], v2, s[20:23], s34 offen offset:1024
    v_mfma_f32_16x16x32_bf16 v[212:215], a[40:43], a[132:135], v[212:215]
    v_cvt_pk_bf16_f32 v23, v28, v29
    v_mfma_f32_16x16x32_bf16 v[216:219], a[40:43], a[136:139], v[216:219]
    ds_write_b64 v7, v[22:23] offset:3072
    v_mfma_f32_16x16x32_bf16 v[220:223], a[40:43], a[140:143], v[220:223]
    v_add_f32 v252, v252, v38
    v_add_f32 v253, v253, v39
    v_mfma_f32_16x16x32_bf16 v[224:227], a[44:47], a[128:131], v[224:227]
    buffer_load_dwordx4 a[40:43], v2, s[20:23], s34 offen offset:2048
    v_mfma_f32_16x16x32_bf16 v[228:231], a[44:47], a[132:135], v[228:231]
    v_add_f32 v254, v254, v40
    v_mfma_f32_16x16x32_bf16 v[232:235], a[44:47], a[136:139], v[232:235]
    v_add_f32 v255, v255, v41
    v_mfma_f32_16x16x32_bf16 v[236:239], a[44:47], a[140:143], v[236:239]
    buffer_load_dwordx4 v[38:41], v12, s[24:27], 0 offen offset:1792
    s_waitcnt lgkmcnt(1)
    v_mfma_f32_16x16x32_bf16 v[144:147], a[48:51], a[112:115], v[144:147]
    buffer_load_dwordx4 a[44:47], v2, s[20:23], s34 offen offset:3072
    v_mfma_f32_16x16x32_bf16 v[148:151], a[48:51], a[116:119], v[148:151]
    ds_read_b128 a[128:131], v3 offset:20480
    ds_read_b128 a[132:135], v3 offset:21504
    v_mfma_f32_16x16x32_bf16 v[152:155], a[48:51], a[120:123], v[152:155]
    ds_read_b128 a[136:139], v3 offset:22528
    ds_read_b128 a[140:143], v3 offset:23552
    v_mfma_f32_16x16x32_bf16 v[156:159], a[48:51], a[124:127], v[156:159]
    buffer_load_dwordx4 v[42:45], v12, s[24:27], 0 offen offset:1856
    v_mfma_f32_16x16x32_bf16 v[160:163], a[52:55], a[112:115], v[160:163]
    s_mov_b32 s34, 585728
    v_accvgpr_read_b32 v14, a144
    v_mfma_f32_16x16x32_bf16 v[164:167], a[52:55], a[116:119], v[164:167]
    buffer_load_dwordx4 a[48:51], v2, s[20:23], s34 offen offset:0
    v_mfma_f32_16x16x32_bf16 v[168:171], a[52:55], a[120:123], v[168:171]
    v_accvgpr_read_b32 v15, a145
    v_accvgpr_read_b32 v16, a146
    v_mfma_f32_16x16x32_bf16 v[172:175], a[52:55], a[124:127], v[172:175]
    v_accvgpr_read_b32 v17, a147
    v_lshlrev_b32 v18, 16, v14
    v_mfma_f32_16x16x32_bf16 v[176:179], a[56:59], a[112:115], v[176:179]
    buffer_load_dwordx4 a[52:55], v2, s[20:23], s34 offen offset:1024
    v_mfma_f32_16x16x32_bf16 v[180:183], a[56:59], a[116:119], v[180:183]
    v_and_b32 v19, 0xffff0000, v14
    v_lshlrev_b32 v20, 16, v15
    v_mfma_f32_16x16x32_bf16 v[184:187], a[56:59], a[120:123], v[184:187]
    v_and_b32 v21, 0xffff0000, v15
    v_mfma_f32_16x16x32_bf16 v[188:191], a[56:59], a[124:127], v[188:191]
    v_mul_f32 v18, v18, v48
    v_mfma_f32_16x16x32_bf16 v[192:195], a[60:63], a[112:115], v[192:195]
    buffer_load_dwordx4 a[56:59], v2, s[20:23], s34 offen offset:2048
    v_mfma_f32_16x16x32_bf16 v[196:199], a[60:63], a[116:119], v[196:199]
    v_mul_f32 v19, v19, v49
    v_mul_f32 v20, v20, v50
    v_mfma_f32_16x16x32_bf16 v[200:203], a[60:63], a[120:123], v[200:203]
    v_mul_f32 v21, v21, v51
    v_mfma_f32_16x16x32_bf16 v[204:207], a[60:63], a[124:127], v[204:207]
    v_mfma_f32_16x16x32_bf16 v[208:211], a[64:67], a[112:115], v[208:211]
    buffer_load_dwordx4 a[60:63], v2, s[20:23], s34 offen offset:3072
    v_mfma_f32_16x16x32_bf16 v[212:215], a[64:67], a[116:119], v[212:215]
    v_cvt_pk_bf16_f32 v14, v18, v19
    v_cvt_pk_bf16_f32 v15, v20, v21
    v_mfma_f32_16x16x32_bf16 v[216:219], a[64:67], a[120:123], v[216:219]
    v_lshlrev_b32 v18, 16, v16
    v_mfma_f32_16x16x32_bf16 v[220:223], a[64:67], a[124:127], v[220:223]
    v_and_b32 v19, 0xffff0000, v16
    v_mfma_f32_16x16x32_bf16 v[224:227], a[68:71], a[112:115], v[224:227]
    s_mov_b32 s34, 589824
    v_lshlrev_b32 v20, 16, v17
    v_mfma_f32_16x16x32_bf16 v[228:231], a[68:71], a[116:119], v[228:231]
    buffer_load_dwordx4 a[64:67], v2, s[20:23], s34 offen offset:0
    v_mfma_f32_16x16x32_bf16 v[232:235], a[68:71], a[120:123], v[232:235]
    v_and_b32 v21, 0xffff0000, v17
    v_mfma_f32_16x16x32_bf16 v[236:239], a[68:71], a[124:127], v[236:239]
    v_mul_f32 v18, v18, v64
    s_waitcnt vmcnt(29) lgkmcnt(0)
    v_mfma_f32_16x16x32_bf16 v[144:147], a[72:75], a[128:131], v[144:147]
    buffer_load_dwordx4 a[68:71], v2, s[20:23], s34 offen offset:1024
    v_mfma_f32_16x16x32_bf16 v[148:151], a[72:75], a[132:135], v[148:151]
    ds_read_b128 a[112:115], v3 offset:24576
    ds_read_b128 a[116:119], v3 offset:25600
    v_mfma_f32_16x16x32_bf16 v[152:155], a[72:75], a[136:139], v[152:155]
    ds_read_b128 a[120:123], v3 offset:26624
    ds_read_b128 a[124:127], v3 offset:27648
    v_mfma_f32_16x16x32_bf16 v[156:159], a[72:75], a[140:143], v[156:159]
    v_mul_f32 v19, v19, v65
    v_mul_f32 v20, v20, v66
    s_waitcnt vmcnt(22)
    v_mfma_f32_16x16x32_bf16 v[160:163], a[76:79], a[128:131], v[160:163]
    buffer_load_dwordx4 a[72:75], v2, s[20:23], s34 offen offset:2048
    v_mfma_f32_16x16x32_bf16 v[164:167], a[76:79], a[132:135], v[164:167]
    v_mul_f32 v21, v21, v67
    v_cvt_pk_bf16_f32 v16, v18, v19
    v_mfma_f32_16x16x32_bf16 v[168:171], a[76:79], a[136:139], v[168:171]
    v_cvt_pk_bf16_f32 v17, v20, v21
    v_mfma_f32_16x16x32_bf16 v[172:175], a[76:79], a[140:143], v[172:175]
    ds_write_b128 v5, v[14:17] offset:0
    v_mfma_f32_16x16x32_bf16 v[176:179], a[80:83], a[128:131], v[176:179]
    buffer_load_dwordx4 a[76:79], v2, s[20:23], s34 offen offset:3072
    v_mfma_f32_16x16x32_bf16 v[180:183], a[80:83], a[132:135], v[180:183]
    v_add_f32 v48, v48, v30
    v_add_f32 v49, v49, v31
    v_mfma_f32_16x16x32_bf16 v[184:187], a[80:83], a[136:139], v[184:187]
    v_add_f32 v50, v50, v32
    v_mfma_f32_16x16x32_bf16 v[188:191], a[80:83], a[140:143], v[188:191]
    v_add_f32 v51, v51, v33
    v_mfma_f32_16x16x32_bf16 v[192:195], a[84:87], a[128:131], v[192:195]
    s_mov_b32 s34, 593920
    v_add_f32 v64, v64, v34
    v_mfma_f32_16x16x32_bf16 v[196:199], a[84:87], a[132:135], v[196:199]
    buffer_load_dwordx4 a[80:83], v2, s[20:23], s34 offen offset:0
    v_mfma_f32_16x16x32_bf16 v[200:203], a[84:87], a[136:139], v[200:203]
    v_add_f32 v65, v65, v35
    v_add_f32 v66, v66, v36
    v_mfma_f32_16x16x32_bf16 v[204:207], a[84:87], a[140:143], v[204:207]
    v_mfma_f32_16x16x32_bf16 v[208:211], a[88:91], a[128:131], v[208:211]
    buffer_load_dwordx4 a[84:87], v2, s[20:23], s34 offen offset:1024
    v_mfma_f32_16x16x32_bf16 v[212:215], a[88:91], a[132:135], v[212:215]
    v_add_f32 v67, v67, v37
    v_accvgpr_read_b32 v22, a148
    v_mfma_f32_16x16x32_bf16 v[216:219], a[88:91], a[136:139], v[216:219]
    v_accvgpr_read_b32 v23, a149
    v_mfma_f32_16x16x32_bf16 v[220:223], a[88:91], a[140:143], v[220:223]
    v_accvgpr_read_b32 v24, a150
    v_mfma_f32_16x16x32_bf16 v[224:227], a[92:95], a[128:131], v[224:227]
    buffer_load_dwordx4 a[88:91], v2, s[20:23], s34 offen offset:2048
    v_mfma_f32_16x16x32_bf16 v[228:231], a[92:95], a[132:135], v[228:231]
    v_accvgpr_read_b32 v25, a151
    v_mfma_f32_16x16x32_bf16 v[232:235], a[92:95], a[136:139], v[232:235]
    v_lshlrev_b32 v26, 16, v22
    v_mfma_f32_16x16x32_bf16 v[236:239], a[92:95], a[140:143], v[236:239]
    v_and_b32 v27, 0xffff0000, v22
    s_waitcnt lgkmcnt(1)
    v_mfma_f32_16x16x32_bf16 v[144:147], a[96:99], a[112:115], v[144:147]
    buffer_load_dwordx4 a[92:95], v2, s[20:23], s34 offen offset:3072
    v_mfma_f32_16x16x32_bf16 v[148:151], a[96:99], a[116:119], v[148:151]
    ds_read_b128 a[128:131], v3 offset:28672
    ds_read_b128 a[132:135], v3 offset:29696
    v_mfma_f32_16x16x32_bf16 v[152:155], a[96:99], a[120:123], v[152:155]
    ds_read_b128 a[136:139], v3 offset:30720
    ds_read_b128 a[140:143], v3 offset:31744
    v_mfma_f32_16x16x32_bf16 v[156:159], a[96:99], a[124:127], v[156:159]
    v_lshlrev_b32 v28, 16, v23
    v_and_b32 v29, 0xffff0000, v23
    v_mfma_f32_16x16x32_bf16 v[160:163], a[100:103], a[112:115], v[160:163]
    s_mov_b32 s34, 598016
    v_mul_f32 v26, v26, v52
    v_mfma_f32_16x16x32_bf16 v[164:167], a[100:103], a[116:119], v[164:167]
    buffer_load_dwordx4 a[96:99], v2, s[20:23], s34 offen offset:0
    v_mfma_f32_16x16x32_bf16 v[168:171], a[100:103], a[120:123], v[168:171]
    v_mul_f32 v27, v27, v53
    v_mul_f32 v28, v28, v54
    v_mfma_f32_16x16x32_bf16 v[172:175], a[100:103], a[124:127], v[172:175]
    v_mul_f32 v29, v29, v55
    v_cvt_pk_bf16_f32 v22, v26, v27
    s_waitcnt vmcnt(22)
    v_mfma_f32_16x16x32_bf16 v[176:179], a[104:107], a[112:115], v[176:179]
    buffer_load_dwordx4 a[100:103], v2, s[20:23], s34 offen offset:1024
    v_mfma_f32_16x16x32_bf16 v[180:183], a[104:107], a[116:119], v[180:183]
    v_cvt_pk_bf16_f32 v23, v28, v29
    v_mfma_f32_16x16x32_bf16 v[184:187], a[104:107], a[120:123], v[184:187]
    v_lshlrev_b32 v26, 16, v24
    v_mfma_f32_16x16x32_bf16 v[188:191], a[104:107], a[124:127], v[188:191]
    v_and_b32 v27, 0xffff0000, v24
    v_mfma_f32_16x16x32_bf16 v[192:195], a[108:111], a[112:115], v[192:195]
    buffer_load_dwordx4 a[104:107], v2, s[20:23], s34 offen offset:2048
    v_mfma_f32_16x16x32_bf16 v[196:199], a[108:111], a[116:119], v[196:199]
    v_lshlrev_b32 v28, 16, v25
    v_and_b32 v29, 0xffff0000, v25
    v_mfma_f32_16x16x32_bf16 v[200:203], a[108:111], a[120:123], v[200:203]
    v_mfma_f32_16x16x32_bf16 v[204:207], a[108:111], a[124:127], v[204:207]
    v_mul_f32 v26, v26, v68
    v_mfma_f32_16x16x32_bf16 v[208:211], a[0:3], a[112:115], v[208:211]
    buffer_load_dwordx4 a[108:111], v2, s[20:23], s34 offen offset:3072
    v_mfma_f32_16x16x32_bf16 v[212:215], a[0:3], a[116:119], v[212:215]
    v_mul_f32 v27, v27, v69
    v_mul_f32 v28, v28, v70
    v_mfma_f32_16x16x32_bf16 v[216:219], a[0:3], a[120:123], v[216:219]
    v_mul_f32 v29, v29, v71
    v_mfma_f32_16x16x32_bf16 v[220:223], a[0:3], a[124:127], v[220:223]
    v_cvt_pk_bf16_f32 v24, v26, v27
    v_mfma_f32_16x16x32_bf16 v[224:227], a[4:7], a[112:115], v[224:227]
    s_mov_b32 s34, 602112
    v_mfma_f32_16x16x32_bf16 v[228:231], a[4:7], a[116:119], v[228:231]
    buffer_load_dwordx4 a[0:3], v2, s[20:23], s34 offen offset:0
    v_mfma_f32_16x16x32_bf16 v[232:235], a[4:7], a[120:123], v[232:235]
    v_cvt_pk_bf16_f32 v25, v28, v29
    v_mfma_f32_16x16x32_bf16 v[236:239], a[4:7], a[124:127], v[236:239]
    ds_write_b128 v5, v[22:25] offset:1024
    s_waitcnt lgkmcnt(1)
    v_mfma_f32_16x16x32_bf16 v[144:147], a[8:11], a[128:131], v[144:147]
    buffer_load_dwordx4 a[4:7], v2, s[20:23], s34 offen offset:1024
    v_mfma_f32_16x16x32_bf16 v[148:151], a[8:11], a[132:135], v[148:151]
    ds_read_b128 a[112:115], v3 offset:32768
    ds_read_b128 a[116:119], v3 offset:33792
    v_mfma_f32_16x16x32_bf16 v[152:155], a[8:11], a[136:139], v[152:155]
    ds_read_b128 a[120:123], v3 offset:34816
    ds_read_b128 a[124:127], v3 offset:35840
    v_mfma_f32_16x16x32_bf16 v[156:159], a[8:11], a[140:143], v[156:159]
    v_add_f32 v52, v52, v30
    v_add_f32 v53, v53, v31
    v_mfma_f32_16x16x32_bf16 v[160:163], a[12:15], a[128:131], v[160:163]
    buffer_load_dwordx4 a[8:11], v2, s[20:23], s34 offen offset:2048
    v_mfma_f32_16x16x32_bf16 v[164:167], a[12:15], a[132:135], v[164:167]
    v_add_f32 v54, v54, v32
    v_add_f32 v55, v55, v33
    v_mfma_f32_16x16x32_bf16 v[168:171], a[12:15], a[136:139], v[168:171]
    v_add_f32 v68, v68, v34
    v_add_f32 v69, v69, v35
    v_mfma_f32_16x16x32_bf16 v[172:175], a[12:15], a[140:143], v[172:175]
    v_add_f32 v70, v70, v36
    v_add_f32 v71, v71, v37
    v_mfma_f32_16x16x32_bf16 v[176:179], a[16:19], a[128:131], v[176:179]
    buffer_load_dwordx4 a[12:15], v2, s[20:23], s34 offen offset:3072
    v_mfma_f32_16x16x32_bf16 v[180:183], a[16:19], a[132:135], v[180:183]
    v_accvgpr_read_b32 v14, a152
    v_mfma_f32_16x16x32_bf16 v[184:187], a[16:19], a[136:139], v[184:187]
    v_accvgpr_read_b32 v15, a153
    v_mfma_f32_16x16x32_bf16 v[188:191], a[16:19], a[140:143], v[188:191]
    v_accvgpr_read_b32 v16, a154
    s_waitcnt vmcnt(23)
    v_mfma_f32_16x16x32_bf16 v[192:195], a[20:23], a[128:131], v[192:195]
    s_mov_b32 s34, 606208
    v_accvgpr_read_b32 v17, a155
    v_mfma_f32_16x16x32_bf16 v[196:199], a[20:23], a[132:135], v[196:199]
    buffer_load_dwordx4 a[16:19], v2, s[20:23], s34 offen offset:0
    v_mfma_f32_16x16x32_bf16 v[200:203], a[20:23], a[136:139], v[200:203]
    v_lshlrev_b32 v18, 16, v14
    v_mfma_f32_16x16x32_bf16 v[204:207], a[20:23], a[140:143], v[204:207]
    v_and_b32 v19, 0xffff0000, v14
    v_mfma_f32_16x16x32_bf16 v[208:211], a[24:27], a[128:131], v[208:211]
    buffer_load_dwordx4 a[20:23], v2, s[20:23], s34 offen offset:1024
    v_mfma_f32_16x16x32_bf16 v[212:215], a[24:27], a[132:135], v[212:215]
    v_lshlrev_b32 v20, 16, v15
    v_and_b32 v21, 0xffff0000, v15
    v_mfma_f32_16x16x32_bf16 v[216:219], a[24:27], a[136:139], v[216:219]
    v_mul_f32 v18, v18, v56
    v_mfma_f32_16x16x32_bf16 v[220:223], a[24:27], a[140:143], v[220:223]
    v_mul_f32 v19, v19, v57
    v_mfma_f32_16x16x32_bf16 v[224:227], a[28:31], a[128:131], v[224:227]
    buffer_load_dwordx4 a[24:27], v2, s[20:23], s34 offen offset:2048
    v_mfma_f32_16x16x32_bf16 v[228:231], a[28:31], a[132:135], v[228:231]
    v_mul_f32 v20, v20, v58
    v_mfma_f32_16x16x32_bf16 v[232:235], a[28:31], a[136:139], v[232:235]
    v_mul_f32 v21, v21, v59
    v_mfma_f32_16x16x32_bf16 v[236:239], a[28:31], a[140:143], v[236:239]
    v_cvt_pk_bf16_f32 v14, v18, v19
    s_waitcnt lgkmcnt(0)
    v_mfma_f32_16x16x32_bf16 v[144:147], a[32:35], a[112:115], v[144:147]
    buffer_load_dwordx4 a[28:31], v2, s[20:23], s34 offen offset:3072
    v_mfma_f32_16x16x32_bf16 v[148:151], a[32:35], a[116:119], v[148:151]
    ds_read_b128 a[128:131], v3 offset:36864
    ds_read_b128 a[132:135], v3 offset:37888
    v_mfma_f32_16x16x32_bf16 v[152:155], a[32:35], a[120:123], v[152:155]
    ds_read_b128 a[136:139], v3 offset:38912
    ds_read_b128 a[140:143], v3 offset:39936
    v_mfma_f32_16x16x32_bf16 v[156:159], a[32:35], a[124:127], v[156:159]
    v_cvt_pk_bf16_f32 v15, v20, v21
    v_lshlrev_b32 v18, 16, v16
    v_mfma_f32_16x16x32_bf16 v[160:163], a[36:39], a[112:115], v[160:163]
    s_mov_b32 s34, 610304
    v_and_b32 v19, 0xffff0000, v16
    v_mfma_f32_16x16x32_bf16 v[164:167], a[36:39], a[116:119], v[164:167]
    buffer_load_dwordx4 a[32:35], v2, s[20:23], s34 offen offset:0
    v_mfma_f32_16x16x32_bf16 v[168:171], a[36:39], a[120:123], v[168:171]
    v_lshlrev_b32 v20, 16, v17
    v_and_b32 v21, 0xffff0000, v17
    v_mfma_f32_16x16x32_bf16 v[172:175], a[36:39], a[124:127], v[172:175]
    v_mul_f32 v18, v18, v72
    v_mul_f32 v19, v19, v73
    v_mfma_f32_16x16x32_bf16 v[176:179], a[40:43], a[112:115], v[176:179]
    buffer_load_dwordx4 a[36:39], v2, s[20:23], s34 offen offset:1024
    v_mfma_f32_16x16x32_bf16 v[180:183], a[40:43], a[116:119], v[180:183]
    v_mul_f32 v20, v20, v74
    v_mfma_f32_16x16x32_bf16 v[184:187], a[40:43], a[120:123], v[184:187]
    v_mul_f32 v21, v21, v75
    v_mfma_f32_16x16x32_bf16 v[188:191], a[40:43], a[124:127], v[188:191]
    v_cvt_pk_bf16_f32 v16, v18, v19
    s_waitcnt vmcnt(27)
    v_mfma_f32_16x16x32_bf16 v[192:195], a[44:47], a[112:115], v[192:195]
    buffer_load_dwordx4 a[40:43], v2, s[20:23], s34 offen offset:2048
    v_mfma_f32_16x16x32_bf16 v[196:199], a[44:47], a[116:119], v[196:199]
    v_cvt_pk_bf16_f32 v17, v20, v21
    v_mfma_f32_16x16x32_bf16 v[200:203], a[44:47], a[120:123], v[200:203]
    ds_write_b128 v5, v[14:17] offset:2048
    v_mfma_f32_16x16x32_bf16 v[204:207], a[44:47], a[124:127], v[204:207]
    v_add_f32 v56, v56, v30
    s_waitcnt vmcnt(20)
    v_mfma_f32_16x16x32_bf16 v[208:211], a[48:51], a[112:115], v[208:211]
    buffer_load_dwordx4 a[44:47], v2, s[20:23], s34 offen offset:3072
    v_mfma_f32_16x16x32_bf16 v[212:215], a[48:51], a[116:119], v[212:215]
    v_add_f32 v57, v57, v31
    v_add_f32 v58, v58, v32
    v_mfma_f32_16x16x32_bf16 v[216:219], a[48:51], a[120:123], v[216:219]
    v_add_f32 v59, v59, v33
    v_mfma_f32_16x16x32_bf16 v[220:223], a[48:51], a[124:127], v[220:223]
    v_add_f32 v72, v72, v34
    v_mfma_f32_16x16x32_bf16 v[224:227], a[52:55], a[112:115], v[224:227]
    s_mov_b32 s34, 614400
    v_mfma_f32_16x16x32_bf16 v[228:231], a[52:55], a[116:119], v[228:231]
    buffer_load_dwordx4 a[48:51], v2, s[20:23], s34 offen offset:0
    v_mfma_f32_16x16x32_bf16 v[232:235], a[52:55], a[120:123], v[232:235]
    v_add_f32 v73, v73, v35
    v_add_f32 v74, v74, v36
    v_mfma_f32_16x16x32_bf16 v[236:239], a[52:55], a[124:127], v[236:239]
    v_add_f32 v75, v75, v37
    s_waitcnt lgkmcnt(1)
    v_mfma_f32_16x16x32_bf16 v[144:147], a[56:59], a[128:131], v[144:147]
    buffer_load_dwordx4 a[52:55], v2, s[20:23], s34 offen offset:1024
    v_mfma_f32_16x16x32_bf16 v[148:151], a[56:59], a[132:135], v[148:151]
    ds_read_b128 a[112:115], v3 offset:40960
    ds_read_b128 a[116:119], v3 offset:41984
    v_mfma_f32_16x16x32_bf16 v[152:155], a[56:59], a[136:139], v[152:155]
    ds_read_b128 a[120:123], v3 offset:43008
    ds_read_b128 a[124:127], v3 offset:44032
    v_mfma_f32_16x16x32_bf16 v[156:159], a[56:59], a[140:143], v[156:159]
    v_accvgpr_read_b32 v22, a156
    v_accvgpr_read_b32 v23, a157
    v_mfma_f32_16x16x32_bf16 v[160:163], a[60:63], a[128:131], v[160:163]
    buffer_load_dwordx4 a[56:59], v2, s[20:23], s34 offen offset:2048
    v_mfma_f32_16x16x32_bf16 v[164:167], a[60:63], a[132:135], v[164:167]
    v_accvgpr_read_b32 v24, a158
    v_accvgpr_read_b32 v25, a159
    v_mfma_f32_16x16x32_bf16 v[168:171], a[60:63], a[136:139], v[168:171]
    v_lshlrev_b32 v26, 16, v22
    v_and_b32 v27, 0xffff0000, v22
    v_mfma_f32_16x16x32_bf16 v[172:175], a[60:63], a[140:143], v[172:175]
    v_lshlrev_b32 v28, 16, v23
    v_mfma_f32_16x16x32_bf16 v[176:179], a[64:67], a[128:131], v[176:179]
    buffer_load_dwordx4 a[60:63], v2, s[20:23], s34 offen offset:3072
    v_mfma_f32_16x16x32_bf16 v[180:183], a[64:67], a[132:135], v[180:183]
    v_and_b32 v29, 0xffff0000, v23
    v_mfma_f32_16x16x32_bf16 v[184:187], a[64:67], a[136:139], v[184:187]
    v_mul_f32 v26, v26, v60
    v_mfma_f32_16x16x32_bf16 v[188:191], a[64:67], a[140:143], v[188:191]
    v_mul_f32 v27, v27, v61
    v_mfma_f32_16x16x32_bf16 v[192:195], a[68:71], a[128:131], v[192:195]
    s_mov_b32 s34, 618496
    v_mul_f32 v28, v28, v62
    v_mfma_f32_16x16x32_bf16 v[196:199], a[68:71], a[132:135], v[196:199]
    buffer_load_dwordx4 a[64:67], v2, s[20:23], s34 offen offset:0
    v_mfma_f32_16x16x32_bf16 v[200:203], a[68:71], a[136:139], v[200:203]
    v_mul_f32 v29, v29, v63
    v_mfma_f32_16x16x32_bf16 v[204:207], a[68:71], a[140:143], v[204:207]
    v_cvt_pk_bf16_f32 v22, v26, v27
    v_mfma_f32_16x16x32_bf16 v[208:211], a[72:75], a[128:131], v[208:211]
    buffer_load_dwordx4 a[68:71], v2, s[20:23], s34 offen offset:1024
    v_mfma_f32_16x16x32_bf16 v[212:215], a[72:75], a[132:135], v[212:215]
    v_cvt_pk_bf16_f32 v23, v28, v29
    v_lshlrev_b32 v26, 16, v24
    v_mfma_f32_16x16x32_bf16 v[216:219], a[72:75], a[136:139], v[216:219]
    v_and_b32 v27, 0xffff0000, v24
    v_mfma_f32_16x16x32_bf16 v[220:223], a[72:75], a[140:143], v[220:223]
    v_lshlrev_b32 v28, 16, v25
    s_waitcnt vmcnt(20)
    v_mfma_f32_16x16x32_bf16 v[224:227], a[76:79], a[128:131], v[224:227]
    buffer_load_dwordx4 a[72:75], v2, s[20:23], s34 offen offset:2048
    v_mfma_f32_16x16x32_bf16 v[228:231], a[76:79], a[132:135], v[228:231]
    v_and_b32 v29, 0xffff0000, v25
    v_mfma_f32_16x16x32_bf16 v[232:235], a[76:79], a[136:139], v[232:235]
    v_mul_f32 v26, v26, v76
    v_mfma_f32_16x16x32_bf16 v[236:239], a[76:79], a[140:143], v[236:239]
    v_mul_f32 v27, v27, v77
    s_waitcnt lgkmcnt(0)
    v_mfma_f32_16x16x32_bf16 v[144:147], a[80:83], a[112:115], v[144:147]
    buffer_load_dwordx4 a[76:79], v2, s[20:23], s34 offen offset:3072
    v_mfma_f32_16x16x32_bf16 v[148:151], a[80:83], a[116:119], v[148:151]
    ds_read_b128 a[128:131], v3 offset:45056
    ds_read_b128 a[132:135], v3 offset:46080
    v_mfma_f32_16x16x32_bf16 v[152:155], a[80:83], a[120:123], v[152:155]
    ds_read_b128 a[136:139], v3 offset:47104
    ds_read_b128 a[140:143], v3 offset:48128
    v_mfma_f32_16x16x32_bf16 v[156:159], a[80:83], a[124:127], v[156:159]
    v_mul_f32 v28, v28, v78
    v_mul_f32 v29, v29, v79
    v_mfma_f32_16x16x32_bf16 v[160:163], a[84:87], a[112:115], v[160:163]
    s_mov_b32 s34, 622592
    v_cvt_pk_bf16_f32 v24, v26, v27
    v_mfma_f32_16x16x32_bf16 v[164:167], a[84:87], a[116:119], v[164:167]
    buffer_load_dwordx4 a[80:83], v2, s[20:23], s34 offen offset:0
    v_mfma_f32_16x16x32_bf16 v[168:171], a[84:87], a[120:123], v[168:171]
    v_cvt_pk_bf16_f32 v25, v28, v29
    v_mfma_f32_16x16x32_bf16 v[172:175], a[84:87], a[124:127], v[172:175]
    ds_write_b128 v5, v[22:25] offset:3072
    v_mfma_f32_16x16x32_bf16 v[176:179], a[88:91], a[112:115], v[176:179]
    buffer_load_dwordx4 a[84:87], v2, s[20:23], s34 offen offset:1024
    v_mfma_f32_16x16x32_bf16 v[180:183], a[88:91], a[116:119], v[180:183]
    v_add_f32 v60, v60, v30
    v_add_f32 v61, v61, v31
    v_mfma_f32_16x16x32_bf16 v[184:187], a[88:91], a[120:123], v[184:187]
    v_add_f32 v62, v62, v32
    v_add_f32 v63, v63, v33
    v_mfma_f32_16x16x32_bf16 v[188:191], a[88:91], a[124:127], v[188:191]
    v_add_f32 v76, v76, v34
    v_mfma_f32_16x16x32_bf16 v[192:195], a[92:95], a[112:115], v[192:195]
    buffer_load_dwordx4 a[88:91], v2, s[20:23], s34 offen offset:2048
    v_mfma_f32_16x16x32_bf16 v[196:199], a[92:95], a[116:119], v[196:199]
    v_add_f32 v77, v77, v35
    v_add_f32 v78, v78, v36
    v_mfma_f32_16x16x32_bf16 v[200:203], a[92:95], a[120:123], v[200:203]
    v_mfma_f32_16x16x32_bf16 v[204:207], a[92:95], a[124:127], v[204:207]
    v_add_f32 v79, v79, v37
    v_mfma_f32_16x16x32_bf16 v[208:211], a[96:99], a[112:115], v[208:211]
    buffer_load_dwordx4 a[92:95], v2, s[20:23], s34 offen offset:3072
    v_mfma_f32_16x16x32_bf16 v[212:215], a[96:99], a[116:119], v[212:215]
    buffer_load_dwordx4 v[30:33], v12, s[24:27], 0 offen offset:1920
    v_mfma_f32_16x16x32_bf16 v[216:219], a[96:99], a[120:123], v[216:219]
    buffer_load_dwordx4 v[34:37], v12, s[24:27], 0 offen offset:1984
    v_mfma_f32_16x16x32_bf16 v[220:223], a[96:99], a[124:127], v[220:223]
    v_accvgpr_read_b32 v14, a160
    v_accvgpr_read_b32 v15, a161
    v_mfma_f32_16x16x32_bf16 v[224:227], a[100:103], a[112:115], v[224:227]
    s_mov_b32 s34, 626688
    v_mfma_f32_16x16x32_bf16 v[228:231], a[100:103], a[116:119], v[228:231]
    buffer_load_dwordx4 a[96:99], v2, s[20:23], s34 offen offset:0
    v_mfma_f32_16x16x32_bf16 v[232:235], a[100:103], a[120:123], v[232:235]
    v_accvgpr_read_b32 v16, a162
    v_accvgpr_read_b32 v17, a163
    v_mfma_f32_16x16x32_bf16 v[236:239], a[100:103], a[124:127], v[236:239]
    v_lshlrev_b32 v18, 16, v14
    s_waitcnt vmcnt(22) lgkmcnt(1)
    v_mfma_f32_16x16x32_bf16 v[144:147], a[104:107], a[128:131], v[144:147]
    buffer_load_dwordx4 a[100:103], v2, s[20:23], s34 offen offset:1024
    v_mfma_f32_16x16x32_bf16 v[148:151], a[104:107], a[132:135], v[148:151]
    ds_read_b128 a[112:115], v3 offset:49152
    ds_read_b128 a[116:119], v3 offset:50176
    v_mfma_f32_16x16x32_bf16 v[152:155], a[104:107], a[136:139], v[152:155]
    ds_read_b128 a[120:123], v3 offset:51200
    ds_read_b128 a[124:127], v3 offset:52224
    v_mfma_f32_16x16x32_bf16 v[156:159], a[104:107], a[140:143], v[156:159]
    v_and_b32 v19, 0xffff0000, v14
    v_lshlrev_b32 v20, 16, v15
    v_mfma_f32_16x16x32_bf16 v[160:163], a[108:111], a[128:131], v[160:163]
    buffer_load_dwordx4 a[104:107], v2, s[20:23], s34 offen offset:2048
    v_mfma_f32_16x16x32_bf16 v[164:167], a[108:111], a[132:135], v[164:167]
    v_and_b32 v21, 0xffff0000, v15
    v_mul_f32 v18, v18, v80
    v_mfma_f32_16x16x32_bf16 v[168:171], a[108:111], a[136:139], v[168:171]
    v_mul_f32 v19, v19, v81
    v_mul_f32 v20, v20, v82
    v_mfma_f32_16x16x32_bf16 v[172:175], a[108:111], a[140:143], v[172:175]
    v_mul_f32 v21, v21, v83
    v_mfma_f32_16x16x32_bf16 v[176:179], a[0:3], a[128:131], v[176:179]
    buffer_load_dwordx4 a[108:111], v2, s[20:23], s34 offen offset:3072
    v_mfma_f32_16x16x32_bf16 v[180:183], a[0:3], a[132:135], v[180:183]
    v_cvt_pk_bf16_f32 v14, v18, v19
    v_mfma_f32_16x16x32_bf16 v[184:187], a[0:3], a[136:139], v[184:187]
    v_cvt_pk_bf16_f32 v15, v20, v21
    v_mfma_f32_16x16x32_bf16 v[188:191], a[0:3], a[140:143], v[188:191]
    v_lshlrev_b32 v18, 16, v16
    v_mfma_f32_16x16x32_bf16 v[192:195], a[4:7], a[128:131], v[192:195]
    s_mov_b32 s34, 630784
    v_and_b32 v19, 0xffff0000, v16
    v_mfma_f32_16x16x32_bf16 v[196:199], a[4:7], a[132:135], v[196:199]
    buffer_load_dwordx4 a[0:3], v2, s[20:23], s34 offen offset:0
    v_mfma_f32_16x16x32_bf16 v[200:203], a[4:7], a[136:139], v[200:203]
    v_lshlrev_b32 v20, 16, v17
    v_mfma_f32_16x16x32_bf16 v[204:207], a[4:7], a[140:143], v[204:207]
    v_and_b32 v21, 0xffff0000, v17
    v_mfma_f32_16x16x32_bf16 v[208:211], a[8:11], a[128:131], v[208:211]
    buffer_load_dwordx4 a[4:7], v2, s[20:23], s34 offen offset:1024
    v_mfma_f32_16x16x32_bf16 v[212:215], a[8:11], a[132:135], v[212:215]
    v_mul_f32 v18, v18, v96
    v_mul_f32 v19, v19, v97
    v_mfma_f32_16x16x32_bf16 v[216:219], a[8:11], a[136:139], v[216:219]
    v_mul_f32 v20, v20, v98
    v_mfma_f32_16x16x32_bf16 v[220:223], a[8:11], a[140:143], v[220:223]
    v_mul_f32 v21, v21, v99
    v_mfma_f32_16x16x32_bf16 v[224:227], a[12:15], a[128:131], v[224:227]
    buffer_load_dwordx4 a[8:11], v2, s[20:23], s34 offen offset:2048
    v_mfma_f32_16x16x32_bf16 v[228:231], a[12:15], a[132:135], v[228:231]
    v_cvt_pk_bf16_f32 v16, v18, v19
    v_mfma_f32_16x16x32_bf16 v[232:235], a[12:15], a[136:139], v[232:235]
    v_cvt_pk_bf16_f32 v17, v20, v21
    v_mfma_f32_16x16x32_bf16 v[236:239], a[12:15], a[140:143], v[236:239]
    ds_write_b128 v5, v[14:17] offset:4096
    s_waitcnt lgkmcnt(1)
    v_mfma_f32_16x16x32_bf16 v[144:147], a[16:19], a[112:115], v[144:147]
    buffer_load_dwordx4 a[12:15], v2, s[20:23], s34 offen offset:3072
    v_mfma_f32_16x16x32_bf16 v[148:151], a[16:19], a[116:119], v[148:151]
    ds_read_b128 a[128:131], v3 offset:53248
    ds_read_b128 a[132:135], v3 offset:54272
    v_mfma_f32_16x16x32_bf16 v[152:155], a[16:19], a[120:123], v[152:155]
    ds_read_b128 a[136:139], v3 offset:55296
    ds_read_b128 a[140:143], v3 offset:56320
    v_mfma_f32_16x16x32_bf16 v[156:159], a[16:19], a[124:127], v[156:159]
    v_add_f32 v80, v80, v38
    v_add_f32 v81, v81, v39
    s_waitcnt vmcnt(22)
    v_mfma_f32_16x16x32_bf16 v[160:163], a[20:23], a[112:115], v[160:163]
    s_mov_b32 s34, 634880
    v_add_f32 v82, v82, v40
    v_mfma_f32_16x16x32_bf16 v[164:167], a[20:23], a[116:119], v[164:167]
    buffer_load_dwordx4 a[16:19], v2, s[20:23], s34 offen offset:0
    v_mfma_f32_16x16x32_bf16 v[168:171], a[20:23], a[120:123], v[168:171]
    v_add_f32 v83, v83, v41
    v_add_f32 v96, v96, v42
    v_mfma_f32_16x16x32_bf16 v[172:175], a[20:23], a[124:127], v[172:175]
    v_add_f32 v97, v97, v43
    v_mfma_f32_16x16x32_bf16 v[176:179], a[24:27], a[112:115], v[176:179]
    buffer_load_dwordx4 a[20:23], v2, s[20:23], s34 offen offset:1024
    v_mfma_f32_16x16x32_bf16 v[180:183], a[24:27], a[116:119], v[180:183]
    v_add_f32 v98, v98, v44
    v_add_f32 v99, v99, v45
    v_mfma_f32_16x16x32_bf16 v[184:187], a[24:27], a[120:123], v[184:187]
    v_accvgpr_read_b32 v22, a164
    v_mfma_f32_16x16x32_bf16 v[188:191], a[24:27], a[124:127], v[188:191]
    v_accvgpr_read_b32 v23, a165
    v_mfma_f32_16x16x32_bf16 v[192:195], a[28:31], a[112:115], v[192:195]
    buffer_load_dwordx4 a[24:27], v2, s[20:23], s34 offen offset:2048
    v_mfma_f32_16x16x32_bf16 v[196:199], a[28:31], a[116:119], v[196:199]
    v_accvgpr_read_b32 v24, a166
    v_mfma_f32_16x16x32_bf16 v[200:203], a[28:31], a[120:123], v[200:203]
    v_accvgpr_read_b32 v25, a167
    v_mfma_f32_16x16x32_bf16 v[204:207], a[28:31], a[124:127], v[204:207]
    v_lshlrev_b32 v26, 16, v22
    v_mfma_f32_16x16x32_bf16 v[208:211], a[32:35], a[112:115], v[208:211]
    buffer_load_dwordx4 a[28:31], v2, s[20:23], s34 offen offset:3072
    v_mfma_f32_16x16x32_bf16 v[212:215], a[32:35], a[116:119], v[212:215]
    v_and_b32 v27, 0xffff0000, v22
    v_lshlrev_b32 v28, 16, v23
    v_mfma_f32_16x16x32_bf16 v[216:219], a[32:35], a[120:123], v[216:219]
    v_and_b32 v29, 0xffff0000, v23
    v_mfma_f32_16x16x32_bf16 v[220:223], a[32:35], a[124:127], v[220:223]
    v_mfma_f32_16x16x32_bf16 v[224:227], a[36:39], a[112:115], v[224:227]
    s_mov_b32 s34, 638976
    v_mul_f32 v26, v26, v84
    v_mfma_f32_16x16x32_bf16 v[228:231], a[36:39], a[116:119], v[228:231]
    buffer_load_dwordx4 a[32:35], v2, s[20:23], s34 offen offset:0
    v_mfma_f32_16x16x32_bf16 v[232:235], a[36:39], a[120:123], v[232:235]
    v_mul_f32 v27, v27, v85
    v_mul_f32 v28, v28, v86
    v_mfma_f32_16x16x32_bf16 v[236:239], a[36:39], a[124:127], v[236:239]
    v_mul_f32 v29, v29, v87
    s_waitcnt lgkmcnt(0)
    v_mfma_f32_16x16x32_bf16 v[144:147], a[40:43], a[128:131], v[144:147]
    buffer_load_dwordx4 a[36:39], v2, s[20:23], s34 offen offset:1024
    v_mfma_f32_16x16x32_bf16 v[148:151], a[40:43], a[132:135], v[148:151]
    ds_read_b128 a[112:115], v4 offset:0
    ds_read_b128 a[116:119], v4 offset:1024
    v_mfma_f32_16x16x32_bf16 v[152:155], a[40:43], a[136:139], v[152:155]
    ds_read_b128 a[120:123], v4 offset:2048
    ds_read_b128 a[124:127], v4 offset:3072
    v_mfma_f32_16x16x32_bf16 v[156:159], a[40:43], a[140:143], v[156:159]
    v_cvt_pk_bf16_f32 v22, v26, v27
    v_cvt_pk_bf16_f32 v23, v28, v29
    v_mfma_f32_16x16x32_bf16 v[160:163], a[44:47], a[128:131], v[160:163]
    buffer_load_dwordx4 a[40:43], v2, s[20:23], s34 offen offset:2048
    v_mfma_f32_16x16x32_bf16 v[164:167], a[44:47], a[132:135], v[164:167]
    v_lshlrev_b32 v26, 16, v24
    v_and_b32 v27, 0xffff0000, v24
    v_mfma_f32_16x16x32_bf16 v[168:171], a[44:47], a[136:139], v[168:171]
    v_lshlrev_b32 v28, 16, v25
    v_and_b32 v29, 0xffff0000, v25
    v_mfma_f32_16x16x32_bf16 v[172:175], a[44:47], a[140:143], v[172:175]
    s_waitcnt vmcnt(22)
    v_mfma_f32_16x16x32_bf16 v[176:179], a[48:51], a[128:131], v[176:179]
    buffer_load_dwordx4 a[44:47], v2, s[20:23], s34 offen offset:3072
    v_mfma_f32_16x16x32_bf16 v[180:183], a[48:51], a[132:135], v[180:183]
    v_mul_f32 v26, v26, v100
    v_mul_f32 v27, v27, v101
    v_mfma_f32_16x16x32_bf16 v[184:187], a[48:51], a[136:139], v[184:187]
    v_mul_f32 v28, v28, v102
    v_mfma_f32_16x16x32_bf16 v[188:191], a[48:51], a[140:143], v[188:191]
    v_mul_f32 v29, v29, v103
    v_mfma_f32_16x16x32_bf16 v[192:195], a[52:55], a[128:131], v[192:195]
    s_mov_b32 s34, 643072
    v_cvt_pk_bf16_f32 v24, v26, v27
    v_mfma_f32_16x16x32_bf16 v[196:199], a[52:55], a[132:135], v[196:199]
    buffer_load_dwordx4 a[48:51], v2, s[20:23], s34 offen offset:0
    v_mfma_f32_16x16x32_bf16 v[200:203], a[52:55], a[136:139], v[200:203]
    v_cvt_pk_bf16_f32 v25, v28, v29
    v_mfma_f32_16x16x32_bf16 v[204:207], a[52:55], a[140:143], v[204:207]
    ds_write_b128 v5, v[22:25] offset:5120
    v_mfma_f32_16x16x32_bf16 v[208:211], a[56:59], a[128:131], v[208:211]
    buffer_load_dwordx4 a[52:55], v2, s[20:23], s34 offen offset:1024
    v_mfma_f32_16x16x32_bf16 v[212:215], a[56:59], a[132:135], v[212:215]
    v_add_f32 v84, v84, v38
    v_add_f32 v85, v85, v39
    v_mfma_f32_16x16x32_bf16 v[216:219], a[56:59], a[136:139], v[216:219]
    v_add_f32 v86, v86, v40
    v_mfma_f32_16x16x32_bf16 v[220:223], a[56:59], a[140:143], v[220:223]
    v_mfma_f32_16x16x32_bf16 v[224:227], a[60:63], a[128:131], v[224:227]
    buffer_load_dwordx4 a[56:59], v2, s[20:23], s34 offen offset:2048
    v_mfma_f32_16x16x32_bf16 v[228:231], a[60:63], a[132:135], v[228:231]
    v_add_f32 v87, v87, v41
    v_add_f32 v100, v100, v42
    v_mfma_f32_16x16x32_bf16 v[232:235], a[60:63], a[136:139], v[232:235]
    v_add_f32 v101, v101, v43
    v_mfma_f32_16x16x32_bf16 v[236:239], a[60:63], a[140:143], v[236:239]
    v_add_f32 v102, v102, v44
    s_waitcnt lgkmcnt(1)
    v_mfma_f32_16x16x32_bf16 v[144:147], a[64:67], a[112:115], v[144:147]
    buffer_load_dwordx4 a[60:63], v2, s[20:23], s34 offen offset:3072
    v_mfma_f32_16x16x32_bf16 v[148:151], a[64:67], a[116:119], v[148:151]
    ds_read_b128 a[128:131], v4 offset:4096
    ds_read_b128 a[132:135], v4 offset:5120
    v_mfma_f32_16x16x32_bf16 v[152:155], a[64:67], a[120:123], v[152:155]
    ds_read_b128 a[136:139], v4 offset:6144
    ds_read_b128 a[140:143], v4 offset:7168
    v_mfma_f32_16x16x32_bf16 v[156:159], a[64:67], a[124:127], v[156:159]
    v_add_f32 v103, v103, v45
    v_accvgpr_read_b32 v14, a168
    v_mfma_f32_16x16x32_bf16 v[160:163], a[68:71], a[112:115], v[160:163]
    s_mov_b32 s34, 647168
    v_accvgpr_read_b32 v15, a169
    v_mfma_f32_16x16x32_bf16 v[164:167], a[68:71], a[116:119], v[164:167]
    buffer_load_dwordx4 a[64:67], v2, s[20:23], s34 offen offset:0
    v_mfma_f32_16x16x32_bf16 v[168:171], a[68:71], a[120:123], v[168:171]
    v_accvgpr_read_b32 v16, a170
    v_accvgpr_read_b32 v17, a171
    v_mfma_f32_16x16x32_bf16 v[172:175], a[68:71], a[124:127], v[172:175]
    v_lshlrev_b32 v18, 16, v14
    v_mfma_f32_16x16x32_bf16 v[176:179], a[72:75], a[112:115], v[176:179]
    buffer_load_dwordx4 a[68:71], v2, s[20:23], s34 offen offset:1024
    v_mfma_f32_16x16x32_bf16 v[180:183], a[72:75], a[116:119], v[180:183]
    v_and_b32 v19, 0xffff0000, v14
    v_lshlrev_b32 v20, 16, v15
    v_mfma_f32_16x16x32_bf16 v[184:187], a[72:75], a[120:123], v[184:187]
    v_and_b32 v21, 0xffff0000, v15
    v_mfma_f32_16x16x32_bf16 v[188:191], a[72:75], a[124:127], v[188:191]
    v_mul_f32 v18, v18, v88
    s_waitcnt vmcnt(24)
    v_mfma_f32_16x16x32_bf16 v[192:195], a[76:79], a[112:115], v[192:195]
    buffer_load_dwordx4 a[72:75], v2, s[20:23], s34 offen offset:2048
    v_mfma_f32_16x16x32_bf16 v[196:199], a[76:79], a[116:119], v[196:199]
    v_mul_f32 v19, v19, v89
    v_mfma_f32_16x16x32_bf16 v[200:203], a[76:79], a[120:123], v[200:203]
    v_mul_f32 v20, v20, v90
    v_mfma_f32_16x16x32_bf16 v[204:207], a[76:79], a[124:127], v[204:207]
    v_mul_f32 v21, v21, v91
    v_mfma_f32_16x16x32_bf16 v[208:211], a[80:83], a[112:115], v[208:211]
    buffer_load_dwordx4 a[76:79], v2, s[20:23], s34 offen offset:3072
    v_mfma_f32_16x16x32_bf16 v[212:215], a[80:83], a[116:119], v[212:215]
    v_cvt_pk_bf16_f32 v14, v18, v19
    v_cvt_pk_bf16_f32 v15, v20, v21
    v_mfma_f32_16x16x32_bf16 v[216:219], a[80:83], a[120:123], v[216:219]
    v_lshlrev_b32 v18, 16, v16
    v_mfma_f32_16x16x32_bf16 v[220:223], a[80:83], a[124:127], v[220:223]
    v_mfma_f32_16x16x32_bf16 v[224:227], a[84:87], a[112:115], v[224:227]
    s_mov_b32 s34, 651264
    v_and_b32 v19, 0xffff0000, v16
    v_mfma_f32_16x16x32_bf16 v[228:231], a[84:87], a[116:119], v[228:231]
    buffer_load_dwordx4 a[80:83], v2, s[20:23], s34 offen offset:0
    v_mfma_f32_16x16x32_bf16 v[232:235], a[84:87], a[120:123], v[232:235]
    v_lshlrev_b32 v20, 16, v17
    v_and_b32 v21, 0xffff0000, v17
    v_mfma_f32_16x16x32_bf16 v[236:239], a[84:87], a[124:127], v[236:239]
    v_mul_f32 v18, v18, v104
    s_waitcnt lgkmcnt(0)
    v_mfma_f32_16x16x32_bf16 v[144:147], a[88:91], a[128:131], v[144:147]
    buffer_load_dwordx4 a[84:87], v2, s[20:23], s34 offen offset:1024
    v_mfma_f32_16x16x32_bf16 v[148:151], a[88:91], a[132:135], v[148:151]
    ds_read_b128 a[112:115], v4 offset:8192
    ds_read_b128 a[116:119], v4 offset:9216
    v_mfma_f32_16x16x32_bf16 v[152:155], a[88:91], a[136:139], v[152:155]
    ds_read_b128 a[120:123], v4 offset:10240
    ds_read_b128 a[124:127], v4 offset:11264
    v_mfma_f32_16x16x32_bf16 v[156:159], a[88:91], a[140:143], v[156:159]
    v_mul_f32 v19, v19, v105
    v_mul_f32 v20, v20, v106
    v_mfma_f32_16x16x32_bf16 v[160:163], a[92:95], a[128:131], v[160:163]
    buffer_load_dwordx4 a[88:91], v2, s[20:23], s34 offen offset:2048
    v_mfma_f32_16x16x32_bf16 v[164:167], a[92:95], a[132:135], v[164:167]
    v_mul_f32 v21, v21, v107
    v_cvt_pk_bf16_f32 v16, v18, v19
    v_mfma_f32_16x16x32_bf16 v[168:171], a[92:95], a[136:139], v[168:171]
    v_cvt_pk_bf16_f32 v17, v20, v21
    v_mfma_f32_16x16x32_bf16 v[172:175], a[92:95], a[140:143], v[172:175]
    ds_write_b128 v5, v[14:17] offset:6144
    s_waitcnt vmcnt(20)
    v_mfma_f32_16x16x32_bf16 v[176:179], a[96:99], a[128:131], v[176:179]
    buffer_load_dwordx4 a[92:95], v2, s[20:23], s34 offen offset:3072
    v_mfma_f32_16x16x32_bf16 v[180:183], a[96:99], a[132:135], v[180:183]
    v_add_f32 v88, v88, v38
    v_add_f32 v89, v89, v39
    v_mfma_f32_16x16x32_bf16 v[184:187], a[96:99], a[136:139], v[184:187]
    v_add_f32 v90, v90, v40
    v_mfma_f32_16x16x32_bf16 v[188:191], a[96:99], a[140:143], v[188:191]
    v_add_f32 v91, v91, v41
    v_mfma_f32_16x16x32_bf16 v[192:195], a[100:103], a[128:131], v[192:195]
    s_mov_b32 s34, 655360
    v_add_f32 v104, v104, v42
    v_mfma_f32_16x16x32_bf16 v[196:199], a[100:103], a[132:135], v[196:199]
    buffer_load_dwordx4 a[96:99], v2, s[20:23], s34 offen offset:0
    v_mfma_f32_16x16x32_bf16 v[200:203], a[100:103], a[136:139], v[200:203]
    v_add_f32 v105, v105, v43
    v_mfma_f32_16x16x32_bf16 v[204:207], a[100:103], a[140:143], v[204:207]
    v_add_f32 v106, v106, v44
    v_mfma_f32_16x16x32_bf16 v[208:211], a[104:107], a[128:131], v[208:211]
    buffer_load_dwordx4 a[100:103], v2, s[20:23], s34 offen offset:1024
    v_mfma_f32_16x16x32_bf16 v[212:215], a[104:107], a[132:135], v[212:215]
    v_add_f32 v107, v107, v45
    v_accvgpr_read_b32 v22, a172
    v_mfma_f32_16x16x32_bf16 v[216:219], a[104:107], a[136:139], v[216:219]
    v_accvgpr_read_b32 v23, a173
    v_mfma_f32_16x16x32_bf16 v[220:223], a[104:107], a[140:143], v[220:223]
    v_mfma_f32_16x16x32_bf16 v[224:227], a[108:111], a[128:131], v[224:227]
    buffer_load_dwordx4 a[104:107], v2, s[20:23], s34 offen offset:2048
    v_mfma_f32_16x16x32_bf16 v[228:231], a[108:111], a[132:135], v[228:231]
    v_accvgpr_read_b32 v24, a174
    v_accvgpr_read_b32 v25, a175
    v_mfma_f32_16x16x32_bf16 v[232:235], a[108:111], a[136:139], v[232:235]
    v_lshlrev_b32 v26, 16, v22
    v_mfma_f32_16x16x32_bf16 v[236:239], a[108:111], a[140:143], v[236:239]
    v_and_b32 v27, 0xffff0000, v22
    s_waitcnt lgkmcnt(1)
    v_mfma_f32_16x16x32_bf16 v[144:147], a[0:3], a[112:115], v[144:147]
    buffer_load_dwordx4 a[108:111], v2, s[20:23], s34 offen offset:3072
    v_mfma_f32_16x16x32_bf16 v[148:151], a[0:3], a[116:119], v[148:151]
    ds_read_b128 a[128:131], v4 offset:12288
    ds_read_b128 a[132:135], v4 offset:13312
    v_mfma_f32_16x16x32_bf16 v[152:155], a[0:3], a[120:123], v[152:155]
    ds_read_b128 a[136:139], v4 offset:14336
    ds_read_b128 a[140:143], v4 offset:15360
    v_mfma_f32_16x16x32_bf16 v[156:159], a[0:3], a[124:127], v[156:159]
    v_lshlrev_b32 v28, 16, v23
    v_and_b32 v29, 0xffff0000, v23
    v_mfma_f32_16x16x32_bf16 v[160:163], a[4:7], a[112:115], v[160:163]
    s_mov_b32 s34, 659456
    v_mul_f32 v26, v26, v92
    v_mfma_f32_16x16x32_bf16 v[164:167], a[4:7], a[116:119], v[164:167]
    buffer_load_dwordx4 a[0:3], v2, s[20:23], s34 offen offset:0
    v_mfma_f32_16x16x32_bf16 v[168:171], a[4:7], a[120:123], v[168:171]
    v_mul_f32 v27, v27, v93
    v_mul_f32 v28, v28, v94
    v_mfma_f32_16x16x32_bf16 v[172:175], a[4:7], a[124:127], v[172:175]
    v_mul_f32 v29, v29, v95
    v_mfma_f32_16x16x32_bf16 v[176:179], a[8:11], a[112:115], v[176:179]
    buffer_load_dwordx4 a[4:7], v2, s[20:23], s34 offen offset:1024
    v_mfma_f32_16x16x32_bf16 v[180:183], a[8:11], a[116:119], v[180:183]
    v_cvt_pk_bf16_f32 v22, v26, v27
    v_cvt_pk_bf16_f32 v23, v28, v29
    v_mfma_f32_16x16x32_bf16 v[184:187], a[8:11], a[120:123], v[184:187]
    v_lshlrev_b32 v26, 16, v24
    v_mfma_f32_16x16x32_bf16 v[188:191], a[8:11], a[124:127], v[188:191]
    v_and_b32 v27, 0xffff0000, v24
    s_waitcnt vmcnt(20)
    v_mfma_f32_16x16x32_bf16 v[192:195], a[12:15], a[112:115], v[192:195]
    buffer_load_dwordx4 a[8:11], v2, s[20:23], s34 offen offset:2048
    v_mfma_f32_16x16x32_bf16 v[196:199], a[12:15], a[116:119], v[196:199]
    v_lshlrev_b32 v28, 16, v25
    v_mfma_f32_16x16x32_bf16 v[200:203], a[12:15], a[120:123], v[200:203]
    v_and_b32 v29, 0xffff0000, v25
    v_mfma_f32_16x16x32_bf16 v[204:207], a[12:15], a[124:127], v[204:207]
    v_mul_f32 v26, v26, v108
    v_mfma_f32_16x16x32_bf16 v[208:211], a[16:19], a[112:115], v[208:211]
    buffer_load_dwordx4 a[12:15], v2, s[20:23], s34 offen offset:3072
    v_mfma_f32_16x16x32_bf16 v[212:215], a[16:19], a[116:119], v[212:215]
    v_mul_f32 v27, v27, v109
    v_mul_f32 v28, v28, v110
    v_mfma_f32_16x16x32_bf16 v[216:219], a[16:19], a[120:123], v[216:219]
    v_mul_f32 v29, v29, v111
    v_mfma_f32_16x16x32_bf16 v[220:223], a[16:19], a[124:127], v[220:223]
    v_mfma_f32_16x16x32_bf16 v[224:227], a[20:23], a[112:115], v[224:227]
    s_mov_b32 s34, 663552
    v_cvt_pk_bf16_f32 v24, v26, v27
    v_mfma_f32_16x16x32_bf16 v[228:231], a[20:23], a[116:119], v[228:231]
    buffer_load_dwordx4 a[16:19], v2, s[20:23], s34 offen offset:0
    v_mfma_f32_16x16x32_bf16 v[232:235], a[20:23], a[120:123], v[232:235]
    v_cvt_pk_bf16_f32 v25, v28, v29
    v_mfma_f32_16x16x32_bf16 v[236:239], a[20:23], a[124:127], v[236:239]
    ds_write_b128 v5, v[22:25] offset:7168
    s_waitcnt lgkmcnt(1)
    v_mfma_f32_16x16x32_bf16 v[144:147], a[24:27], a[128:131], v[144:147]
    buffer_load_dwordx4 a[20:23], v2, s[20:23], s34 offen offset:1024
    v_mfma_f32_16x16x32_bf16 v[148:151], a[24:27], a[132:135], v[148:151]
    ds_read_b128 a[112:115], v4 offset:16384
    ds_read_b128 a[116:119], v4 offset:17408
    v_mfma_f32_16x16x32_bf16 v[152:155], a[24:27], a[136:139], v[152:155]
    ds_read_b128 a[120:123], v4 offset:18432
    ds_read_b128 a[124:127], v4 offset:19456
    v_mfma_f32_16x16x32_bf16 v[156:159], a[24:27], a[140:143], v[156:159]
    v_add_f32 v92, v92, v38
    v_add_f32 v93, v93, v39
    v_mfma_f32_16x16x32_bf16 v[160:163], a[28:31], a[128:131], v[160:163]
    buffer_load_dwordx4 a[24:27], v2, s[20:23], s34 offen offset:2048
    v_mfma_f32_16x16x32_bf16 v[164:167], a[28:31], a[132:135], v[164:167]
    v_add_f32 v94, v94, v40
    v_add_f32 v95, v95, v41
    v_mfma_f32_16x16x32_bf16 v[168:171], a[28:31], a[136:139], v[168:171]
    v_add_f32 v108, v108, v42
    v_add_f32 v109, v109, v43
    v_mfma_f32_16x16x32_bf16 v[172:175], a[28:31], a[140:143], v[172:175]
    v_add_f32 v110, v110, v44
    v_mfma_f32_16x16x32_bf16 v[176:179], a[32:35], a[128:131], v[176:179]
    buffer_load_dwordx4 a[28:31], v2, s[20:23], s34 offen offset:3072
    v_mfma_f32_16x16x32_bf16 v[180:183], a[32:35], a[132:135], v[180:183]
    v_add_f32 v111, v111, v45
    v_accvgpr_read_b32 v14, a176
    v_mfma_f32_16x16x32_bf16 v[184:187], a[32:35], a[136:139], v[184:187]
    v_accvgpr_read_b32 v15, a177
    v_mfma_f32_16x16x32_bf16 v[188:191], a[32:35], a[140:143], v[188:191]
    v_accvgpr_read_b32 v16, a178
    v_mfma_f32_16x16x32_bf16 v[192:195], a[36:39], a[128:131], v[192:195]
    s_mov_b32 s34, 667648
    v_accvgpr_read_b32 v17, a179
    v_mfma_f32_16x16x32_bf16 v[196:199], a[36:39], a[132:135], v[196:199]
    buffer_load_dwordx4 a[32:35], v2, s[20:23], s34 offen offset:0
    v_mfma_f32_16x16x32_bf16 v[200:203], a[36:39], a[136:139], v[200:203]
    v_lshlrev_b32 v18, 16, v14
    v_mfma_f32_16x16x32_bf16 v[204:207], a[36:39], a[140:143], v[204:207]
    v_and_b32 v19, 0xffff0000, v14
    s_waitcnt vmcnt(20)
    v_mfma_f32_16x16x32_bf16 v[208:211], a[40:43], a[128:131], v[208:211]
    buffer_load_dwordx4 a[36:39], v2, s[20:23], s34 offen offset:1024
    v_mfma_f32_16x16x32_bf16 v[212:215], a[40:43], a[132:135], v[212:215]
    v_lshlrev_b32 v20, 16, v15
    v_and_b32 v21, 0xffff0000, v15
    v_mfma_f32_16x16x32_bf16 v[216:219], a[40:43], a[136:139], v[216:219]
    v_mul_f32 v18, v18, v112
    v_mfma_f32_16x16x32_bf16 v[220:223], a[40:43], a[140:143], v[220:223]
    v_mfma_f32_16x16x32_bf16 v[224:227], a[44:47], a[128:131], v[224:227]
    buffer_load_dwordx4 a[40:43], v2, s[20:23], s34 offen offset:2048
    v_mfma_f32_16x16x32_bf16 v[228:231], a[44:47], a[132:135], v[228:231]
    v_mul_f32 v19, v19, v113
    v_mul_f32 v20, v20, v114
    v_mfma_f32_16x16x32_bf16 v[232:235], a[44:47], a[136:139], v[232:235]
    v_mul_f32 v21, v21, v115
    v_mfma_f32_16x16x32_bf16 v[236:239], a[44:47], a[140:143], v[236:239]
    v_cvt_pk_bf16_f32 v14, v18, v19
    s_waitcnt lgkmcnt(0)
    v_mfma_f32_16x16x32_bf16 v[144:147], a[48:51], a[112:115], v[144:147]
    buffer_load_dwordx4 a[44:47], v2, s[20:23], s34 offen offset:3072
    v_mfma_f32_16x16x32_bf16 v[148:151], a[48:51], a[116:119], v[148:151]
    ds_read_b128 a[128:131], v4 offset:20480
    ds_read_b128 a[132:135], v4 offset:21504
    v_mfma_f32_16x16x32_bf16 v[152:155], a[48:51], a[120:123], v[152:155]
    ds_read_b128 a[136:139], v4 offset:22528
    ds_read_b128 a[140:143], v4 offset:23552
    v_mfma_f32_16x16x32_bf16 v[156:159], a[48:51], a[124:127], v[156:159]
    v_cvt_pk_bf16_f32 v15, v20, v21
    v_lshlrev_b32 v18, 16, v16
    v_mfma_f32_16x16x32_bf16 v[160:163], a[52:55], a[112:115], v[160:163]
    s_mov_b32 s34, 671744
    v_and_b32 v19, 0xffff0000, v16
    v_mfma_f32_16x16x32_bf16 v[164:167], a[52:55], a[116:119], v[164:167]
    buffer_load_dwordx4 a[48:51], v2, s[20:23], s34 offen offset:0
    v_mfma_f32_16x16x32_bf16 v[168:171], a[52:55], a[120:123], v[168:171]
    v_lshlrev_b32 v20, 16, v17
    v_and_b32 v21, 0xffff0000, v17
    v_mfma_f32_16x16x32_bf16 v[172:175], a[52:55], a[124:127], v[172:175]
    v_mul_f32 v18, v18, v128
    v_mfma_f32_16x16x32_bf16 v[176:179], a[56:59], a[112:115], v[176:179]
    buffer_load_dwordx4 a[52:55], v2, s[20:23], s34 offen offset:1024
    v_mfma_f32_16x16x32_bf16 v[180:183], a[56:59], a[116:119], v[180:183]
    v_mul_f32 v19, v19, v129
    v_mul_f32 v20, v20, v130
    v_mfma_f32_16x16x32_bf16 v[184:187], a[56:59], a[120:123], v[184:187]
    v_mul_f32 v21, v21, v131
    v_mfma_f32_16x16x32_bf16 v[188:191], a[56:59], a[124:127], v[188:191]
    v_cvt_pk_bf16_f32 v16, v18, v19
    v_mfma_f32_16x16x32_bf16 v[192:195], a[60:63], a[112:115], v[192:195]
    buffer_load_dwordx4 a[56:59], v2, s[20:23], s34 offen offset:2048
    v_mfma_f32_16x16x32_bf16 v[196:199], a[60:63], a[116:119], v[196:199]
    v_cvt_pk_bf16_f32 v17, v20, v21
    v_mfma_f32_16x16x32_bf16 v[200:203], a[60:63], a[120:123], v[200:203]
    ds_write_b128 v5, v[14:17] offset:8192
    v_mfma_f32_16x16x32_bf16 v[204:207], a[60:63], a[124:127], v[204:207]
    v_add_f32 v112, v112, v30
    v_mfma_f32_16x16x32_bf16 v[208:211], a[64:67], a[112:115], v[208:211]
    buffer_load_dwordx4 a[60:63], v2, s[20:23], s34 offen offset:3072
    v_mfma_f32_16x16x32_bf16 v[212:215], a[64:67], a[116:119], v[212:215]
    v_add_f32 v113, v113, v31
    v_add_f32 v114, v114, v32
    v_mfma_f32_16x16x32_bf16 v[216:219], a[64:67], a[120:123], v[216:219]
    v_mfma_f32_16x16x32_bf16 v[220:223], a[64:67], a[124:127], v[220:223]
    v_add_f32 v115, v115, v33
    s_waitcnt vmcnt(20)
    v_mfma_f32_16x16x32_bf16 v[224:227], a[68:71], a[112:115], v[224:227]
    s_mov_b32 s34, 675840
    v_add_f32 v128, v128, v34
    v_mfma_f32_16x16x32_bf16 v[228:231], a[68:71], a[116:119], v[228:231]
    buffer_load_dwordx4 a[64:67], v2, s[20:23], s34 offen offset:0
    v_mfma_f32_16x16x32_bf16 v[232:235], a[68:71], a[120:123], v[232:235]
    v_add_f32 v129, v129, v35
    v_add_f32 v130, v130, v36
    v_mfma_f32_16x16x32_bf16 v[236:239], a[68:71], a[124:127], v[236:239]
    v_add_f32 v131, v131, v37
    s_waitcnt lgkmcnt(1)
    v_mfma_f32_16x16x32_bf16 v[144:147], a[72:75], a[128:131], v[144:147]
    buffer_load_dwordx4 a[68:71], v2, s[20:23], s34 offen offset:1024
    v_mfma_f32_16x16x32_bf16 v[148:151], a[72:75], a[132:135], v[148:151]
    ds_read_b128 a[112:115], v4 offset:24576
    ds_read_b128 a[116:119], v4 offset:25600
    v_mfma_f32_16x16x32_bf16 v[152:155], a[72:75], a[136:139], v[152:155]
    ds_read_b128 a[120:123], v4 offset:26624
    ds_read_b128 a[124:127], v4 offset:27648
    v_mfma_f32_16x16x32_bf16 v[156:159], a[72:75], a[140:143], v[156:159]
    v_accvgpr_read_b32 v22, a180
    v_accvgpr_read_b32 v23, a181
    v_mfma_f32_16x16x32_bf16 v[160:163], a[76:79], a[128:131], v[160:163]
    buffer_load_dwordx4 a[72:75], v2, s[20:23], s34 offen offset:2048
    v_mfma_f32_16x16x32_bf16 v[164:167], a[76:79], a[132:135], v[164:167]
    v_accvgpr_read_b32 v24, a182
    v_accvgpr_read_b32 v25, a183
    v_mfma_f32_16x16x32_bf16 v[168:171], a[76:79], a[136:139], v[168:171]
    v_lshlrev_b32 v26, 16, v22
    v_mfma_f32_16x16x32_bf16 v[172:175], a[76:79], a[140:143], v[172:175]
    v_and_b32 v27, 0xffff0000, v22
    v_mfma_f32_16x16x32_bf16 v[176:179], a[80:83], a[128:131], v[176:179]
    buffer_load_dwordx4 a[76:79], v2, s[20:23], s34 offen offset:3072
    v_mfma_f32_16x16x32_bf16 v[180:183], a[80:83], a[132:135], v[180:183]
    v_lshlrev_b32 v28, 16, v23
    v_and_b32 v29, 0xffff0000, v23
    v_mfma_f32_16x16x32_bf16 v[184:187], a[80:83], a[136:139], v[184:187]
    v_mul_f32 v26, v26, v116
    v_mfma_f32_16x16x32_bf16 v[188:191], a[80:83], a[140:143], v[188:191]
    v_mul_f32 v27, v27, v117
    v_mfma_f32_16x16x32_bf16 v[192:195], a[84:87], a[128:131], v[192:195]
    s_mov_b32 s34, 679936
    v_mfma_f32_16x16x32_bf16 v[196:199], a[84:87], a[132:135], v[196:199]
    buffer_load_dwordx4 a[80:83], v2, s[20:23], s34 offen offset:0
    v_mfma_f32_16x16x32_bf16 v[200:203], a[84:87], a[136:139], v[200:203]
    v_mul_f32 v28, v28, v118
    v_mul_f32 v29, v29, v119
    v_mfma_f32_16x16x32_bf16 v[204:207], a[84:87], a[140:143], v[204:207]
    v_cvt_pk_bf16_f32 v22, v26, v27
    v_mfma_f32_16x16x32_bf16 v[208:211], a[88:91], a[128:131], v[208:211]
    buffer_load_dwordx4 a[84:87], v2, s[20:23], s34 offen offset:1024
    v_mfma_f32_16x16x32_bf16 v[212:215], a[88:91], a[132:135], v[212:215]
    v_cvt_pk_bf16_f32 v23, v28, v29
    v_lshlrev_b32 v26, 16, v24
    v_mfma_f32_16x16x32_bf16 v[216:219], a[88:91], a[136:139], v[216:219]
    v_mfma_f32_16x16x32_bf16 v[220:223], a[88:91], a[140:143], v[220:223]
    v_and_b32 v27, 0xffff0000, v24
    v_mfma_f32_16x16x32_bf16 v[224:227], a[92:95], a[128:131], v[224:227]
    buffer_load_dwordx4 a[88:91], v2, s[20:23], s34 offen offset:2048
    v_mfma_f32_16x16x32_bf16 v[228:231], a[92:95], a[132:135], v[228:231]
    v_lshlrev_b32 v28, 16, v25
    v_and_b32 v29, 0xffff0000, v25
    v_mfma_f32_16x16x32_bf16 v[232:235], a[92:95], a[136:139], v[232:235]
    v_mul_f32 v26, v26, v132
    v_mfma_f32_16x16x32_bf16 v[236:239], a[92:95], a[140:143], v[236:239]
    v_mul_f32 v27, v27, v133
    s_waitcnt vmcnt(20) lgkmcnt(0)
    v_mfma_f32_16x16x32_bf16 v[144:147], a[96:99], a[112:115], v[144:147]
    buffer_load_dwordx4 a[92:95], v2, s[20:23], s34 offen offset:3072
    v_mfma_f32_16x16x32_bf16 v[148:151], a[96:99], a[116:119], v[148:151]
    ds_read_b128 a[128:131], v4 offset:28672
    ds_read_b128 a[132:135], v4 offset:29696
    v_mfma_f32_16x16x32_bf16 v[152:155], a[96:99], a[120:123], v[152:155]
    ds_read_b128 a[136:139], v4 offset:30720
    ds_read_b128 a[140:143], v4 offset:31744
    v_mfma_f32_16x16x32_bf16 v[156:159], a[96:99], a[124:127], v[156:159]
    v_mul_f32 v28, v28, v134
    v_mul_f32 v29, v29, v135
    v_mfma_f32_16x16x32_bf16 v[160:163], a[100:103], a[112:115], v[160:163]
    s_mov_b32 s34, 684032
    v_cvt_pk_bf16_f32 v24, v26, v27
    v_mfma_f32_16x16x32_bf16 v[164:167], a[100:103], a[116:119], v[164:167]
    buffer_load_dwordx4 a[96:99], v2, s[20:23], s34 offen offset:0
    v_mfma_f32_16x16x32_bf16 v[168:171], a[100:103], a[120:123], v[168:171]
    v_cvt_pk_bf16_f32 v25, v28, v29
    v_mfma_f32_16x16x32_bf16 v[172:175], a[100:103], a[124:127], v[172:175]
    ds_write_b128 v5, v[22:25] offset:9216
    v_mfma_f32_16x16x32_bf16 v[176:179], a[104:107], a[112:115], v[176:179]
    buffer_load_dwordx4 a[100:103], v2, s[20:23], s34 offen offset:1024
    v_mfma_f32_16x16x32_bf16 v[180:183], a[104:107], a[116:119], v[180:183]
    v_add_f32 v116, v116, v30
    v_add_f32 v117, v117, v31
    v_mfma_f32_16x16x32_bf16 v[184:187], a[104:107], a[120:123], v[184:187]
    v_add_f32 v118, v118, v32
    v_add_f32 v119, v119, v33
    v_mfma_f32_16x16x32_bf16 v[188:191], a[104:107], a[124:127], v[188:191]
    v_add_f32 v132, v132, v34
    v_mfma_f32_16x16x32_bf16 v[192:195], a[108:111], a[112:115], v[192:195]
    buffer_load_dwordx4 a[104:107], v2, s[20:23], s34 offen offset:2048
    v_mfma_f32_16x16x32_bf16 v[196:199], a[108:111], a[116:119], v[196:199]
    v_add_f32 v133, v133, v35
    v_mfma_f32_16x16x32_bf16 v[200:203], a[108:111], a[120:123], v[200:203]
    v_add_f32 v134, v134, v36
    v_mfma_f32_16x16x32_bf16 v[204:207], a[108:111], a[124:127], v[204:207]
    v_add_f32 v135, v135, v37
    v_mfma_f32_16x16x32_bf16 v[208:211], a[0:3], a[112:115], v[208:211]
    buffer_load_dwordx4 a[108:111], v2, s[20:23], s34 offen offset:3072
    v_mfma_f32_16x16x32_bf16 v[212:215], a[0:3], a[116:119], v[212:215]
    v_accvgpr_read_b32 v14, a184
    v_accvgpr_read_b32 v15, a185
    v_mfma_f32_16x16x32_bf16 v[216:219], a[0:3], a[120:123], v[216:219]
    v_mfma_f32_16x16x32_bf16 v[220:223], a[0:3], a[124:127], v[220:223]
    v_accvgpr_read_b32 v16, a186
    v_mfma_f32_16x16x32_bf16 v[224:227], a[4:7], a[112:115], v[224:227]
    s_mov_b32 s34, 688128
    v_accvgpr_read_b32 v17, a187
    v_mfma_f32_16x16x32_bf16 v[228:231], a[4:7], a[116:119], v[228:231]
    buffer_load_dwordx4 a[0:3], v2, s[20:23], s34 offen offset:0
    v_mfma_f32_16x16x32_bf16 v[232:235], a[4:7], a[120:123], v[232:235]
    v_lshlrev_b32 v18, 16, v14
    v_and_b32 v19, 0xffff0000, v14
    v_mfma_f32_16x16x32_bf16 v[236:239], a[4:7], a[124:127], v[236:239]
    v_lshlrev_b32 v20, 16, v15
    s_waitcnt lgkmcnt(1)
    v_mfma_f32_16x16x32_bf16 v[144:147], a[8:11], a[128:131], v[144:147]
    buffer_load_dwordx4 a[4:7], v2, s[20:23], s34 offen offset:1024
    v_mfma_f32_16x16x32_bf16 v[148:151], a[8:11], a[132:135], v[148:151]
    ds_read_b128 a[112:115], v4 offset:32768
    ds_read_b128 a[116:119], v4 offset:33792
    v_mfma_f32_16x16x32_bf16 v[152:155], a[8:11], a[136:139], v[152:155]
    ds_read_b128 a[120:123], v4 offset:34816
    ds_read_b128 a[124:127], v4 offset:35840
    v_mfma_f32_16x16x32_bf16 v[156:159], a[8:11], a[140:143], v[156:159]
    v_and_b32 v21, 0xffff0000, v15
    v_mul_f32 v18, v18, v120
    s_waitcnt vmcnt(20)
    v_mfma_f32_16x16x32_bf16 v[160:163], a[12:15], a[128:131], v[160:163]
    buffer_load_dwordx4 a[8:11], v2, s[20:23], s34 offen offset:2048
    v_mfma_f32_16x16x32_bf16 v[164:167], a[12:15], a[132:135], v[164:167]
    v_mul_f32 v19, v19, v121
    v_mul_f32 v20, v20, v122
    v_mfma_f32_16x16x32_bf16 v[168:171], a[12:15], a[136:139], v[168:171]
    v_mul_f32 v21, v21, v123
    v_mfma_f32_16x16x32_bf16 v[172:175], a[12:15], a[140:143], v[172:175]
    v_cvt_pk_bf16_f32 v14, v18, v19
    v_mfma_f32_16x16x32_bf16 v[176:179], a[16:19], a[128:131], v[176:179]
    buffer_load_dwordx4 a[12:15], v2, s[20:23], s34 offen offset:3072
    v_mfma_f32_16x16x32_bf16 v[180:183], a[16:19], a[132:135], v[180:183]
    v_cvt_pk_bf16_f32 v15, v20, v21
    v_lshlrev_b32 v18, 16, v16
    v_mfma_f32_16x16x32_bf16 v[184:187], a[16:19], a[136:139], v[184:187]
    v_and_b32 v19, 0xffff0000, v16
    v_mfma_f32_16x16x32_bf16 v[188:191], a[16:19], a[140:143], v[188:191]
    v_lshlrev_b32 v20, 16, v17
    v_mfma_f32_16x16x32_bf16 v[192:195], a[20:23], a[128:131], v[192:195]
    s_mov_b32 s34, 692224
    v_mfma_f32_16x16x32_bf16 v[196:199], a[20:23], a[132:135], v[196:199]
    buffer_load_dwordx4 a[16:19], v2, s[20:23], s34 offen offset:0
    v_mfma_f32_16x16x32_bf16 v[200:203], a[20:23], a[136:139], v[200:203]
    v_and_b32 v21, 0xffff0000, v17
    v_mul_f32 v18, v18, v136
    v_mfma_f32_16x16x32_bf16 v[204:207], a[20:23], a[140:143], v[204:207]
    v_mul_f32 v19, v19, v137
    v_mfma_f32_16x16x32_bf16 v[208:211], a[24:27], a[128:131], v[208:211]
    buffer_load_dwordx4 a[20:23], v2, s[20:23], s34 offen offset:1024
    v_mfma_f32_16x16x32_bf16 v[212:215], a[24:27], a[132:135], v[212:215]
    v_mul_f32 v20, v20, v138
    v_mul_f32 v21, v21, v139
    v_mfma_f32_16x16x32_bf16 v[216:219], a[24:27], a[136:139], v[216:219]
    v_mfma_f32_16x16x32_bf16 v[220:223], a[24:27], a[140:143], v[220:223]
    v_cvt_pk_bf16_f32 v16, v18, v19
    v_mfma_f32_16x16x32_bf16 v[224:227], a[28:31], a[128:131], v[224:227]
    buffer_load_dwordx4 a[24:27], v2, s[20:23], s34 offen offset:2048
    v_mfma_f32_16x16x32_bf16 v[228:231], a[28:31], a[132:135], v[228:231]
    v_cvt_pk_bf16_f32 v17, v20, v21
    v_mfma_f32_16x16x32_bf16 v[232:235], a[28:31], a[136:139], v[232:235]
    ds_write_b128 v5, v[14:17] offset:10240
    v_mfma_f32_16x16x32_bf16 v[236:239], a[28:31], a[140:143], v[236:239]
    v_add_f32 v120, v120, v30
    v_add_f32 v121, v121, v31
    s_waitcnt lgkmcnt(1)
    v_mfma_f32_16x16x32_bf16 v[144:147], a[32:35], a[112:115], v[144:147]
    buffer_load_dwordx4 a[28:31], v2, s[20:23], s34 offen offset:3072
    v_mfma_f32_16x16x32_bf16 v[148:151], a[32:35], a[116:119], v[148:151]
    ds_read_b128 a[128:131], v4 offset:36864
    ds_read_b128 a[132:135], v4 offset:37888
    v_mfma_f32_16x16x32_bf16 v[152:155], a[32:35], a[120:123], v[152:155]
    ds_read_b128 a[136:139], v4 offset:38912
    ds_read_b128 a[140:143], v4 offset:39936
    v_mfma_f32_16x16x32_bf16 v[156:159], a[32:35], a[124:127], v[156:159]
    v_add_f32 v122, v122, v32
    v_add_f32 v123, v123, v33
    v_mfma_f32_16x16x32_bf16 v[160:163], a[36:39], a[112:115], v[160:163]
    s_mov_b32 s34, 696320
    v_add_f32 v136, v136, v34
    v_mfma_f32_16x16x32_bf16 v[164:167], a[36:39], a[116:119], v[164:167]
    buffer_load_dwordx4 a[32:35], v2, s[20:23], s34 offen offset:0
    v_mfma_f32_16x16x32_bf16 v[168:171], a[36:39], a[120:123], v[168:171]
    v_add_f32 v137, v137, v35
    v_add_f32 v138, v138, v36
    v_mfma_f32_16x16x32_bf16 v[172:175], a[36:39], a[124:127], v[172:175]
    v_add_f32 v139, v139, v37
    s_waitcnt vmcnt(20)
    v_mfma_f32_16x16x32_bf16 v[176:179], a[40:43], a[112:115], v[176:179]
    buffer_load_dwordx4 a[36:39], v2, s[20:23], s34 offen offset:1024
    v_mfma_f32_16x16x32_bf16 v[180:183], a[40:43], a[116:119], v[180:183]
    v_accvgpr_read_b32 v22, a188
    v_accvgpr_read_b32 v23, a189
    v_mfma_f32_16x16x32_bf16 v[184:187], a[40:43], a[120:123], v[184:187]
    v_accvgpr_read_b32 v24, a190
    v_mfma_f32_16x16x32_bf16 v[188:191], a[40:43], a[124:127], v[188:191]
    v_accvgpr_read_b32 v25, a191
    v_mfma_f32_16x16x32_bf16 v[192:195], a[44:47], a[112:115], v[192:195]
    buffer_load_dwordx4 a[40:43], v2, s[20:23], s34 offen offset:2048
    v_mfma_f32_16x16x32_bf16 v[196:199], a[44:47], a[116:119], v[196:199]
    v_lshlrev_b32 v26, 16, v22
    v_mfma_f32_16x16x32_bf16 v[200:203], a[44:47], a[120:123], v[200:203]
    v_and_b32 v27, 0xffff0000, v22
    v_mfma_f32_16x16x32_bf16 v[204:207], a[44:47], a[124:127], v[204:207]
    v_lshlrev_b32 v28, 16, v23
    v_mfma_f32_16x16x32_bf16 v[208:211], a[48:51], a[112:115], v[208:211]
    buffer_load_dwordx4 a[44:47], v2, s[20:23], s34 offen offset:3072
    v_mfma_f32_16x16x32_bf16 v[212:215], a[48:51], a[116:119], v[212:215]
    v_and_b32 v29, 0xffff0000, v23
    v_mul_f32 v26, v26, v124
    v_mfma_f32_16x16x32_bf16 v[216:219], a[48:51], a[120:123], v[216:219]
    v_mfma_f32_16x16x32_bf16 v[220:223], a[48:51], a[124:127], v[220:223]
    v_mul_f32 v27, v27, v125
    v_mfma_f32_16x16x32_bf16 v[224:227], a[52:55], a[112:115], v[224:227]
    s_mov_b32 s34, 700416
    v_mul_f32 v28, v28, v126
    v_mfma_f32_16x16x32_bf16 v[228:231], a[52:55], a[116:119], v[228:231]
    buffer_load_dwordx4 a[48:51], v2, s[20:23], s34 offen offset:0
    v_mfma_f32_16x16x32_bf16 v[232:235], a[52:55], a[120:123], v[232:235]
    v_mul_f32 v29, v29, v127
    v_cvt_pk_bf16_f32 v22, v26, v27
    v_mfma_f32_16x16x32_bf16 v[236:239], a[52:55], a[124:127], v[236:239]
    v_cvt_pk_bf16_f32 v23, v28, v29
    s_waitcnt lgkmcnt(0)
    v_mfma_f32_16x16x32_bf16 v[144:147], a[56:59], a[128:131], v[144:147]
    buffer_load_dwordx4 a[52:55], v2, s[20:23], s34 offen offset:1024
    v_mfma_f32_16x16x32_bf16 v[148:151], a[56:59], a[132:135], v[148:151]
    ds_read_b128 a[112:115], v4 offset:40960
    ds_read_b128 a[116:119], v4 offset:41984
    v_mfma_f32_16x16x32_bf16 v[152:155], a[56:59], a[136:139], v[152:155]
    ds_read_b128 a[120:123], v4 offset:43008
    ds_read_b128 a[124:127], v4 offset:44032
    v_mfma_f32_16x16x32_bf16 v[156:159], a[56:59], a[140:143], v[156:159]
    v_lshlrev_b32 v26, 16, v24
    v_and_b32 v27, 0xffff0000, v24
    v_mfma_f32_16x16x32_bf16 v[160:163], a[60:63], a[128:131], v[160:163]
    buffer_load_dwordx4 a[56:59], v2, s[20:23], s34 offen offset:2048
    v_mfma_f32_16x16x32_bf16 v[164:167], a[60:63], a[132:135], v[164:167]
    v_lshlrev_b32 v28, 16, v25
    v_and_b32 v29, 0xffff0000, v25
    v_mfma_f32_16x16x32_bf16 v[168:171], a[60:63], a[136:139], v[168:171]
    v_mul_f32 v26, v26, v140
    v_mfma_f32_16x16x32_bf16 v[172:175], a[60:63], a[140:143], v[172:175]
    v_mul_f32 v27, v27, v141
    v_mfma_f32_16x16x32_bf16 v[176:179], a[64:67], a[128:131], v[176:179]
    buffer_load_dwordx4 a[60:63], v2, s[20:23], s34 offen offset:3072
    v_mfma_f32_16x16x32_bf16 v[180:183], a[64:67], a[132:135], v[180:183]
    v_mul_f32 v28, v28, v142
    v_mul_f32 v29, v29, v143
    v_mfma_f32_16x16x32_bf16 v[184:187], a[64:67], a[136:139], v[184:187]
    v_cvt_pk_bf16_f32 v24, v26, v27
    v_mfma_f32_16x16x32_bf16 v[188:191], a[64:67], a[140:143], v[188:191]
    v_cvt_pk_bf16_f32 v25, v28, v29
    s_waitcnt vmcnt(20)
    v_mfma_f32_16x16x32_bf16 v[192:195], a[68:71], a[128:131], v[192:195]
    s_mov_b32 s34, 704512
    v_mfma_f32_16x16x32_bf16 v[196:199], a[68:71], a[132:135], v[196:199]
    buffer_load_dwordx4 a[64:67], v2, s[20:23], s34 offen offset:0
    v_mfma_f32_16x16x32_bf16 v[200:203], a[68:71], a[136:139], v[200:203]
    ds_write_b128 v5, v[22:25] offset:11264
    v_mfma_f32_16x16x32_bf16 v[204:207], a[68:71], a[140:143], v[204:207]
    v_add_f32 v124, v124, v30
    v_add_f32 v125, v125, v31
    v_mfma_f32_16x16x32_bf16 v[208:211], a[72:75], a[128:131], v[208:211]
    buffer_load_dwordx4 a[68:71], v2, s[20:23], s34 offen offset:1024
    v_mfma_f32_16x16x32_bf16 v[212:215], a[72:75], a[132:135], v[212:215]
    v_add_f32 v126, v126, v32
    v_add_f32 v127, v127, v33
    v_mfma_f32_16x16x32_bf16 v[216:219], a[72:75], a[136:139], v[216:219]
    buffer_load_dwordx4 v[38:41], v12, s[24:27], 0 offen offset:2048
    v_mfma_f32_16x16x32_bf16 v[220:223], a[72:75], a[140:143], v[220:223]
    v_add_f32 v140, v140, v34
    v_mfma_f32_16x16x32_bf16 v[224:227], a[76:79], a[128:131], v[224:227]
    buffer_load_dwordx4 a[72:75], v2, s[20:23], s34 offen offset:2048
    v_mfma_f32_16x16x32_bf16 v[228:231], a[76:79], a[132:135], v[228:231]
    v_add_f32 v141, v141, v35
    v_add_f32 v142, v142, v36
    v_mfma_f32_16x16x32_bf16 v[232:235], a[76:79], a[136:139], v[232:235]
    v_add_f32 v143, v143, v37
    v_mfma_f32_16x16x32_bf16 v[236:239], a[76:79], a[140:143], v[236:239]
    buffer_load_dwordx4 v[42:45], v12, s[24:27], 0 offen offset:2112
    s_waitcnt lgkmcnt(1)
    v_mfma_f32_16x16x32_bf16 v[144:147], a[80:83], a[112:115], v[144:147]
    buffer_load_dwordx4 a[76:79], v2, s[20:23], s34 offen offset:3072
    v_mfma_f32_16x16x32_bf16 v[148:151], a[80:83], a[116:119], v[148:151]
    ds_read_b128 a[128:131], v4 offset:45056
    ds_read_b128 a[132:135], v4 offset:46080
    v_mfma_f32_16x16x32_bf16 v[152:155], a[80:83], a[120:123], v[152:155]
    ds_read_b128 a[136:139], v4 offset:47104
    ds_read_b128 a[140:143], v4 offset:48128
    v_mfma_f32_16x16x32_bf16 v[156:159], a[80:83], a[124:127], v[156:159]
    v_mfma_f32_16x16x32_bf16 v[160:163], a[84:87], a[112:115], v[160:163]
    s_mov_b32 s34, 708608
    v_mfma_f32_16x16x32_bf16 v[164:167], a[84:87], a[116:119], v[164:167]
    buffer_load_dwordx4 a[80:83], v2, s[20:23], s34 offen offset:0
    v_mfma_f32_16x16x32_bf16 v[168:171], a[84:87], a[120:123], v[168:171]
    v_mfma_f32_16x16x32_bf16 v[172:175], a[84:87], a[124:127], v[172:175]
    v_mfma_f32_16x16x32_bf16 v[176:179], a[88:91], a[112:115], v[176:179]
    buffer_load_dwordx4 a[84:87], v2, s[20:23], s34 offen offset:1024
    v_mfma_f32_16x16x32_bf16 v[180:183], a[88:91], a[116:119], v[180:183]
    v_mfma_f32_16x16x32_bf16 v[184:187], a[88:91], a[120:123], v[184:187]
    v_mfma_f32_16x16x32_bf16 v[188:191], a[88:91], a[124:127], v[188:191]
    v_mfma_f32_16x16x32_bf16 v[192:195], a[92:95], a[112:115], v[192:195]
    buffer_load_dwordx4 a[88:91], v2, s[20:23], s34 offen offset:2048
    v_mfma_f32_16x16x32_bf16 v[196:199], a[92:95], a[116:119], v[196:199]
    v_mfma_f32_16x16x32_bf16 v[200:203], a[92:95], a[120:123], v[200:203]
    v_mfma_f32_16x16x32_bf16 v[204:207], a[92:95], a[124:127], v[204:207]
    s_waitcnt vmcnt(22)
    v_mfma_f32_16x16x32_bf16 v[208:211], a[96:99], a[112:115], v[208:211]
    buffer_load_dwordx4 a[92:95], v2, s[20:23], s34 offen offset:3072
    v_mfma_f32_16x16x32_bf16 v[212:215], a[96:99], a[116:119], v[212:215]
    v_mfma_f32_16x16x32_bf16 v[216:219], a[96:99], a[120:123], v[216:219]
    v_mfma_f32_16x16x32_bf16 v[220:223], a[96:99], a[124:127], v[220:223]
    v_mfma_f32_16x16x32_bf16 v[224:227], a[100:103], a[112:115], v[224:227]
    s_mov_b32 s34, 712704
    v_mfma_f32_16x16x32_bf16 v[228:231], a[100:103], a[116:119], v[228:231]
    buffer_load_dwordx4 a[96:99], v2, s[20:23], s34 offen offset:0
    v_mfma_f32_16x16x32_bf16 v[232:235], a[100:103], a[120:123], v[232:235]
    v_mfma_f32_16x16x32_bf16 v[236:239], a[100:103], a[124:127], v[236:239]
    s_waitcnt lgkmcnt(0)
    s_barrier
    v_mfma_f32_16x16x32_bf16 v[144:147], a[104:107], a[128:131], v[144:147]
    buffer_load_dwordx4 a[100:103], v2, s[20:23], s34 offen offset:1024
    v_mfma_f32_16x16x32_bf16 v[148:151], a[104:107], a[132:135], v[148:151]
    ds_read_b128 a[112:115], v2 offset:0
    ds_read_b128 a[116:119], v2 offset:1024
    v_mfma_f32_16x16x32_bf16 v[152:155], a[104:107], a[136:139], v[152:155]
    ds_read_b128 a[120:123], v2 offset:2048
    ds_read_b128 a[124:127], v2 offset:3072
    v_mfma_f32_16x16x32_bf16 v[156:159], a[104:107], a[140:143], v[156:159]
    v_mfma_f32_16x16x32_bf16 v[160:163], a[108:111], a[128:131], v[160:163]
    buffer_load_dwordx4 a[104:107], v2, s[20:23], s34 offen offset:2048
    v_mfma_f32_16x16x32_bf16 v[164:167], a[108:111], a[132:135], v[164:167]
    v_mfma_f32_16x16x32_bf16 v[168:171], a[108:111], a[136:139], v[168:171]
    v_mfma_f32_16x16x32_bf16 v[172:175], a[108:111], a[140:143], v[172:175]
    v_mfma_f32_16x16x32_bf16 v[176:179], a[0:3], a[128:131], v[176:179]
    buffer_load_dwordx4 a[108:111], v2, s[20:23], s34 offen offset:3072
    v_mfma_f32_16x16x32_bf16 v[180:183], a[0:3], a[132:135], v[180:183]
    v_mfma_f32_16x16x32_bf16 v[184:187], a[0:3], a[136:139], v[184:187]
    v_mfma_f32_16x16x32_bf16 v[188:191], a[0:3], a[140:143], v[188:191]
    v_mfma_f32_16x16x32_bf16 v[192:195], a[4:7], a[128:131], v[192:195]
    s_mov_b32 s34, 716800
    v_mfma_f32_16x16x32_bf16 v[196:199], a[4:7], a[132:135], v[196:199]
    buffer_load_dwordx4 a[0:3], v2, s[20:23], s34 offen offset:0
    v_mfma_f32_16x16x32_bf16 v[200:203], a[4:7], a[136:139], v[200:203]
    v_mfma_f32_16x16x32_bf16 v[204:207], a[4:7], a[140:143], v[204:207]
    v_mfma_f32_16x16x32_bf16 v[208:211], a[8:11], a[128:131], v[208:211]
    buffer_load_dwordx4 a[4:7], v2, s[20:23], s34 offen offset:1024
    v_mfma_f32_16x16x32_bf16 v[212:215], a[8:11], a[132:135], v[212:215]
    v_mfma_f32_16x16x32_bf16 v[216:219], a[8:11], a[136:139], v[216:219]
    v_mfma_f32_16x16x32_bf16 v[220:223], a[8:11], a[140:143], v[220:223]
    s_waitcnt vmcnt(22)
    v_mfma_f32_16x16x32_bf16 v[224:227], a[12:15], a[128:131], v[224:227]
    buffer_load_dwordx4 a[8:11], v2, s[20:23], s34 offen offset:2048
    v_mfma_f32_16x16x32_bf16 v[228:231], a[12:15], a[132:135], v[228:231]
    v_mfma_f32_16x16x32_bf16 v[232:235], a[12:15], a[136:139], v[232:235]
    v_mfma_f32_16x16x32_bf16 v[236:239], a[12:15], a[140:143], v[236:239]
    s_waitcnt lgkmcnt(0)
    v_mfma_f32_16x16x32_bf16 v[240:243], a[16:19], a[112:115], v[240:243]
    buffer_load_dwordx4 a[12:15], v2, s[20:23], s34 offen offset:3072
    v_mfma_f32_16x16x32_bf16 v[244:247], a[16:19], a[116:119], v[244:247]
    ds_read_b128 a[128:131], v2 offset:4096
    ds_read_b128 a[132:135], v2 offset:5120
    v_mfma_f32_16x16x32_bf16 v[248:251], a[16:19], a[120:123], v[248:251]
    ds_read_b128 a[136:139], v2 offset:6144
    ds_read_b128 a[140:143], v2 offset:7168
    v_mfma_f32_16x16x32_bf16 v[252:255], a[16:19], a[124:127], v[252:255]
    v_mfma_f32_16x16x32_bf16 v[48:51], a[20:23], a[112:115], v[48:51]
    s_mov_b32 s34, 720896
    v_mfma_f32_16x16x32_bf16 v[52:55], a[20:23], a[116:119], v[52:55]
    buffer_load_dwordx4 a[16:19], v2, s[20:23], s34 offen offset:0
    v_mfma_f32_16x16x32_bf16 v[56:59], a[20:23], a[120:123], v[56:59]
    v_mfma_f32_16x16x32_bf16 v[60:63], a[20:23], a[124:127], v[60:63]
    v_mfma_f32_16x16x32_bf16 v[64:67], a[24:27], a[112:115], v[64:67]
    buffer_load_dwordx4 a[20:23], v2, s[20:23], s34 offen offset:1024
    v_mfma_f32_16x16x32_bf16 v[68:71], a[24:27], a[116:119], v[68:71]
    v_mfma_f32_16x16x32_bf16 v[72:75], a[24:27], a[120:123], v[72:75]
    buffer_load_dwordx4 v[30:33], v12, s[24:27], 0 offen offset:2176
    v_mfma_f32_16x16x32_bf16 v[76:79], a[24:27], a[124:127], v[76:79]
    buffer_load_dwordx4 v[34:37], v12, s[24:27], 0 offen offset:2240
    v_mfma_f32_16x16x32_bf16 v[80:83], a[28:31], a[112:115], v[80:83]
    buffer_load_dwordx4 a[24:27], v2, s[20:23], s34 offen offset:2048
    v_mfma_f32_16x16x32_bf16 v[84:87], a[28:31], a[116:119], v[84:87]
    v_accvgpr_read_b32 v14, a192
    v_accvgpr_read_b32 v15, a193
    v_mfma_f32_16x16x32_bf16 v[88:91], a[28:31], a[120:123], v[88:91]
    v_accvgpr_read_b32 v16, a194
    v_accvgpr_read_b32 v17, a195
    v_mfma_f32_16x16x32_bf16 v[92:95], a[28:31], a[124:127], v[92:95]
    v_lshlrev_b32 v18, 16, v14
    v_and_b32 v19, 0xffff0000, v14
    v_mfma_f32_16x16x32_bf16 v[96:99], a[32:35], a[112:115], v[96:99]
    buffer_load_dwordx4 a[28:31], v2, s[20:23], s34 offen offset:3072
    v_mfma_f32_16x16x32_bf16 v[100:103], a[32:35], a[116:119], v[100:103]
    v_lshlrev_b32 v20, 16, v15
    v_and_b32 v21, 0xffff0000, v15
    v_mfma_f32_16x16x32_bf16 v[104:107], a[32:35], a[120:123], v[104:107]
    v_mul_f32 v18, v18, v144
    v_mul_f32 v19, v19, v145
    v_mfma_f32_16x16x32_bf16 v[108:111], a[32:35], a[124:127], v[108:111]
    v_mul_f32 v20, v20, v146
    v_mfma_f32_16x16x32_bf16 v[112:115], a[36:39], a[112:115], v[112:115]
    s_mov_b32 s34, 724992
    v_mul_f32 v21, v21, v147
    v_mfma_f32_16x16x32_bf16 v[116:119], a[36:39], a[116:119], v[116:119]
    buffer_load_dwordx4 a[32:35], v2, s[20:23], s34 offen offset:0
    v_mfma_f32_16x16x32_bf16 v[120:123], a[36:39], a[120:123], v[120:123]
    v_cvt_pk_bf16_f32 v14, v18, v19
    v_cvt_pk_bf16_f32 v15, v20, v21
    v_mfma_f32_16x16x32_bf16 v[124:127], a[36:39], a[124:127], v[124:127]
    v_lshlrev_b32 v18, 16, v16
    v_and_b32 v19, 0xffff0000, v16
    s_waitcnt vmcnt(24)
    v_mfma_f32_16x16x32_bf16 v[128:131], a[40:43], a[112:115], v[128:131]
    buffer_load_dwordx4 a[36:39], v2, s[20:23], s34 offen offset:1024
    v_mfma_f32_16x16x32_bf16 v[132:135], a[40:43], a[116:119], v[132:135]
    v_lshlrev_b32 v20, 16, v17
    v_and_b32 v21, 0xffff0000, v17
    v_mfma_f32_16x16x32_bf16 v[136:139], a[40:43], a[120:123], v[136:139]
    v_mul_f32 v18, v18, v160
    v_mfma_f32_16x16x32_bf16 v[140:143], a[40:43], a[124:127], v[140:143]
    v_mul_f32 v19, v19, v161
    v_mul_f32 v20, v20, v162
    s_waitcnt lgkmcnt(0)
    v_mfma_f32_16x16x32_bf16 v[240:243], a[44:47], a[128:131], v[240:243]
    buffer_load_dwordx4 a[40:43], v2, s[20:23], s34 offen offset:2048
    v_mfma_f32_16x16x32_bf16 v[244:247], a[44:47], a[132:135], v[244:247]
    ds_read_b128 a[112:115], v2 offset:8192
    ds_read_b128 a[116:119], v2 offset:9216
    v_mfma_f32_16x16x32_bf16 v[248:251], a[44:47], a[136:139], v[248:251]
    ds_read_b128 a[120:123], v2 offset:10240
    ds_read_b128 a[124:127], v2 offset:11264
    v_mfma_f32_16x16x32_bf16 v[252:255], a[44:47], a[140:143], v[252:255]
    v_mul_f32 v21, v21, v163
    v_cvt_pk_bf16_f32 v16, v18, v19
    v_mfma_f32_16x16x32_bf16 v[48:51], a[48:51], a[128:131], v[48:51]
    buffer_load_dwordx4 a[44:47], v2, s[20:23], s34 offen offset:3072
    v_mfma_f32_16x16x32_bf16 v[52:55], a[48:51], a[132:135], v[52:55]
    v_cvt_pk_bf16_f32 v17, v20, v21
    v_mfma_f32_16x16x32_bf16 v[56:59], a[48:51], a[136:139], v[56:59]
    ds_write_b128 v9, v[14:17] offset:0
    v_mfma_f32_16x16x32_bf16 v[60:63], a[48:51], a[140:143], v[60:63]
    s_waitcnt vmcnt(24)
    v_add_f32 v144, v144, v38
    v_add_f32 v145, v145, v39
    v_mfma_f32_16x16x32_bf16 v[64:67], a[52:55], a[128:131], v[64:67]
    s_mov_b32 s34, 729088
    v_add_f32 v146, v146, v40
    v_mfma_f32_16x16x32_bf16 v[68:71], a[52:55], a[132:135], v[68:71]
    buffer_load_dwordx4 a[48:51], v2, s[20:23], s34 offen offset:0
    v_mfma_f32_16x16x32_bf16 v[72:75], a[52:55], a[136:139], v[72:75]
    v_add_f32 v147, v147, v41
    s_waitcnt vmcnt(19)
    v_add_f32 v160, v160, v42
    v_mfma_f32_16x16x32_bf16 v[76:79], a[52:55], a[140:143], v[76:79]
    v_add_f32 v161, v161, v43
    v_add_f32 v162, v162, v44
    v_mfma_f32_16x16x32_bf16 v[80:83], a[56:59], a[128:131], v[80:83]
    buffer_load_dwordx4 a[52:55], v2, s[20:23], s34 offen offset:1024
    v_mfma_f32_16x16x32_bf16 v[84:87], a[56:59], a[132:135], v[84:87]
    v_add_f32 v163, v163, v45
    v_accvgpr_read_b32 v22, a196
    v_mfma_f32_16x16x32_bf16 v[88:91], a[56:59], a[136:139], v[88:91]
    v_accvgpr_read_b32 v23, a197
    v_accvgpr_read_b32 v24, a198
    v_mfma_f32_16x16x32_bf16 v[92:95], a[56:59], a[140:143], v[92:95]
    v_accvgpr_read_b32 v25, a199
    v_lshlrev_b32 v26, 16, v22
    v_mfma_f32_16x16x32_bf16 v[96:99], a[60:63], a[128:131], v[96:99]
    buffer_load_dwordx4 a[56:59], v2, s[20:23], s34 offen offset:2048
    v_mfma_f32_16x16x32_bf16 v[100:103], a[60:63], a[132:135], v[100:103]
    v_and_b32 v27, 0xffff0000, v22
    v_lshlrev_b32 v28, 16, v23
    v_mfma_f32_16x16x32_bf16 v[104:107], a[60:63], a[136:139], v[104:107]
    v_and_b32 v29, 0xffff0000, v23
    v_mul_f32 v26, v26, v148
    v_mfma_f32_16x16x32_bf16 v[108:111], a[60:63], a[140:143], v[108:111]
    v_mul_f32 v27, v27, v149
    v_mul_f32 v28, v28, v150
    v_mfma_f32_16x16x32_bf16 v[112:115], a[64:67], a[128:131], v[112:115]
    buffer_load_dwordx4 a[60:63], v2, s[20:23], s34 offen offset:3072
    v_mfma_f32_16x16x32_bf16 v[116:119], a[64:67], a[132:135], v[116:119]
    v_mul_f32 v29, v29, v151
    v_cvt_pk_bf16_f32 v22, v26, v27
    v_mfma_f32_16x16x32_bf16 v[120:123], a[64:67], a[136:139], v[120:123]
    v_cvt_pk_bf16_f32 v23, v28, v29
    v_lshlrev_b32 v26, 16, v24
    v_mfma_f32_16x16x32_bf16 v[124:127], a[64:67], a[140:143], v[124:127]
    v_and_b32 v27, 0xffff0000, v24
    v_lshlrev_b32 v28, 16, v25
    v_mfma_f32_16x16x32_bf16 v[128:131], a[68:71], a[128:131], v[128:131]
    s_mov_b32 s34, 733184
    v_and_b32 v29, 0xffff0000, v25
    v_mfma_f32_16x16x32_bf16 v[132:135], a[68:71], a[132:135], v[132:135]
    buffer_load_dwordx4 a[64:67], v2, s[20:23], s34 offen offset:0
    v_mfma_f32_16x16x32_bf16 v[136:139], a[68:71], a[136:139], v[136:139]
    v_mul_f32 v26, v26, v164
    v_mul_f32 v27, v27, v165
    v_mfma_f32_16x16x32_bf16 v[140:143], a[68:71], a[140:143], v[140:143]
    v_mul_f32 v28, v28, v166
    v_mul_f32 v29, v29, v167
    s_waitcnt lgkmcnt(1)
    v_mfma_f32_16x16x32_bf16 v[240:243], a[72:75], a[112:115], v[240:243]
    buffer_load_dwordx4 a[68:71], v2, s[20:23], s34 offen offset:1024
    v_mfma_f32_16x16x32_bf16 v[244:247], a[72:75], a[116:119], v[244:247]
    ds_read_b128 a[128:131], v2 offset:12288
    ds_read_b128 a[132:135], v2 offset:13312
    v_mfma_f32_16x16x32_bf16 v[248:251], a[72:75], a[120:123], v[248:251]
    ds_read_b128 a[136:139], v2 offset:14336
    ds_read_b128 a[140:143], v2 offset:15360
    v_mfma_f32_16x16x32_bf16 v[252:255], a[72:75], a[124:127], v[252:255]
    v_cvt_pk_bf16_f32 v24, v26, v27
    v_cvt_pk_bf16_f32 v25, v28, v29
    v_mfma_f32_16x16x32_bf16 v[48:51], a[76:79], a[112:115], v[48:51]
    buffer_load_dwordx4 a[72:75], v2, s[20:23], s34 offen offset:2048
    v_mfma_f32_16x16x32_bf16 v[52:55], a[76:79], a[116:119], v[52:55]
    ds_write_b128 v9, v[22:25] offset:1024
    v_mfma_f32_16x16x32_bf16 v[56:59], a[76:79], a[120:123], v[56:59]
    v_add_f32 v148, v148, v38
    v_add_f32 v149, v149, v39
    v_mfma_f32_16x16x32_bf16 v[60:63], a[76:79], a[124:127], v[60:63]
    v_add_f32 v150, v150, v40
    v_add_f32 v151, v151, v41
    v_mfma_f32_16x16x32_bf16 v[64:67], a[80:83], a[112:115], v[64:67]
    buffer_load_dwordx4 a[76:79], v2, s[20:23], s34 offen offset:3072
    v_mfma_f32_16x16x32_bf16 v[68:71], a[80:83], a[116:119], v[68:71]
    v_add_f32 v164, v164, v42
    v_add_f32 v165, v165, v43
    v_mfma_f32_16x16x32_bf16 v[72:75], a[80:83], a[120:123], v[72:75]
    v_add_f32 v166, v166, v44
    v_add_f32 v167, v167, v45
    v_mfma_f32_16x16x32_bf16 v[76:79], a[80:83], a[124:127], v[76:79]
    v_accvgpr_read_b32 v14, a200
    v_accvgpr_read_b32 v15, a201
    v_mfma_f32_16x16x32_bf16 v[80:83], a[84:87], a[112:115], v[80:83]
    s_mov_b32 s34, 737280
    v_accvgpr_read_b32 v16, a202
    v_mfma_f32_16x16x32_bf16 v[84:87], a[84:87], a[116:119], v[84:87]
    buffer_load_dwordx4 a[80:83], v2, s[20:23], s34 offen offset:0
    v_mfma_f32_16x16x32_bf16 v[88:91], a[84:87], a[120:123], v[88:91]
    v_accvgpr_read_b32 v17, a203
    v_lshlrev_b32 v18, 16, v14
    v_mfma_f32_16x16x32_bf16 v[92:95], a[84:87], a[124:127], v[92:95]
    v_and_b32 v19, 0xffff0000, v14
    v_lshlrev_b32 v20, 16, v15
    v_mfma_f32_16x16x32_bf16 v[96:99], a[88:91], a[112:115], v[96:99]
    buffer_load_dwordx4 a[84:87], v2, s[20:23], s34 offen offset:1024
    v_mfma_f32_16x16x32_bf16 v[100:103], a[88:91], a[116:119], v[100:103]
    v_and_b32 v21, 0xffff0000, v15
    v_mul_f32 v18, v18, v152
    v_mfma_f32_16x16x32_bf16 v[104:107], a[88:91], a[120:123], v[104:107]
    v_mul_f32 v19, v19, v153
    v_mul_f32 v20, v20, v154
    v_mfma_f32_16x16x32_bf16 v[108:111], a[88:91], a[124:127], v[108:111]
    v_mul_f32 v21, v21, v155
    v_cvt_pk_bf16_f32 v14, v18, v19
    v_mfma_f32_16x16x32_bf16 v[112:115], a[92:95], a[112:115], v[112:115]
    buffer_load_dwordx4 a[88:91], v2, s[20:23], s34 offen offset:2048
    v_mfma_f32_16x16x32_bf16 v[116:119], a[92:95], a[116:119], v[116:119]
    v_cvt_pk_bf16_f32 v15, v20, v21
    v_lshlrev_b32 v18, 16, v16
    v_mfma_f32_16x16x32_bf16 v[120:123], a[92:95], a[120:123], v[120:123]
    v_and_b32 v19, 0xffff0000, v16
    v_lshlrev_b32 v20, 16, v17
    v_mfma_f32_16x16x32_bf16 v[124:127], a[92:95], a[124:127], v[124:127]
    v_and_b32 v21, 0xffff0000, v17
    s_waitcnt vmcnt(22)
    v_mfma_f32_16x16x32_bf16 v[128:131], a[96:99], a[112:115], v[128:131]
    buffer_load_dwordx4 a[92:95], v2, s[20:23], s34 offen offset:3072
    v_mfma_f32_16x16x32_bf16 v[132:135], a[96:99], a[116:119], v[132:135]
    v_mul_f32 v18, v18, v168
    v_mul_f32 v19, v19, v169
    v_mfma_f32_16x16x32_bf16 v[136:139], a[96:99], a[120:123], v[136:139]
    v_mul_f32 v20, v20, v170
    v_mul_f32 v21, v21, v171
    v_mfma_f32_16x16x32_bf16 v[140:143], a[96:99], a[124:127], v[140:143]
    v_cvt_pk_bf16_f32 v16, v18, v19
    s_waitcnt lgkmcnt(1)
    v_mfma_f32_16x16x32_bf16 v[240:243], a[100:103], a[128:131], v[240:243]
    s_mov_b32 s34, 741376
    v_cvt_pk_bf16_f32 v17, v20, v21
    v_mfma_f32_16x16x32_bf16 v[244:247], a[100:103], a[132:135], v[244:247]
    ds_read_b128 a[112:115], v2 offset:16384
    ds_read_b128 a[116:119], v2 offset:17408
    v_mfma_f32_16x16x32_bf16 v[248:251], a[100:103], a[136:139], v[248:251]
    ds_read_b128 a[120:123], v2 offset:18432
    ds_read_b128 a[124:127], v2 offset:19456
    v_mfma_f32_16x16x32_bf16 v[252:255], a[100:103], a[140:143], v[252:255]
    buffer_load_dwordx4 a[96:99], v2, s[20:23], s34 offen offset:0
    v_mfma_f32_16x16x32_bf16 v[48:51], a[104:107], a[128:131], v[48:51]
    buffer_load_dwordx4 a[100:103], v2, s[20:23], s34 offen offset:1024
    v_mfma_f32_16x16x32_bf16 v[52:55], a[104:107], a[132:135], v[52:55]
    ds_write_b128 v9, v[14:17] offset:2048
    v_mfma_f32_16x16x32_bf16 v[56:59], a[104:107], a[136:139], v[56:59]
    v_add_f32 v152, v152, v38
    v_add_f32 v153, v153, v39
    v_mfma_f32_16x16x32_bf16 v[60:63], a[104:107], a[140:143], v[60:63]
    v_add_f32 v154, v154, v40
    v_add_f32 v155, v155, v41
    v_mfma_f32_16x16x32_bf16 v[64:67], a[108:111], a[128:131], v[64:67]
    buffer_load_dwordx4 a[104:107], v2, s[20:23], s34 offen offset:2048
    v_mfma_f32_16x16x32_bf16 v[68:71], a[108:111], a[132:135], v[68:71]
    v_add_f32 v168, v168, v42
    v_add_f32 v169, v169, v43
    v_mfma_f32_16x16x32_bf16 v[72:75], a[108:111], a[136:139], v[72:75]
    v_add_f32 v170, v170, v44
    v_add_f32 v171, v171, v45
    v_mfma_f32_16x16x32_bf16 v[76:79], a[108:111], a[140:143], v[76:79]
    v_accvgpr_read_b32 v22, a204
    v_accvgpr_read_b32 v23, a205
    v_mfma_f32_16x16x32_bf16 v[80:83], a[0:3], a[128:131], v[80:83]
    buffer_load_dwordx4 a[108:111], v2, s[20:23], s34 offen offset:3072
    v_mfma_f32_16x16x32_bf16 v[84:87], a[0:3], a[132:135], v[84:87]
    v_accvgpr_read_b32 v24, a206
    v_accvgpr_read_b32 v25, a207
    v_mfma_f32_16x16x32_bf16 v[88:91], a[0:3], a[136:139], v[88:91]
    v_lshlrev_b32 v26, 16, v22
    v_and_b32 v27, 0xffff0000, v22
    v_mfma_f32_16x16x32_bf16 v[92:95], a[0:3], a[140:143], v[92:95]
    v_lshlrev_b32 v28, 16, v23
    v_and_b32 v29, 0xffff0000, v23
    v_mfma_f32_16x16x32_bf16 v[96:99], a[4:7], a[128:131], v[96:99]
    s_mov_b32 s34, 745472
    v_mul_f32 v26, v26, v156
    v_mfma_f32_16x16x32_bf16 v[100:103], a[4:7], a[132:135], v[100:103]
    buffer_load_dwordx4 a[0:3], v2, s[20:23], s34 offen offset:0
    v_mfma_f32_16x16x32_bf16 v[104:107], a[4:7], a[136:139], v[104:107]
    v_mul_f32 v27, v27, v157
    v_mul_f32 v28, v28, v158
    v_mfma_f32_16x16x32_bf16 v[108:111], a[4:7], a[140:143], v[108:111]
    v_mul_f32 v29, v29, v159
    v_cvt_pk_bf16_f32 v22, v26, v27
    v_mfma_f32_16x16x32_bf16 v[112:115], a[8:11], a[128:131], v[112:115]
    buffer_load_dwordx4 a[4:7], v2, s[20:23], s34 offen offset:1024
    v_mfma_f32_16x16x32_bf16 v[116:119], a[8:11], a[132:135], v[116:119]
    v_cvt_pk_bf16_f32 v23, v28, v29
    v_lshlrev_b32 v26, 16, v24
    v_mfma_f32_16x16x32_bf16 v[120:123], a[8:11], a[136:139], v[120:123]
    v_and_b32 v27, 0xffff0000, v24
    v_lshlrev_b32 v28, 16, v25
    v_mfma_f32_16x16x32_bf16 v[124:127], a[8:11], a[140:143], v[124:127]
    v_and_b32 v29, 0xffff0000, v25
    v_mul_f32 v26, v26, v172
    s_waitcnt vmcnt(26)
    v_mfma_f32_16x16x32_bf16 v[128:131], a[12:15], a[128:131], v[128:131]
    buffer_load_dwordx4 a[8:11], v2, s[20:23], s34 offen offset:2048
    v_mfma_f32_16x16x32_bf16 v[132:135], a[12:15], a[132:135], v[132:135]
    v_mul_f32 v27, v27, v173
    v_mul_f32 v28, v28, v174
    v_mfma_f32_16x16x32_bf16 v[136:139], a[12:15], a[136:139], v[136:139]
    v_mul_f32 v29, v29, v175
    v_cvt_pk_bf16_f32 v24, v26, v27
    v_mfma_f32_16x16x32_bf16 v[140:143], a[12:15], a[140:143], v[140:143]
    v_cvt_pk_bf16_f32 v25, v28, v29
    s_waitcnt lgkmcnt(1)
    v_mfma_f32_16x16x32_bf16 v[240:243], a[16:19], a[112:115], v[240:243]
    buffer_load_dwordx4 a[12:15], v2, s[20:23], s34 offen offset:3072
    v_mfma_f32_16x16x32_bf16 v[244:247], a[16:19], a[116:119], v[244:247]
    ds_read_b128 a[128:131], v2 offset:20480
    ds_read_b128 a[132:135], v2 offset:21504
    v_mfma_f32_16x16x32_bf16 v[248:251], a[16:19], a[120:123], v[248:251]
    ds_read_b128 a[136:139], v2 offset:22528
    ds_read_b128 a[140:143], v2 offset:23552
    v_mfma_f32_16x16x32_bf16 v[252:255], a[16:19], a[124:127], v[252:255]
    ds_write_b128 v9, v[22:25] offset:3072
    v_mfma_f32_16x16x32_bf16 v[48:51], a[20:23], a[112:115], v[48:51]
    s_mov_b32 s34, 749568
    v_add_f32 v156, v156, v38
    v_mfma_f32_16x16x32_bf16 v[52:55], a[20:23], a[116:119], v[52:55]
    buffer_load_dwordx4 a[16:19], v2, s[20:23], s34 offen offset:0
    v_mfma_f32_16x16x32_bf16 v[56:59], a[20:23], a[120:123], v[56:59]
    v_add_f32 v157, v157, v39
    v_add_f32 v158, v158, v40
    v_mfma_f32_16x16x32_bf16 v[60:63], a[20:23], a[124:127], v[60:63]
    v_add_f32 v159, v159, v41
    v_add_f32 v172, v172, v42
    s_waitcnt vmcnt(20)
    v_mfma_f32_16x16x32_bf16 v[64:67], a[24:27], a[112:115], v[64:67]
    buffer_load_dwordx4 a[20:23], v2, s[20:23], s34 offen offset:1024
    v_mfma_f32_16x16x32_bf16 v[68:71], a[24:27], a[116:119], v[68:71]
    v_add_f32 v173, v173, v43
    v_add_f32 v174, v174, v44
    v_mfma_f32_16x16x32_bf16 v[72:75], a[24:27], a[120:123], v[72:75]
    v_add_f32 v175, v175, v45
    v_mfma_f32_16x16x32_bf16 v[76:79], a[24:27], a[124:127], v[76:79]
    buffer_load_dwordx4 v[38:41], v12, s[24:27], 0 offen offset:2304
    v_mfma_f32_16x16x32_bf16 v[80:83], a[28:31], a[112:115], v[80:83]
    buffer_load_dwordx4 a[24:27], v2, s[20:23], s34 offen offset:2048
    v_mfma_f32_16x16x32_bf16 v[84:87], a[28:31], a[116:119], v[84:87]
    buffer_load_dwordx4 v[42:45], v12, s[24:27], 0 offen offset:2368
    v_mfma_f32_16x16x32_bf16 v[88:91], a[28:31], a[120:123], v[88:91]
    v_accvgpr_read_b32 v14, a208
    v_accvgpr_read_b32 v15, a209
    v_mfma_f32_16x16x32_bf16 v[92:95], a[28:31], a[124:127], v[92:95]
    v_accvgpr_read_b32 v16, a210
    v_accvgpr_read_b32 v17, a211
    v_mfma_f32_16x16x32_bf16 v[96:99], a[32:35], a[112:115], v[96:99]
    buffer_load_dwordx4 a[28:31], v2, s[20:23], s34 offen offset:3072
    v_mfma_f32_16x16x32_bf16 v[100:103], a[32:35], a[116:119], v[100:103]
    v_lshlrev_b32 v18, 16, v14
    v_and_b32 v19, 0xffff0000, v14
    v_mfma_f32_16x16x32_bf16 v[104:107], a[32:35], a[120:123], v[104:107]
    v_lshlrev_b32 v20, 16, v15
    v_and_b32 v21, 0xffff0000, v15
    v_mfma_f32_16x16x32_bf16 v[108:111], a[32:35], a[124:127], v[108:111]
    v_mul_f32 v18, v18, v176
    v_mul_f32 v19, v19, v177
    v_mfma_f32_16x16x32_bf16 v[112:115], a[36:39], a[112:115], v[112:115]
    s_mov_b32 s34, 753664
    v_mul_f32 v20, v20, v178
    v_mfma_f32_16x16x32_bf16 v[116:119], a[36:39], a[116:119], v[116:119]
    buffer_load_dwordx4 a[32:35], v2, s[20:23], s34 offen offset:0
    v_mfma_f32_16x16x32_bf16 v[120:123], a[36:39], a[120:123], v[120:123]
    v_mul_f32 v21, v21, v179
    v_cvt_pk_bf16_f32 v14, v18, v19
    v_mfma_f32_16x16x32_bf16 v[124:127], a[36:39], a[124:127], v[124:127]
    v_cvt_pk_bf16_f32 v15, v20, v21
    v_lshlrev_b32 v18, 16, v16
    v_mfma_f32_16x16x32_bf16 v[128:131], a[40:43], a[112:115], v[128:131]
    buffer_load_dwordx4 a[36:39], v2, s[20:23], s34 offen offset:1024
    v_mfma_f32_16x16x32_bf16 v[132:135], a[40:43], a[116:119], v[132:135]
    v_and_b32 v19, 0xffff0000, v16
    v_lshlrev_b32 v20, 16, v17
    v_mfma_f32_16x16x32_bf16 v[136:139], a[40:43], a[120:123], v[136:139]
    v_and_b32 v21, 0xffff0000, v17
    v_mul_f32 v18, v18, v192
    v_mfma_f32_16x16x32_bf16 v[140:143], a[40:43], a[124:127], v[140:143]
    v_mul_f32 v19, v19, v193
    v_mul_f32 v20, v20, v194
    s_waitcnt lgkmcnt(1)
    v_mfma_f32_16x16x32_bf16 v[240:243], a[44:47], a[128:131], v[240:243]
    buffer_load_dwordx4 a[40:43], v2, s[20:23], s34 offen offset:2048
    v_mfma_f32_16x16x32_bf16 v[244:247], a[44:47], a[132:135], v[244:247]
    ds_read_b128 a[112:115], v2 offset:24576
    ds_read_b128 a[116:119], v2 offset:25600
    v_mfma_f32_16x16x32_bf16 v[248:251], a[44:47], a[136:139], v[248:251]
    ds_read_b128 a[120:123], v2 offset:26624
    ds_read_b128 a[124:127], v2 offset:27648
    v_mfma_f32_16x16x32_bf16 v[252:255], a[44:47], a[140:143], v[252:255]
    v_mul_f32 v21, v21, v195
    v_cvt_pk_bf16_f32 v16, v18, v19
    v_mfma_f32_16x16x32_bf16 v[48:51], a[48:51], a[128:131], v[48:51]
    buffer_load_dwordx4 a[44:47], v2, s[20:23], s34 offen offset:3072
    v_mfma_f32_16x16x32_bf16 v[52:55], a[48:51], a[132:135], v[52:55]
    v_cvt_pk_bf16_f32 v17, v20, v21
    v_mfma_f32_16x16x32_bf16 v[56:59], a[48:51], a[136:139], v[56:59]
    ds_write_b128 v9, v[14:17] offset:4096
    v_mfma_f32_16x16x32_bf16 v[60:63], a[48:51], a[140:143], v[60:63]
    v_add_f32 v176, v176, v30
    v_add_f32 v177, v177, v31
    s_waitcnt vmcnt(22)
    v_mfma_f32_16x16x32_bf16 v[64:67], a[52:55], a[128:131], v[64:67]
    s_mov_b32 s34, 757760
    v_add_f32 v178, v178, v32
    v_mfma_f32_16x16x32_bf16 v[68:71], a[52:55], a[132:135], v[68:71]
    buffer_load_dwordx4 a[48:51], v2, s[20:23], s34 offen offset:0
    v_mfma_f32_16x16x32_bf16 v[72:75], a[52:55], a[136:139], v[72:75]
    v_add_f32 v179, v179, v33
    v_add_f32 v192, v192, v34
    v_mfma_f32_16x16x32_bf16 v[76:79], a[52:55], a[140:143], v[76:79]
    v_add_f32 v193, v193, v35
    v_add_f32 v194, v194, v36
    v_mfma_f32_16x16x32_bf16 v[80:83], a[56:59], a[128:131], v[80:83]
    buffer_load_dwordx4 a[52:55], v2, s[20:23], s34 offen offset:1024
    v_mfma_f32_16x16x32_bf16 v[84:87], a[56:59], a[132:135], v[84:87]
    v_add_f32 v195, v195, v37
    v_accvgpr_read_b32 v22, a212
    v_mfma_f32_16x16x32_bf16 v[88:91], a[56:59], a[136:139], v[88:91]
    v_accvgpr_read_b32 v23, a213
    v_accvgpr_read_b32 v24, a214
    v_mfma_f32_16x16x32_bf16 v[92:95], a[56:59], a[140:143], v[92:95]
    v_accvgpr_read_b32 v25, a215
    v_lshlrev_b32 v26, 16, v22
    v_mfma_f32_16x16x32_bf16 v[96:99], a[60:63], a[128:131], v[96:99]
    buffer_load_dwordx4 a[56:59], v2, s[20:23], s34 offen offset:2048
    v_mfma_f32_16x16x32_bf16 v[100:103], a[60:63], a[132:135], v[100:103]
    v_and_b32 v27, 0xffff0000, v22
    v_lshlrev_b32 v28, 16, v23
    v_mfma_f32_16x16x32_bf16 v[104:107], a[60:63], a[136:139], v[104:107]
    v_and_b32 v29, 0xffff0000, v23
    v_mul_f32 v26, v26, v180
    v_mfma_f32_16x16x32_bf16 v[108:111], a[60:63], a[140:143], v[108:111]
    v_mul_f32 v27, v27, v181
    v_mul_f32 v28, v28, v182
    v_mfma_f32_16x16x32_bf16 v[112:115], a[64:67], a[128:131], v[112:115]
    buffer_load_dwordx4 a[60:63], v2, s[20:23], s34 offen offset:3072
    v_mfma_f32_16x16x32_bf16 v[116:119], a[64:67], a[132:135], v[116:119]
    v_mul_f32 v29, v29, v183
    v_cvt_pk_bf16_f32 v22, v26, v27
    v_mfma_f32_16x16x32_bf16 v[120:123], a[64:67], a[136:139], v[120:123]
    v_cvt_pk_bf16_f32 v23, v28, v29
    v_lshlrev_b32 v26, 16, v24
    v_mfma_f32_16x16x32_bf16 v[124:127], a[64:67], a[140:143], v[124:127]
    v_and_b32 v27, 0xffff0000, v24
    v_lshlrev_b32 v28, 16, v25
    v_mfma_f32_16x16x32_bf16 v[128:131], a[68:71], a[128:131], v[128:131]
    s_mov_b32 s34, 761856
    v_and_b32 v29, 0xffff0000, v25
    v_mfma_f32_16x16x32_bf16 v[132:135], a[68:71], a[132:135], v[132:135]
    buffer_load_dwordx4 a[64:67], v2, s[20:23], s34 offen offset:0
    v_mfma_f32_16x16x32_bf16 v[136:139], a[68:71], a[136:139], v[136:139]
    v_mul_f32 v26, v26, v196
    v_mul_f32 v27, v27, v197
    v_mfma_f32_16x16x32_bf16 v[140:143], a[68:71], a[140:143], v[140:143]
    v_mul_f32 v28, v28, v198
    v_mul_f32 v29, v29, v199
    s_waitcnt lgkmcnt(1)
    v_mfma_f32_16x16x32_bf16 v[240:243], a[72:75], a[112:115], v[240:243]
    buffer_load_dwordx4 a[68:71], v2, s[20:23], s34 offen offset:1024
    v_mfma_f32_16x16x32_bf16 v[244:247], a[72:75], a[116:119], v[244:247]
    ds_read_b128 a[128:131], v2 offset:28672
    ds_read_b128 a[132:135], v2 offset:29696
    v_mfma_f32_16x16x32_bf16 v[248:251], a[72:75], a[120:123], v[248:251]
    ds_read_b128 a[136:139], v2 offset:30720
    ds_read_b128 a[140:143], v2 offset:31744
    v_mfma_f32_16x16x32_bf16 v[252:255], a[72:75], a[124:127], v[252:255]
    v_cvt_pk_bf16_f32 v24, v26, v27
    v_cvt_pk_bf16_f32 v25, v28, v29
    v_mfma_f32_16x16x32_bf16 v[48:51], a[76:79], a[112:115], v[48:51]
    buffer_load_dwordx4 a[72:75], v2, s[20:23], s34 offen offset:2048
    v_mfma_f32_16x16x32_bf16 v[52:55], a[76:79], a[116:119], v[52:55]
    ds_write_b128 v9, v[22:25] offset:5120
    v_mfma_f32_16x16x32_bf16 v[56:59], a[76:79], a[120:123], v[56:59]
    v_add_f32 v180, v180, v30
    v_add_f32 v181, v181, v31
    v_mfma_f32_16x16x32_bf16 v[60:63], a[76:79], a[124:127], v[60:63]
    v_add_f32 v182, v182, v32
    v_add_f32 v183, v183, v33
    s_waitcnt vmcnt(22)
    v_mfma_f32_16x16x32_bf16 v[64:67], a[80:83], a[112:115], v[64:67]
    buffer_load_dwordx4 a[76:79], v2, s[20:23], s34 offen offset:3072
    v_mfma_f32_16x16x32_bf16 v[68:71], a[80:83], a[116:119], v[68:71]
    v_add_f32 v196, v196, v34
    v_add_f32 v197, v197, v35
    v_mfma_f32_16x16x32_bf16 v[72:75], a[80:83], a[120:123], v[72:75]
    v_add_f32 v198, v198, v36
    v_add_f32 v199, v199, v37
    v_mfma_f32_16x16x32_bf16 v[76:79], a[80:83], a[124:127], v[76:79]
    v_accvgpr_read_b32 v14, a216
    v_accvgpr_read_b32 v15, a217
    v_mfma_f32_16x16x32_bf16 v[80:83], a[84:87], a[112:115], v[80:83]
    s_mov_b32 s34, 765952
    v_accvgpr_read_b32 v16, a218
    v_mfma_f32_16x16x32_bf16 v[84:87], a[84:87], a[116:119], v[84:87]
    buffer_load_dwordx4 a[80:83], v2, s[20:23], s34 offen offset:0
    v_mfma_f32_16x16x32_bf16 v[88:91], a[84:87], a[120:123], v[88:91]
    v_accvgpr_read_b32 v17, a219
    v_lshlrev_b32 v18, 16, v14
    v_mfma_f32_16x16x32_bf16 v[92:95], a[84:87], a[124:127], v[92:95]
    v_and_b32 v19, 0xffff0000, v14
    v_lshlrev_b32 v20, 16, v15
    v_mfma_f32_16x16x32_bf16 v[96:99], a[88:91], a[112:115], v[96:99]
    buffer_load_dwordx4 a[84:87], v2, s[20:23], s34 offen offset:1024
    v_mfma_f32_16x16x32_bf16 v[100:103], a[88:91], a[116:119], v[100:103]
    v_and_b32 v21, 0xffff0000, v15
    v_mul_f32 v18, v18, v184
    v_mfma_f32_16x16x32_bf16 v[104:107], a[88:91], a[120:123], v[104:107]
    v_mul_f32 v19, v19, v185
    v_mul_f32 v20, v20, v186
    v_mfma_f32_16x16x32_bf16 v[108:111], a[88:91], a[124:127], v[108:111]
    v_mul_f32 v21, v21, v187
    v_cvt_pk_bf16_f32 v14, v18, v19
    v_mfma_f32_16x16x32_bf16 v[112:115], a[92:95], a[112:115], v[112:115]
    buffer_load_dwordx4 a[88:91], v2, s[20:23], s34 offen offset:2048
    v_mfma_f32_16x16x32_bf16 v[116:119], a[92:95], a[116:119], v[116:119]
    v_cvt_pk_bf16_f32 v15, v20, v21
    v_lshlrev_b32 v18, 16, v16
    v_mfma_f32_16x16x32_bf16 v[120:123], a[92:95], a[120:123], v[120:123]
    v_and_b32 v19, 0xffff0000, v16
    v_lshlrev_b32 v20, 16, v17
    v_mfma_f32_16x16x32_bf16 v[124:127], a[92:95], a[124:127], v[124:127]
    v_and_b32 v21, 0xffff0000, v17
    v_mul_f32 v18, v18, v200
    v_mfma_f32_16x16x32_bf16 v[128:131], a[96:99], a[112:115], v[128:131]
    buffer_load_dwordx4 a[92:95], v2, s[20:23], s34 offen offset:3072
    v_mfma_f32_16x16x32_bf16 v[132:135], a[96:99], a[116:119], v[132:135]
    v_mul_f32 v19, v19, v201
    v_mul_f32 v20, v20, v202
    v_mfma_f32_16x16x32_bf16 v[136:139], a[96:99], a[120:123], v[136:139]
    v_mul_f32 v21, v21, v203
    v_cvt_pk_bf16_f32 v16, v18, v19
    v_mfma_f32_16x16x32_bf16 v[140:143], a[96:99], a[124:127], v[140:143]
    v_cvt_pk_bf16_f32 v17, v20, v21
    s_waitcnt lgkmcnt(1)
    v_mfma_f32_16x16x32_bf16 v[240:243], a[100:103], a[128:131], v[240:243]
    s_mov_b32 s34, 770048
    v_mfma_f32_16x16x32_bf16 v[244:247], a[100:103], a[132:135], v[244:247]
    ds_read_b128 a[112:115], v2 offset:32768
    ds_read_b128 a[116:119], v2 offset:33792
    v_mfma_f32_16x16x32_bf16 v[248:251], a[100:103], a[136:139], v[248:251]
    ds_read_b128 a[120:123], v2 offset:34816
    ds_read_b128 a[124:127], v2 offset:35840
    v_mfma_f32_16x16x32_bf16 v[252:255], a[100:103], a[140:143], v[252:255]
    buffer_load_dwordx4 a[96:99], v2, s[20:23], s34 offen offset:0
    v_mfma_f32_16x16x32_bf16 v[48:51], a[104:107], a[128:131], v[48:51]
    buffer_load_dwordx4 a[100:103], v2, s[20:23], s34 offen offset:1024
    v_mfma_f32_16x16x32_bf16 v[52:55], a[104:107], a[132:135], v[52:55]
    ds_write_b128 v9, v[14:17] offset:6144
    v_mfma_f32_16x16x32_bf16 v[56:59], a[104:107], a[136:139], v[56:59]
    v_add_f32 v184, v184, v30
    v_add_f32 v185, v185, v31
    v_mfma_f32_16x16x32_bf16 v[60:63], a[104:107], a[140:143], v[60:63]
    v_add_f32 v186, v186, v32
    v_add_f32 v187, v187, v33
    s_waitcnt vmcnt(22)
    v_mfma_f32_16x16x32_bf16 v[64:67], a[108:111], a[128:131], v[64:67]
    buffer_load_dwordx4 a[104:107], v2, s[20:23], s34 offen offset:2048
    v_mfma_f32_16x16x32_bf16 v[68:71], a[108:111], a[132:135], v[68:71]
    v_add_f32 v200, v200, v34
    v_add_f32 v201, v201, v35
    v_mfma_f32_16x16x32_bf16 v[72:75], a[108:111], a[136:139], v[72:75]
    v_add_f32 v202, v202, v36
    v_add_f32 v203, v203, v37
    v_mfma_f32_16x16x32_bf16 v[76:79], a[108:111], a[140:143], v[76:79]
    v_accvgpr_read_b32 v22, a220
    v_accvgpr_read_b32 v23, a221
    v_mfma_f32_16x16x32_bf16 v[80:83], a[0:3], a[128:131], v[80:83]
    buffer_load_dwordx4 a[108:111], v2, s[20:23], s34 offen offset:3072
    v_mfma_f32_16x16x32_bf16 v[84:87], a[0:3], a[132:135], v[84:87]
    v_accvgpr_read_b32 v24, a222
    v_accvgpr_read_b32 v25, a223
    v_mfma_f32_16x16x32_bf16 v[88:91], a[0:3], a[136:139], v[88:91]
    v_lshlrev_b32 v26, 16, v22
    v_and_b32 v27, 0xffff0000, v22
    v_mfma_f32_16x16x32_bf16 v[92:95], a[0:3], a[140:143], v[92:95]
    v_lshlrev_b32 v28, 16, v23
    v_and_b32 v29, 0xffff0000, v23
    v_mfma_f32_16x16x32_bf16 v[96:99], a[4:7], a[128:131], v[96:99]
    s_mov_b32 s34, 774144
    v_mul_f32 v26, v26, v188
    v_mfma_f32_16x16x32_bf16 v[100:103], a[4:7], a[132:135], v[100:103]
    buffer_load_dwordx4 a[0:3], v2, s[20:23], s34 offen offset:0
    v_mfma_f32_16x16x32_bf16 v[104:107], a[4:7], a[136:139], v[104:107]
    v_mul_f32 v27, v27, v189
    v_mul_f32 v28, v28, v190
    v_mfma_f32_16x16x32_bf16 v[108:111], a[4:7], a[140:143], v[108:111]
    v_mul_f32 v29, v29, v191
    v_cvt_pk_bf16_f32 v22, v26, v27
    v_mfma_f32_16x16x32_bf16 v[112:115], a[8:11], a[128:131], v[112:115]
    buffer_load_dwordx4 a[4:7], v2, s[20:23], s34 offen offset:1024
    v_mfma_f32_16x16x32_bf16 v[116:119], a[8:11], a[132:135], v[116:119]
    v_cvt_pk_bf16_f32 v23, v28, v29
    v_lshlrev_b32 v26, 16, v24
    v_mfma_f32_16x16x32_bf16 v[120:123], a[8:11], a[136:139], v[120:123]
    v_and_b32 v27, 0xffff0000, v24
    v_lshlrev_b32 v28, 16, v25
    v_mfma_f32_16x16x32_bf16 v[124:127], a[8:11], a[140:143], v[124:127]
    v_and_b32 v29, 0xffff0000, v25
    v_mul_f32 v26, v26, v204
    v_mfma_f32_16x16x32_bf16 v[128:131], a[12:15], a[128:131], v[128:131]
    buffer_load_dwordx4 a[8:11], v2, s[20:23], s34 offen offset:2048
    v_mfma_f32_16x16x32_bf16 v[132:135], a[12:15], a[132:135], v[132:135]
    v_mul_f32 v27, v27, v205
    v_mul_f32 v28, v28, v206
    v_mfma_f32_16x16x32_bf16 v[136:139], a[12:15], a[136:139], v[136:139]
    v_mul_f32 v29, v29, v207
    v_cvt_pk_bf16_f32 v24, v26, v27
    v_mfma_f32_16x16x32_bf16 v[140:143], a[12:15], a[140:143], v[140:143]
    v_cvt_pk_bf16_f32 v25, v28, v29
    s_waitcnt lgkmcnt(1)
    v_mfma_f32_16x16x32_bf16 v[240:243], a[16:19], a[112:115], v[240:243]
    buffer_load_dwordx4 a[12:15], v2, s[20:23], s34 offen offset:3072
    v_mfma_f32_16x16x32_bf16 v[244:247], a[16:19], a[116:119], v[244:247]
    ds_read_b128 a[128:131], v2 offset:36864
    ds_read_b128 a[132:135], v2 offset:37888
    v_mfma_f32_16x16x32_bf16 v[248:251], a[16:19], a[120:123], v[248:251]
    ds_read_b128 a[136:139], v2 offset:38912
    ds_read_b128 a[140:143], v2 offset:39936
    v_mfma_f32_16x16x32_bf16 v[252:255], a[16:19], a[124:127], v[252:255]
    ds_write_b128 v9, v[22:25] offset:7168
    v_mfma_f32_16x16x32_bf16 v[48:51], a[20:23], a[112:115], v[48:51]
    s_mov_b32 s34, 778240
    v_add_f32 v188, v188, v30
    v_mfma_f32_16x16x32_bf16 v[52:55], a[20:23], a[116:119], v[52:55]
    buffer_load_dwordx4 a[16:19], v2, s[20:23], s34 offen offset:0
    v_mfma_f32_16x16x32_bf16 v[56:59], a[20:23], a[120:123], v[56:59]
    v_add_f32 v189, v189, v31
    v_add_f32 v190, v190, v32
    v_mfma_f32_16x16x32_bf16 v[60:63], a[20:23], a[124:127], v[60:63]
    v_add_f32 v191, v191, v33
    v_add_f32 v204, v204, v34
    s_waitcnt vmcnt(27)
    v_mfma_f32_16x16x32_bf16 v[64:67], a[24:27], a[112:115], v[64:67]
    buffer_load_dwordx4 a[20:23], v2, s[20:23], s34 offen offset:1024
    v_mfma_f32_16x16x32_bf16 v[68:71], a[24:27], a[116:119], v[68:71]
    v_add_f32 v205, v205, v35
    v_add_f32 v206, v206, v36
    v_mfma_f32_16x16x32_bf16 v[72:75], a[24:27], a[120:123], v[72:75]
    v_add_f32 v207, v207, v37
    v_accvgpr_read_b32 v14, a224
    v_mfma_f32_16x16x32_bf16 v[76:79], a[24:27], a[124:127], v[76:79]
    v_accvgpr_read_b32 v15, a225
    v_accvgpr_read_b32 v16, a226
    s_waitcnt vmcnt(20)
    v_mfma_f32_16x16x32_bf16 v[80:83], a[28:31], a[112:115], v[80:83]
    buffer_load_dwordx4 a[24:27], v2, s[20:23], s34 offen offset:2048
    v_mfma_f32_16x16x32_bf16 v[84:87], a[28:31], a[116:119], v[84:87]
    v_accvgpr_read_b32 v17, a227
    v_lshlrev_b32 v18, 16, v14
    v_mfma_f32_16x16x32_bf16 v[88:91], a[28:31], a[120:123], v[88:91]
    v_and_b32 v19, 0xffff0000, v14
    v_lshlrev_b32 v20, 16, v15
    v_mfma_f32_16x16x32_bf16 v[92:95], a[28:31], a[124:127], v[92:95]
    v_and_b32 v21, 0xffff0000, v15
    v_mul_f32 v18, v18, v208
    v_mfma_f32_16x16x32_bf16 v[96:99], a[32:35], a[112:115], v[96:99]
    buffer_load_dwordx4 a[28:31], v2, s[20:23], s34 offen offset:3072
    v_mfma_f32_16x16x32_bf16 v[100:103], a[32:35], a[116:119], v[100:103]
    v_mul_f32 v19, v19, v209
    v_mul_f32 v20, v20, v210
    v_mfma_f32_16x16x32_bf16 v[104:107], a[32:35], a[120:123], v[104:107]
    v_mul_f32 v21, v21, v211
    v_cvt_pk_bf16_f32 v14, v18, v19
    v_mfma_f32_16x16x32_bf16 v[108:111], a[32:35], a[124:127], v[108:111]
    v_cvt_pk_bf16_f32 v15, v20, v21
    v_lshlrev_b32 v18, 16, v16
    v_mfma_f32_16x16x32_bf16 v[112:115], a[36:39], a[112:115], v[112:115]
    s_mov_b32 s34, 782336
    v_and_b32 v19, 0xffff0000, v16
    v_mfma_f32_16x16x32_bf16 v[116:119], a[36:39], a[116:119], v[116:119]
    buffer_load_dwordx4 a[32:35], v2, s[20:23], s34 offen offset:0
    v_mfma_f32_16x16x32_bf16 v[120:123], a[36:39], a[120:123], v[120:123]
    v_lshlrev_b32 v20, 16, v17
    v_and_b32 v21, 0xffff0000, v17
    v_mfma_f32_16x16x32_bf16 v[124:127], a[36:39], a[124:127], v[124:127]
    v_mul_f32 v18, v18, v224
    v_mul_f32 v19, v19, v225
    v_mfma_f32_16x16x32_bf16 v[128:131], a[40:43], a[112:115], v[128:131]
    buffer_load_dwordx4 a[36:39], v2, s[20:23], s34 offen offset:1024
    v_mfma_f32_16x16x32_bf16 v[132:135], a[40:43], a[116:119], v[132:135]
    v_mul_f32 v20, v20, v226
    v_mul_f32 v21, v21, v227
    v_mfma_f32_16x16x32_bf16 v[136:139], a[40:43], a[120:123], v[136:139]
    v_cvt_pk_bf16_f32 v16, v18, v19
    v_cvt_pk_bf16_f32 v17, v20, v21
    v_mfma_f32_16x16x32_bf16 v[140:143], a[40:43], a[124:127], v[140:143]
    ds_write_b128 v9, v[14:17] offset:8192
    s_waitcnt lgkmcnt(2)
    v_mfma_f32_16x16x32_bf16 v[240:243], a[44:47], a[128:131], v[240:243]
    buffer_load_dwordx4 a[40:43], v2, s[20:23], s34 offen offset:2048
    v_mfma_f32_16x16x32_bf16 v[244:247], a[44:47], a[132:135], v[244:247]
    ds_read_b128 a[112:115], v2 offset:40960
    ds_read_b128 a[116:119], v2 offset:41984
    v_mfma_f32_16x16x32_bf16 v[248:251], a[44:47], a[136:139], v[248:251]
    ds_read_b128 a[120:123], v2 offset:43008
    ds_read_b128 a[124:127], v2 offset:44032
    v_mfma_f32_16x16x32_bf16 v[252:255], a[44:47], a[140:143], v[252:255]
    v_add_f32 v208, v208, v38
    v_add_f32 v209, v209, v39
    v_mfma_f32_16x16x32_bf16 v[48:51], a[48:51], a[128:131], v[48:51]
    buffer_load_dwordx4 a[44:47], v2, s[20:23], s34 offen offset:3072
    v_mfma_f32_16x16x32_bf16 v[52:55], a[48:51], a[132:135], v[52:55]
    v_add_f32 v210, v210, v40
    v_add_f32 v211, v211, v41
    v_mfma_f32_16x16x32_bf16 v[56:59], a[48:51], a[136:139], v[56:59]
    v_add_f32 v224, v224, v42
    v_add_f32 v225, v225, v43
    v_mfma_f32_16x16x32_bf16 v[60:63], a[48:51], a[140:143], v[60:63]
    v_add_f32 v226, v226, v44
    v_add_f32 v227, v227, v45
    v_mfma_f32_16x16x32_bf16 v[64:67], a[52:55], a[128:131], v[64:67]
    s_mov_b32 s34, 786432
    v_accvgpr_read_b32 v22, a228
    v_mfma_f32_16x16x32_bf16 v[68:71], a[52:55], a[132:135], v[68:71]
    buffer_load_dwordx4 a[48:51], v2, s[20:23], s34 offen offset:0
    v_mfma_f32_16x16x32_bf16 v[72:75], a[52:55], a[136:139], v[72:75]
    v_accvgpr_read_b32 v23, a229
    v_accvgpr_read_b32 v24, a230
    v_mfma_f32_16x16x32_bf16 v[76:79], a[52:55], a[140:143], v[76:79]
    v_accvgpr_read_b32 v25, a231
    v_lshlrev_b32 v26, 16, v22
    s_waitcnt vmcnt(20)
    v_mfma_f32_16x16x32_bf16 v[80:83], a[56:59], a[128:131], v[80:83]
    buffer_load_dwordx4 a[52:55], v2, s[20:23], s34 offen offset:1024
    v_mfma_f32_16x16x32_bf16 v[84:87], a[56:59], a[132:135], v[84:87]
    v_and_b32 v27, 0xffff0000, v22
    v_lshlrev_b32 v28, 16, v23
    v_mfma_f32_16x16x32_bf16 v[88:91], a[56:59], a[136:139], v[88:91]
    v_and_b32 v29, 0xffff0000, v23
    v_mul_f32 v26, v26, v212
    v_mfma_f32_16x16x32_bf16 v[92:95], a[56:59], a[140:143], v[92:95]
    v_mul_f32 v27, v27, v213
    v_mul_f32 v28, v28, v214
    v_mfma_f32_16x16x32_bf16 v[96:99], a[60:63], a[128:131], v[96:99]
    buffer_load_dwordx4 a[56:59], v2, s[20:23], s34 offen offset:2048
    v_mfma_f32_16x16x32_bf16 v[100:103], a[60:63], a[132:135], v[100:103]
    v_mul_f32 v29, v29, v215
    v_cvt_pk_bf16_f32 v22, v26, v27
    v_mfma_f32_16x16x32_bf16 v[104:107], a[60:63], a[136:139], v[104:107]
    v_cvt_pk_bf16_f32 v23, v28, v29
    v_lshlrev_b32 v26, 16, v24
    v_mfma_f32_16x16x32_bf16 v[108:111], a[60:63], a[140:143], v[108:111]
    v_and_b32 v27, 0xffff0000, v24
    v_lshlrev_b32 v28, 16, v25
    v_mfma_f32_16x16x32_bf16 v[112:115], a[64:67], a[128:131], v[112:115]
    buffer_load_dwordx4 a[60:63], v2, s[20:23], s34 offen offset:3072
    v_mfma_f32_16x16x32_bf16 v[116:119], a[64:67], a[132:135], v[116:119]
    v_and_b32 v29, 0xffff0000, v25
    v_mul_f32 v26, v26, v228
    v_mfma_f32_16x16x32_bf16 v[120:123], a[64:67], a[136:139], v[120:123]
    v_mul_f32 v27, v27, v229
    v_mul_f32 v28, v28, v230
    v_mfma_f32_16x16x32_bf16 v[124:127], a[64:67], a[140:143], v[124:127]
    v_mul_f32 v29, v29, v231
    v_cvt_pk_bf16_f32 v24, v26, v27
    v_mfma_f32_16x16x32_bf16 v[128:131], a[68:71], a[128:131], v[128:131]
    s_mov_b32 s34, 790528
    v_cvt_pk_bf16_f32 v25, v28, v29
    v_mfma_f32_16x16x32_bf16 v[132:135], a[68:71], a[132:135], v[132:135]
    buffer_load_dwordx4 a[64:67], v2, s[20:23], s34 offen offset:0
    v_mfma_f32_16x16x32_bf16 v[136:139], a[68:71], a[136:139], v[136:139]
    ds_write_b128 v9, v[22:25] offset:9216
    v_mfma_f32_16x16x32_bf16 v[140:143], a[68:71], a[140:143], v[140:143]
    v_add_f32 v212, v212, v38
    v_add_f32 v213, v213, v39
    s_waitcnt lgkmcnt(1)
    v_mfma_f32_16x16x32_bf16 v[240:243], a[72:75], a[112:115], v[240:243]
    buffer_load_dwordx4 a[68:71], v2, s[20:23], s34 offen offset:1024
    v_mfma_f32_16x16x32_bf16 v[244:247], a[72:75], a[116:119], v[244:247]
    ds_read_b128 a[128:131], v2 offset:45056
    ds_read_b128 a[132:135], v2 offset:46080
    v_mfma_f32_16x16x32_bf16 v[248:251], a[72:75], a[120:123], v[248:251]
    ds_read_b128 a[136:139], v2 offset:47104
    ds_read_b128 a[140:143], v2 offset:48128
    v_mfma_f32_16x16x32_bf16 v[252:255], a[72:75], a[124:127], v[252:255]
    v_add_f32 v214, v214, v40
    v_add_f32 v215, v215, v41
    v_mfma_f32_16x16x32_bf16 v[48:51], a[76:79], a[112:115], v[48:51]
    buffer_load_dwordx4 a[72:75], v2, s[20:23], s34 offen offset:2048
    v_mfma_f32_16x16x32_bf16 v[52:55], a[76:79], a[116:119], v[52:55]
    v_add_f32 v228, v228, v42
    v_add_f32 v229, v229, v43
    v_mfma_f32_16x16x32_bf16 v[56:59], a[76:79], a[120:123], v[56:59]
    v_add_f32 v230, v230, v44
    v_add_f32 v231, v231, v45
    v_mfma_f32_16x16x32_bf16 v[60:63], a[76:79], a[124:127], v[60:63]
    v_accvgpr_read_b32 v14, a232
    v_accvgpr_read_b32 v15, a233
    v_mfma_f32_16x16x32_bf16 v[64:67], a[80:83], a[112:115], v[64:67]
    buffer_load_dwordx4 a[76:79], v2, s[20:23], s34 offen offset:3072
    v_mfma_f32_16x16x32_bf16 v[68:71], a[80:83], a[116:119], v[68:71]
    v_accvgpr_read_b32 v16, a234
    v_accvgpr_read_b32 v17, a235
    v_mfma_f32_16x16x32_bf16 v[72:75], a[80:83], a[120:123], v[72:75]
    v_lshlrev_b32 v18, 16, v14
    v_and_b32 v19, 0xffff0000, v14
    v_mfma_f32_16x16x32_bf16 v[76:79], a[80:83], a[124:127], v[76:79]
    v_lshlrev_b32 v20, 16, v15
    v_and_b32 v21, 0xffff0000, v15
    s_waitcnt vmcnt(20)
    v_mfma_f32_16x16x32_bf16 v[80:83], a[84:87], a[112:115], v[80:83]
    s_mov_b32 s34, 794624
    v_mul_f32 v18, v18, v216
    v_mfma_f32_16x16x32_bf16 v[84:87], a[84:87], a[116:119], v[84:87]
    buffer_load_dwordx4 a[80:83], v2, s[20:23], s34 offen offset:0
    v_mfma_f32_16x16x32_bf16 v[88:91], a[84:87], a[120:123], v[88:91]
    v_mul_f32 v19, v19, v217
    v_mul_f32 v20, v20, v218
    v_mfma_f32_16x16x32_bf16 v[92:95], a[84:87], a[124:127], v[92:95]
    v_mul_f32 v21, v21, v219
    v_cvt_pk_bf16_f32 v14, v18, v19
    v_mfma_f32_16x16x32_bf16 v[96:99], a[88:91], a[112:115], v[96:99]
    buffer_load_dwordx4 a[84:87], v2, s[20:23], s34 offen offset:1024
    v_mfma_f32_16x16x32_bf16 v[100:103], a[88:91], a[116:119], v[100:103]
    v_cvt_pk_bf16_f32 v15, v20, v21
    v_lshlrev_b32 v18, 16, v16
    v_mfma_f32_16x16x32_bf16 v[104:107], a[88:91], a[120:123], v[104:107]
    v_and_b32 v19, 0xffff0000, v16
    v_lshlrev_b32 v20, 16, v17
    v_mfma_f32_16x16x32_bf16 v[108:111], a[88:91], a[124:127], v[108:111]
    v_and_b32 v21, 0xffff0000, v17
    v_mul_f32 v18, v18, v232
    v_mfma_f32_16x16x32_bf16 v[112:115], a[92:95], a[112:115], v[112:115]
    buffer_load_dwordx4 a[88:91], v2, s[20:23], s34 offen offset:2048
    v_mfma_f32_16x16x32_bf16 v[116:119], a[92:95], a[116:119], v[116:119]
    v_mul_f32 v19, v19, v233
    v_mul_f32 v20, v20, v234
    v_mfma_f32_16x16x32_bf16 v[120:123], a[92:95], a[120:123], v[120:123]
    v_mul_f32 v21, v21, v235
    v_cvt_pk_bf16_f32 v16, v18, v19
    v_mfma_f32_16x16x32_bf16 v[124:127], a[92:95], a[124:127], v[124:127]
    v_cvt_pk_bf16_f32 v17, v20, v21
    v_mfma_f32_16x16x32_bf16 v[128:131], a[96:99], a[112:115], v[128:131]
    buffer_load_dwordx4 a[92:95], v2, s[20:23], s34 offen offset:3072
    v_mfma_f32_16x16x32_bf16 v[132:135], a[96:99], a[116:119], v[132:135]
    ds_write_b128 v9, v[14:17] offset:10240
    v_mfma_f32_16x16x32_bf16 v[136:139], a[96:99], a[120:123], v[136:139]
    v_add_f32 v216, v216, v38
    v_add_f32 v217, v217, v39
    v_mfma_f32_16x16x32_bf16 v[140:143], a[96:99], a[124:127], v[140:143]
    v_add_f32 v218, v218, v40
    v_add_f32 v219, v219, v41
    s_waitcnt lgkmcnt(1)
    v_mfma_f32_16x16x32_bf16 v[240:243], a[100:103], a[128:131], v[240:243]
    s_mov_b32 s34, 798720
    v_add_f32 v232, v232, v42
    v_mfma_f32_16x16x32_bf16 v[244:247], a[100:103], a[132:135], v[244:247]
    ds_read_b128 a[112:115], v2 offset:49152
    ds_read_b128 a[116:119], v2 offset:50176
    v_mfma_f32_16x16x32_bf16 v[248:251], a[100:103], a[136:139], v[248:251]
    ds_read_b128 a[120:123], v2 offset:51200
    ds_read_b128 a[124:127], v2 offset:52224
    v_mfma_f32_16x16x32_bf16 v[252:255], a[100:103], a[140:143], v[252:255]
    buffer_load_dwordx4 a[96:99], v2, s[20:23], s34 offen offset:0
    v_mfma_f32_16x16x32_bf16 v[48:51], a[104:107], a[128:131], v[48:51]
    buffer_load_dwordx4 a[100:103], v2, s[20:23], s34 offen offset:1024
    v_mfma_f32_16x16x32_bf16 v[52:55], a[104:107], a[132:135], v[52:55]
    v_add_f32 v233, v233, v43
    v_add_f32 v234, v234, v44
    v_mfma_f32_16x16x32_bf16 v[56:59], a[104:107], a[136:139], v[56:59]
    v_add_f32 v235, v235, v45
    v_accvgpr_read_b32 v22, a236
    v_mfma_f32_16x16x32_bf16 v[60:63], a[104:107], a[140:143], v[60:63]
    v_accvgpr_read_b32 v23, a237
    v_accvgpr_read_b32 v24, a238
    v_mfma_f32_16x16x32_bf16 v[64:67], a[108:111], a[128:131], v[64:67]
    buffer_load_dwordx4 a[104:107], v2, s[20:23], s34 offen offset:2048
    v_mfma_f32_16x16x32_bf16 v[68:71], a[108:111], a[132:135], v[68:71]
    v_accvgpr_read_b32 v25, a239
    v_lshlrev_b32 v26, 16, v22
    v_mfma_f32_16x16x32_bf16 v[72:75], a[108:111], a[136:139], v[72:75]
    v_and_b32 v27, 0xffff0000, v22
    v_lshlrev_b32 v28, 16, v23
    v_mfma_f32_16x16x32_bf16 v[76:79], a[108:111], a[140:143], v[76:79]
    v_and_b32 v29, 0xffff0000, v23
    v_mul_f32 v26, v26, v220
    s_waitcnt vmcnt(20)
    v_mfma_f32_16x16x32_bf16 v[80:83], a[0:3], a[128:131], v[80:83]
    buffer_load_dwordx4 a[108:111], v2, s[20:23], s34 offen offset:3072
    v_mfma_f32_16x16x32_bf16 v[84:87], a[0:3], a[132:135], v[84:87]
    v_mul_f32 v27, v27, v221
    v_mul_f32 v28, v28, v222
    v_mfma_f32_16x16x32_bf16 v[88:91], a[0:3], a[136:139], v[88:91]
    v_mul_f32 v29, v29, v223
    v_cvt_pk_bf16_f32 v22, v26, v27
    v_mfma_f32_16x16x32_bf16 v[92:95], a[0:3], a[140:143], v[92:95]
    v_cvt_pk_bf16_f32 v23, v28, v29
    v_lshlrev_b32 v26, 16, v24
    v_mfma_f32_16x16x32_bf16 v[96:99], a[4:7], a[128:131], v[96:99]
    s_mov_b32 s34, 802816
    v_and_b32 v27, 0xffff0000, v24
    v_mfma_f32_16x16x32_bf16 v[100:103], a[4:7], a[132:135], v[100:103]
    buffer_load_dwordx4 a[0:3], v2, s[20:23], s34 offen offset:0
    v_mfma_f32_16x16x32_bf16 v[104:107], a[4:7], a[136:139], v[104:107]
    v_lshlrev_b32 v28, 16, v25
    v_and_b32 v29, 0xffff0000, v25
    v_mfma_f32_16x16x32_bf16 v[108:111], a[4:7], a[140:143], v[108:111]
    v_mul_f32 v26, v26, v236
    v_mul_f32 v27, v27, v237
    v_mfma_f32_16x16x32_bf16 v[112:115], a[8:11], a[128:131], v[112:115]
    buffer_load_dwordx4 a[4:7], v2, s[20:23], s34 offen offset:1024
    v_mfma_f32_16x16x32_bf16 v[116:119], a[8:11], a[132:135], v[116:119]
    v_mul_f32 v28, v28, v238
    v_mul_f32 v29, v29, v239
    v_mfma_f32_16x16x32_bf16 v[120:123], a[8:11], a[136:139], v[120:123]
    v_cvt_pk_bf16_f32 v24, v26, v27
    v_cvt_pk_bf16_f32 v25, v28, v29
    v_mfma_f32_16x16x32_bf16 v[124:127], a[8:11], a[140:143], v[124:127]
    ds_write_b128 v9, v[22:25] offset:11264
    v_mfma_f32_16x16x32_bf16 v[128:131], a[12:15], a[128:131], v[128:131]
    buffer_load_dwordx4 a[8:11], v2, s[20:23], s34 offen offset:2048
    v_mfma_f32_16x16x32_bf16 v[132:135], a[12:15], a[132:135], v[132:135]
    v_add_f32 v220, v220, v38
    v_add_f32 v221, v221, v39
    v_mfma_f32_16x16x32_bf16 v[136:139], a[12:15], a[136:139], v[136:139]
    v_add_f32 v222, v222, v40
    v_add_f32 v223, v223, v41
    v_mfma_f32_16x16x32_bf16 v[140:143], a[12:15], a[140:143], v[140:143]
    v_add_f32 v236, v236, v42
    v_add_f32 v237, v237, v43
    s_waitcnt lgkmcnt(1)
    v_mfma_f32_16x16x32_bf16 v[240:243], a[16:19], a[112:115], v[240:243]
    buffer_load_dwordx4 a[12:15], v2, s[20:23], s34 offen offset:3072
    v_mfma_f32_16x16x32_bf16 v[244:247], a[16:19], a[116:119], v[244:247]
    ds_read_b128 a[128:131], v2 offset:53248
    ds_read_b128 a[132:135], v2 offset:54272
    v_mfma_f32_16x16x32_bf16 v[248:251], a[16:19], a[120:123], v[248:251]
    ds_read_b128 a[136:139], v2 offset:55296
    ds_read_b128 a[140:143], v2 offset:56320
    v_mfma_f32_16x16x32_bf16 v[252:255], a[16:19], a[124:127], v[252:255]
    v_add_f32 v238, v238, v44
    v_add_f32 v239, v239, v45
    v_mfma_f32_16x16x32_bf16 v[48:51], a[20:23], a[112:115], v[48:51]
    s_mov_b32 s34, 806912
    v_mfma_f32_16x16x32_bf16 v[52:55], a[20:23], a[116:119], v[52:55]
    buffer_load_dwordx4 a[16:19], v2, s[20:23], s34 offen offset:0
    v_mfma_f32_16x16x32_bf16 v[56:59], a[20:23], a[120:123], v[56:59]
    v_mfma_f32_16x16x32_bf16 v[60:63], a[20:23], a[124:127], v[60:63]
    v_mfma_f32_16x16x32_bf16 v[64:67], a[24:27], a[112:115], v[64:67]
    buffer_load_dwordx4 a[20:23], v2, s[20:23], s34 offen offset:1024
    v_mfma_f32_16x16x32_bf16 v[68:71], a[24:27], a[116:119], v[68:71]
    v_mfma_f32_16x16x32_bf16 v[72:75], a[24:27], a[120:123], v[72:75]
    v_mfma_f32_16x16x32_bf16 v[76:79], a[24:27], a[124:127], v[76:79]
    s_waitcnt vmcnt(20)
    v_mfma_f32_16x16x32_bf16 v[80:83], a[28:31], a[112:115], v[80:83]
    buffer_load_dwordx4 a[24:27], v2, s[20:23], s34 offen offset:2048
    v_mfma_f32_16x16x32_bf16 v[84:87], a[28:31], a[116:119], v[84:87]
    v_mfma_f32_16x16x32_bf16 v[88:91], a[28:31], a[120:123], v[88:91]
    v_mfma_f32_16x16x32_bf16 v[92:95], a[28:31], a[124:127], v[92:95]
    v_mfma_f32_16x16x32_bf16 v[96:99], a[32:35], a[112:115], v[96:99]
    buffer_load_dwordx4 a[28:31], v2, s[20:23], s34 offen offset:3072
    v_mfma_f32_16x16x32_bf16 v[100:103], a[32:35], a[116:119], v[100:103]
    v_mfma_f32_16x16x32_bf16 v[104:107], a[32:35], a[120:123], v[104:107]
    v_mfma_f32_16x16x32_bf16 v[108:111], a[32:35], a[124:127], v[108:111]
    v_mfma_f32_16x16x32_bf16 v[112:115], a[36:39], a[112:115], v[112:115]
    s_mov_b32 s34, 811008
    v_mfma_f32_16x16x32_bf16 v[116:119], a[36:39], a[116:119], v[116:119]
    buffer_load_dwordx4 a[32:35], v2, s[20:23], s34 offen offset:0
    v_mfma_f32_16x16x32_bf16 v[120:123], a[36:39], a[120:123], v[120:123]
    v_mfma_f32_16x16x32_bf16 v[124:127], a[36:39], a[124:127], v[124:127]
    v_mfma_f32_16x16x32_bf16 v[128:131], a[40:43], a[112:115], v[128:131]
    buffer_load_dwordx4 a[36:39], v2, s[20:23], s34 offen offset:1024
    v_mfma_f32_16x16x32_bf16 v[132:135], a[40:43], a[116:119], v[132:135]
    v_mfma_f32_16x16x32_bf16 v[136:139], a[40:43], a[120:123], v[136:139]
    v_mfma_f32_16x16x32_bf16 v[140:143], a[40:43], a[124:127], v[140:143]
    s_waitcnt lgkmcnt(0)
    s_barrier
    v_mfma_f32_16x16x32_bf16 v[240:243], a[44:47], a[128:131], v[240:243]
    buffer_load_dwordx4 a[40:43], v2, s[20:23], s34 offen offset:2048
    v_mfma_f32_16x16x32_bf16 v[244:247], a[44:47], a[132:135], v[244:247]
    ds_read_b128 a[112:115], v4 offset:0
    ds_read_b128 a[116:119], v4 offset:1024
    v_mfma_f32_16x16x32_bf16 v[248:251], a[44:47], a[136:139], v[248:251]
    ds_read_b128 a[120:123], v4 offset:2048
    ds_read_b128 a[124:127], v4 offset:3072
    v_mfma_f32_16x16x32_bf16 v[252:255], a[44:47], a[140:143], v[252:255]
    v_mfma_f32_16x16x32_bf16 v[48:51], a[48:51], a[128:131], v[48:51]
    buffer_load_dwordx4 a[44:47], v2, s[20:23], s34 offen offset:3072
    v_mfma_f32_16x16x32_bf16 v[52:55], a[48:51], a[132:135], v[52:55]
    v_mfma_f32_16x16x32_bf16 v[56:59], a[48:51], a[136:139], v[56:59]
    v_mfma_f32_16x16x32_bf16 v[60:63], a[48:51], a[140:143], v[60:63]
    v_mfma_f32_16x16x32_bf16 v[64:67], a[52:55], a[128:131], v[64:67]
    s_mov_b32 s34, 815104
    v_mfma_f32_16x16x32_bf16 v[68:71], a[52:55], a[132:135], v[68:71]
    buffer_load_dwordx4 a[48:51], v2, s[20:23], s34 offen offset:0
    v_mfma_f32_16x16x32_bf16 v[72:75], a[52:55], a[136:139], v[72:75]
    v_mfma_f32_16x16x32_bf16 v[76:79], a[52:55], a[140:143], v[76:79]
    s_waitcnt vmcnt(20)
    v_mfma_f32_16x16x32_bf16 v[80:83], a[56:59], a[128:131], v[80:83]
    buffer_load_dwordx4 a[52:55], v2, s[20:23], s34 offen offset:1024
    v_mfma_f32_16x16x32_bf16 v[84:87], a[56:59], a[132:135], v[84:87]
    v_mfma_f32_16x16x32_bf16 v[88:91], a[56:59], a[136:139], v[88:91]
    v_mfma_f32_16x16x32_bf16 v[92:95], a[56:59], a[140:143], v[92:95]
    v_mfma_f32_16x16x32_bf16 v[96:99], a[60:63], a[128:131], v[96:99]
    buffer_load_dwordx4 a[56:59], v2, s[20:23], s34 offen offset:2048
    v_mfma_f32_16x16x32_bf16 v[100:103], a[60:63], a[132:135], v[100:103]
    v_mfma_f32_16x16x32_bf16 v[104:107], a[60:63], a[136:139], v[104:107]
    v_mfma_f32_16x16x32_bf16 v[108:111], a[60:63], a[140:143], v[108:111]
    v_mfma_f32_16x16x32_bf16 v[112:115], a[64:67], a[128:131], v[112:115]
    buffer_load_dwordx4 a[60:63], v2, s[20:23], s34 offen offset:3072
    v_mfma_f32_16x16x32_bf16 v[116:119], a[64:67], a[132:135], v[116:119]
    v_mfma_f32_16x16x32_bf16 v[120:123], a[64:67], a[136:139], v[120:123]
    v_mfma_f32_16x16x32_bf16 v[124:127], a[64:67], a[140:143], v[124:127]
    v_mfma_f32_16x16x32_bf16 v[128:131], a[68:71], a[128:131], v[128:131]
    s_mov_b32 s34, 819200
    v_mfma_f32_16x16x32_bf16 v[132:135], a[68:71], a[132:135], v[132:135]
    buffer_load_dwordx4 a[64:67], v2, s[20:23], s34 offen offset:0
    v_mfma_f32_16x16x32_bf16 v[136:139], a[68:71], a[136:139], v[136:139]
    v_mfma_f32_16x16x32_bf16 v[140:143], a[68:71], a[140:143], v[140:143]
    s_waitcnt lgkmcnt(0)
    v_mfma_f32_16x16x32_bf16 v[240:243], a[72:75], a[112:115], v[240:243]
    buffer_load_dwordx4 a[68:71], v2, s[20:23], s34 offen offset:1024
    v_mfma_f32_16x16x32_bf16 v[244:247], a[72:75], a[116:119], v[244:247]
    ds_read_b128 a[128:131], v4 offset:4096
    ds_read_b128 a[132:135], v4 offset:5120
    v_mfma_f32_16x16x32_bf16 v[248:251], a[72:75], a[120:123], v[248:251]
    ds_read_b128 a[136:139], v4 offset:6144
    ds_read_b128 a[140:143], v4 offset:7168
    v_mfma_f32_16x16x32_bf16 v[252:255], a[72:75], a[124:127], v[252:255]
    v_mfma_f32_16x16x32_bf16 v[48:51], a[76:79], a[112:115], v[48:51]
    buffer_load_dwordx4 a[72:75], v2, s[20:23], s34 offen offset:2048
    v_mfma_f32_16x16x32_bf16 v[52:55], a[76:79], a[116:119], v[52:55]
    v_mfma_f32_16x16x32_bf16 v[56:59], a[76:79], a[120:123], v[56:59]
    v_mfma_f32_16x16x32_bf16 v[60:63], a[76:79], a[124:127], v[60:63]
    v_mfma_f32_16x16x32_bf16 v[64:67], a[80:83], a[112:115], v[64:67]
    buffer_load_dwordx4 a[76:79], v2, s[20:23], s34 offen offset:3072
    v_mfma_f32_16x16x32_bf16 v[68:71], a[80:83], a[116:119], v[68:71]
    v_mfma_f32_16x16x32_bf16 v[72:75], a[80:83], a[120:123], v[72:75]
    v_mfma_f32_16x16x32_bf16 v[76:79], a[80:83], a[124:127], v[76:79]
    s_waitcnt vmcnt(20)
    v_mfma_f32_16x16x32_bf16 v[80:83], a[84:87], a[112:115], v[80:83]
    s_mov_b32 s34, 823296
    v_mfma_f32_16x16x32_bf16 v[84:87], a[84:87], a[116:119], v[84:87]
    buffer_load_dwordx4 a[80:83], v2, s[20:23], s34 offen offset:0
    v_mfma_f32_16x16x32_bf16 v[88:91], a[84:87], a[120:123], v[88:91]
    v_mfma_f32_16x16x32_bf16 v[92:95], a[84:87], a[124:127], v[92:95]
    v_mfma_f32_16x16x32_bf16 v[96:99], a[88:91], a[112:115], v[96:99]
    buffer_load_dwordx4 a[84:87], v2, s[20:23], s34 offen offset:1024
    v_mfma_f32_16x16x32_bf16 v[100:103], a[88:91], a[116:119], v[100:103]
    v_mfma_f32_16x16x32_bf16 v[104:107], a[88:91], a[120:123], v[104:107]
    v_mfma_f32_16x16x32_bf16 v[108:111], a[88:91], a[124:127], v[108:111]
    v_mfma_f32_16x16x32_bf16 v[112:115], a[92:95], a[112:115], v[112:115]
    buffer_load_dwordx4 a[88:91], v2, s[20:23], s34 offen offset:2048
    v_mfma_f32_16x16x32_bf16 v[116:119], a[92:95], a[116:119], v[116:119]
    v_mfma_f32_16x16x32_bf16 v[120:123], a[92:95], a[120:123], v[120:123]
    v_mfma_f32_16x16x32_bf16 v[124:127], a[92:95], a[124:127], v[124:127]
    v_mfma_f32_16x16x32_bf16 v[128:131], a[96:99], a[112:115], v[128:131]
    buffer_load_dwordx4 a[92:95], v2, s[20:23], s34 offen offset:3072
    v_mfma_f32_16x16x32_bf16 v[132:135], a[96:99], a[116:119], v[132:135]
    v_mfma_f32_16x16x32_bf16 v[136:139], a[96:99], a[120:123], v[136:139]
    v_mfma_f32_16x16x32_bf16 v[140:143], a[96:99], a[124:127], v[140:143]
    s_waitcnt lgkmcnt(0)
    v_mfma_f32_16x16x32_bf16 v[240:243], a[100:103], a[128:131], v[240:243]
    s_mov_b32 s34, 827392
    v_mfma_f32_16x16x32_bf16 v[244:247], a[100:103], a[132:135], v[244:247]
    ds_read_b128 a[112:115], v4 offset:8192
    ds_read_b128 a[116:119], v4 offset:9216
    v_mfma_f32_16x16x32_bf16 v[248:251], a[100:103], a[136:139], v[248:251]
    ds_read_b128 a[120:123], v4 offset:10240
    ds_read_b128 a[124:127], v4 offset:11264
    v_mfma_f32_16x16x32_bf16 v[252:255], a[100:103], a[140:143], v[252:255]
    buffer_load_dwordx4 a[96:99], v2, s[20:23], s34 offen offset:0
    v_mfma_f32_16x16x32_bf16 v[48:51], a[104:107], a[128:131], v[48:51]
    buffer_load_dwordx4 a[100:103], v2, s[20:23], s34 offen offset:1024
    v_mfma_f32_16x16x32_bf16 v[52:55], a[104:107], a[132:135], v[52:55]
    v_mfma_f32_16x16x32_bf16 v[56:59], a[104:107], a[136:139], v[56:59]
    v_mfma_f32_16x16x32_bf16 v[60:63], a[104:107], a[140:143], v[60:63]
    v_mfma_f32_16x16x32_bf16 v[64:67], a[108:111], a[128:131], v[64:67]
    buffer_load_dwordx4 a[104:107], v2, s[20:23], s34 offen offset:2048
    v_mfma_f32_16x16x32_bf16 v[68:71], a[108:111], a[132:135], v[68:71]
    v_mfma_f32_16x16x32_bf16 v[72:75], a[108:111], a[136:139], v[72:75]
    v_mfma_f32_16x16x32_bf16 v[76:79], a[108:111], a[140:143], v[76:79]
    s_waitcnt vmcnt(20)
    v_mfma_f32_16x16x32_bf16 v[80:83], a[0:3], a[128:131], v[80:83]
    buffer_load_dwordx4 a[108:111], v2, s[20:23], s34 offen offset:3072
    v_mfma_f32_16x16x32_bf16 v[84:87], a[0:3], a[132:135], v[84:87]
    v_mfma_f32_16x16x32_bf16 v[88:91], a[0:3], a[136:139], v[88:91]
    v_mfma_f32_16x16x32_bf16 v[92:95], a[0:3], a[140:143], v[92:95]
    v_mfma_f32_16x16x32_bf16 v[96:99], a[4:7], a[128:131], v[96:99]
    s_mov_b32 s34, 831488
    v_mfma_f32_16x16x32_bf16 v[100:103], a[4:7], a[132:135], v[100:103]
    buffer_load_dwordx4 a[0:3], v2, s[20:23], s34 offen offset:0
    v_mfma_f32_16x16x32_bf16 v[104:107], a[4:7], a[136:139], v[104:107]
    v_mfma_f32_16x16x32_bf16 v[108:111], a[4:7], a[140:143], v[108:111]
    v_mfma_f32_16x16x32_bf16 v[112:115], a[8:11], a[128:131], v[112:115]
    buffer_load_dwordx4 a[4:7], v2, s[20:23], s34 offen offset:1024
    v_mfma_f32_16x16x32_bf16 v[116:119], a[8:11], a[132:135], v[116:119]
    v_mfma_f32_16x16x32_bf16 v[120:123], a[8:11], a[136:139], v[120:123]
    v_mfma_f32_16x16x32_bf16 v[124:127], a[8:11], a[140:143], v[124:127]
    v_mfma_f32_16x16x32_bf16 v[128:131], a[12:15], a[128:131], v[128:131]
    buffer_load_dwordx4 a[8:11], v2, s[20:23], s34 offen offset:2048
    v_mfma_f32_16x16x32_bf16 v[132:135], a[12:15], a[132:135], v[132:135]
    v_mfma_f32_16x16x32_bf16 v[136:139], a[12:15], a[136:139], v[136:139]
    v_mfma_f32_16x16x32_bf16 v[140:143], a[12:15], a[140:143], v[140:143]
    s_waitcnt lgkmcnt(0)
    v_mfma_f32_16x16x32_bf16 v[240:243], a[16:19], a[112:115], v[240:243]
    buffer_load_dwordx4 a[12:15], v2, s[20:23], s34 offen offset:3072
    v_mfma_f32_16x16x32_bf16 v[244:247], a[16:19], a[116:119], v[244:247]
    ds_read_b128 a[128:131], v4 offset:12288
    ds_read_b128 a[132:135], v4 offset:13312
    v_mfma_f32_16x16x32_bf16 v[248:251], a[16:19], a[120:123], v[248:251]
    ds_read_b128 a[136:139], v4 offset:14336
    ds_read_b128 a[140:143], v4 offset:15360
    v_mfma_f32_16x16x32_bf16 v[252:255], a[16:19], a[124:127], v[252:255]
    v_mfma_f32_16x16x32_bf16 v[48:51], a[20:23], a[112:115], v[48:51]
    s_mov_b32 s34, 835584
    v_mfma_f32_16x16x32_bf16 v[52:55], a[20:23], a[116:119], v[52:55]
    buffer_load_dwordx4 a[16:19], v2, s[20:23], s34 offen offset:0
    v_mfma_f32_16x16x32_bf16 v[56:59], a[20:23], a[120:123], v[56:59]
    v_mfma_f32_16x16x32_bf16 v[60:63], a[20:23], a[124:127], v[60:63]
    v_mfma_f32_16x16x32_bf16 v[64:67], a[24:27], a[112:115], v[64:67]
    buffer_load_dwordx4 a[20:23], v2, s[20:23], s34 offen offset:1024
    v_mfma_f32_16x16x32_bf16 v[68:71], a[24:27], a[116:119], v[68:71]
    v_mfma_f32_16x16x32_bf16 v[72:75], a[24:27], a[120:123], v[72:75]
    v_mfma_f32_16x16x32_bf16 v[76:79], a[24:27], a[124:127], v[76:79]
    s_waitcnt vmcnt(20)
    v_mfma_f32_16x16x32_bf16 v[80:83], a[28:31], a[112:115], v[80:83]
    buffer_load_dwordx4 a[24:27], v2, s[20:23], s34 offen offset:2048
    v_mfma_f32_16x16x32_bf16 v[84:87], a[28:31], a[116:119], v[84:87]
    v_mfma_f32_16x16x32_bf16 v[88:91], a[28:31], a[120:123], v[88:91]
    v_mfma_f32_16x16x32_bf16 v[92:95], a[28:31], a[124:127], v[92:95]
    v_mfma_f32_16x16x32_bf16 v[96:99], a[32:35], a[112:115], v[96:99]
    buffer_load_dwordx4 a[28:31], v2, s[20:23], s34 offen offset:3072
    v_mfma_f32_16x16x32_bf16 v[100:103], a[32:35], a[116:119], v[100:103]
    v_mfma_f32_16x16x32_bf16 v[104:107], a[32:35], a[120:123], v[104:107]
    v_mfma_f32_16x16x32_bf16 v[108:111], a[32:35], a[124:127], v[108:111]
    v_mfma_f32_16x16x32_bf16 v[112:115], a[36:39], a[112:115], v[112:115]
    s_mov_b32 s34, 839680
    v_mfma_f32_16x16x32_bf16 v[116:119], a[36:39], a[116:119], v[116:119]
    buffer_load_dwordx4 a[32:35], v2, s[20:23], s34 offen offset:0
    v_mfma_f32_16x16x32_bf16 v[120:123], a[36:39], a[120:123], v[120:123]
    v_mfma_f32_16x16x32_bf16 v[124:127], a[36:39], a[124:127], v[124:127]
    v_mfma_f32_16x16x32_bf16 v[128:131], a[40:43], a[112:115], v[128:131]
    buffer_load_dwordx4 a[36:39], v2, s[20:23], s34 offen offset:1024
    v_mfma_f32_16x16x32_bf16 v[132:135], a[40:43], a[116:119], v[132:135]
    v_mfma_f32_16x16x32_bf16 v[136:139], a[40:43], a[120:123], v[136:139]
    v_mfma_f32_16x16x32_bf16 v[140:143], a[40:43], a[124:127], v[140:143]
    s_waitcnt lgkmcnt(0)
    v_mfma_f32_16x16x32_bf16 v[240:243], a[44:47], a[128:131], v[240:243]
    buffer_load_dwordx4 a[40:43], v2, s[20:23], s34 offen offset:2048
    v_mfma_f32_16x16x32_bf16 v[244:247], a[44:47], a[132:135], v[244:247]
    ds_read_b128 a[112:115], v4 offset:16384
    ds_read_b128 a[116:119], v4 offset:17408
    v_mfma_f32_16x16x32_bf16 v[248:251], a[44:47], a[136:139], v[248:251]
    ds_read_b128 a[120:123], v4 offset:18432
    ds_read_b128 a[124:127], v4 offset:19456
    v_mfma_f32_16x16x32_bf16 v[252:255], a[44:47], a[140:143], v[252:255]
    v_mfma_f32_16x16x32_bf16 v[48:51], a[48:51], a[128:131], v[48:51]
    buffer_load_dwordx4 a[44:47], v2, s[20:23], s34 offen offset:3072
    v_mfma_f32_16x16x32_bf16 v[52:55], a[48:51], a[132:135], v[52:55]
    v_mfma_f32_16x16x32_bf16 v[56:59], a[48:51], a[136:139], v[56:59]
    v_mfma_f32_16x16x32_bf16 v[60:63], a[48:51], a[140:143], v[60:63]
    v_mfma_f32_16x16x32_bf16 v[64:67], a[52:55], a[128:131], v[64:67]
    s_mov_b32 s34, 843776
    v_mfma_f32_16x16x32_bf16 v[68:71], a[52:55], a[132:135], v[68:71]
    buffer_load_dwordx4 a[48:51], v2, s[20:23], s34 offen offset:0
    v_mfma_f32_16x16x32_bf16 v[72:75], a[52:55], a[136:139], v[72:75]
    v_mfma_f32_16x16x32_bf16 v[76:79], a[52:55], a[140:143], v[76:79]
    s_waitcnt vmcnt(20)
    v_mfma_f32_16x16x32_bf16 v[80:83], a[56:59], a[128:131], v[80:83]
    buffer_load_dwordx4 a[52:55], v2, s[20:23], s34 offen offset:1024
    v_mfma_f32_16x16x32_bf16 v[84:87], a[56:59], a[132:135], v[84:87]
    v_mfma_f32_16x16x32_bf16 v[88:91], a[56:59], a[136:139], v[88:91]
    v_mfma_f32_16x16x32_bf16 v[92:95], a[56:59], a[140:143], v[92:95]
    v_mfma_f32_16x16x32_bf16 v[96:99], a[60:63], a[128:131], v[96:99]
    buffer_load_dwordx4 a[56:59], v2, s[20:23], s34 offen offset:2048
    v_mfma_f32_16x16x32_bf16 v[100:103], a[60:63], a[132:135], v[100:103]
    v_mfma_f32_16x16x32_bf16 v[104:107], a[60:63], a[136:139], v[104:107]
    v_mfma_f32_16x16x32_bf16 v[108:111], a[60:63], a[140:143], v[108:111]
    v_mfma_f32_16x16x32_bf16 v[112:115], a[64:67], a[128:131], v[112:115]
    buffer_load_dwordx4 a[60:63], v2, s[20:23], s34 offen offset:3072
    v_mfma_f32_16x16x32_bf16 v[116:119], a[64:67], a[132:135], v[116:119]
    v_mfma_f32_16x16x32_bf16 v[120:123], a[64:67], a[136:139], v[120:123]
    v_mfma_f32_16x16x32_bf16 v[124:127], a[64:67], a[140:143], v[124:127]
    v_mfma_f32_16x16x32_bf16 v[128:131], a[68:71], a[128:131], v[128:131]
    s_mov_b32 s34, 847872
    v_mfma_f32_16x16x32_bf16 v[132:135], a[68:71], a[132:135], v[132:135]
    buffer_load_dwordx4 a[64:67], v2, s[20:23], s34 offen offset:0
    v_mfma_f32_16x16x32_bf16 v[136:139], a[68:71], a[136:139], v[136:139]
    v_mfma_f32_16x16x32_bf16 v[140:143], a[68:71], a[140:143], v[140:143]
    s_waitcnt lgkmcnt(0)
    v_mfma_f32_16x16x32_bf16 v[240:243], a[72:75], a[112:115], v[240:243]
    buffer_load_dwordx4 a[68:71], v2, s[20:23], s34 offen offset:1024
    v_mfma_f32_16x16x32_bf16 v[244:247], a[72:75], a[116:119], v[244:247]
    ds_read_b128 a[128:131], v4 offset:20480
    ds_read_b128 a[132:135], v4 offset:21504
    v_mfma_f32_16x16x32_bf16 v[248:251], a[72:75], a[120:123], v[248:251]
    ds_read_b128 a[136:139], v4 offset:22528
    ds_read_b128 a[140:143], v4 offset:23552
    v_mfma_f32_16x16x32_bf16 v[252:255], a[72:75], a[124:127], v[252:255]
    v_mfma_f32_16x16x32_bf16 v[48:51], a[76:79], a[112:115], v[48:51]
    buffer_load_dwordx4 a[72:75], v2, s[20:23], s34 offen offset:2048
    v_mfma_f32_16x16x32_bf16 v[52:55], a[76:79], a[116:119], v[52:55]
    v_mfma_f32_16x16x32_bf16 v[56:59], a[76:79], a[120:123], v[56:59]
    v_mfma_f32_16x16x32_bf16 v[60:63], a[76:79], a[124:127], v[60:63]
    v_mfma_f32_16x16x32_bf16 v[64:67], a[80:83], a[112:115], v[64:67]
    buffer_load_dwordx4 a[76:79], v2, s[20:23], s34 offen offset:3072
    v_mfma_f32_16x16x32_bf16 v[68:71], a[80:83], a[116:119], v[68:71]
    v_mfma_f32_16x16x32_bf16 v[72:75], a[80:83], a[120:123], v[72:75]
    v_mfma_f32_16x16x32_bf16 v[76:79], a[80:83], a[124:127], v[76:79]
    s_waitcnt vmcnt(20)
    v_mfma_f32_16x16x32_bf16 v[80:83], a[84:87], a[112:115], v[80:83]
    s_mov_b32 s34, 851968
    v_mfma_f32_16x16x32_bf16 v[84:87], a[84:87], a[116:119], v[84:87]
    buffer_load_dwordx4 a[80:83], v2, s[20:23], s34 offen offset:0
    v_mfma_f32_16x16x32_bf16 v[88:91], a[84:87], a[120:123], v[88:91]
    v_mfma_f32_16x16x32_bf16 v[92:95], a[84:87], a[124:127], v[92:95]
    v_mfma_f32_16x16x32_bf16 v[96:99], a[88:91], a[112:115], v[96:99]
    buffer_load_dwordx4 a[84:87], v2, s[20:23], s34 offen offset:1024
    v_mfma_f32_16x16x32_bf16 v[100:103], a[88:91], a[116:119], v[100:103]
    v_mfma_f32_16x16x32_bf16 v[104:107], a[88:91], a[120:123], v[104:107]
    v_mfma_f32_16x16x32_bf16 v[108:111], a[88:91], a[124:127], v[108:111]
    v_mfma_f32_16x16x32_bf16 v[112:115], a[92:95], a[112:115], v[112:115]
    buffer_load_dwordx4 a[88:91], v2, s[20:23], s34 offen offset:2048
    v_mfma_f32_16x16x32_bf16 v[116:119], a[92:95], a[116:119], v[116:119]
    v_mfma_f32_16x16x32_bf16 v[120:123], a[92:95], a[120:123], v[120:123]
    v_mfma_f32_16x16x32_bf16 v[124:127], a[92:95], a[124:127], v[124:127]
    v_mfma_f32_16x16x32_bf16 v[128:131], a[96:99], a[112:115], v[128:131]
    buffer_load_dwordx4 a[92:95], v2, s[20:23], s34 offen offset:3072
    v_mfma_f32_16x16x32_bf16 v[132:135], a[96:99], a[116:119], v[132:135]
    v_mfma_f32_16x16x32_bf16 v[136:139], a[96:99], a[120:123], v[136:139]
    v_mfma_f32_16x16x32_bf16 v[140:143], a[96:99], a[124:127], v[140:143]
    s_waitcnt lgkmcnt(0)
    v_mfma_f32_16x16x32_bf16 v[240:243], a[100:103], a[128:131], v[240:243]
    s_mov_b32 s34, 856064
    v_mfma_f32_16x16x32_bf16 v[244:247], a[100:103], a[132:135], v[244:247]
    ds_read_b128 a[112:115], v4 offset:24576
    ds_read_b128 a[116:119], v4 offset:25600
    v_mfma_f32_16x16x32_bf16 v[248:251], a[100:103], a[136:139], v[248:251]
    ds_read_b128 a[120:123], v4 offset:26624
    ds_read_b128 a[124:127], v4 offset:27648
    v_mfma_f32_16x16x32_bf16 v[252:255], a[100:103], a[140:143], v[252:255]
    buffer_load_dwordx4 a[96:99], v2, s[20:23], s34 offen offset:0
    v_mfma_f32_16x16x32_bf16 v[48:51], a[104:107], a[128:131], v[48:51]
    buffer_load_dwordx4 a[100:103], v2, s[20:23], s34 offen offset:1024
    v_mfma_f32_16x16x32_bf16 v[52:55], a[104:107], a[132:135], v[52:55]
    v_mfma_f32_16x16x32_bf16 v[56:59], a[104:107], a[136:139], v[56:59]
    v_mfma_f32_16x16x32_bf16 v[60:63], a[104:107], a[140:143], v[60:63]
    v_mfma_f32_16x16x32_bf16 v[64:67], a[108:111], a[128:131], v[64:67]
    buffer_load_dwordx4 a[104:107], v2, s[20:23], s34 offen offset:2048
    v_mfma_f32_16x16x32_bf16 v[68:71], a[108:111], a[132:135], v[68:71]
    v_mfma_f32_16x16x32_bf16 v[72:75], a[108:111], a[136:139], v[72:75]
    v_mfma_f32_16x16x32_bf16 v[76:79], a[108:111], a[140:143], v[76:79]
    s_waitcnt vmcnt(20)
    v_mfma_f32_16x16x32_bf16 v[80:83], a[0:3], a[128:131], v[80:83]
    buffer_load_dwordx4 a[108:111], v2, s[20:23], s34 offen offset:3072
    v_mfma_f32_16x16x32_bf16 v[84:87], a[0:3], a[132:135], v[84:87]
    v_mfma_f32_16x16x32_bf16 v[88:91], a[0:3], a[136:139], v[88:91]
    v_mfma_f32_16x16x32_bf16 v[92:95], a[0:3], a[140:143], v[92:95]
    v_mfma_f32_16x16x32_bf16 v[96:99], a[4:7], a[128:131], v[96:99]
    s_mov_b32 s34, 860160
    v_mfma_f32_16x16x32_bf16 v[100:103], a[4:7], a[132:135], v[100:103]
    buffer_load_dwordx4 a[0:3], v2, s[20:23], s34 offen offset:0
    v_mfma_f32_16x16x32_bf16 v[104:107], a[4:7], a[136:139], v[104:107]
    v_mfma_f32_16x16x32_bf16 v[108:111], a[4:7], a[140:143], v[108:111]
    v_mfma_f32_16x16x32_bf16 v[112:115], a[8:11], a[128:131], v[112:115]
    buffer_load_dwordx4 a[4:7], v2, s[20:23], s34 offen offset:1024
    v_mfma_f32_16x16x32_bf16 v[116:119], a[8:11], a[132:135], v[116:119]
    v_mfma_f32_16x16x32_bf16 v[120:123], a[8:11], a[136:139], v[120:123]
    v_mfma_f32_16x16x32_bf16 v[124:127], a[8:11], a[140:143], v[124:127]
    v_mfma_f32_16x16x32_bf16 v[128:131], a[12:15], a[128:131], v[128:131]
    buffer_load_dwordx4 a[8:11], v2, s[20:23], s34 offen offset:2048
    v_mfma_f32_16x16x32_bf16 v[132:135], a[12:15], a[132:135], v[132:135]
    v_mfma_f32_16x16x32_bf16 v[136:139], a[12:15], a[136:139], v[136:139]
    v_mfma_f32_16x16x32_bf16 v[140:143], a[12:15], a[140:143], v[140:143]
    s_waitcnt lgkmcnt(0)
    v_mfma_f32_16x16x32_bf16 v[240:243], a[16:19], a[112:115], v[240:243]
    buffer_load_dwordx4 a[12:15], v2, s[20:23], s34 offen offset:3072
    v_mfma_f32_16x16x32_bf16 v[244:247], a[16:19], a[116:119], v[244:247]
    ds_read_b128 a[128:131], v4 offset:28672
    ds_read_b128 a[132:135], v4 offset:29696
    v_mfma_f32_16x16x32_bf16 v[248:251], a[16:19], a[120:123], v[248:251]
    ds_read_b128 a[136:139], v4 offset:30720
    ds_read_b128 a[140:143], v4 offset:31744
    v_mfma_f32_16x16x32_bf16 v[252:255], a[16:19], a[124:127], v[252:255]
    v_mfma_f32_16x16x32_bf16 v[48:51], a[20:23], a[112:115], v[48:51]
    s_mov_b32 s34, 864256
    v_mfma_f32_16x16x32_bf16 v[52:55], a[20:23], a[116:119], v[52:55]
    buffer_load_dwordx4 a[16:19], v2, s[20:23], s34 offen offset:0
    v_mfma_f32_16x16x32_bf16 v[56:59], a[20:23], a[120:123], v[56:59]
    v_mfma_f32_16x16x32_bf16 v[60:63], a[20:23], a[124:127], v[60:63]
    v_mfma_f32_16x16x32_bf16 v[64:67], a[24:27], a[112:115], v[64:67]
    buffer_load_dwordx4 a[20:23], v2, s[20:23], s34 offen offset:1024
    v_mfma_f32_16x16x32_bf16 v[68:71], a[24:27], a[116:119], v[68:71]
    v_mfma_f32_16x16x32_bf16 v[72:75], a[24:27], a[120:123], v[72:75]
    v_mfma_f32_16x16x32_bf16 v[76:79], a[24:27], a[124:127], v[76:79]
    s_waitcnt vmcnt(20)
    v_mfma_f32_16x16x32_bf16 v[80:83], a[28:31], a[112:115], v[80:83]
    buffer_load_dwordx4 a[24:27], v2, s[20:23], s34 offen offset:2048
    v_mfma_f32_16x16x32_bf16 v[84:87], a[28:31], a[116:119], v[84:87]
    v_mfma_f32_16x16x32_bf16 v[88:91], a[28:31], a[120:123], v[88:91]
    v_mfma_f32_16x16x32_bf16 v[92:95], a[28:31], a[124:127], v[92:95]
    v_mfma_f32_16x16x32_bf16 v[96:99], a[32:35], a[112:115], v[96:99]
    buffer_load_dwordx4 a[28:31], v2, s[20:23], s34 offen offset:3072
    v_mfma_f32_16x16x32_bf16 v[100:103], a[32:35], a[116:119], v[100:103]
    v_mfma_f32_16x16x32_bf16 v[104:107], a[32:35], a[120:123], v[104:107]
    v_mfma_f32_16x16x32_bf16 v[108:111], a[32:35], a[124:127], v[108:111]
    v_mfma_f32_16x16x32_bf16 v[112:115], a[36:39], a[112:115], v[112:115]
    s_mov_b32 s34, 868352
    v_mfma_f32_16x16x32_bf16 v[116:119], a[36:39], a[116:119], v[116:119]
    buffer_load_dwordx4 a[32:35], v2, s[20:23], s34 offen offset:0
    v_mfma_f32_16x16x32_bf16 v[120:123], a[36:39], a[120:123], v[120:123]
    v_mfma_f32_16x16x32_bf16 v[124:127], a[36:39], a[124:127], v[124:127]
    v_mfma_f32_16x16x32_bf16 v[128:131], a[40:43], a[112:115], v[128:131]
    buffer_load_dwordx4 a[36:39], v2, s[20:23], s34 offen offset:1024
    v_mfma_f32_16x16x32_bf16 v[132:135], a[40:43], a[116:119], v[132:135]
    v_mfma_f32_16x16x32_bf16 v[136:139], a[40:43], a[120:123], v[136:139]
    v_mfma_f32_16x16x32_bf16 v[140:143], a[40:43], a[124:127], v[140:143]
    s_waitcnt lgkmcnt(0)
    v_mfma_f32_16x16x32_bf16 v[240:243], a[44:47], a[128:131], v[240:243]
    buffer_load_dwordx4 a[40:43], v2, s[20:23], s34 offen offset:2048
    v_mfma_f32_16x16x32_bf16 v[244:247], a[44:47], a[132:135], v[244:247]
    ds_read_b128 a[112:115], v4 offset:32768
    ds_read_b128 a[116:119], v4 offset:33792
    v_mfma_f32_16x16x32_bf16 v[248:251], a[44:47], a[136:139], v[248:251]
    ds_read_b128 a[120:123], v4 offset:34816
    ds_read_b128 a[124:127], v4 offset:35840
    v_mfma_f32_16x16x32_bf16 v[252:255], a[44:47], a[140:143], v[252:255]
    v_mfma_f32_16x16x32_bf16 v[48:51], a[48:51], a[128:131], v[48:51]
    buffer_load_dwordx4 a[44:47], v2, s[20:23], s34 offen offset:3072
    v_mfma_f32_16x16x32_bf16 v[52:55], a[48:51], a[132:135], v[52:55]
    v_mfma_f32_16x16x32_bf16 v[56:59], a[48:51], a[136:139], v[56:59]
    v_mfma_f32_16x16x32_bf16 v[60:63], a[48:51], a[140:143], v[60:63]
    v_mfma_f32_16x16x32_bf16 v[64:67], a[52:55], a[128:131], v[64:67]
    s_mov_b32 s34, 872448
    v_mfma_f32_16x16x32_bf16 v[68:71], a[52:55], a[132:135], v[68:71]
    buffer_load_dwordx4 a[48:51], v2, s[20:23], s34 offen offset:0
    v_mfma_f32_16x16x32_bf16 v[72:75], a[52:55], a[136:139], v[72:75]
    v_mfma_f32_16x16x32_bf16 v[76:79], a[52:55], a[140:143], v[76:79]
    s_waitcnt vmcnt(20)
    v_mfma_f32_16x16x32_bf16 v[80:83], a[56:59], a[128:131], v[80:83]
    buffer_load_dwordx4 a[52:55], v2, s[20:23], s34 offen offset:1024
    v_mfma_f32_16x16x32_bf16 v[84:87], a[56:59], a[132:135], v[84:87]
    v_mfma_f32_16x16x32_bf16 v[88:91], a[56:59], a[136:139], v[88:91]
    v_mfma_f32_16x16x32_bf16 v[92:95], a[56:59], a[140:143], v[92:95]
    v_mfma_f32_16x16x32_bf16 v[96:99], a[60:63], a[128:131], v[96:99]
    buffer_load_dwordx4 a[56:59], v2, s[20:23], s34 offen offset:2048
    v_mfma_f32_16x16x32_bf16 v[100:103], a[60:63], a[132:135], v[100:103]
    v_mfma_f32_16x16x32_bf16 v[104:107], a[60:63], a[136:139], v[104:107]
    v_mfma_f32_16x16x32_bf16 v[108:111], a[60:63], a[140:143], v[108:111]
    v_mfma_f32_16x16x32_bf16 v[112:115], a[64:67], a[128:131], v[112:115]
    buffer_load_dwordx4 a[60:63], v2, s[20:23], s34 offen offset:3072
    v_mfma_f32_16x16x32_bf16 v[116:119], a[64:67], a[132:135], v[116:119]
    v_mfma_f32_16x16x32_bf16 v[120:123], a[64:67], a[136:139], v[120:123]
    v_mfma_f32_16x16x32_bf16 v[124:127], a[64:67], a[140:143], v[124:127]
    v_mfma_f32_16x16x32_bf16 v[128:131], a[68:71], a[128:131], v[128:131]
    s_mov_b32 s34, 876544
    v_mfma_f32_16x16x32_bf16 v[132:135], a[68:71], a[132:135], v[132:135]
    buffer_load_dwordx4 a[64:67], v2, s[20:23], s34 offen offset:0
    v_mfma_f32_16x16x32_bf16 v[136:139], a[68:71], a[136:139], v[136:139]
    v_mfma_f32_16x16x32_bf16 v[140:143], a[68:71], a[140:143], v[140:143]
    s_waitcnt lgkmcnt(0)
    v_mfma_f32_16x16x32_bf16 v[240:243], a[72:75], a[112:115], v[240:243]
    buffer_load_dwordx4 a[68:71], v2, s[20:23], s34 offen offset:1024
    v_mfma_f32_16x16x32_bf16 v[244:247], a[72:75], a[116:119], v[244:247]
    ds_read_b128 a[128:131], v4 offset:36864
    ds_read_b128 a[132:135], v4 offset:37888
    v_mfma_f32_16x16x32_bf16 v[248:251], a[72:75], a[120:123], v[248:251]
    ds_read_b128 a[136:139], v4 offset:38912
    ds_read_b128 a[140:143], v4 offset:39936
    v_mfma_f32_16x16x32_bf16 v[252:255], a[72:75], a[124:127], v[252:255]
    v_mfma_f32_16x16x32_bf16 v[48:51], a[76:79], a[112:115], v[48:51]
    buffer_load_dwordx4 a[72:75], v2, s[20:23], s34 offen offset:2048
    v_mfma_f32_16x16x32_bf16 v[52:55], a[76:79], a[116:119], v[52:55]
    v_mfma_f32_16x16x32_bf16 v[56:59], a[76:79], a[120:123], v[56:59]
    v_mfma_f32_16x16x32_bf16 v[60:63], a[76:79], a[124:127], v[60:63]
    v_mfma_f32_16x16x32_bf16 v[64:67], a[80:83], a[112:115], v[64:67]
    buffer_load_dwordx4 a[76:79], v2, s[20:23], s34 offen offset:3072
    v_mfma_f32_16x16x32_bf16 v[68:71], a[80:83], a[116:119], v[68:71]
    v_mfma_f32_16x16x32_bf16 v[72:75], a[80:83], a[120:123], v[72:75]
    v_mfma_f32_16x16x32_bf16 v[76:79], a[80:83], a[124:127], v[76:79]
    s_waitcnt vmcnt(20)
    v_mfma_f32_16x16x32_bf16 v[80:83], a[84:87], a[112:115], v[80:83]
    s_mov_b32 s34, 880640
    v_mfma_f32_16x16x32_bf16 v[84:87], a[84:87], a[116:119], v[84:87]
    buffer_load_dwordx4 a[80:83], v2, s[20:23], s34 offen offset:0
    v_mfma_f32_16x16x32_bf16 v[88:91], a[84:87], a[120:123], v[88:91]
    v_mfma_f32_16x16x32_bf16 v[92:95], a[84:87], a[124:127], v[92:95]
    v_mfma_f32_16x16x32_bf16 v[96:99], a[88:91], a[112:115], v[96:99]
    buffer_load_dwordx4 a[84:87], v2, s[20:23], s34 offen offset:1024
    v_mfma_f32_16x16x32_bf16 v[100:103], a[88:91], a[116:119], v[100:103]
    v_mfma_f32_16x16x32_bf16 v[104:107], a[88:91], a[120:123], v[104:107]
    v_mfma_f32_16x16x32_bf16 v[108:111], a[88:91], a[124:127], v[108:111]
    v_mfma_f32_16x16x32_bf16 v[112:115], a[92:95], a[112:115], v[112:115]
    buffer_load_dwordx4 a[88:91], v2, s[20:23], s34 offen offset:2048
    v_mfma_f32_16x16x32_bf16 v[116:119], a[92:95], a[116:119], v[116:119]
    v_mfma_f32_16x16x32_bf16 v[120:123], a[92:95], a[120:123], v[120:123]
    v_mfma_f32_16x16x32_bf16 v[124:127], a[92:95], a[124:127], v[124:127]
    v_mfma_f32_16x16x32_bf16 v[128:131], a[96:99], a[112:115], v[128:131]
    buffer_load_dwordx4 a[92:95], v2, s[20:23], s34 offen offset:3072
    v_mfma_f32_16x16x32_bf16 v[132:135], a[96:99], a[116:119], v[132:135]
    v_mfma_f32_16x16x32_bf16 v[136:139], a[96:99], a[120:123], v[136:139]
    v_mfma_f32_16x16x32_bf16 v[140:143], a[96:99], a[124:127], v[140:143]
    s_waitcnt lgkmcnt(0)
    v_mfma_f32_16x16x32_bf16 v[240:243], a[100:103], a[128:131], v[240:243]
    s_mov_b32 s34, 884736
    v_mfma_f32_16x16x32_bf16 v[244:247], a[100:103], a[132:135], v[244:247]
    ds_read_b128 a[112:115], v4 offset:40960
    ds_read_b128 a[116:119], v4 offset:41984
    v_mfma_f32_16x16x32_bf16 v[248:251], a[100:103], a[136:139], v[248:251]
    ds_read_b128 a[120:123], v4 offset:43008
    ds_read_b128 a[124:127], v4 offset:44032
    v_mfma_f32_16x16x32_bf16 v[252:255], a[100:103], a[140:143], v[252:255]
    buffer_load_dwordx4 a[96:99], v2, s[20:23], s34 offen offset:0
    v_mfma_f32_16x16x32_bf16 v[48:51], a[104:107], a[128:131], v[48:51]
    buffer_load_dwordx4 a[100:103], v2, s[20:23], s34 offen offset:1024
    v_mfma_f32_16x16x32_bf16 v[52:55], a[104:107], a[132:135], v[52:55]
    v_mfma_f32_16x16x32_bf16 v[56:59], a[104:107], a[136:139], v[56:59]
    v_mfma_f32_16x16x32_bf16 v[60:63], a[104:107], a[140:143], v[60:63]
    v_mfma_f32_16x16x32_bf16 v[64:67], a[108:111], a[128:131], v[64:67]
    buffer_load_dwordx4 a[104:107], v2, s[20:23], s34 offen offset:2048
    v_mfma_f32_16x16x32_bf16 v[68:71], a[108:111], a[132:135], v[68:71]
    v_mfma_f32_16x16x32_bf16 v[72:75], a[108:111], a[136:139], v[72:75]
    v_mfma_f32_16x16x32_bf16 v[76:79], a[108:111], a[140:143], v[76:79]
    s_waitcnt vmcnt(20)
    v_mfma_f32_16x16x32_bf16 v[80:83], a[0:3], a[128:131], v[80:83]
    buffer_load_dwordx4 a[108:111], v2, s[20:23], s34 offen offset:3072
    v_mfma_f32_16x16x32_bf16 v[84:87], a[0:3], a[132:135], v[84:87]
    v_mfma_f32_16x16x32_bf16 v[88:91], a[0:3], a[136:139], v[88:91]
    v_mfma_f32_16x16x32_bf16 v[92:95], a[0:3], a[140:143], v[92:95]
    v_mfma_f32_16x16x32_bf16 v[96:99], a[4:7], a[128:131], v[96:99]
    s_mov_b32 s34, 888832
    v_mfma_f32_16x16x32_bf16 v[100:103], a[4:7], a[132:135], v[100:103]
    buffer_load_dwordx4 a[0:3], v2, s[20:23], s34 offen offset:0
    v_mfma_f32_16x16x32_bf16 v[104:107], a[4:7], a[136:139], v[104:107]
    v_mfma_f32_16x16x32_bf16 v[108:111], a[4:7], a[140:143], v[108:111]
    v_mfma_f32_16x16x32_bf16 v[112:115], a[8:11], a[128:131], v[112:115]
    buffer_load_dwordx4 a[4:7], v2, s[20:23], s34 offen offset:1024
    v_mfma_f32_16x16x32_bf16 v[116:119], a[8:11], a[132:135], v[116:119]
    v_mfma_f32_16x16x32_bf16 v[120:123], a[8:11], a[136:139], v[120:123]
    v_mfma_f32_16x16x32_bf16 v[124:127], a[8:11], a[140:143], v[124:127]
    v_mfma_f32_16x16x32_bf16 v[128:131], a[12:15], a[128:131], v[128:131]
    buffer_load_dwordx4 a[8:11], v2, s[20:23], s34 offen offset:2048
    v_mfma_f32_16x16x32_bf16 v[132:135], a[12:15], a[132:135], v[132:135]
    v_mfma_f32_16x16x32_bf16 v[136:139], a[12:15], a[136:139], v[136:139]
    v_mfma_f32_16x16x32_bf16 v[140:143], a[12:15], a[140:143], v[140:143]
    s_waitcnt lgkmcnt(0)
    v_mfma_f32_16x16x32_bf16 v[240:243], a[16:19], a[112:115], v[240:243]
    buffer_load_dwordx4 a[12:15], v2, s[20:23], s34 offen offset:3072
    v_mfma_f32_16x16x32_bf16 v[244:247], a[16:19], a[116:119], v[244:247]
    ds_read_b128 a[128:131], v4 offset:45056
    ds_read_b128 a[132:135], v4 offset:46080
    v_mfma_f32_16x16x32_bf16 v[248:251], a[16:19], a[120:123], v[248:251]
    ds_read_b128 a[136:139], v4 offset:47104
    ds_read_b128 a[140:143], v4 offset:48128
    v_mfma_f32_16x16x32_bf16 v[252:255], a[16:19], a[124:127], v[252:255]
    v_mfma_f32_16x16x32_bf16 v[48:51], a[20:23], a[112:115], v[48:51]
    s_mov_b32 s34, 892928
    v_mfma_f32_16x16x32_bf16 v[52:55], a[20:23], a[116:119], v[52:55]
    buffer_load_dwordx4 a[16:19], v2, s[20:23], s34 offen offset:0
    v_mfma_f32_16x16x32_bf16 v[56:59], a[20:23], a[120:123], v[56:59]
    v_mfma_f32_16x16x32_bf16 v[60:63], a[20:23], a[124:127], v[60:63]
    v_mfma_f32_16x16x32_bf16 v[64:67], a[24:27], a[112:115], v[64:67]
    buffer_load_dwordx4 a[20:23], v2, s[20:23], s34 offen offset:1024
    v_mfma_f32_16x16x32_bf16 v[68:71], a[24:27], a[116:119], v[68:71]
    v_mfma_f32_16x16x32_bf16 v[72:75], a[24:27], a[120:123], v[72:75]
    v_mfma_f32_16x16x32_bf16 v[76:79], a[24:27], a[124:127], v[76:79]
    s_waitcnt vmcnt(20)
    v_mfma_f32_16x16x32_bf16 v[80:83], a[28:31], a[112:115], v[80:83]
    buffer_load_dwordx4 a[24:27], v2, s[20:23], s34 offen offset:2048
    v_mfma_f32_16x16x32_bf16 v[84:87], a[28:31], a[116:119], v[84:87]
    v_mfma_f32_16x16x32_bf16 v[88:91], a[28:31], a[120:123], v[88:91]
    v_mfma_f32_16x16x32_bf16 v[92:95], a[28:31], a[124:127], v[92:95]
    v_mfma_f32_16x16x32_bf16 v[96:99], a[32:35], a[112:115], v[96:99]
    buffer_load_dwordx4 a[28:31], v2, s[20:23], s34 offen offset:3072
    v_mfma_f32_16x16x32_bf16 v[100:103], a[32:35], a[116:119], v[100:103]
    v_mfma_f32_16x16x32_bf16 v[104:107], a[32:35], a[120:123], v[104:107]
    v_mfma_f32_16x16x32_bf16 v[108:111], a[32:35], a[124:127], v[108:111]
    v_mfma_f32_16x16x32_bf16 v[112:115], a[36:39], a[112:115], v[112:115]
    s_mov_b32 s34, 897024
    v_mfma_f32_16x16x32_bf16 v[116:119], a[36:39], a[116:119], v[116:119]
    buffer_load_dwordx4 a[32:35], v2, s[20:23], s34 offen offset:0
    v_mfma_f32_16x16x32_bf16 v[120:123], a[36:39], a[120:123], v[120:123]
    v_mfma_f32_16x16x32_bf16 v[124:127], a[36:39], a[124:127], v[124:127]
    v_mfma_f32_16x16x32_bf16 v[128:131], a[40:43], a[112:115], v[128:131]
    buffer_load_dwordx4 a[36:39], v2, s[20:23], s34 offen offset:1024
    v_mfma_f32_16x16x32_bf16 v[132:135], a[40:43], a[116:119], v[132:135]
    v_mfma_f32_16x16x32_bf16 v[136:139], a[40:43], a[120:123], v[136:139]
    v_mfma_f32_16x16x32_bf16 v[140:143], a[40:43], a[124:127], v[140:143]
    s_waitcnt lgkmcnt(0)
    v_mfma_f32_16x16x32_bf16 v[240:243], a[44:47], a[128:131], v[240:243]
    buffer_load_dwordx4 a[40:43], v2, s[20:23], s34 offen offset:2048
    v_mfma_f32_16x16x32_bf16 v[244:247], a[44:47], a[132:135], v[244:247]
    ds_read_b128 a[112:115], v2 offset:0
    ds_read_b128 a[116:119], v2 offset:1024
    v_mfma_f32_16x16x32_bf16 v[248:251], a[44:47], a[136:139], v[248:251]
    ds_read_b128 a[120:123], v2 offset:2048
    ds_read_b128 a[124:127], v2 offset:3072
    v_mfma_f32_16x16x32_bf16 v[252:255], a[44:47], a[140:143], v[252:255]
    v_mfma_f32_16x16x32_bf16 v[48:51], a[48:51], a[128:131], v[48:51]
    buffer_load_dwordx4 a[44:47], v2, s[20:23], s34 offen offset:3072
    v_mfma_f32_16x16x32_bf16 v[52:55], a[48:51], a[132:135], v[52:55]
    v_mfma_f32_16x16x32_bf16 v[56:59], a[48:51], a[136:139], v[56:59]
    v_mfma_f32_16x16x32_bf16 v[60:63], a[48:51], a[140:143], v[60:63]
    v_mfma_f32_16x16x32_bf16 v[64:67], a[52:55], a[128:131], v[64:67]
    s_mov_b32 s34, 901120
    v_mfma_f32_16x16x32_bf16 v[68:71], a[52:55], a[132:135], v[68:71]
    buffer_load_dwordx4 a[48:51], v2, s[20:23], s34 offen offset:0
    v_mfma_f32_16x16x32_bf16 v[72:75], a[52:55], a[136:139], v[72:75]
    v_mfma_f32_16x16x32_bf16 v[76:79], a[52:55], a[140:143], v[76:79]
    s_waitcnt vmcnt(20)
    v_mfma_f32_16x16x32_bf16 v[80:83], a[56:59], a[128:131], v[80:83]
    buffer_load_dwordx4 a[52:55], v2, s[20:23], s34 offen offset:1024
    v_mfma_f32_16x16x32_bf16 v[84:87], a[56:59], a[132:135], v[84:87]
    v_mfma_f32_16x16x32_bf16 v[88:91], a[56:59], a[136:139], v[88:91]
    v_mfma_f32_16x16x32_bf16 v[92:95], a[56:59], a[140:143], v[92:95]
    v_mfma_f32_16x16x32_bf16 v[96:99], a[60:63], a[128:131], v[96:99]
    buffer_load_dwordx4 a[56:59], v2, s[20:23], s34 offen offset:2048
    v_mfma_f32_16x16x32_bf16 v[100:103], a[60:63], a[132:135], v[100:103]
    v_mfma_f32_16x16x32_bf16 v[104:107], a[60:63], a[136:139], v[104:107]
    v_mfma_f32_16x16x32_bf16 v[108:111], a[60:63], a[140:143], v[108:111]
    v_mfma_f32_16x16x32_bf16 v[112:115], a[64:67], a[128:131], v[112:115]
    buffer_load_dwordx4 a[60:63], v2, s[20:23], s34 offen offset:3072
    v_mfma_f32_16x16x32_bf16 v[116:119], a[64:67], a[132:135], v[116:119]
    v_mfma_f32_16x16x32_bf16 v[120:123], a[64:67], a[136:139], v[120:123]
    v_mfma_f32_16x16x32_bf16 v[124:127], a[64:67], a[140:143], v[124:127]
    v_mfma_f32_16x16x32_bf16 v[128:131], a[68:71], a[128:131], v[128:131]
    s_mov_b32 s34, 905216
    v_mfma_f32_16x16x32_bf16 v[132:135], a[68:71], a[132:135], v[132:135]
    buffer_load_dwordx4 a[64:67], v2, s[20:23], s34 offen offset:0
    v_mfma_f32_16x16x32_bf16 v[136:139], a[68:71], a[136:139], v[136:139]
    v_mfma_f32_16x16x32_bf16 v[140:143], a[68:71], a[140:143], v[140:143]
    s_waitcnt lgkmcnt(0)
    v_mfma_f32_16x16x32_bf16 v[144:147], a[72:75], a[112:115], v[144:147]
    buffer_load_dwordx4 a[68:71], v2, s[20:23], s34 offen offset:1024
    v_mfma_f32_16x16x32_bf16 v[148:151], a[72:75], a[116:119], v[148:151]
    ds_read_b128 a[128:131], v2 offset:4096
    ds_read_b128 a[132:135], v2 offset:5120
    v_mfma_f32_16x16x32_bf16 v[152:155], a[72:75], a[120:123], v[152:155]
    ds_read_b128 a[136:139], v2 offset:6144
    ds_read_b128 a[140:143], v2 offset:7168
    v_mfma_f32_16x16x32_bf16 v[156:159], a[72:75], a[124:127], v[156:159]
    v_mfma_f32_16x16x32_bf16 v[160:163], a[76:79], a[112:115], v[160:163]
    buffer_load_dwordx4 a[72:75], v2, s[20:23], s34 offen offset:2048
    v_mfma_f32_16x16x32_bf16 v[164:167], a[76:79], a[116:119], v[164:167]
    v_mfma_f32_16x16x32_bf16 v[168:171], a[76:79], a[120:123], v[168:171]
    v_mfma_f32_16x16x32_bf16 v[172:175], a[76:79], a[124:127], v[172:175]
    v_mfma_f32_16x16x32_bf16 v[176:179], a[80:83], a[112:115], v[176:179]
    buffer_load_dwordx4 a[76:79], v2, s[20:23], s34 offen offset:3072
    v_mfma_f32_16x16x32_bf16 v[180:183], a[80:83], a[116:119], v[180:183]
    v_mfma_f32_16x16x32_bf16 v[184:187], a[80:83], a[120:123], v[184:187]
    v_accvgpr_read_b32 v14, a240
    v_mfma_f32_16x16x32_bf16 v[188:191], a[80:83], a[124:127], v[188:191]
    v_accvgpr_read_b32 v15, a241
    s_waitcnt vmcnt(20)
    v_mfma_f32_16x16x32_bf16 v[192:195], a[84:87], a[112:115], v[192:195]
    s_mov_b32 s34, 909312
    v_mfma_f32_16x16x32_bf16 v[196:199], a[84:87], a[116:119], v[196:199]
    buffer_load_dwordx4 a[80:83], v2, s[20:23], s34 offen offset:0
    v_mfma_f32_16x16x32_bf16 v[200:203], a[84:87], a[120:123], v[200:203]
    v_lshlrev_b32 v18, 16, v14
    v_and_b32 v19, 0xffff0000, v14
    v_mfma_f32_16x16x32_bf16 v[204:207], a[84:87], a[124:127], v[204:207]
    v_mfma_f32_16x16x32_bf16 v[208:211], a[88:91], a[112:115], v[208:211]
    buffer_load_dwordx4 a[84:87], v2, s[20:23], s34 offen offset:1024
    v_mfma_f32_16x16x32_bf16 v[212:215], a[88:91], a[116:119], v[212:215]
    v_lshlrev_b32 v20, 16, v15
    v_mfma_f32_16x16x32_bf16 v[216:219], a[88:91], a[120:123], v[216:219]
    v_and_b32 v21, 0xffff0000, v15
    v_mfma_f32_16x16x32_bf16 v[220:223], a[88:91], a[124:127], v[220:223]
    v_mul_f32 v18, v18, v240
    v_mfma_f32_16x16x32_bf16 v[224:227], a[92:95], a[112:115], v[224:227]
    buffer_load_dwordx4 a[88:91], v2, s[20:23], s34 offen offset:2048
    v_mfma_f32_16x16x32_bf16 v[228:231], a[92:95], a[116:119], v[228:231]
    v_mul_f32 v19, v19, v241
    v_mfma_f32_16x16x32_bf16 v[232:235], a[92:95], a[120:123], v[232:235]
    v_mul_f32 v20, v20, v242
    v_mfma_f32_16x16x32_bf16 v[236:239], a[92:95], a[124:127], v[236:239]
    s_waitcnt lgkmcnt(0)
    v_mfma_f32_16x16x32_bf16 v[144:147], a[96:99], a[128:131], v[144:147]
    buffer_load_dwordx4 a[92:95], v2, s[20:23], s34 offen offset:3072
    v_mfma_f32_16x16x32_bf16 v[148:151], a[96:99], a[132:135], v[148:151]
    ds_read_b128 a[112:115], v2 offset:8192
    ds_read_b128 a[116:119], v2 offset:9216
    v_mfma_f32_16x16x32_bf16 v[152:155], a[96:99], a[136:139], v[152:155]
    ds_read_b128 a[120:123], v2 offset:10240
    ds_read_b128 a[124:127], v2 offset:11264
    v_mfma_f32_16x16x32_bf16 v[156:159], a[96:99], a[140:143], v[156:159]
    v_mul_f32 v21, v21, v243
    v_cvt_pk_bf16_f32 v14, v18, v19
    v_mfma_f32_16x16x32_bf16 v[160:163], a[100:103], a[128:131], v[160:163]
    s_mov_b32 s34, 913408
    v_cvt_pk_bf16_f32 v15, v20, v21
    v_mfma_f32_16x16x32_bf16 v[164:167], a[100:103], a[132:135], v[164:167]
    buffer_load_dwordx4 a[96:99], v2, s[20:23], s34 offen offset:0
    v_mfma_f32_16x16x32_bf16 v[168:171], a[100:103], a[136:139], v[168:171]
    buffer_store_dwordx2 v[14:15], v11, s[28:31], 0 offen
    v_mfma_f32_16x16x32_bf16 v[172:175], a[100:103], a[140:143], v[172:175]
    v_accvgpr_read_b32 v22, a242
    v_mfma_f32_16x16x32_bf16 v[176:179], a[104:107], a[128:131], v[176:179]
    buffer_load_dwordx4 a[100:103], v2, s[20:23], s34 offen offset:1024
    v_mfma_f32_16x16x32_bf16 v[180:183], a[104:107], a[132:135], v[180:183]
    v_accvgpr_read_b32 v23, a243
    v_mfma_f32_16x16x32_bf16 v[184:187], a[104:107], a[136:139], v[184:187]
    v_lshlrev_b32 v26, 16, v22
    v_mfma_f32_16x16x32_bf16 v[188:191], a[104:107], a[140:143], v[188:191]
    v_and_b32 v27, 0xffff0000, v22
    v_mfma_f32_16x16x32_bf16 v[192:195], a[108:111], a[128:131], v[192:195]
    buffer_load_dwordx4 a[104:107], v2, s[20:23], s34 offen offset:2048
    v_mfma_f32_16x16x32_bf16 v[196:199], a[108:111], a[132:135], v[196:199]
    v_lshlrev_b32 v28, 16, v23
    v_mfma_f32_16x16x32_bf16 v[200:203], a[108:111], a[136:139], v[200:203]
    v_and_b32 v29, 0xffff0000, v23
    v_mfma_f32_16x16x32_bf16 v[204:207], a[108:111], a[140:143], v[204:207]
    s_waitcnt vmcnt(21)
    v_mfma_f32_16x16x32_bf16 v[208:211], a[0:3], a[128:131], v[208:211]
    buffer_load_dwordx4 a[108:111], v2, s[20:23], s34 offen offset:3072
    v_mfma_f32_16x16x32_bf16 v[212:215], a[0:3], a[132:135], v[212:215]
    v_mul_f32 v26, v26, v244
    v_mfma_f32_16x16x32_bf16 v[216:219], a[0:3], a[136:139], v[216:219]
    v_mul_f32 v27, v27, v245
    v_mfma_f32_16x16x32_bf16 v[220:223], a[0:3], a[140:143], v[220:223]
    v_mul_f32 v28, v28, v246
    v_mfma_f32_16x16x32_bf16 v[224:227], a[4:7], a[128:131], v[224:227]
    s_mov_b32 s34, 917504
    v_mfma_f32_16x16x32_bf16 v[228:231], a[4:7], a[132:135], v[228:231]
    buffer_load_dwordx4 a[0:3], v2, s[20:23], s34 offen offset:0
    v_mfma_f32_16x16x32_bf16 v[232:235], a[4:7], a[136:139], v[232:235]
    v_mul_f32 v29, v29, v247
    v_cvt_pk_bf16_f32 v22, v26, v27
    v_mfma_f32_16x16x32_bf16 v[236:239], a[4:7], a[140:143], v[236:239]
    s_waitcnt lgkmcnt(0)
    v_mfma_f32_16x16x32_bf16 v[144:147], a[8:11], a[112:115], v[144:147]
    buffer_load_dwordx4 a[4:7], v2, s[20:23], s34 offen offset:1024
    v_mfma_f32_16x16x32_bf16 v[148:151], a[8:11], a[116:119], v[148:151]
    ds_read_b128 a[128:131], v2 offset:12288
    ds_read_b128 a[132:135], v2 offset:13312
    v_mfma_f32_16x16x32_bf16 v[152:155], a[8:11], a[120:123], v[152:155]
    ds_read_b128 a[136:139], v2 offset:14336
    ds_read_b128 a[140:143], v2 offset:15360
    v_mfma_f32_16x16x32_bf16 v[156:159], a[8:11], a[124:127], v[156:159]
    v_cvt_pk_bf16_f32 v23, v28, v29
    v_mfma_f32_16x16x32_bf16 v[160:163], a[12:15], a[112:115], v[160:163]
    buffer_load_dwordx4 a[8:11], v2, s[20:23], s34 offen offset:2048
    v_mfma_f32_16x16x32_bf16 v[164:167], a[12:15], a[116:119], v[164:167]
    buffer_store_dwordx2 v[22:23], v11, s[28:31], s40 offen
    v_mfma_f32_16x16x32_bf16 v[168:171], a[12:15], a[120:123], v[168:171]
    v_accvgpr_read_b32 v14, a244
    v_accvgpr_read_b32 v15, a245
    v_mfma_f32_16x16x32_bf16 v[172:175], a[12:15], a[124:127], v[172:175]
    v_lshlrev_b32 v18, 16, v14
    v_mfma_f32_16x16x32_bf16 v[176:179], a[16:19], a[112:115], v[176:179]
    buffer_load_dwordx4 a[12:15], v2, s[20:23], s34 offen offset:3072
    v_mfma_f32_16x16x32_bf16 v[180:183], a[16:19], a[116:119], v[180:183]
    v_and_b32 v19, 0xffff0000, v14
    v_mfma_f32_16x16x32_bf16 v[184:187], a[16:19], a[120:123], v[184:187]
    v_lshlrev_b32 v20, 16, v15
    v_mfma_f32_16x16x32_bf16 v[188:191], a[16:19], a[124:127], v[188:191]
    v_and_b32 v21, 0xffff0000, v15
    v_mfma_f32_16x16x32_bf16 v[192:195], a[20:23], a[112:115], v[192:195]
    s_mov_b32 s34, 921600
    v_mfma_f32_16x16x32_bf16 v[196:199], a[20:23], a[116:119], v[196:199]
    buffer_load_dwordx4 a[16:19], v2, s[20:23], s34 offen offset:0
    v_mfma_f32_16x16x32_bf16 v[200:203], a[20:23], a[120:123], v[200:203]
    v_mul_f32 v18, v18, v248
    v_mfma_f32_16x16x32_bf16 v[204:207], a[20:23], a[124:127], v[204:207]
    v_mul_f32 v19, v19, v249
    v_mfma_f32_16x16x32_bf16 v[208:211], a[24:27], a[112:115], v[208:211]
    buffer_load_dwordx4 a[20:23], v2, s[20:23], s34 offen offset:1024
    v_mfma_f32_16x16x32_bf16 v[212:215], a[24:27], a[116:119], v[212:215]
    v_mul_f32 v20, v20, v250
    v_mfma_f32_16x16x32_bf16 v[216:219], a[24:27], a[120:123], v[216:219]
    v_mul_f32 v21, v21, v251
    v_mfma_f32_16x16x32_bf16 v[220:223], a[24:27], a[124:127], v[220:223]
    v_cvt_pk_bf16_f32 v14, v18, v19
    s_waitcnt vmcnt(22)
    v_mfma_f32_16x16x32_bf16 v[224:227], a[28:31], a[112:115], v[224:227]
    buffer_load_dwordx4 a[24:27], v2, s[20:23], s34 offen offset:2048
    v_mfma_f32_16x16x32_bf16 v[228:231], a[28:31], a[116:119], v[228:231]
    v_cvt_pk_bf16_f32 v15, v20, v21
    v_mfma_f32_16x16x32_bf16 v[232:235], a[28:31], a[120:123], v[232:235]
    v_mfma_f32_16x16x32_bf16 v[236:239], a[28:31], a[124:127], v[236:239]
    buffer_store_dwordx2 v[14:15], v11, s[28:31], s41 offen
    s_waitcnt lgkmcnt(0)
    v_mfma_f32_16x16x32_bf16 v[144:147], a[32:35], a[128:131], v[144:147]
    buffer_load_dwordx4 a[28:31], v2, s[20:23], s34 offen offset:3072
    v_mfma_f32_16x16x32_bf16 v[148:151], a[32:35], a[132:135], v[148:151]
    ds_read_b128 a[112:115], v2 offset:16384
    ds_read_b128 a[116:119], v2 offset:17408
    v_mfma_f32_16x16x32_bf16 v[152:155], a[32:35], a[136:139], v[152:155]
    ds_read_b128 a[120:123], v2 offset:18432
    ds_read_b128 a[124:127], v2 offset:19456
    v_mfma_f32_16x16x32_bf16 v[156:159], a[32:35], a[140:143], v[156:159]
    v_accvgpr_read_b32 v22, a246
    v_accvgpr_read_b32 v23, a247
    v_mfma_f32_16x16x32_bf16 v[160:163], a[36:39], a[128:131], v[160:163]
    s_mov_b32 s34, 925696
    v_lshlrev_b32 v26, 16, v22
    v_mfma_f32_16x16x32_bf16 v[164:167], a[36:39], a[132:135], v[164:167]
    buffer_load_dwordx4 a[32:35], v2, s[20:23], s34 offen offset:0
    v_mfma_f32_16x16x32_bf16 v[168:171], a[36:39], a[136:139], v[168:171]
    v_and_b32 v27, 0xffff0000, v22
    v_mfma_f32_16x16x32_bf16 v[172:175], a[36:39], a[140:143], v[172:175]
    v_lshlrev_b32 v28, 16, v23
    v_mfma_f32_16x16x32_bf16 v[176:179], a[40:43], a[128:131], v[176:179]
    buffer_load_dwordx4 a[36:39], v2, s[20:23], s34 offen offset:1024
    v_mfma_f32_16x16x32_bf16 v[180:183], a[40:43], a[132:135], v[180:183]
    v_and_b32 v29, 0xffff0000, v23
    v_mfma_f32_16x16x32_bf16 v[184:187], a[40:43], a[136:139], v[184:187]
    v_mul_f32 v26, v26, v252
    v_mfma_f32_16x16x32_bf16 v[188:191], a[40:43], a[140:143], v[188:191]
    v_mul_f32 v27, v27, v253
    v_mfma_f32_16x16x32_bf16 v[192:195], a[44:47], a[128:131], v[192:195]
    buffer_load_dwordx4 a[40:43], v2, s[20:23], s34 offen offset:2048
    v_mfma_f32_16x16x32_bf16 v[196:199], a[44:47], a[132:135], v[196:199]
    v_mul_f32 v28, v28, v254
    v_mfma_f32_16x16x32_bf16 v[200:203], a[44:47], a[136:139], v[200:203]
    v_mfma_f32_16x16x32_bf16 v[204:207], a[44:47], a[140:143], v[204:207]
    v_mul_f32 v29, v29, v255
    v_mfma_f32_16x16x32_bf16 v[208:211], a[48:51], a[128:131], v[208:211]
    buffer_load_dwordx4 a[44:47], v2, s[20:23], s34 offen offset:3072
    v_mfma_f32_16x16x32_bf16 v[212:215], a[48:51], a[132:135], v[212:215]
    v_cvt_pk_bf16_f32 v22, v26, v27
    v_mfma_f32_16x16x32_bf16 v[216:219], a[48:51], a[136:139], v[216:219]
    v_cvt_pk_bf16_f32 v23, v28, v29
    v_mfma_f32_16x16x32_bf16 v[220:223], a[48:51], a[140:143], v[220:223]
    v_mfma_f32_16x16x32_bf16 v[224:227], a[52:55], a[128:131], v[224:227]
    s_mov_b32 s34, 929792
    v_mfma_f32_16x16x32_bf16 v[228:231], a[52:55], a[132:135], v[228:231]
    buffer_load_dwordx4 a[48:51], v2, s[20:23], s34 offen offset:0
    v_mfma_f32_16x16x32_bf16 v[232:235], a[52:55], a[136:139], v[232:235]
    buffer_store_dwordx2 v[22:23], v11, s[28:31], s42 offen
    v_mfma_f32_16x16x32_bf16 v[236:239], a[52:55], a[140:143], v[236:239]
    v_accvgpr_read_b32 v14, a144
    v_accvgpr_read_b32 v15, a145
    s_waitcnt vmcnt(24) lgkmcnt(0)
    v_mfma_f32_16x16x32_bf16 v[144:147], a[56:59], a[112:115], v[144:147]
    buffer_load_dwordx4 a[52:55], v2, s[20:23], s34 offen offset:1024
    v_mfma_f32_16x16x32_bf16 v[148:151], a[56:59], a[116:119], v[148:151]
    ds_read_b128 a[128:131], v2 offset:20480
    ds_read_b128 a[132:135], v2 offset:21504
    v_mfma_f32_16x16x32_bf16 v[152:155], a[56:59], a[120:123], v[152:155]
    ds_read_b128 a[136:139], v2 offset:22528
    ds_read_b128 a[140:143], v2 offset:23552
    v_mfma_f32_16x16x32_bf16 v[156:159], a[56:59], a[124:127], v[156:159]
    v_accvgpr_read_b32 v16, a146
    v_accvgpr_read_b32 v17, a147
    v_mfma_f32_16x16x32_bf16 v[160:163], a[60:63], a[112:115], v[160:163]
    buffer_load_dwordx4 a[56:59], v2, s[20:23], s34 offen offset:2048
    v_mfma_f32_16x16x32_bf16 v[164:167], a[60:63], a[116:119], v[164:167]
    v_lshlrev_b32 v18, 16, v14
    v_and_b32 v19, 0xffff0000, v14
    v_mfma_f32_16x16x32_bf16 v[168:171], a[60:63], a[120:123], v[168:171]
    v_mfma_f32_16x16x32_bf16 v[172:175], a[60:63], a[124:127], v[172:175]
    v_lshlrev_b32 v20, 16, v15
    v_mfma_f32_16x16x32_bf16 v[176:179], a[64:67], a[112:115], v[176:179]
    buffer_load_dwordx4 a[60:63], v2, s[20:23], s34 offen offset:3072
    v_mfma_f32_16x16x32_bf16 v[180:183], a[64:67], a[116:119], v[180:183]
    v_and_b32 v21, 0xffff0000, v15
    v_mfma_f32_16x16x32_bf16 v[184:187], a[64:67], a[120:123], v[184:187]
    v_mul_f32 v18, v18, v48
    v_mfma_f32_16x16x32_bf16 v[188:191], a[64:67], a[124:127], v[188:191]
    v_mfma_f32_16x16x32_bf16 v[192:195], a[68:71], a[112:115], v[192:195]
    s_mov_b32 s34, 933888
    v_mul_f32 v19, v19, v49
    v_mfma_f32_16x16x32_bf16 v[196:199], a[68:71], a[116:119], v[196:199]
    buffer_load_dwordx4 a[64:67], v2, s[20:23], s34 offen offset:0
    v_mfma_f32_16x16x32_bf16 v[200:203], a[68:71], a[120:123], v[200:203]
    v_mul_f32 v20, v20, v50
    v_mfma_f32_16x16x32_bf16 v[204:207], a[68:71], a[124:127], v[204:207]
    v_mul_f32 v21, v21, v51
    v_mfma_f32_16x16x32_bf16 v[208:211], a[72:75], a[112:115], v[208:211]
    buffer_load_dwordx4 a[68:71], v2, s[20:23], s34 offen offset:1024
    v_mfma_f32_16x16x32_bf16 v[212:215], a[72:75], a[116:119], v[212:215]
    v_cvt_pk_bf16_f32 v14, v18, v19
    v_mfma_f32_16x16x32_bf16 v[216:219], a[72:75], a[120:123], v[216:219]
    v_cvt_pk_bf16_f32 v15, v20, v21
    v_mfma_f32_16x16x32_bf16 v[220:223], a[72:75], a[124:127], v[220:223]
    v_mfma_f32_16x16x32_bf16 v[224:227], a[76:79], a[112:115], v[224:227]
    buffer_load_dwordx4 a[72:75], v2, s[20:23], s34 offen offset:2048
    v_mfma_f32_16x16x32_bf16 v[228:231], a[76:79], a[116:119], v[228:231]
    v_lshlrev_b32 v18, 16, v16
    v_and_b32 v19, 0xffff0000, v16
    v_mfma_f32_16x16x32_bf16 v[232:235], a[76:79], a[120:123], v[232:235]
    v_mfma_f32_16x16x32_bf16 v[236:239], a[76:79], a[124:127], v[236:239]
    v_lshlrev_b32 v20, 16, v17
    s_waitcnt lgkmcnt(0)
    v_mfma_f32_16x16x32_bf16 v[144:147], a[80:83], a[128:131], v[144:147]
    buffer_load_dwordx4 a[76:79], v2, s[20:23], s34 offen offset:3072
    v_mfma_f32_16x16x32_bf16 v[148:151], a[80:83], a[132:135], v[148:151]
    ds_read_b128 a[112:115], v2 offset:24576
    ds_read_b128 a[116:119], v2 offset:25600
    v_mfma_f32_16x16x32_bf16 v[152:155], a[80:83], a[136:139], v[152:155]
    ds_read_b128 a[120:123], v2 offset:26624
    ds_read_b128 a[124:127], v2 offset:27648
    v_mfma_f32_16x16x32_bf16 v[156:159], a[80:83], a[140:143], v[156:159]
    v_and_b32 v21, 0xffff0000, v17
    v_mul_f32 v18, v18, v64
    s_waitcnt vmcnt(27)
    v_mfma_f32_16x16x32_bf16 v[160:163], a[84:87], a[128:131], v[160:163]
    s_mov_b32 s34, 937984
    v_mul_f32 v19, v19, v65
    v_mfma_f32_16x16x32_bf16 v[164:167], a[84:87], a[132:135], v[164:167]
    buffer_load_dwordx4 a[80:83], v2, s[20:23], s34 offen offset:0
    v_mfma_f32_16x16x32_bf16 v[168:171], a[84:87], a[136:139], v[168:171]
    v_mul_f32 v20, v20, v66
    v_mfma_f32_16x16x32_bf16 v[172:175], a[84:87], a[140:143], v[172:175]
    v_mul_f32 v21, v21, v67
    v_mfma_f32_16x16x32_bf16 v[176:179], a[88:91], a[128:131], v[176:179]
    buffer_load_dwordx4 a[84:87], v2, s[20:23], s34 offen offset:1024
    v_mfma_f32_16x16x32_bf16 v[180:183], a[88:91], a[132:135], v[180:183]
    v_cvt_pk_bf16_f32 v16, v18, v19
    v_mfma_f32_16x16x32_bf16 v[184:187], a[88:91], a[136:139], v[184:187]
    v_cvt_pk_bf16_f32 v17, v20, v21
    v_mfma_f32_16x16x32_bf16 v[188:191], a[88:91], a[140:143], v[188:191]
    v_mfma_f32_16x16x32_bf16 v[192:195], a[92:95], a[128:131], v[192:195]
    buffer_load_dwordx4 a[88:91], v2, s[20:23], s34 offen offset:2048
    v_mfma_f32_16x16x32_bf16 v[196:199], a[92:95], a[132:135], v[196:199]
    buffer_store_dwordx4 v[14:17], v10, s[28:31], 0 offen offset:0
    v_mfma_f32_16x16x32_bf16 v[200:203], a[92:95], a[136:139], v[200:203]
    v_accvgpr_read_b32 v22, a148
    v_mfma_f32_16x16x32_bf16 v[204:207], a[92:95], a[140:143], v[204:207]
    v_accvgpr_read_b32 v23, a149
    v_mfma_f32_16x16x32_bf16 v[208:211], a[96:99], a[128:131], v[208:211]
    buffer_load_dwordx4 a[92:95], v2, s[20:23], s34 offen offset:3072
    v_mfma_f32_16x16x32_bf16 v[212:215], a[96:99], a[132:135], v[212:215]
    v_accvgpr_read_b32 v24, a150
    v_mfma_f32_16x16x32_bf16 v[216:219], a[96:99], a[136:139], v[216:219]
    v_accvgpr_read_b32 v25, a151
    v_mfma_f32_16x16x32_bf16 v[220:223], a[96:99], a[140:143], v[220:223]
    s_waitcnt vmcnt(25)
    v_mfma_f32_16x16x32_bf16 v[224:227], a[100:103], a[128:131], v[224:227]
    s_mov_b32 s34, 942080
    v_lshlrev_b32 v26, 16, v22
    v_mfma_f32_16x16x32_bf16 v[228:231], a[100:103], a[132:135], v[228:231]
    buffer_load_dwordx4 a[96:99], v2, s[20:23], s34 offen offset:0
    v_mfma_f32_16x16x32_bf16 v[232:235], a[100:103], a[136:139], v[232:235]
    v_and_b32 v27, 0xffff0000, v22
    v_mfma_f32_16x16x32_bf16 v[236:239], a[100:103], a[140:143], v[236:239]
    v_lshlrev_b32 v28, 16, v23
    s_waitcnt lgkmcnt(0)
    v_mfma_f32_16x16x32_bf16 v[144:147], a[104:107], a[112:115], v[144:147]
    buffer_load_dwordx4 a[100:103], v2, s[20:23], s34 offen offset:1024
    v_mfma_f32_16x16x32_bf16 v[148:151], a[104:107], a[116:119], v[148:151]
    ds_read_b128 a[128:131], v2 offset:28672
    ds_read_b128 a[132:135], v2 offset:29696
    v_mfma_f32_16x16x32_bf16 v[152:155], a[104:107], a[120:123], v[152:155]
    ds_read_b128 a[136:139], v2 offset:30720
    ds_read_b128 a[140:143], v2 offset:31744
    v_mfma_f32_16x16x32_bf16 v[156:159], a[104:107], a[124:127], v[156:159]
    v_and_b32 v29, 0xffff0000, v23
    v_mul_f32 v26, v26, v52
    v_mfma_f32_16x16x32_bf16 v[160:163], a[108:111], a[112:115], v[160:163]
    buffer_load_dwordx4 a[104:107], v2, s[20:23], s34 offen offset:2048
    v_mfma_f32_16x16x32_bf16 v[164:167], a[108:111], a[116:119], v[164:167]
    v_mul_f32 v27, v27, v53
    v_mul_f32 v28, v28, v54
    v_mfma_f32_16x16x32_bf16 v[168:171], a[108:111], a[120:123], v[168:171]
    v_mfma_f32_16x16x32_bf16 v[172:175], a[108:111], a[124:127], v[172:175]
    v_mul_f32 v29, v29, v55
    v_mfma_f32_16x16x32_bf16 v[176:179], a[0:3], a[112:115], v[176:179]
    buffer_load_dwordx4 a[108:111], v2, s[20:23], s34 offen offset:3072
    v_mfma_f32_16x16x32_bf16 v[180:183], a[0:3], a[116:119], v[180:183]
    v_cvt_pk_bf16_f32 v22, v26, v27
    v_mfma_f32_16x16x32_bf16 v[184:187], a[0:3], a[120:123], v[184:187]
    v_cvt_pk_bf16_f32 v23, v28, v29
    v_mfma_f32_16x16x32_bf16 v[188:191], a[0:3], a[124:127], v[188:191]
    v_mfma_f32_16x16x32_bf16 v[192:195], a[4:7], a[112:115], v[192:195]
    s_mov_b32 s34, 946176
    v_lshlrev_b32 v26, 16, v24
    v_mfma_f32_16x16x32_bf16 v[196:199], a[4:7], a[116:119], v[196:199]
    buffer_load_dwordx4 a[0:3], v2, s[20:23], s34 offen offset:0
    v_mfma_f32_16x16x32_bf16 v[200:203], a[4:7], a[120:123], v[200:203]
    v_and_b32 v27, 0xffff0000, v24
    v_mfma_f32_16x16x32_bf16 v[204:207], a[4:7], a[124:127], v[204:207]
    v_lshlrev_b32 v28, 16, v25
    v_mfma_f32_16x16x32_bf16 v[208:211], a[8:11], a[112:115], v[208:211]
    buffer_load_dwordx4 a[4:7], v2, s[20:23], s34 offen offset:1024
    v_mfma_f32_16x16x32_bf16 v[212:215], a[8:11], a[116:119], v[212:215]
    v_and_b32 v29, 0xffff0000, v25
    v_mfma_f32_16x16x32_bf16 v[216:219], a[8:11], a[120:123], v[216:219]
    v_mul_f32 v26, v26, v68
    v_mfma_f32_16x16x32_bf16 v[220:223], a[8:11], a[124:127], v[220:223]
    s_waitcnt vmcnt(26)
    v_mfma_f32_16x16x32_bf16 v[224:227], a[12:15], a[112:115], v[224:227]
    buffer_load_dwordx4 a[8:11], v2, s[20:23], s34 offen offset:2048
    v_mfma_f32_16x16x32_bf16 v[228:231], a[12:15], a[116:119], v[228:231]
    v_mul_f32 v27, v27, v69
    v_mul_f32 v28, v28, v70
    v_mfma_f32_16x16x32_bf16 v[232:235], a[12:15], a[120:123], v[232:235]
    v_mfma_f32_16x16x32_bf16 v[236:239], a[12:15], a[124:127], v[236:239]
    v_mul_f32 v29, v29, v71
    s_waitcnt lgkmcnt(0)
    v_mfma_f32_16x16x32_bf16 v[144:147], a[16:19], a[128:131], v[144:147]
    buffer_load_dwordx4 a[12:15], v2, s[20:23], s34 offen offset:3072
    v_mfma_f32_16x16x32_bf16 v[148:151], a[16:19], a[132:135], v[148:151]
    ds_read_b128 a[112:115], v2 offset:32768
    ds_read_b128 a[116:119], v2 offset:33792
    v_mfma_f32_16x16x32_bf16 v[152:155], a[16:19], a[136:139], v[152:155]
    ds_read_b128 a[120:123], v2 offset:34816
    ds_read_b128 a[124:127], v2 offset:35840
    v_mfma_f32_16x16x32_bf16 v[156:159], a[16:19], a[140:143], v[156:159]
    v_cvt_pk_bf16_f32 v24, v26, v27
    v_cvt_pk_bf16_f32 v25, v28, v29
    v_mfma_f32_16x16x32_bf16 v[160:163], a[20:23], a[128:131], v[160:163]
    s_mov_b32 s34, 950272
    v_mfma_f32_16x16x32_bf16 v[164:167], a[20:23], a[132:135], v[164:167]
    buffer_load_dwordx4 a[16:19], v2, s[20:23], s34 offen offset:0
    v_mfma_f32_16x16x32_bf16 v[168:171], a[20:23], a[136:139], v[168:171]
    buffer_store_dwordx4 v[22:25], v10, s[28:31], s40 offen offset:0
    v_mfma_f32_16x16x32_bf16 v[172:175], a[20:23], a[140:143], v[172:175]
    v_accvgpr_read_b32 v14, a152
    v_accvgpr_read_b32 v15, a153
    v_mfma_f32_16x16x32_bf16 v[176:179], a[24:27], a[128:131], v[176:179]
    buffer_load_dwordx4 a[20:23], v2, s[20:23], s34 offen offset:1024
    v_mfma_f32_16x16x32_bf16 v[180:183], a[24:27], a[132:135], v[180:183]
    v_accvgpr_read_b32 v16, a154
    v_mfma_f32_16x16x32_bf16 v[184:187], a[24:27], a[136:139], v[184:187]
    v_accvgpr_read_b32 v17, a155
    v_mfma_f32_16x16x32_bf16 v[188:191], a[24:27], a[140:143], v[188:191]
    s_waitcnt vmcnt(24)
    v_mfma_f32_16x16x32_bf16 v[192:195], a[28:31], a[128:131], v[192:195]
    buffer_load_dwordx4 a[24:27], v2, s[20:23], s34 offen offset:2048
    v_mfma_f32_16x16x32_bf16 v[196:199], a[28:31], a[132:135], v[196:199]
    v_lshlrev_b32 v18, 16, v14
    v_mfma_f32_16x16x32_bf16 v[200:203], a[28:31], a[136:139], v[200:203]
    v_and_b32 v19, 0xffff0000, v14
    v_mfma_f32_16x16x32_bf16 v[204:207], a[28:31], a[140:143], v[204:207]
    v_lshlrev_b32 v20, 16, v15
    v_mfma_f32_16x16x32_bf16 v[208:211], a[32:35], a[128:131], v[208:211]
    buffer_load_dwordx4 a[28:31], v2, s[20:23], s34 offen offset:3072
    v_mfma_f32_16x16x32_bf16 v[212:215], a[32:35], a[132:135], v[212:215]
    v_and_b32 v21, 0xffff0000, v15
    v_mfma_f32_16x16x32_bf16 v[216:219], a[32:35], a[136:139], v[216:219]
    v_mul_f32 v18, v18, v56
    v_mfma_f32_16x16x32_bf16 v[220:223], a[32:35], a[140:143], v[220:223]
    v_mfma_f32_16x16x32_bf16 v[224:227], a[36:39], a[128:131], v[224:227]
    s_mov_b32 s34, 954368
    v_mul_f32 v19, v19, v57
    v_mfma_f32_16x16x32_bf16 v[228:231], a[36:39], a[132:135], v[228:231]
    buffer_load_dwordx4 a[32:35], v2, s[20:23], s34 offen offset:0
    v_mfma_f32_16x16x32_bf16 v[232:235], a[36:39], a[136:139], v[232:235]
    v_mul_f32 v20, v20, v58
    v_mfma_f32_16x16x32_bf16 v[236:239], a[36:39], a[140:143], v[236:239]
    v_mul_f32 v21, v21, v59
    s_waitcnt lgkmcnt(0)
    v_mfma_f32_16x16x32_bf16 v[144:147], a[40:43], a[112:115], v[144:147]
    buffer_load_dwordx4 a[36:39], v2, s[20:23], s34 offen offset:1024
    v_mfma_f32_16x16x32_bf16 v[148:151], a[40:43], a[116:119], v[148:151]
    ds_read_b128 a[128:131], v2 offset:36864
    ds_read_b128 a[132:135], v2 offset:37888
    v_mfma_f32_16x16x32_bf16 v[152:155], a[40:43], a[120:123], v[152:155]
    ds_read_b128 a[136:139], v2 offset:38912
    ds_read_b128 a[140:143], v2 offset:39936
    v_mfma_f32_16x16x32_bf16 v[156:159], a[40:43], a[124:127], v[156:159]
    v_cvt_pk_bf16_f32 v14, v18, v19
    v_cvt_pk_bf16_f32 v15, v20, v21
    v_mfma_f32_16x16x32_bf16 v[160:163], a[44:47], a[112:115], v[160:163]
    buffer_load_dwordx4 a[40:43], v2, s[20:23], s34 offen offset:2048
    v_mfma_f32_16x16x32_bf16 v[164:167], a[44:47], a[116:119], v[164:167]
    v_lshlrev_b32 v18, 16, v16
    v_mfma_f32_16x16x32_bf16 v[168:171], a[44:47], a[120:123], v[168:171]
    v_and_b32 v19, 0xffff0000, v16
    v_mfma_f32_16x16x32_bf16 v[172:175], a[44:47], a[124:127], v[172:175]
    v_lshlrev_b32 v20, 16, v17
    v_mfma_f32_16x16x32_bf16 v[176:179], a[48:51], a[112:115], v[176:179]
    buffer_load_dwordx4 a[44:47], v2, s[20:23], s34 offen offset:3072
    v_mfma_f32_16x16x32_bf16 v[180:183], a[48:51], a[116:119], v[180:183]
    v_and_b32 v21, 0xffff0000, v17
    v_mfma_f32_16x16x32_bf16 v[184:187], a[48:51], a[120:123], v[184:187]
    v_mul_f32 v18, v18, v72
    v_mfma_f32_16x16x32_bf16 v[188:191], a[48:51], a[124:127], v[188:191]
    s_waitcnt vmcnt(22)
    v_mfma_f32_16x16x32_bf16 v[192:195], a[52:55], a[112:115], v[192:195]
    s_mov_b32 s34, 958464
    v_mul_f32 v19, v19, v73
    v_mfma_f32_16x16x32_bf16 v[196:199], a[52:55], a[116:119], v[196:199]
    buffer_load_dwordx4 a[48:51], v2, s[20:23], s34 offen offset:0
    v_mfma_f32_16x16x32_bf16 v[200:203], a[52:55], a[120:123], v[200:203]
    v_mul_f32 v20, v20, v74
    v_mfma_f32_16x16x32_bf16 v[204:207], a[52:55], a[124:127], v[204:207]
    v_mul_f32 v21, v21, v75
    v_mfma_f32_16x16x32_bf16 v[208:211], a[56:59], a[112:115], v[208:211]
    buffer_load_dwordx4 a[52:55], v2, s[20:23], s34 offen offset:1024
    v_mfma_f32_16x16x32_bf16 v[212:215], a[56:59], a[116:119], v[212:215]
    v_cvt_pk_bf16_f32 v16, v18, v19
    v_mfma_f32_16x16x32_bf16 v[216:219], a[56:59], a[120:123], v[216:219]
    v_cvt_pk_bf16_f32 v17, v20, v21
    v_mfma_f32_16x16x32_bf16 v[220:223], a[56:59], a[124:127], v[220:223]
    v_mfma_f32_16x16x32_bf16 v[224:227], a[60:63], a[112:115], v[224:227]
    buffer_load_dwordx4 a[56:59], v2, s[20:23], s34 offen offset:2048
    v_mfma_f32_16x16x32_bf16 v[228:231], a[60:63], a[116:119], v[228:231]
    buffer_store_dwordx4 v[14:17], v10, s[28:31], s41 offen offset:0
    v_mfma_f32_16x16x32_bf16 v[232:235], a[60:63], a[120:123], v[232:235]
    v_accvgpr_read_b32 v22, a156
    v_mfma_f32_16x16x32_bf16 v[236:239], a[60:63], a[124:127], v[236:239]
    v_accvgpr_read_b32 v23, a157
    s_waitcnt lgkmcnt(0)
    v_mfma_f32_16x16x32_bf16 v[144:147], a[64:67], a[128:131], v[144:147]
    buffer_load_dwordx4 a[60:63], v2, s[20:23], s34 offen offset:3072
    v_mfma_f32_16x16x32_bf16 v[148:151], a[64:67], a[132:135], v[148:151]
    ds_read_b128 a[112:115], v2 offset:40960
    ds_read_b128 a[116:119], v2 offset:41984
    v_mfma_f32_16x16x32_bf16 v[152:155], a[64:67], a[136:139], v[152:155]
    ds_read_b128 a[120:123], v2 offset:43008
    ds_read_b128 a[124:127], v2 offset:44032
    v_mfma_f32_16x16x32_bf16 v[156:159], a[64:67], a[140:143], v[156:159]
    v_accvgpr_read_b32 v24, a158
    v_accvgpr_read_b32 v25, a159
    v_mfma_f32_16x16x32_bf16 v[160:163], a[68:71], a[128:131], v[160:163]
    s_mov_b32 s34, 962560
    v_lshlrev_b32 v26, 16, v22
    v_mfma_f32_16x16x32_bf16 v[164:167], a[68:71], a[132:135], v[164:167]
    buffer_load_dwordx4 a[64:67], v2, s[20:23], s34 offen offset:0
    v_mfma_f32_16x16x32_bf16 v[168:171], a[68:71], a[136:139], v[168:171]
    v_and_b32 v27, 0xffff0000, v22
    v_mfma_f32_16x16x32_bf16 v[172:175], a[68:71], a[140:143], v[172:175]
    v_lshlrev_b32 v28, 16, v23
    v_mfma_f32_16x16x32_bf16 v[176:179], a[72:75], a[128:131], v[176:179]
    buffer_load_dwordx4 a[68:71], v2, s[20:23], s34 offen offset:1024
    v_mfma_f32_16x16x32_bf16 v[180:183], a[72:75], a[132:135], v[180:183]
    v_and_b32 v29, 0xffff0000, v23
    v_mfma_f32_16x16x32_bf16 v[184:187], a[72:75], a[136:139], v[184:187]
    v_mfma_f32_16x16x32_bf16 v[188:191], a[72:75], a[140:143], v[188:191]
    v_mul_f32 v26, v26, v60
    v_mfma_f32_16x16x32_bf16 v[192:195], a[76:79], a[128:131], v[192:195]
    buffer_load_dwordx4 a[72:75], v2, s[20:23], s34 offen offset:2048
    v_mfma_f32_16x16x32_bf16 v[196:199], a[76:79], a[132:135], v[196:199]
    v_mul_f32 v27, v27, v61
    v_mfma_f32_16x16x32_bf16 v[200:203], a[76:79], a[136:139], v[200:203]
    v_mul_f32 v28, v28, v62
    v_mfma_f32_16x16x32_bf16 v[204:207], a[76:79], a[140:143], v[204:207]
    v_mul_f32 v29, v29, v63
    s_waitcnt vmcnt(27)
    v_mfma_f32_16x16x32_bf16 v[208:211], a[80:83], a[128:131], v[208:211]
    buffer_load_dwordx4 a[76:79], v2, s[20:23], s34 offen offset:3072
    v_mfma_f32_16x16x32_bf16 v[212:215], a[80:83], a[132:135], v[212:215]
    v_cvt_pk_bf16_f32 v22, v26, v27
    v_mfma_f32_16x16x32_bf16 v[216:219], a[80:83], a[136:139], v[216:219]
    v_mfma_f32_16x16x32_bf16 v[220:223], a[80:83], a[140:143], v[220:223]
    v_cvt_pk_bf16_f32 v23, v28, v29
    v_mfma_f32_16x16x32_bf16 v[224:227], a[84:87], a[128:131], v[224:227]
    s_mov_b32 s34, 966656
    v_lshlrev_b32 v26, 16, v24
    v_mfma_f32_16x16x32_bf16 v[228:231], a[84:87], a[132:135], v[228:231]
    buffer_load_dwordx4 a[80:83], v2, s[20:23], s34 offen offset:0
    v_mfma_f32_16x16x32_bf16 v[232:235], a[84:87], a[136:139], v[232:235]
    v_and_b32 v27, 0xffff0000, v24
    v_mfma_f32_16x16x32_bf16 v[236:239], a[84:87], a[140:143], v[236:239]
    v_lshlrev_b32 v28, 16, v25
    s_waitcnt lgkmcnt(0)
    v_mfma_f32_16x16x32_bf16 v[144:147], a[88:91], a[112:115], v[144:147]
    buffer_load_dwordx4 a[84:87], v2, s[20:23], s34 offen offset:1024
    v_mfma_f32_16x16x32_bf16 v[148:151], a[88:91], a[116:119], v[148:151]
    ds_read_b128 a[128:131], v2 offset:45056
    ds_read_b128 a[132:135], v2 offset:46080
    v_mfma_f32_16x16x32_bf16 v[152:155], a[88:91], a[120:123], v[152:155]
    ds_read_b128 a[136:139], v2 offset:47104
    ds_read_b128 a[140:143], v2 offset:48128
    v_mfma_f32_16x16x32_bf16 v[156:159], a[88:91], a[124:127], v[156:159]
    v_and_b32 v29, 0xffff0000, v25
    v_mul_f32 v26, v26, v76
    s_waitcnt vmcnt(22)
    v_mfma_f32_16x16x32_bf16 v[160:163], a[92:95], a[112:115], v[160:163]
    buffer_load_dwordx4 a[88:91], v2, s[20:23], s34 offen offset:2048
    v_mfma_f32_16x16x32_bf16 v[164:167], a[92:95], a[116:119], v[164:167]
    v_mul_f32 v27, v27, v77
    v_mfma_f32_16x16x32_bf16 v[168:171], a[92:95], a[120:123], v[168:171]
    v_mul_f32 v28, v28, v78
    v_mfma_f32_16x16x32_bf16 v[172:175], a[92:95], a[124:127], v[172:175]
    v_mul_f32 v29, v29, v79
    v_mfma_f32_16x16x32_bf16 v[176:179], a[96:99], a[112:115], v[176:179]
    buffer_load_dwordx4 a[92:95], v2, s[20:23], s34 offen offset:3072
    v_mfma_f32_16x16x32_bf16 v[180:183], a[96:99], a[116:119], v[180:183]
    v_cvt_pk_bf16_f32 v24, v26, v27
    v_mfma_f32_16x16x32_bf16 v[184:187], a[96:99], a[120:123], v[184:187]
    v_mfma_f32_16x16x32_bf16 v[188:191], a[96:99], a[124:127], v[188:191]
    v_cvt_pk_bf16_f32 v25, v28, v29
    v_mfma_f32_16x16x32_bf16 v[192:195], a[100:103], a[112:115], v[192:195]
    s_mov_b32 s34, 970752
    v_mfma_f32_16x16x32_bf16 v[196:199], a[100:103], a[116:119], v[196:199]
    buffer_load_dwordx4 a[96:99], v2, s[20:23], s34 offen offset:0
    v_mfma_f32_16x16x32_bf16 v[200:203], a[100:103], a[120:123], v[200:203]
    buffer_store_dwordx4 v[22:25], v10, s[28:31], s42 offen offset:0
    v_mfma_f32_16x16x32_bf16 v[204:207], a[100:103], a[124:127], v[204:207]
    v_accvgpr_read_b32 v14, a160
    v_mfma_f32_16x16x32_bf16 v[208:211], a[104:107], a[112:115], v[208:211]
    buffer_load_dwordx4 a[100:103], v2, s[20:23], s34 offen offset:1024
    v_mfma_f32_16x16x32_bf16 v[212:215], a[104:107], a[116:119], v[212:215]
    v_accvgpr_read_b32 v15, a161
    v_accvgpr_read_b32 v16, a162
    v_mfma_f32_16x16x32_bf16 v[216:219], a[104:107], a[120:123], v[216:219]
    v_mfma_f32_16x16x32_bf16 v[220:223], a[104:107], a[124:127], v[220:223]
    v_accvgpr_read_b32 v17, a163
    v_mfma_f32_16x16x32_bf16 v[224:227], a[108:111], a[112:115], v[224:227]
    buffer_load_dwordx4 a[104:107], v2, s[20:23], s34 offen offset:2048
    v_mfma_f32_16x16x32_bf16 v[228:231], a[108:111], a[116:119], v[228:231]
    v_lshlrev_b32 v18, 16, v14
    v_mfma_f32_16x16x32_bf16 v[232:235], a[108:111], a[120:123], v[232:235]
    v_and_b32 v19, 0xffff0000, v14
    v_mfma_f32_16x16x32_bf16 v[236:239], a[108:111], a[124:127], v[236:239]
    s_waitcnt lgkmcnt(0)
    v_mfma_f32_16x16x32_bf16 v[144:147], a[0:3], a[128:131], v[144:147]
    buffer_load_dwordx4 a[108:111], v2, s[20:23], s34 offen offset:3072
    v_mfma_f32_16x16x32_bf16 v[148:151], a[0:3], a[132:135], v[148:151]
    ds_read_b128 a[112:115], v2 offset:49152
    ds_read_b128 a[116:119], v2 offset:50176
    v_mfma_f32_16x16x32_bf16 v[152:155], a[0:3], a[136:139], v[152:155]
    ds_read_b128 a[120:123], v2 offset:51200
    ds_read_b128 a[124:127], v2 offset:52224
    v_mfma_f32_16x16x32_bf16 v[156:159], a[0:3], a[140:143], v[156:159]
    v_lshlrev_b32 v20, 16, v15
    v_and_b32 v21, 0xffff0000, v15
    v_mfma_f32_16x16x32_bf16 v[160:163], a[4:7], a[128:131], v[160:163]
    s_mov_b32 s34, 974848
    v_mul_f32 v18, v18, v80
    v_mfma_f32_16x16x32_bf16 v[164:167], a[4:7], a[132:135], v[164:167]
    buffer_load_dwordx4 a[0:3], v2, s[20:23], s34 offen offset:0
    v_mfma_f32_16x16x32_bf16 v[168:171], a[4:7], a[136:139], v[168:171]
    v_mul_f32 v19, v19, v81
    v_mul_f32 v20, v20, v82
    v_mfma_f32_16x16x32_bf16 v[172:175], a[4:7], a[140:143], v[172:175]
    s_waitcnt vmcnt(27)
    v_mfma_f32_16x16x32_bf16 v[176:179], a[8:11], a[128:131], v[176:179]
    buffer_load_dwordx4 a[4:7], v2, s[20:23], s34 offen offset:1024
    v_mfma_f32_16x16x32_bf16 v[180:183], a[8:11], a[132:135], v[180:183]
    v_mul_f32 v21, v21, v83
    v_cvt_pk_bf16_f32 v14, v18, v19
    v_mfma_f32_16x16x32_bf16 v[184:187], a[8:11], a[136:139], v[184:187]
    v_mfma_f32_16x16x32_bf16 v[188:191], a[8:11], a[140:143], v[188:191]
    v_cvt_pk_bf16_f32 v15, v20, v21
    v_mfma_f32_16x16x32_bf16 v[192:195], a[12:15], a[128:131], v[192:195]
    buffer_load_dwordx4 a[8:11], v2, s[20:23], s34 offen offset:2048
    v_mfma_f32_16x16x32_bf16 v[196:199], a[12:15], a[132:135], v[196:199]
    v_lshlrev_b32 v18, 16, v16
    v_mfma_f32_16x16x32_bf16 v[200:203], a[12:15], a[136:139], v[200:203]
    v_and_b32 v19, 0xffff0000, v16
    v_mfma_f32_16x16x32_bf16 v[204:207], a[12:15], a[140:143], v[204:207]
    v_mfma_f32_16x16x32_bf16 v[208:211], a[16:19], a[128:131], v[208:211]
    buffer_load_dwordx4 a[12:15], v2, s[20:23], s34 offen offset:3072
    v_mfma_f32_16x16x32_bf16 v[212:215], a[16:19], a[132:135], v[212:215]
    v_lshlrev_b32 v20, 16, v17
    v_and_b32 v21, 0xffff0000, v17
    v_mfma_f32_16x16x32_bf16 v[216:219], a[16:19], a[136:139], v[216:219]
    v_mfma_f32_16x16x32_bf16 v[220:223], a[16:19], a[140:143], v[220:223]
    v_mul_f32 v18, v18, v96
    s_waitcnt vmcnt(22)
    v_mfma_f32_16x16x32_bf16 v[224:227], a[20:23], a[128:131], v[224:227]
    s_mov_b32 s34, 978944
    v_mul_f32 v19, v19, v97
    v_mfma_f32_16x16x32_bf16 v[228:231], a[20:23], a[132:135], v[228:231]
    buffer_load_dwordx4 a[16:19], v2, s[20:23], s34 offen offset:0
    v_mfma_f32_16x16x32_bf16 v[232:235], a[20:23], a[136:139], v[232:235]
    v_mul_f32 v20, v20, v98
    v_mfma_f32_16x16x32_bf16 v[236:239], a[20:23], a[140:143], v[236:239]
    s_waitcnt lgkmcnt(0)
    v_mfma_f32_16x16x32_bf16 v[144:147], a[24:27], a[112:115], v[144:147]
    buffer_load_dwordx4 a[20:23], v2, s[20:23], s34 offen offset:1024
    v_mfma_f32_16x16x32_bf16 v[148:151], a[24:27], a[116:119], v[148:151]
    ds_read_b128 a[128:131], v2 offset:53248
    ds_read_b128 a[132:135], v2 offset:54272
    v_mfma_f32_16x16x32_bf16 v[152:155], a[24:27], a[120:123], v[152:155]
    ds_read_b128 a[136:139], v2 offset:55296
    ds_read_b128 a[140:143], v2 offset:56320
    v_mfma_f32_16x16x32_bf16 v[156:159], a[24:27], a[124:127], v[156:159]
    v_mul_f32 v21, v21, v99
    v_cvt_pk_bf16_f32 v16, v18, v19
    v_mfma_f32_16x16x32_bf16 v[160:163], a[28:31], a[112:115], v[160:163]
    buffer_load_dwordx4 a[24:27], v2, s[20:23], s34 offen offset:2048
    v_mfma_f32_16x16x32_bf16 v[164:167], a[28:31], a[116:119], v[164:167]
    v_cvt_pk_bf16_f32 v17, v20, v21
    v_mfma_f32_16x16x32_bf16 v[168:171], a[28:31], a[120:123], v[168:171]
    buffer_store_dwordx4 v[14:17], v10, s[28:31], 0 offen offset:64
    v_mfma_f32_16x16x32_bf16 v[172:175], a[28:31], a[124:127], v[172:175]
    v_accvgpr_read_b32 v22, a164
    v_mfma_f32_16x16x32_bf16 v[176:179], a[32:35], a[112:115], v[176:179]
    buffer_load_dwordx4 a[28:31], v2, s[20:23], s34 offen offset:3072
    v_mfma_f32_16x16x32_bf16 v[180:183], a[32:35], a[116:119], v[180:183]
    v_accvgpr_read_b32 v23, a165
    v_accvgpr_read_b32 v24, a166
    v_mfma_f32_16x16x32_bf16 v[184:187], a[32:35], a[120:123], v[184:187]
    v_mfma_f32_16x16x32_bf16 v[188:191], a[32:35], a[124:127], v[188:191]
    v_accvgpr_read_b32 v25, a167
    v_mfma_f32_16x16x32_bf16 v[192:195], a[36:39], a[112:115], v[192:195]
    s_mov_b32 s34, 983040
    v_mfma_f32_16x16x32_bf16 v[196:199], a[36:39], a[116:119], v[196:199]
    buffer_load_dwordx4 a[32:35], v2, s[20:23], s34 offen offset:0
    v_mfma_f32_16x16x32_bf16 v[200:203], a[36:39], a[120:123], v[200:203]
    v_lshlrev_b32 v26, 16, v22
    v_and_b32 v27, 0xffff0000, v22
    v_mfma_f32_16x16x32_bf16 v[204:207], a[36:39], a[124:127], v[204:207]
    v_mfma_f32_16x16x32_bf16 v[208:211], a[40:43], a[112:115], v[208:211]
    buffer_load_dwordx4 a[36:39], v2, s[20:23], s34 offen offset:1024
    v_mfma_f32_16x16x32_bf16 v[212:215], a[40:43], a[116:119], v[212:215]
    v_lshlrev_b32 v28, 16, v23
    v_and_b32 v29, 0xffff0000, v23
    v_mfma_f32_16x16x32_bf16 v[216:219], a[40:43], a[120:123], v[216:219]
    v_mfma_f32_16x16x32_bf16 v[220:223], a[40:43], a[124:127], v[220:223]
    v_mul_f32 v26, v26, v84
    v_mfma_f32_16x16x32_bf16 v[224:227], a[44:47], a[112:115], v[224:227]
    buffer_load_dwordx4 a[40:43], v2, s[20:23], s34 offen offset:2048
    v_mfma_f32_16x16x32_bf16 v[228:231], a[44:47], a[116:119], v[228:231]
    v_mul_f32 v27, v27, v85
    v_mfma_f32_16x16x32_bf16 v[232:235], a[44:47], a[120:123], v[232:235]
    v_mul_f32 v28, v28, v86
    v_mfma_f32_16x16x32_bf16 v[236:239], a[44:47], a[124:127], v[236:239]
    s_waitcnt vmcnt(27) lgkmcnt(0)
    v_mfma_f32_16x16x32_bf16 v[144:147], a[48:51], a[128:131], v[144:147]
    buffer_load_dwordx4 a[44:47], v2, s[20:23], s34 offen offset:3072
    v_mfma_f32_16x16x32_bf16 v[148:151], a[48:51], a[132:135], v[148:151]
    ds_read_b128 a[112:115], v4 offset:0
    ds_read_b128 a[116:119], v4 offset:1024
    v_mfma_f32_16x16x32_bf16 v[152:155], a[48:51], a[136:139], v[152:155]
    ds_read_b128 a[120:123], v4 offset:2048
    ds_read_b128 a[124:127], v4 offset:3072
    v_mfma_f32_16x16x32_bf16 v[156:159], a[48:51], a[140:143], v[156:159]
    v_mul_f32 v29, v29, v87
    v_cvt_pk_bf16_f32 v22, v26, v27
    v_mfma_f32_16x16x32_bf16 v[160:163], a[52:55], a[128:131], v[160:163]
    s_mov_b32 s34, 987136
    v_cvt_pk_bf16_f32 v23, v28, v29
    v_mfma_f32_16x16x32_bf16 v[164:167], a[52:55], a[132:135], v[164:167]
    buffer_load_dwordx4 a[48:51], v2, s[20:23], s34 offen offset:0
    v_mfma_f32_16x16x32_bf16 v[168:171], a[52:55], a[136:139], v[168:171]
    v_lshlrev_b32 v26, 16, v24
    v_and_b32 v27, 0xffff0000, v24
    v_mfma_f32_16x16x32_bf16 v[172:175], a[52:55], a[140:143], v[172:175]
    v_mfma_f32_16x16x32_bf16 v[176:179], a[56:59], a[128:131], v[176:179]
    buffer_load_dwordx4 a[52:55], v2, s[20:23], s34 offen offset:1024
    v_mfma_f32_16x16x32_bf16 v[180:183], a[56:59], a[132:135], v[180:183]
    v_lshlrev_b32 v28, 16, v25
    v_and_b32 v29, 0xffff0000, v25
    v_mfma_f32_16x16x32_bf16 v[184:187], a[56:59], a[136:139], v[184:187]
    v_mfma_f32_16x16x32_bf16 v[188:191], a[56:59], a[140:143], v[188:191]
    v_mul_f32 v26, v26, v100
    s_waitcnt vmcnt(22)
    v_mfma_f32_16x16x32_bf16 v[192:195], a[60:63], a[128:131], v[192:195]
    buffer_load_dwordx4 a[56:59], v2, s[20:23], s34 offen offset:2048
    v_mfma_f32_16x16x32_bf16 v[196:199], a[60:63], a[132:135], v[196:199]
    v_mul_f32 v27, v27, v101
    v_mfma_f32_16x16x32_bf16 v[200:203], a[60:63], a[136:139], v[200:203]
    v_mul_f32 v28, v28, v102
    v_mfma_f32_16x16x32_bf16 v[204:207], a[60:63], a[140:143], v[204:207]
    v_mfma_f32_16x16x32_bf16 v[208:211], a[64:67], a[128:131], v[208:211]
    buffer_load_dwordx4 a[60:63], v2, s[20:23], s34 offen offset:3072
    v_mfma_f32_16x16x32_bf16 v[212:215], a[64:67], a[132:135], v[212:215]
    v_mul_f32 v29, v29, v103
    v_cvt_pk_bf16_f32 v24, v26, v27
    v_mfma_f32_16x16x32_bf16 v[216:219], a[64:67], a[136:139], v[216:219]
    v_mfma_f32_16x16x32_bf16 v[220:223], a[64:67], a[140:143], v[220:223]
    v_cvt_pk_bf16_f32 v25, v28, v29
    v_mfma_f32_16x16x32_bf16 v[224:227], a[68:71], a[128:131], v[224:227]
    s_mov_b32 s34, 991232
    v_mfma_f32_16x16x32_bf16 v[228:231], a[68:71], a[132:135], v[228:231]
    buffer_load_dwordx4 a[64:67], v2, s[20:23], s34 offen offset:0
    v_mfma_f32_16x16x32_bf16 v[232:235], a[68:71], a[136:139], v[232:235]
    buffer_store_dwordx4 v[22:25], v10, s[28:31], s40 offen offset:64
    v_mfma_f32_16x16x32_bf16 v[236:239], a[68:71], a[140:143], v[236:239]
    v_accvgpr_read_b32 v14, a168
    s_waitcnt lgkmcnt(0)
    v_mfma_f32_16x16x32_bf16 v[144:147], a[72:75], a[112:115], v[144:147]
    buffer_load_dwordx4 a[68:71], v2, s[20:23], s34 offen offset:1024
    v_mfma_f32_16x16x32_bf16 v[148:151], a[72:75], a[116:119], v[148:151]
    ds_read_b128 a[128:131], v4 offset:4096
    ds_read_b128 a[132:135], v4 offset:5120
    v_mfma_f32_16x16x32_bf16 v[152:155], a[72:75], a[120:123], v[152:155]
    ds_read_b128 a[136:139], v4 offset:6144
    ds_read_b128 a[140:143], v4 offset:7168
    v_mfma_f32_16x16x32_bf16 v[156:159], a[72:75], a[124:127], v[156:159]
    v_accvgpr_read_b32 v15, a169
    v_accvgpr_read_b32 v16, a170
    v_mfma_f32_16x16x32_bf16 v[160:163], a[76:79], a[112:115], v[160:163]
    buffer_load_dwordx4 a[72:75], v2, s[20:23], s34 offen offset:2048
    v_mfma_f32_16x16x32_bf16 v[164:167], a[76:79], a[116:119], v[164:167]
    v_accvgpr_read_b32 v17, a171
    v_lshlrev_b32 v18, 16, v14
    v_mfma_f32_16x16x32_bf16 v[168:171], a[76:79], a[120:123], v[168:171]
    v_and_b32 v19, 0xffff0000, v14
    v_mfma_f32_16x16x32_bf16 v[172:175], a[76:79], a[124:127], v[172:175]
    v_mfma_f32_16x16x32_bf16 v[176:179], a[80:83], a[112:115], v[176:179]
    buffer_load_dwordx4 a[76:79], v2, s[20:23], s34 offen offset:3072
    v_mfma_f32_16x16x32_bf16 v[180:183], a[80:83], a[116:119], v[180:183]
    v_lshlrev_b32 v20, 16, v15
    v_mfma_f32_16x16x32_bf16 v[184:187], a[80:83], a[120:123], v[184:187]
    v_and_b32 v21, 0xffff0000, v15
    v_mfma_f32_16x16x32_bf16 v[188:191], a[80:83], a[124:127], v[188:191]
    v_mul_f32 v18, v18, v88
    v_mfma_f32_16x16x32_bf16 v[192:195], a[84:87], a[112:115], v[192:195]
    s_mov_b32 s34, 995328
    v_mfma_f32_16x16x32_bf16 v[196:199], a[84:87], a[116:119], v[196:199]
    buffer_load_dwordx4 a[80:83], v2, s[20:23], s34 offen offset:0
    v_mfma_f32_16x16x32_bf16 v[200:203], a[84:87], a[120:123], v[200:203]
    v_mul_f32 v19, v19, v89
    v_mul_f32 v20, v20, v90
    v_mfma_f32_16x16x32_bf16 v[204:207], a[84:87], a[124:127], v[204:207]
    s_waitcnt vmcnt(27)
    v_mfma_f32_16x16x32_bf16 v[208:211], a[88:91], a[112:115], v[208:211]
    buffer_load_dwordx4 a[84:87], v2, s[20:23], s34 offen offset:1024
    v_mfma_f32_16x16x32_bf16 v[212:215], a[88:91], a[116:119], v[212:215]
    v_mul_f32 v21, v21, v91
    v_mfma_f32_16x16x32_bf16 v[216:219], a[88:91], a[120:123], v[216:219]
    v_cvt_pk_bf16_f32 v14, v18, v19
    v_mfma_f32_16x16x32_bf16 v[220:223], a[88:91], a[124:127], v[220:223]
    v_cvt_pk_bf16_f32 v15, v20, v21
    v_mfma_f32_16x16x32_bf16 v[224:227], a[92:95], a[112:115], v[224:227]
    buffer_load_dwordx4 a[88:91], v2, s[20:23], s34 offen offset:2048
    v_mfma_f32_16x16x32_bf16 v[228:231], a[92:95], a[116:119], v[228:231]
    v_lshlrev_b32 v18, 16, v16
    v_mfma_f32_16x16x32_bf16 v[232:235], a[92:95], a[120:123], v[232:235]
    v_and_b32 v19, 0xffff0000, v16
    v_mfma_f32_16x16x32_bf16 v[236:239], a[92:95], a[124:127], v[236:239]
    s_waitcnt lgkmcnt(0)
    v_mfma_f32_16x16x32_bf16 v[144:147], a[96:99], a[128:131], v[144:147]
    buffer_load_dwordx4 a[92:95], v2, s[20:23], s34 offen offset:3072
    v_mfma_f32_16x16x32_bf16 v[148:151], a[96:99], a[132:135], v[148:151]
    ds_read_b128 a[112:115], v4 offset:8192
    ds_read_b128 a[116:119], v4 offset:9216
    v_mfma_f32_16x16x32_bf16 v[152:155], a[96:99], a[136:139], v[152:155]
    ds_read_b128 a[120:123], v4 offset:10240
    ds_read_b128 a[124:127], v4 offset:11264
    v_mfma_f32_16x16x32_bf16 v[156:159], a[96:99], a[140:143], v[156:159]
    v_lshlrev_b32 v20, 16, v17
    v_and_b32 v21, 0xffff0000, v17
    s_waitcnt vmcnt(22)
    v_mfma_f32_16x16x32_bf16 v[160:163], a[100:103], a[128:131], v[160:163]
    s_mov_b32 s34, 999424
    v_mul_f32 v18, v18, v104
    v_mfma_f32_16x16x32_bf16 v[164:167], a[100:103], a[132:135], v[164:167]
    buffer_load_dwordx4 a[96:99], v2, s[20:23], s34 offen offset:0
    v_mfma_f32_16x16x32_bf16 v[168:171], a[100:103], a[136:139], v[168:171]
    v_mul_f32 v19, v19, v105
    v_mul_f32 v20, v20, v106
    v_mfma_f32_16x16x32_bf16 v[172:175], a[100:103], a[140:143], v[172:175]
    v_mfma_f32_16x16x32_bf16 v[176:179], a[104:107], a[128:131], v[176:179]
    buffer_load_dwordx4 a[100:103], v2, s[20:23], s34 offen offset:1024
    v_mfma_f32_16x16x32_bf16 v[180:183], a[104:107], a[132:135], v[180:183]
    v_mul_f32 v21, v21, v107
    v_mfma_f32_16x16x32_bf16 v[184:187], a[104:107], a[136:139], v[184:187]
    v_cvt_pk_bf16_f32 v16, v18, v19
    v_mfma_f32_16x16x32_bf16 v[188:191], a[104:107], a[140:143], v[188:191]
    v_cvt_pk_bf16_f32 v17, v20, v21
    v_mfma_f32_16x16x32_bf16 v[192:195], a[108:111], a[128:131], v[192:195]
    buffer_load_dwordx4 a[104:107], v2, s[20:23], s34 offen offset:2048
    v_mfma_f32_16x16x32_bf16 v[196:199], a[108:111], a[132:135], v[196:199]
    buffer_store_dwordx4 v[14:17], v10, s[28:31], s41 offen offset:64
    v_mfma_f32_16x16x32_bf16 v[200:203], a[108:111], a[136:139], v[200:203]
    v_mfma_f32_16x16x32_bf16 v[204:207], a[108:111], a[140:143], v[204:207]
    v_accvgpr_read_b32 v22, a172
    v_mfma_f32_16x16x32_bf16 v[208:211], a[0:3], a[128:131], v[208:211]
    buffer_load_dwordx4 a[108:111], v2, s[20:23], s34 offen offset:3072
    v_mfma_f32_16x16x32_bf16 v[212:215], a[0:3], a[132:135], v[212:215]
    v_accvgpr_read_b32 v23, a173
    v_mfma_f32_16x16x32_bf16 v[216:219], a[0:3], a[136:139], v[216:219]
    v_accvgpr_read_b32 v24, a174
    v_mfma_f32_16x16x32_bf16 v[220:223], a[0:3], a[140:143], v[220:223]
    v_accvgpr_read_b32 v25, a175
    v_mfma_f32_16x16x32_bf16 v[224:227], a[4:7], a[128:131], v[224:227]
    s_mov_b32 s34, 1003520
    v_mfma_f32_16x16x32_bf16 v[228:231], a[4:7], a[132:135], v[228:231]
    buffer_load_dwordx4 a[0:3], v2, s[20:23], s34 offen offset:0
    v_mfma_f32_16x16x32_bf16 v[232:235], a[4:7], a[136:139], v[232:235]
    v_lshlrev_b32 v26, 16, v22
    v_mfma_f32_16x16x32_bf16 v[236:239], a[4:7], a[140:143], v[236:239]
    v_and_b32 v27, 0xffff0000, v22
    s_waitcnt lgkmcnt(0)
    v_mfma_f32_16x16x32_bf16 v[144:147], a[8:11], a[112:115], v[144:147]
    buffer_load_dwordx4 a[4:7], v2, s[20:23], s34 offen offset:1024
    v_mfma_f32_16x16x32_bf16 v[148:151], a[8:11], a[116:119], v[148:151]
    ds_read_b128 a[128:131], v4 offset:12288
    ds_read_b128 a[132:135], v4 offset:13312
    v_mfma_f32_16x16x32_bf16 v[152:155], a[8:11], a[120:123], v[152:155]
    ds_read_b128 a[136:139], v4 offset:14336
    ds_read_b128 a[140:143], v4 offset:15360
    v_mfma_f32_16x16x32_bf16 v[156:159], a[8:11], a[124:127], v[156:159]
    v_lshlrev_b32 v28, 16, v23
    v_and_b32 v29, 0xffff0000, v23
    v_mfma_f32_16x16x32_bf16 v[160:163], a[12:15], a[112:115], v[160:163]
    buffer_load_dwordx4 a[8:11], v2, s[20:23], s34 offen offset:2048
    v_mfma_f32_16x16x32_bf16 v[164:167], a[12:15], a[116:119], v[164:167]
    v_mul_f32 v26, v26, v92
    v_mul_f32 v27, v27, v93
    v_mfma_f32_16x16x32_bf16 v[168:171], a[12:15], a[120:123], v[168:171]
    v_mfma_f32_16x16x32_bf16 v[172:175], a[12:15], a[124:127], v[172:175]
    v_mul_f32 v28, v28, v94
    s_waitcnt vmcnt(27)
    v_mfma_f32_16x16x32_bf16 v[176:179], a[16:19], a[112:115], v[176:179]
    buffer_load_dwordx4 a[12:15], v2, s[20:23], s34 offen offset:3072
    v_mfma_f32_16x16x32_bf16 v[180:183], a[16:19], a[116:119], v[180:183]
    v_mul_f32 v29, v29, v95
    v_mfma_f32_16x16x32_bf16 v[184:187], a[16:19], a[120:123], v[184:187]
    v_cvt_pk_bf16_f32 v22, v26, v27
    v_mfma_f32_16x16x32_bf16 v[188:191], a[16:19], a[124:127], v[188:191]
    v_cvt_pk_bf16_f32 v23, v28, v29
    v_mfma_f32_16x16x32_bf16 v[192:195], a[20:23], a[112:115], v[192:195]
    s_mov_b32 s34, 1007616
    v_mfma_f32_16x16x32_bf16 v[196:199], a[20:23], a[116:119], v[196:199]
    buffer_load_dwordx4 a[16:19], v2, s[20:23], s34 offen offset:0
    v_mfma_f32_16x16x32_bf16 v[200:203], a[20:23], a[120:123], v[200:203]
    v_lshlrev_b32 v26, 16, v24
    v_mfma_f32_16x16x32_bf16 v[204:207], a[20:23], a[124:127], v[204:207]
    v_and_b32 v27, 0xffff0000, v24
    v_mfma_f32_16x16x32_bf16 v[208:211], a[24:27], a[112:115], v[208:211]
    buffer_load_dwordx4 a[20:23], v2, s[20:23], s34 offen offset:1024
    v_mfma_f32_16x16x32_bf16 v[212:215], a[24:27], a[116:119], v[212:215]
    v_lshlrev_b32 v28, 16, v25
    v_mfma_f32_16x16x32_bf16 v[216:219], a[24:27], a[120:123], v[216:219]
    v_and_b32 v29, 0xffff0000, v25
    v_mfma_f32_16x16x32_bf16 v[220:223], a[24:27], a[124:127], v[220:223]
    v_mul_f32 v26, v26, v108
    s_waitcnt vmcnt(22)
    v_mfma_f32_16x16x32_bf16 v[224:227], a[28:31], a[112:115], v[224:227]
    buffer_load_dwordx4 a[24:27], v2, s[20:23], s34 offen offset:2048
    v_mfma_f32_16x16x32_bf16 v[228:231], a[28:31], a[116:119], v[228:231]
    v_mul_f32 v27, v27, v109
    v_mfma_f32_16x16x32_bf16 v[232:235], a[28:31], a[120:123], v[232:235]
    v_mfma_f32_16x16x32_bf16 v[236:239], a[28:31], a[124:127], v[236:239]
    v_mul_f32 v28, v28, v110
    s_waitcnt lgkmcnt(0)
    v_mfma_f32_16x16x32_bf16 v[144:147], a[32:35], a[128:131], v[144:147]
    buffer_load_dwordx4 a[28:31], v2, s[20:23], s34 offen offset:3072
    v_mfma_f32_16x16x32_bf16 v[148:151], a[32:35], a[132:135], v[148:151]
    ds_read_b128 a[112:115], v4 offset:16384
    ds_read_b128 a[116:119], v4 offset:17408
    v_mfma_f32_16x16x32_bf16 v[152:155], a[32:35], a[136:139], v[152:155]
    ds_read_b128 a[120:123], v4 offset:18432
    ds_read_b128 a[124:127], v4 offset:19456
    v_mfma_f32_16x16x32_bf16 v[156:159], a[32:35], a[140:143], v[156:159]
    v_mul_f32 v29, v29, v111
    v_cvt_pk_bf16_f32 v24, v26, v27
    v_mfma_f32_16x16x32_bf16 v[160:163], a[36:39], a[128:131], v[160:163]
    s_mov_b32 s34, 1011712
    v_cvt_pk_bf16_f32 v25, v28, v29
    v_mfma_f32_16x16x32_bf16 v[164:167], a[36:39], a[132:135], v[164:167]
    buffer_load_dwordx4 a[32:35], v2, s[20:23], s34 offen offset:0
    v_mfma_f32_16x16x32_bf16 v[168:171], a[36:39], a[136:139], v[168:171]
    buffer_store_dwordx4 v[22:25], v10, s[28:31], s42 offen offset:64
    v_mfma_f32_16x16x32_bf16 v[172:175], a[36:39], a[140:143], v[172:175]
    v_accvgpr_read_b32 v14, a176
    v_mfma_f32_16x16x32_bf16 v[176:179], a[40:43], a[128:131], v[176:179]
    buffer_load_dwordx4 a[36:39], v2, s[20:23], s34 offen offset:1024
    v_mfma_f32_16x16x32_bf16 v[180:183], a[40:43], a[132:135], v[180:183]
    v_accvgpr_read_b32 v15, a177
    v_mfma_f32_16x16x32_bf16 v[184:187], a[40:43], a[136:139], v[184:187]
    v_accvgpr_read_b32 v16, a178
    v_mfma_f32_16x16x32_bf16 v[188:191], a[40:43], a[140:143], v[188:191]
    v_mfma_f32_16x16x32_bf16 v[192:195], a[44:47], a[128:131], v[192:195]
    buffer_load_dwordx4 a[40:43], v2, s[20:23], s34 offen offset:2048
    v_mfma_f32_16x16x32_bf16 v[196:199], a[44:47], a[132:135], v[196:199]
    v_accvgpr_read_b32 v17, a179
    v_lshlrev_b32 v18, 16, v14
    v_mfma_f32_16x16x32_bf16 v[200:203], a[44:47], a[136:139], v[200:203]
    v_mfma_f32_16x16x32_bf16 v[204:207], a[44:47], a[140:143], v[204:207]
    v_and_b32 v19, 0xffff0000, v14
    v_mfma_f32_16x16x32_bf16 v[208:211], a[48:51], a[128:131], v[208:211]
    buffer_load_dwordx4 a[44:47], v2, s[20:23], s34 offen offset:3072
    v_mfma_f32_16x16x32_bf16 v[212:215], a[48:51], a[132:135], v[212:215]
    v_lshlrev_b32 v20, 16, v15
    v_mfma_f32_16x16x32_bf16 v[216:219], a[48:51], a[136:139], v[216:219]
    v_and_b32 v21, 0xffff0000, v15
    v_mfma_f32_16x16x32_bf16 v[220:223], a[48:51], a[140:143], v[220:223]
    v_mfma_f32_16x16x32_bf16 v[224:227], a[52:55], a[128:131], v[224:227]
    s_mov_b32 s34, 1015808
    v_mul_f32 v18, v18, v112
    v_mfma_f32_16x16x32_bf16 v[228:231], a[52:55], a[132:135], v[228:231]
    buffer_load_dwordx4 a[48:51], v2, s[20:23], s34 offen offset:0
    v_mfma_f32_16x16x32_bf16 v[232:235], a[52:55], a[136:139], v[232:235]
    v_mul_f32 v19, v19, v113
    v_mfma_f32_16x16x32_bf16 v[236:239], a[52:55], a[140:143], v[236:239]
    v_mul_f32 v20, v20, v114
    s_waitcnt vmcnt(27) lgkmcnt(0)
    v_mfma_f32_16x16x32_bf16 v[144:147], a[56:59], a[112:115], v[144:147]
    buffer_load_dwordx4 a[52:55], v2, s[20:23], s34 offen offset:1024
    v_mfma_f32_16x16x32_bf16 v[148:151], a[56:59], a[116:119], v[148:151]
    ds_read_b128 a[128:131], v4 offset:20480
    ds_read_b128 a[132:135], v4 offset:21504
    v_mfma_f32_16x16x32_bf16 v[152:155], a[56:59], a[120:123], v[152:155]
    ds_read_b128 a[136:139], v4 offset:22528
    ds_read_b128 a[140:143], v4 offset:23552
    v_mfma_f32_16x16x32_bf16 v[156:159], a[56:59], a[124:127], v[156:159]
    v_mul_f32 v21, v21, v115
    v_cvt_pk_bf16_f32 v14, v18, v19
    v_mfma_f32_16x16x32_bf16 v[160:163], a[60:63], a[112:115], v[160:163]
    buffer_load_dwordx4 a[56:59], v2, s[20:23], s34 offen offset:2048
    v_mfma_f32_16x16x32_bf16 v[164:167], a[60:63], a[116:119], v[164:167]
    v_cvt_pk_bf16_f32 v15, v20, v21
    v_lshlrev_b32 v18, 16, v16
    v_mfma_f32_16x16x32_bf16 v[168:171], a[60:63], a[120:123], v[168:171]
    v_mfma_f32_16x16x32_bf16 v[172:175], a[60:63], a[124:127], v[172:175]
    v_and_b32 v19, 0xffff0000, v16
    v_mfma_f32_16x16x32_bf16 v[176:179], a[64:67], a[112:115], v[176:179]
    buffer_load_dwordx4 a[60:63], v2, s[20:23], s34 offen offset:3072
    v_mfma_f32_16x16x32_bf16 v[180:183], a[64:67], a[116:119], v[180:183]
    v_lshlrev_b32 v20, 16, v17
    v_mfma_f32_16x16x32_bf16 v[184:187], a[64:67], a[120:123], v[184:187]
    v_and_b32 v21, 0xffff0000, v17
    v_mfma_f32_16x16x32_bf16 v[188:191], a[64:67], a[124:127], v[188:191]
    s_waitcnt vmcnt(22)
    v_mfma_f32_16x16x32_bf16 v[192:195], a[68:71], a[112:115], v[192:195]
    s_mov_b32 s34, 1019904
    v_mul_f32 v18, v18, v128
    v_mfma_f32_16x16x32_bf16 v[196:199], a[68:71], a[116:119], v[196:199]
    buffer_load_dwordx4 a[64:67], v2, s[20:23], s34 offen offset:0
    v_mfma_f32_16x16x32_bf16 v[200:203], a[68:71], a[120:123], v[200:203]
    v_mul_f32 v19, v19, v129
    v_mfma_f32_16x16x32_bf16 v[204:207], a[68:71], a[124:127], v[204:207]
    v_mul_f32 v20, v20, v130
    v_mfma_f32_16x16x32_bf16 v[208:211], a[72:75], a[112:115], v[208:211]
    buffer_load_dwordx4 a[68:71], v2, s[20:23], s34 offen offset:1024
    v_mfma_f32_16x16x32_bf16 v[212:215], a[72:75], a[116:119], v[212:215]
    v_mul_f32 v21, v21, v131
    v_mfma_f32_16x16x32_bf16 v[216:219], a[72:75], a[120:123], v[216:219]
    v_cvt_pk_bf16_f32 v16, v18, v19
    v_mfma_f32_16x16x32_bf16 v[220:223], a[72:75], a[124:127], v[220:223]
    v_mfma_f32_16x16x32_bf16 v[224:227], a[76:79], a[112:115], v[224:227]
    buffer_load_dwordx4 a[72:75], v2, s[20:23], s34 offen offset:2048
    v_mfma_f32_16x16x32_bf16 v[228:231], a[76:79], a[116:119], v[228:231]
    v_cvt_pk_bf16_f32 v17, v20, v21
    v_mfma_f32_16x16x32_bf16 v[232:235], a[76:79], a[120:123], v[232:235]
    buffer_store_dwordx4 v[14:17], v10, s[28:31], 0 offen offset:128
    v_mfma_f32_16x16x32_bf16 v[236:239], a[76:79], a[124:127], v[236:239]
    v_accvgpr_read_b32 v22, a180
    s_waitcnt lgkmcnt(0)
    v_mfma_f32_16x16x32_bf16 v[144:147], a[80:83], a[128:131], v[144:147]
    buffer_load_dwordx4 a[76:79], v2, s[20:23], s34 offen offset:3072
    v_mfma_f32_16x16x32_bf16 v[148:151], a[80:83], a[132:135], v[148:151]
    ds_read_b128 a[112:115], v4 offset:24576
    ds_read_b128 a[116:119], v4 offset:25600
    v_mfma_f32_16x16x32_bf16 v[152:155], a[80:83], a[136:139], v[152:155]
    ds_read_b128 a[120:123], v4 offset:26624
    ds_read_b128 a[124:127], v4 offset:27648
    v_mfma_f32_16x16x32_bf16 v[156:159], a[80:83], a[140:143], v[156:159]
    v_accvgpr_read_b32 v23, a181
    v_accvgpr_read_b32 v24, a182
    v_mfma_f32_16x16x32_bf16 v[160:163], a[84:87], a[128:131], v[160:163]
    s_mov_b32 s34, 1024000
    v_accvgpr_read_b32 v25, a183
    v_mfma_f32_16x16x32_bf16 v[164:167], a[84:87], a[132:135], v[164:167]
    buffer_load_dwordx4 a[80:83], v2, s[20:23], s34 offen offset:0
    v_mfma_f32_16x16x32_bf16 v[168:171], a[84:87], a[136:139], v[168:171]
    v_lshlrev_b32 v26, 16, v22
    v_mfma_f32_16x16x32_bf16 v[172:175], a[84:87], a[140:143], v[172:175]
    v_and_b32 v27, 0xffff0000, v22
    v_mfma_f32_16x16x32_bf16 v[176:179], a[88:91], a[128:131], v[176:179]
    buffer_load_dwordx4 a[84:87], v2, s[20:23], s34 offen offset:1024
    v_mfma_f32_16x16x32_bf16 v[180:183], a[88:91], a[132:135], v[180:183]
    v_lshlrev_b32 v28, 16, v23
    v_mfma_f32_16x16x32_bf16 v[184:187], a[88:91], a[136:139], v[184:187]
    v_and_b32 v29, 0xffff0000, v23
    v_mfma_f32_16x16x32_bf16 v[188:191], a[88:91], a[140:143], v[188:191]
    v_mfma_f32_16x16x32_bf16 v[192:195], a[92:95], a[128:131], v[192:195]
    buffer_load_dwordx4 a[88:91], v2, s[20:23], s34 offen offset:2048
    v_mfma_f32_16x16x32_bf16 v[196:199], a[92:95], a[132:135], v[196:199]
    v_mul_f32 v26, v26, v116
    v_mul_f32 v27, v27, v117
    v_mfma_f32_16x16x32_bf16 v[200:203], a[92:95], a[136:139], v[200:203]
    v_mfma_f32_16x16x32_bf16 v[204:207], a[92:95], a[140:143], v[204:207]
    v_mul_f32 v28, v28, v118
    s_waitcnt vmcnt(27)
    v_mfma_f32_16x16x32_bf16 v[208:211], a[96:99], a[128:131], v[208:211]
    buffer_load_dwordx4 a[92:95], v2, s[20:23], s34 offen offset:3072
    v_mfma_f32_16x16x32_bf16 v[212:215], a[96:99], a[132:135], v[212:215]
    v_mul_f32 v29, v29, v119
    v_mfma_f32_16x16x32_bf16 v[216:219], a[96:99], a[136:139], v[216:219]
    v_cvt_pk_bf16_f32 v22, v26, v27
    v_mfma_f32_16x16x32_bf16 v[220:223], a[96:99], a[140:143], v[220:223]
    v_mfma_f32_16x16x32_bf16 v[224:227], a[100:103], a[128:131], v[224:227]
    s_mov_b32 s34, 1028096
    v_cvt_pk_bf16_f32 v23, v28, v29
    v_mfma_f32_16x16x32_bf16 v[228:231], a[100:103], a[132:135], v[228:231]
    buffer_load_dwordx4 a[96:99], v2, s[20:23], s34 offen offset:0
    v_mfma_f32_16x16x32_bf16 v[232:235], a[100:103], a[136:139], v[232:235]
    v_lshlrev_b32 v26, 16, v24
    v_mfma_f32_16x16x32_bf16 v[236:239], a[100:103], a[140:143], v[236:239]
    v_and_b32 v27, 0xffff0000, v24
    s_waitcnt lgkmcnt(0)
    v_mfma_f32_16x16x32_bf16 v[144:147], a[104:107], a[112:115], v[144:147]
    buffer_load_dwordx4 a[100:103], v2, s[20:23], s34 offen offset:1024
    v_mfma_f32_16x16x32_bf16 v[148:151], a[104:107], a[116:119], v[148:151]
    ds_read_b128 a[128:131], v4 offset:28672
    ds_read_b128 a[132:135], v4 offset:29696
    v_mfma_f32_16x16x32_bf16 v[152:155], a[104:107], a[120:123], v[152:155]
    ds_read_b128 a[136:139], v4 offset:30720
    ds_read_b128 a[140:143], v4 offset:31744
    v_mfma_f32_16x16x32_bf16 v[156:159], a[104:107], a[124:127], v[156:159]
    v_lshlrev_b32 v28, 16, v25
    v_and_b32 v29, 0xffff0000, v25
    s_waitcnt vmcnt(22)
    v_mfma_f32_16x16x32_bf16 v[160:163], a[108:111], a[112:115], v[160:163]
    buffer_load_dwordx4 a[104:107], v2, s[20:23], s34 offen offset:2048
    v_mfma_f32_16x16x32_bf16 v[164:167], a[108:111], a[116:119], v[164:167]
    v_mul_f32 v26, v26, v132
    v_mul_f32 v27, v27, v133
    v_mfma_f32_16x16x32_bf16 v[168:171], a[108:111], a[120:123], v[168:171]
    v_mfma_f32_16x16x32_bf16 v[172:175], a[108:111], a[124:127], v[172:175]
    v_mul_f32 v28, v28, v134
    v_mfma_f32_16x16x32_bf16 v[176:179], a[0:3], a[112:115], v[176:179]
    buffer_load_dwordx4 a[108:111], v2, s[20:23], s34 offen offset:3072
    v_mfma_f32_16x16x32_bf16 v[180:183], a[0:3], a[116:119], v[180:183]
    v_mul_f32 v29, v29, v135
    v_mfma_f32_16x16x32_bf16 v[184:187], a[0:3], a[120:123], v[184:187]
    v_cvt_pk_bf16_f32 v24, v26, v27
    v_mfma_f32_16x16x32_bf16 v[188:191], a[0:3], a[124:127], v[188:191]
    v_mfma_f32_16x16x32_bf16 v[192:195], a[4:7], a[112:115], v[192:195]
    s_mov_b32 s34, 1032192
    v_cvt_pk_bf16_f32 v25, v28, v29
    v_mfma_f32_16x16x32_bf16 v[196:199], a[4:7], a[116:119], v[196:199]
    buffer_load_dwordx4 a[0:3], v2, s[20:23], s34 offen offset:0
    v_mfma_f32_16x16x32_bf16 v[200:203], a[4:7], a[120:123], v[200:203]
    buffer_store_dwordx4 v[22:25], v10, s[28:31], s40 offen offset:128
    v_mfma_f32_16x16x32_bf16 v[204:207], a[4:7], a[124:127], v[204:207]
    v_accvgpr_read_b32 v14, a184
    v_mfma_f32_16x16x32_bf16 v[208:211], a[8:11], a[112:115], v[208:211]
    buffer_load_dwordx4 a[4:7], v2, s[20:23], s34 offen offset:1024
    v_mfma_f32_16x16x32_bf16 v[212:215], a[8:11], a[116:119], v[212:215]
    v_accvgpr_read_b32 v15, a185
    v_mfma_f32_16x16x32_bf16 v[216:219], a[8:11], a[120:123], v[216:219]
    v_accvgpr_read_b32 v16, a186
    v_mfma_f32_16x16x32_bf16 v[220:223], a[8:11], a[124:127], v[220:223]
    v_mfma_f32_16x16x32_bf16 v[224:227], a[12:15], a[112:115], v[224:227]
    buffer_load_dwordx4 a[8:11], v2, s[20:23], s34 offen offset:2048
    v_mfma_f32_16x16x32_bf16 v[228:231], a[12:15], a[116:119], v[228:231]
    v_accvgpr_read_b32 v17, a187
    v_mfma_f32_16x16x32_bf16 v[232:235], a[12:15], a[120:123], v[232:235]
    v_lshlrev_b32 v18, 16, v14
    v_mfma_f32_16x16x32_bf16 v[236:239], a[12:15], a[124:127], v[236:239]
    v_and_b32 v19, 0xffff0000, v14
    s_waitcnt lgkmcnt(0)
    v_mfma_f32_16x16x32_bf16 v[144:147], a[16:19], a[128:131], v[144:147]
    buffer_load_dwordx4 a[12:15], v2, s[20:23], s34 offen offset:3072
    v_mfma_f32_16x16x32_bf16 v[148:151], a[16:19], a[132:135], v[148:151]
    ds_read_b128 a[112:115], v4 offset:32768
    ds_read_b128 a[116:119], v4 offset:33792
    v_mfma_f32_16x16x32_bf16 v[152:155], a[16:19], a[136:139], v[152:155]
    ds_read_b128 a[120:123], v4 offset:34816
    ds_read_b128 a[124:127], v4 offset:35840
    v_mfma_f32_16x16x32_bf16 v[156:159], a[16:19], a[140:143], v[156:159]
    v_lshlrev_b32 v20, 16, v15
    v_and_b32 v21, 0xffff0000, v15
    v_mfma_f32_16x16x32_bf16 v[160:163], a[20:23], a[128:131], v[160:163]
    s_mov_b32 s34, 1036288
    v_mul_f32 v18, v18, v120
    v_mfma_f32_16x16x32_bf16 v[164:167], a[20:23], a[132:135], v[164:167]
    buffer_load_dwordx4 a[16:19], v2, s[20:23], s34 offen offset:0
    v_mfma_f32_16x16x32_bf16 v[168:171], a[20:23], a[136:139], v[168:171]
    v_mul_f32 v19, v19, v121
    v_mfma_f32_16x16x32_bf16 v[172:175], a[20:23], a[140:143], v[172:175]
    v_mul_f32 v20, v20, v122
    s_waitcnt vmcnt(27)
    v_mfma_f32_16x16x32_bf16 v[176:179], a[24:27], a[128:131], v[176:179]
    buffer_load_dwordx4 a[20:23], v2, s[20:23], s34 offen offset:1024
    v_mfma_f32_16x16x32_bf16 v[180:183], a[24:27], a[132:135], v[180:183]
    v_mul_f32 v21, v21, v123
    v_mfma_f32_16x16x32_bf16 v[184:187], a[24:27], a[136:139], v[184:187]
    v_cvt_pk_bf16_f32 v14, v18, v19
    v_mfma_f32_16x16x32_bf16 v[188:191], a[24:27], a[140:143], v[188:191]
    v_mfma_f32_16x16x32_bf16 v[192:195], a[28:31], a[128:131], v[192:195]
    v_cvt_pk_bf16_f32 v15, v20, v21
    v_mfma_f32_16x16x32_bf16 v[196:199], a[28:31], a[132:135], v[196:199]
    v_mfma_f32_16x16x32_bf16 v[200:203], a[28:31], a[136:139], v[200:203]
    v_lshlrev_b32 v18, 16, v16
    v_mfma_f32_16x16x32_bf16 v[204:207], a[28:31], a[140:143], v[204:207]
    v_and_b32 v19, 0xffff0000, v16
    v_mfma_f32_16x16x32_bf16 v[208:211], a[32:35], a[128:131], v[208:211]
    v_mfma_f32_16x16x32_bf16 v[212:215], a[32:35], a[132:135], v[212:215]
    v_lshlrev_b32 v20, 16, v17
    v_mfma_f32_16x16x32_bf16 v[216:219], a[32:35], a[136:139], v[216:219]
    v_and_b32 v21, 0xffff0000, v17
    v_mfma_f32_16x16x32_bf16 v[220:223], a[32:35], a[140:143], v[220:223]
    s_waitcnt vmcnt(20)
    v_mfma_f32_16x16x32_bf16 v[224:227], a[36:39], a[128:131], v[224:227]
    v_mul_f32 v18, v18, v136
    v_mfma_f32_16x16x32_bf16 v[228:231], a[36:39], a[132:135], v[228:231]
    v_mfma_f32_16x16x32_bf16 v[232:235], a[36:39], a[136:139], v[232:235]
    v_mul_f32 v19, v19, v137
    v_mfma_f32_16x16x32_bf16 v[236:239], a[36:39], a[140:143], v[236:239]
    v_mul_f32 v20, v20, v138
    s_waitcnt lgkmcnt(0)
    v_mfma_f32_16x16x32_bf16 v[144:147], a[40:43], a[112:115], v[144:147]
    v_mfma_f32_16x16x32_bf16 v[148:151], a[40:43], a[116:119], v[148:151]
    ds_read_b128 a[128:131], v4 offset:36864
    ds_read_b128 a[132:135], v4 offset:37888
    v_mfma_f32_16x16x32_bf16 v[152:155], a[40:43], a[120:123], v[152:155]
    ds_read_b128 a[136:139], v4 offset:38912
    ds_read_b128 a[140:143], v4 offset:39936
    v_mfma_f32_16x16x32_bf16 v[156:159], a[40:43], a[124:127], v[156:159]
    v_mul_f32 v21, v21, v139
    v_cvt_pk_bf16_f32 v16, v18, v19
    v_mfma_f32_16x16x32_bf16 v[160:163], a[44:47], a[112:115], v[160:163]
    v_cvt_pk_bf16_f32 v17, v20, v21
    v_mfma_f32_16x16x32_bf16 v[164:167], a[44:47], a[116:119], v[164:167]
    v_mfma_f32_16x16x32_bf16 v[168:171], a[44:47], a[120:123], v[168:171]
    buffer_store_dwordx4 v[14:17], v10, s[28:31], s41 offen offset:128
    v_mfma_f32_16x16x32_bf16 v[172:175], a[44:47], a[124:127], v[172:175]
    v_accvgpr_read_b32 v22, a188
    v_mfma_f32_16x16x32_bf16 v[176:179], a[48:51], a[112:115], v[176:179]
    v_mfma_f32_16x16x32_bf16 v[180:183], a[48:51], a[116:119], v[180:183]
    v_accvgpr_read_b32 v23, a189
    v_mfma_f32_16x16x32_bf16 v[184:187], a[48:51], a[120:123], v[184:187]
    v_mfma_f32_16x16x32_bf16 v[188:191], a[48:51], a[124:127], v[188:191]
    v_accvgpr_read_b32 v24, a190
    v_mfma_f32_16x16x32_bf16 v[192:195], a[52:55], a[112:115], v[192:195]
    v_accvgpr_read_b32 v25, a191
    v_mfma_f32_16x16x32_bf16 v[196:199], a[52:55], a[116:119], v[196:199]
    v_mfma_f32_16x16x32_bf16 v[200:203], a[52:55], a[120:123], v[200:203]
    v_lshlrev_b32 v26, 16, v22
    v_mfma_f32_16x16x32_bf16 v[204:207], a[52:55], a[124:127], v[204:207]
    v_and_b32 v27, 0xffff0000, v22
    v_mfma_f32_16x16x32_bf16 v[208:211], a[56:59], a[112:115], v[208:211]
    v_mfma_f32_16x16x32_bf16 v[212:215], a[56:59], a[116:119], v[212:215]
    v_lshlrev_b32 v28, 16, v23
    v_mfma_f32_16x16x32_bf16 v[216:219], a[56:59], a[120:123], v[216:219]
    v_mfma_f32_16x16x32_bf16 v[220:223], a[56:59], a[124:127], v[220:223]
    v_and_b32 v29, 0xffff0000, v23
    v_mfma_f32_16x16x32_bf16 v[224:227], a[60:63], a[112:115], v[224:227]
    v_mul_f32 v26, v26, v124
    v_mfma_f32_16x16x32_bf16 v[228:231], a[60:63], a[116:119], v[228:231]
    v_mfma_f32_16x16x32_bf16 v[232:235], a[60:63], a[120:123], v[232:235]
    v_mul_f32 v27, v27, v125
    v_mfma_f32_16x16x32_bf16 v[236:239], a[60:63], a[124:127], v[236:239]
    v_mul_f32 v28, v28, v126
    s_waitcnt vmcnt(19) lgkmcnt(0)
    v_mfma_f32_16x16x32_bf16 v[144:147], a[64:67], a[128:131], v[144:147]
    v_mfma_f32_16x16x32_bf16 v[148:151], a[64:67], a[132:135], v[148:151]
    ds_read_b128 a[112:115], v4 offset:40960
    ds_read_b128 a[116:119], v4 offset:41984
    v_mfma_f32_16x16x32_bf16 v[152:155], a[64:67], a[136:139], v[152:155]
    ds_read_b128 a[120:123], v4 offset:43008
    ds_read_b128 a[124:127], v4 offset:44032
    v_mfma_f32_16x16x32_bf16 v[156:159], a[64:67], a[140:143], v[156:159]
    v_mul_f32 v29, v29, v127
    v_cvt_pk_bf16_f32 v22, v26, v27
    v_mfma_f32_16x16x32_bf16 v[160:163], a[68:71], a[128:131], v[160:163]
    v_cvt_pk_bf16_f32 v23, v28, v29
    v_mfma_f32_16x16x32_bf16 v[164:167], a[68:71], a[132:135], v[164:167]
    v_mfma_f32_16x16x32_bf16 v[168:171], a[68:71], a[136:139], v[168:171]
    v_lshlrev_b32 v26, 16, v24
    v_mfma_f32_16x16x32_bf16 v[172:175], a[68:71], a[140:143], v[172:175]
    v_and_b32 v27, 0xffff0000, v24
    s_waitcnt vmcnt(18)
    v_mfma_f32_16x16x32_bf16 v[176:179], a[72:75], a[128:131], v[176:179]
    v_mfma_f32_16x16x32_bf16 v[180:183], a[72:75], a[132:135], v[180:183]
    v_lshlrev_b32 v28, 16, v25
    v_mfma_f32_16x16x32_bf16 v[184:187], a[72:75], a[136:139], v[184:187]
    v_mfma_f32_16x16x32_bf16 v[188:191], a[72:75], a[140:143], v[188:191]
    v_and_b32 v29, 0xffff0000, v25
    s_waitcnt vmcnt(16)
    v_mfma_f32_16x16x32_bf16 v[192:195], a[76:79], a[128:131], v[192:195]
    v_mul_f32 v26, v26, v140
    v_mfma_f32_16x16x32_bf16 v[196:199], a[76:79], a[132:135], v[196:199]
    v_mfma_f32_16x16x32_bf16 v[200:203], a[76:79], a[136:139], v[200:203]
    v_mul_f32 v27, v27, v141
    v_mfma_f32_16x16x32_bf16 v[204:207], a[76:79], a[140:143], v[204:207]
    v_mul_f32 v28, v28, v142
    s_waitcnt vmcnt(15)
    v_mfma_f32_16x16x32_bf16 v[208:211], a[80:83], a[128:131], v[208:211]
    v_mfma_f32_16x16x32_bf16 v[212:215], a[80:83], a[132:135], v[212:215]
    v_mul_f32 v29, v29, v143
    v_mfma_f32_16x16x32_bf16 v[216:219], a[80:83], a[136:139], v[216:219]
    v_mfma_f32_16x16x32_bf16 v[220:223], a[80:83], a[140:143], v[220:223]
    v_cvt_pk_bf16_f32 v24, v26, v27
    s_waitcnt vmcnt(14)
    v_mfma_f32_16x16x32_bf16 v[224:227], a[84:87], a[128:131], v[224:227]
    v_cvt_pk_bf16_f32 v25, v28, v29
    v_mfma_f32_16x16x32_bf16 v[228:231], a[84:87], a[132:135], v[228:231]
    v_mfma_f32_16x16x32_bf16 v[232:235], a[84:87], a[136:139], v[232:235]
    buffer_store_dwordx4 v[22:25], v10, s[28:31], s42 offen offset:128
    v_mfma_f32_16x16x32_bf16 v[236:239], a[84:87], a[140:143], v[236:239]
    s_waitcnt vmcnt(14) lgkmcnt(0)
    v_mfma_f32_16x16x32_bf16 v[144:147], a[88:91], a[112:115], v[144:147]
    v_mfma_f32_16x16x32_bf16 v[148:151], a[88:91], a[116:119], v[148:151]
    ds_read_b128 a[128:131], v4 offset:45056
    ds_read_b128 a[132:135], v4 offset:46080
    v_mfma_f32_16x16x32_bf16 v[152:155], a[88:91], a[120:123], v[152:155]
    ds_read_b128 a[136:139], v4 offset:47104
    ds_read_b128 a[140:143], v4 offset:48128
    v_mfma_f32_16x16x32_bf16 v[156:159], a[88:91], a[124:127], v[156:159]
    s_waitcnt vmcnt(13)
    v_mfma_f32_16x16x32_bf16 v[160:163], a[92:95], a[112:115], v[160:163]
    v_mfma_f32_16x16x32_bf16 v[164:167], a[92:95], a[116:119], v[164:167]
    v_mfma_f32_16x16x32_bf16 v[168:171], a[92:95], a[120:123], v[168:171]
    v_mfma_f32_16x16x32_bf16 v[172:175], a[92:95], a[124:127], v[172:175]
    s_waitcnt vmcnt(12)
    v_mfma_f32_16x16x32_bf16 v[176:179], a[96:99], a[112:115], v[176:179]
    v_mfma_f32_16x16x32_bf16 v[180:183], a[96:99], a[116:119], v[180:183]
    v_mfma_f32_16x16x32_bf16 v[184:187], a[96:99], a[120:123], v[184:187]
    v_mfma_f32_16x16x32_bf16 v[188:191], a[96:99], a[124:127], v[188:191]
    s_waitcnt vmcnt(11)
    v_mfma_f32_16x16x32_bf16 v[192:195], a[100:103], a[112:115], v[192:195]
    v_mfma_f32_16x16x32_bf16 v[196:199], a[100:103], a[116:119], v[196:199]
    v_mfma_f32_16x16x32_bf16 v[200:203], a[100:103], a[120:123], v[200:203]
    v_mfma_f32_16x16x32_bf16 v[204:207], a[100:103], a[124:127], v[204:207]
    s_waitcnt vmcnt(10)
    v_mfma_f32_16x16x32_bf16 v[208:211], a[104:107], a[112:115], v[208:211]
    v_mfma_f32_16x16x32_bf16 v[212:215], a[104:107], a[116:119], v[212:215]
    v_mfma_f32_16x16x32_bf16 v[216:219], a[104:107], a[120:123], v[216:219]
    v_mfma_f32_16x16x32_bf16 v[220:223], a[104:107], a[124:127], v[220:223]
    s_waitcnt vmcnt(9)
    v_mfma_f32_16x16x32_bf16 v[224:227], a[108:111], a[112:115], v[224:227]
    v_mfma_f32_16x16x32_bf16 v[228:231], a[108:111], a[116:119], v[228:231]
    v_mfma_f32_16x16x32_bf16 v[232:235], a[108:111], a[120:123], v[232:235]
    v_mfma_f32_16x16x32_bf16 v[236:239], a[108:111], a[124:127], v[236:239]
    s_waitcnt vmcnt(8) lgkmcnt(0)
    v_mfma_f32_16x16x32_bf16 v[144:147], a[0:3], a[128:131], v[144:147]
    v_mfma_f32_16x16x32_bf16 v[148:151], a[0:3], a[132:135], v[148:151]
    v_mfma_f32_16x16x32_bf16 v[152:155], a[0:3], a[136:139], v[152:155]
    v_mfma_f32_16x16x32_bf16 v[156:159], a[0:3], a[140:143], v[156:159]
    s_waitcnt vmcnt(6)
    v_mfma_f32_16x16x32_bf16 v[160:163], a[4:7], a[128:131], v[160:163]
    v_mfma_f32_16x16x32_bf16 v[164:167], a[4:7], a[132:135], v[164:167]
    v_mfma_f32_16x16x32_bf16 v[168:171], a[4:7], a[136:139], v[168:171]
    v_mfma_f32_16x16x32_bf16 v[172:175], a[4:7], a[140:143], v[172:175]
    s_waitcnt vmcnt(5)
    v_mfma_f32_16x16x32_bf16 v[176:179], a[8:11], a[128:131], v[176:179]
    v_mfma_f32_16x16x32_bf16 v[180:183], a[8:11], a[132:135], v[180:183]
    v_mfma_f32_16x16x32_bf16 v[184:187], a[8:11], a[136:139], v[184:187]
    v_mfma_f32_16x16x32_bf16 v[188:191], a[8:11], a[140:143], v[188:191]
    s_waitcnt vmcnt(4)
    v_mfma_f32_16x16x32_bf16 v[192:195], a[12:15], a[128:131], v[192:195]
    v_mfma_f32_16x16x32_bf16 v[196:199], a[12:15], a[132:135], v[196:199]
    v_mfma_f32_16x16x32_bf16 v[200:203], a[12:15], a[136:139], v[200:203]
    v_mfma_f32_16x16x32_bf16 v[204:207], a[12:15], a[140:143], v[204:207]
    s_waitcnt vmcnt(3)
    v_mfma_f32_16x16x32_bf16 v[208:211], a[16:19], a[128:131], v[208:211]
    v_mfma_f32_16x16x32_bf16 v[212:215], a[16:19], a[132:135], v[212:215]
    v_mfma_f32_16x16x32_bf16 v[216:219], a[16:19], a[136:139], v[216:219]
    v_mfma_f32_16x16x32_bf16 v[220:223], a[16:19], a[140:143], v[220:223]
    s_waitcnt vmcnt(2)
    v_mfma_f32_16x16x32_bf16 v[224:227], a[20:23], a[128:131], v[224:227]
    v_mfma_f32_16x16x32_bf16 v[228:231], a[20:23], a[132:135], v[228:231]
    v_mfma_f32_16x16x32_bf16 v[232:235], a[20:23], a[136:139], v[232:235]
    v_mfma_f32_16x16x32_bf16 v[236:239], a[20:23], a[140:143], v[236:239]
    v_accvgpr_read_b32 v14, a192
    v_accvgpr_read_b32 v15, a193
    v_accvgpr_read_b32 v16, a194
    v_accvgpr_read_b32 v17, a195
    v_lshlrev_b32 v18, 16, v14
    v_and_b32 v19, 0xffff0000, v14
    v_lshlrev_b32 v20, 16, v15
    v_and_b32 v21, 0xffff0000, v15
    v_mul_f32 v18, v18, v144
    v_mul_f32 v19, v19, v145
    v_mul_f32 v20, v20, v146
    v_mul_f32 v21, v21, v147
    v_cvt_pk_bf16_f32 v14, v18, v19
    v_cvt_pk_bf16_f32 v15, v20, v21
    v_lshlrev_b32 v18, 16, v16
    v_and_b32 v19, 0xffff0000, v16
    v_lshlrev_b32 v20, 16, v17
    v_and_b32 v21, 0xffff0000, v17
    v_mul_f32 v18, v18, v160
    v_mul_f32 v19, v19, v161
    v_mul_f32 v20, v20, v162
    v_mul_f32 v21, v21, v163
    v_cvt_pk_bf16_f32 v16, v18, v19
    v_cvt_pk_bf16_f32 v17, v20, v21
    buffer_store_dwordx4 v[14:17], v10, s[28:31], 0 offen offset:192
    v_accvgpr_read_b32 v22, a196
    v_accvgpr_read_b32 v23, a197
    v_accvgpr_read_b32 v24, a198
    v_accvgpr_read_b32 v25, a199
    v_lshlrev_b32 v26, 16, v22
    v_and_b32 v27, 0xffff0000, v22
    v_lshlrev_b32 v28, 16, v23
    v_and_b32 v29, 0xffff0000, v23
    v_mul_f32 v26, v26, v148
    v_mul_f32 v27, v27, v149
    v_mul_f32 v28, v28, v150
    v_mul_f32 v29, v29, v151
    v_cvt_pk_bf16_f32 v22, v26, v27
    v_cvt_pk_bf16_f32 v23, v28, v29
    v_lshlrev_b32 v26, 16, v24
    v_and_b32 v27, 0xffff0000, v24
    v_lshlrev_b32 v28, 16, v25
    v_and_b32 v29, 0xffff0000, v25
    v_mul_f32 v26, v26, v164
    v_mul_f32 v27, v27, v165
    v_mul_f32 v28, v28, v166
    v_mul_f32 v29, v29, v167
    v_cvt_pk_bf16_f32 v24, v26, v27
    v_cvt_pk_bf16_f32 v25, v28, v29
    buffer_store_dwordx4 v[22:25], v10, s[28:31], s40 offen offset:192
    v_accvgpr_read_b32 v14, a200
    v_accvgpr_read_b32 v15, a201
    v_accvgpr_read_b32 v16, a202
    v_accvgpr_read_b32 v17, a203
    v_lshlrev_b32 v18, 16, v14
    v_and_b32 v19, 0xffff0000, v14
    v_lshlrev_b32 v20, 16, v15
    v_and_b32 v21, 0xffff0000, v15
    v_mul_f32 v18, v18, v152
    v_mul_f32 v19, v19, v153
    v_mul_f32 v20, v20, v154
    v_mul_f32 v21, v21, v155
    v_cvt_pk_bf16_f32 v14, v18, v19
    v_cvt_pk_bf16_f32 v15, v20, v21
    v_lshlrev_b32 v18, 16, v16
    v_and_b32 v19, 0xffff0000, v16
    v_lshlrev_b32 v20, 16, v17
    v_and_b32 v21, 0xffff0000, v17
    v_mul_f32 v18, v18, v168
    v_mul_f32 v19, v19, v169
    v_mul_f32 v20, v20, v170
    v_mul_f32 v21, v21, v171
    v_cvt_pk_bf16_f32 v16, v18, v19
    v_cvt_pk_bf16_f32 v17, v20, v21
    buffer_store_dwordx4 v[14:17], v10, s[28:31], s41 offen offset:192
    v_accvgpr_read_b32 v22, a204
    v_accvgpr_read_b32 v23, a205
    v_accvgpr_read_b32 v24, a206
    v_accvgpr_read_b32 v25, a207
    v_lshlrev_b32 v26, 16, v22
    v_and_b32 v27, 0xffff0000, v22
    v_lshlrev_b32 v28, 16, v23
    v_and_b32 v29, 0xffff0000, v23
    v_mul_f32 v26, v26, v156
    v_mul_f32 v27, v27, v157
    v_mul_f32 v28, v28, v158
    v_mul_f32 v29, v29, v159
    v_cvt_pk_bf16_f32 v22, v26, v27
    v_cvt_pk_bf16_f32 v23, v28, v29
    v_lshlrev_b32 v26, 16, v24
    v_and_b32 v27, 0xffff0000, v24
    v_lshlrev_b32 v28, 16, v25
    v_and_b32 v29, 0xffff0000, v25
    v_mul_f32 v26, v26, v172
    v_mul_f32 v27, v27, v173
    v_mul_f32 v28, v28, v174
    v_mul_f32 v29, v29, v175
    v_cvt_pk_bf16_f32 v24, v26, v27
    v_cvt_pk_bf16_f32 v25, v28, v29
    buffer_store_dwordx4 v[22:25], v10, s[28:31], s42 offen offset:192
    v_accvgpr_read_b32 v14, a208
    v_accvgpr_read_b32 v15, a209
    v_accvgpr_read_b32 v16, a210
    v_accvgpr_read_b32 v17, a211
    v_lshlrev_b32 v18, 16, v14
    v_and_b32 v19, 0xffff0000, v14
    v_lshlrev_b32 v20, 16, v15
    v_and_b32 v21, 0xffff0000, v15
    v_mul_f32 v18, v18, v176
    v_mul_f32 v19, v19, v177
    v_mul_f32 v20, v20, v178
    v_mul_f32 v21, v21, v179
    v_cvt_pk_bf16_f32 v14, v18, v19
    v_cvt_pk_bf16_f32 v15, v20, v21
    v_lshlrev_b32 v18, 16, v16
    v_and_b32 v19, 0xffff0000, v16
    v_lshlrev_b32 v20, 16, v17
    v_and_b32 v21, 0xffff0000, v17
    v_mul_f32 v18, v18, v192
    v_mul_f32 v19, v19, v193
    v_mul_f32 v20, v20, v194
    v_mul_f32 v21, v21, v195
    v_cvt_pk_bf16_f32 v16, v18, v19
    v_cvt_pk_bf16_f32 v17, v20, v21
    buffer_store_dwordx4 v[14:17], v10, s[28:31], 0 offen offset:256
    v_accvgpr_read_b32 v22, a212
    v_accvgpr_read_b32 v23, a213
    v_accvgpr_read_b32 v24, a214
    v_accvgpr_read_b32 v25, a215
    v_lshlrev_b32 v26, 16, v22
    v_and_b32 v27, 0xffff0000, v22
    v_lshlrev_b32 v28, 16, v23
    v_and_b32 v29, 0xffff0000, v23
    v_mul_f32 v26, v26, v180
    v_mul_f32 v27, v27, v181
    v_mul_f32 v28, v28, v182
    v_mul_f32 v29, v29, v183
    v_cvt_pk_bf16_f32 v22, v26, v27
    v_cvt_pk_bf16_f32 v23, v28, v29
    v_lshlrev_b32 v26, 16, v24
    v_and_b32 v27, 0xffff0000, v24
    v_lshlrev_b32 v28, 16, v25
    v_and_b32 v29, 0xffff0000, v25
    v_mul_f32 v26, v26, v196
    v_mul_f32 v27, v27, v197
    v_mul_f32 v28, v28, v198
    v_mul_f32 v29, v29, v199
    v_cvt_pk_bf16_f32 v24, v26, v27
    v_cvt_pk_bf16_f32 v25, v28, v29
    buffer_store_dwordx4 v[22:25], v10, s[28:31], s40 offen offset:256
    v_accvgpr_read_b32 v14, a216
    v_accvgpr_read_b32 v15, a217
    v_accvgpr_read_b32 v16, a218
    v_accvgpr_read_b32 v17, a219
    v_lshlrev_b32 v18, 16, v14
    v_and_b32 v19, 0xffff0000, v14
    v_lshlrev_b32 v20, 16, v15
    v_and_b32 v21, 0xffff0000, v15
    v_mul_f32 v18, v18, v184
    v_mul_f32 v19, v19, v185
    v_mul_f32 v20, v20, v186
    v_mul_f32 v21, v21, v187
    v_cvt_pk_bf16_f32 v14, v18, v19
    v_cvt_pk_bf16_f32 v15, v20, v21
    v_lshlrev_b32 v18, 16, v16
    v_and_b32 v19, 0xffff0000, v16
    v_lshlrev_b32 v20, 16, v17
    v_and_b32 v21, 0xffff0000, v17
    v_mul_f32 v18, v18, v200
    v_mul_f32 v19, v19, v201
    v_mul_f32 v20, v20, v202
    v_mul_f32 v21, v21, v203
    v_cvt_pk_bf16_f32 v16, v18, v19
    v_cvt_pk_bf16_f32 v17, v20, v21
    buffer_store_dwordx4 v[14:17], v10, s[28:31], s41 offen offset:256
    v_accvgpr_read_b32 v22, a220
    v_accvgpr_read_b32 v23, a221
    v_accvgpr_read_b32 v24, a222
    v_accvgpr_read_b32 v25, a223
    v_lshlrev_b32 v26, 16, v22
    v_and_b32 v27, 0xffff0000, v22
    v_lshlrev_b32 v28, 16, v23
    v_and_b32 v29, 0xffff0000, v23
    v_mul_f32 v26, v26, v188
    v_mul_f32 v27, v27, v189
    v_mul_f32 v28, v28, v190
    v_mul_f32 v29, v29, v191
    v_cvt_pk_bf16_f32 v22, v26, v27
    v_cvt_pk_bf16_f32 v23, v28, v29
    v_lshlrev_b32 v26, 16, v24
    v_and_b32 v27, 0xffff0000, v24
    v_lshlrev_b32 v28, 16, v25
    v_and_b32 v29, 0xffff0000, v25
    v_mul_f32 v26, v26, v204
    v_mul_f32 v27, v27, v205
    v_mul_f32 v28, v28, v206
    v_mul_f32 v29, v29, v207
    v_cvt_pk_bf16_f32 v24, v26, v27
    v_cvt_pk_bf16_f32 v25, v28, v29
    buffer_store_dwordx4 v[22:25], v10, s[28:31], s42 offen offset:256
    v_accvgpr_read_b32 v14, a224
    v_accvgpr_read_b32 v15, a225
    v_accvgpr_read_b32 v16, a226
    v_accvgpr_read_b32 v17, a227
    v_lshlrev_b32 v18, 16, v14
    v_and_b32 v19, 0xffff0000, v14
    v_lshlrev_b32 v20, 16, v15
    v_and_b32 v21, 0xffff0000, v15
    v_mul_f32 v18, v18, v208
    v_mul_f32 v19, v19, v209
    v_mul_f32 v20, v20, v210
    v_mul_f32 v21, v21, v211
    v_cvt_pk_bf16_f32 v14, v18, v19
    v_cvt_pk_bf16_f32 v15, v20, v21
    v_lshlrev_b32 v18, 16, v16
    v_and_b32 v19, 0xffff0000, v16
    v_lshlrev_b32 v20, 16, v17
    v_and_b32 v21, 0xffff0000, v17
    v_mul_f32 v18, v18, v224
    v_mul_f32 v19, v19, v225
    v_mul_f32 v20, v20, v226
    v_mul_f32 v21, v21, v227
    v_cvt_pk_bf16_f32 v16, v18, v19
    v_cvt_pk_bf16_f32 v17, v20, v21
    buffer_store_dwordx4 v[14:17], v10, s[28:31], 0 offen offset:320
    v_accvgpr_read_b32 v22, a228
    v_accvgpr_read_b32 v23, a229
    v_accvgpr_read_b32 v24, a230
    v_accvgpr_read_b32 v25, a231
    v_lshlrev_b32 v26, 16, v22
    v_and_b32 v27, 0xffff0000, v22
    v_lshlrev_b32 v28, 16, v23
    v_and_b32 v29, 0xffff0000, v23
    v_mul_f32 v26, v26, v212
    v_mul_f32 v27, v27, v213
    v_mul_f32 v28, v28, v214
    v_mul_f32 v29, v29, v215
    v_cvt_pk_bf16_f32 v22, v26, v27
    v_cvt_pk_bf16_f32 v23, v28, v29
    v_lshlrev_b32 v26, 16, v24
    v_and_b32 v27, 0xffff0000, v24
    v_lshlrev_b32 v28, 16, v25
    v_and_b32 v29, 0xffff0000, v25
    v_mul_f32 v26, v26, v228
    v_mul_f32 v27, v27, v229
    v_mul_f32 v28, v28, v230
    v_mul_f32 v29, v29, v231
    v_cvt_pk_bf16_f32 v24, v26, v27
    v_cvt_pk_bf16_f32 v25, v28, v29
    buffer_store_dwordx4 v[22:25], v10, s[28:31], s40 offen offset:320
    v_accvgpr_read_b32 v14, a232
    v_accvgpr_read_b32 v15, a233
    v_accvgpr_read_b32 v16, a234
    v_accvgpr_read_b32 v17, a235
    v_lshlrev_b32 v18, 16, v14
    v_and_b32 v19, 0xffff0000, v14
    v_lshlrev_b32 v20, 16, v15
    v_and_b32 v21, 0xffff0000, v15
    v_mul_f32 v18, v18, v216
    v_mul_f32 v19, v19, v217
    v_mul_f32 v20, v20, v218
    v_mul_f32 v21, v21, v219
    v_cvt_pk_bf16_f32 v14, v18, v19
    v_cvt_pk_bf16_f32 v15, v20, v21
    v_lshlrev_b32 v18, 16, v16
    v_and_b32 v19, 0xffff0000, v16
    v_lshlrev_b32 v20, 16, v17
    v_and_b32 v21, 0xffff0000, v17
    v_mul_f32 v18, v18, v232
    v_mul_f32 v19, v19, v233
    v_mul_f32 v20, v20, v234
    v_mul_f32 v21, v21, v235
    v_cvt_pk_bf16_f32 v16, v18, v19
    v_cvt_pk_bf16_f32 v17, v20, v21
    buffer_store_dwordx4 v[14:17], v10, s[28:31], s41 offen offset:320
    v_accvgpr_read_b32 v22, a236
    v_accvgpr_read_b32 v23, a237
    v_accvgpr_read_b32 v24, a238
    v_accvgpr_read_b32 v25, a239
    v_lshlrev_b32 v26, 16, v22
    v_and_b32 v27, 0xffff0000, v22
    v_lshlrev_b32 v28, 16, v23
    v_and_b32 v29, 0xffff0000, v23
    v_mul_f32 v26, v26, v220
    v_mul_f32 v27, v27, v221
    v_mul_f32 v28, v28, v222
    v_mul_f32 v29, v29, v223
    v_cvt_pk_bf16_f32 v22, v26, v27
    v_cvt_pk_bf16_f32 v23, v28, v29
    v_lshlrev_b32 v26, 16, v24
    v_and_b32 v27, 0xffff0000, v24
    v_lshlrev_b32 v28, 16, v25
    v_and_b32 v29, 0xffff0000, v25
    v_mul_f32 v26, v26, v236
    v_mul_f32 v27, v27, v237
    v_mul_f32 v28, v28, v238
    v_mul_f32 v29, v29, v239
    v_cvt_pk_bf16_f32 v24, v26, v27
    v_cvt_pk_bf16_f32 v25, v28, v29
    buffer_store_dwordx4 v[22:25], v10, s[28:31], s42 offen offset:320
L_done:
    s_endpgm
.section .rodata,"a"
.p2align 6
.amdhsa_kernel dcn_prep_kernel
  .amdhsa_next_free_vgpr 72
  .amdhsa_next_free_sgpr 56
  .amdhsa_accum_offset 72
  .amdhsa_group_segment_fixed_size 0
  .amdhsa_kernarg_size 48
  .amdhsa_user_sgpr_count 2
  .amdhsa_user_sgpr_kernarg_segment_ptr 1
  .amdhsa_system_sgpr_workgroup_id_x 1
.end_amdhsa_kernel
.section .rodata,"a"
.p2align 6
.amdhsa_kernel standalone__cross_network_dcn__recsys_kernel
  .amdhsa_next_free_vgpr 504
  .amdhsa_next_free_sgpr 96
  .amdhsa_accum_offset 256
  .amdhsa_group_segment_fixed_size 0
  .amdhsa_kernarg_size 48
  .amdhsa_user_sgpr_count 2
  .amdhsa_user_sgpr_kernarg_segment_ptr 1
  .amdhsa_system_sgpr_workgroup_id_x 1
.end_amdhsa_kernel
```
